```python
import torch

def _softmax(x, axis=-1):
    return torch.softmax(x, dim=axis)
def _gelu(x):
    return torch.nn.functional.gelu(x, approximate="tanh")
def _silu(x):
    return torch.nn.functional.silu(x)
def _sigmoid(x):
    return torch.sigmoid(x)
def _layernorm(x, axis=-1, eps=1e-5):
    m = x.mean(dim=axis, keepdim=True)
    v = x.var(dim=axis, keepdim=True, unbiased=False)
    return (x - m) / torch.sqrt(v + eps)
def _scatter_add(tgt, idx, src, axis=0):
    return tgt.clone().index_add_(axis, idx, src)
def _segment_sum(src, seg, n):
    out = torch.zeros((n,) + src.shape[1:], dtype=src.dtype)
    return out.index_add_(0, seg, src)
def _pad(x, pw):
    flat = tuple(v for pair in reversed(pw) for v in pair)
    return torch.nn.functional.pad(x, flat)

kernel_name = 'parallel_sum__compressed_kv_cla__glu_gated_reglu__prompt'

def setup_inputs():

    _w = (lambda a: (lambda t: t.to(torch.bfloat16) if t.is_floating_point() else t)(torch.as_tensor(a)))
    def _A_setup():
        B, H, Sq, Sk, D, M = 1, 32, 2048, 2048, 128, 512
        Dc = 4 * D
        return {
            "x": _w((lambda *s: torch.randn(*s, dtype=torch.bfloat16) * 0.05)(B, Sq, M)),
            "c_kv": _w((lambda *s: torch.randn(*s, dtype=torch.bfloat16) * 0.4)(B, Sk, Dc)),
            "w_q": _w((lambda *s: torch.randn(*s, dtype=torch.bfloat16) * 1.6)(M, H, D) * (M ** -0.5)),
            "w_uk": _w((lambda *s: torch.randn(*s, dtype=torch.bfloat16) * 1.6)(Dc, H, D) * (Dc ** -0.5)),
            "w_uv": _w((lambda *s: torch.randn(*s, dtype=torch.bfloat16) * 0.4)(Dc, H, D) * (Dc ** -0.5)),
            "w_o": _w((lambda *s: torch.randn(*s, dtype=torch.bfloat16) * 0.4)(H, D, M) * ((H * D) ** -0.5)),
        }
    _A_in = _A_setup()

    def _B_setup():
        B, S, D, F = 1, 2048, 512, 1376
        return {
            "x": _w((lambda *s: torch.randn(*s, dtype=torch.bfloat16) * 0.05)(B, S, D)),
            "W_gate": _w((lambda *s: torch.randn(*s, dtype=torch.bfloat16) * 0.2)(D, F) * (2.0 / D) ** 0.5),
            "W_up": _w((lambda *s: torch.randn(*s, dtype=torch.bfloat16) * 0.2)(D, F) * (2.0 / D) ** 0.5),
            "W_down": _w((lambda *s: torch.randn(*s, dtype=torch.bfloat16) * 0.2)(F, D) * (1.0 / F) ** 0.5),
        }
    _B_in = _B_setup()

    return {
        "A_x": _A_in["x"],
        "A_c_kv": _A_in["c_kv"],
        "A_w_q": _A_in["w_q"],
        "A_w_uk": _A_in["w_uk"],
        "A_w_uv": _A_in["w_uv"],
        "A_w_o": _A_in["w_o"],
        "B_x": _B_in["x"],
        "B_W_gate": _B_in["W_gate"],
        "B_W_up": _B_in["W_up"],
        "B_W_down": _B_in["W_down"],
    }

def reference(A_x, A_c_kv, A_w_q, A_w_uk, A_w_uv, A_w_o, B_x, B_W_gate, B_W_up, B_W_down):
    def _A_ref(x, c_kv, w_q, w_uk, w_uv, w_o):
        B, Sq, M = x.shape[0], x.shape[1], x.shape[2]
        Sk = c_kv.shape[1]
        H, D = w_q.shape[1], w_q.shape[2]
        q = torch.einsum("bqm,mhd->bhqd", x, w_q)
        k = torch.einsum("bkc,chd->bhkd", c_kv, w_uk)
        v = torch.einsum("bkc,chd->bhkd", c_kv, w_uv)
        scores = torch.einsum("bhqd,bhkd->bhqk", q, k) * (D ** -0.5)
        off = Sk - Sq
        qi = torch.arange(Sq)[:, None]
        kj = torch.arange(Sk)[None, :]
        cmask = kj <= (qi + off)
        scores = torch.where(cmask[None, None], scores, -1e9)
        p = _softmax(scores, axis=-1)
        ctx = torch.einsum("bhqk,bhkd->bhqd", p, v)
        return torch.einsum("bhqd,hdm->bqm", ctx, w_o)

    def _B_ref(x, W_gate, W_up, W_down):
        gate = torch.einsum("bsd,df->bsf", x, W_gate)
        up = torch.einsum("bsd,df->bsf", x, W_up)
        gate = gate * (lambda x, dt: x.to(dt))(gate > 0, gate.dtype)
        h = gate * up
        return torch.einsum("bsf,fd->bsd", h, W_down)

    x = A_x
    xn = _layernorm(x, axis=-1)
    return x + _A_ref(xn, A_c_kv, A_w_q, A_w_uk, A_w_uv, A_w_o) + _B_ref(xn, B_W_gate, B_W_up, B_W_down)
```

```asm
; @launch grid=(256,1,1) block=(256,1,1) lds=163840
.amdgcn_target "amdgcn-amd-amdhsa--gfx950"
.text
.globl parallel_sum__compressed_kv_cla__glu_gated_reglu__prompt_kernel
.p2align 8
.type parallel_sum__compressed_kv_cla__glu_gated_reglu__prompt_kernel,@function
parallel_sum__compressed_kv_cla__glu_gated_reglu__prompt_kernel:
    s_cmp_lt_u32 s2, 256
    s_cbranch_scc1 L_g1_go
    s_endpgm
L_g1_go:
    s_load_dwordx4 s[64:67], s[0:1], 0
    s_load_dwordx2 s[68:69], s[0:1], 16
    s_load_dwordx4 s[72:75], s[0:1], 24
    s_load_dwordx4 s[76:79], s[0:1], 56
    s_load_dwordx4 s[80:83], s[0:1], 88
    v_lshrrev_b32 v22, 6, v0
    v_and_b32 v0, 63, v0
    v_readfirstlane_b32 s32, v22
    v_lshlrev_b32 v1, 4, v0
    s_and_b32 s3, s2, 7
    s_lshr_b32 s6, s2, 3
    s_and_b32 s7, s6, 3
    s_lshl_b32 s3, s3, 2
    s_add_u32 s33, s3, s7
    s_lshr_b32 s34, s6, 2
    s_lshl_b32 s40, s32, 13
    s_sub_u32 s4, s33, 10
    s_cmp_lt_u32 s33, 0
    s_cselect_b32 s42, s33, s4
    s_sub_u32 s4, s33, 0
    s_add_u32 s5, s4, 22
    s_cmp_lt_u32 s4, 10
    s_cselect_b32 s42, s5, s42
    v_lshrrev_b32 v22, 3, v0
    v_and_b32 v23, 7, v0
    v_lshrrev_b32 v24, 1, v22
    v_xor_b32 v25, v23, v24
    v_lshlrev_b32 v25, 4, v25
    v_lshl_add_u32 v2, v22, 10, v25
    v_xor_b32 v26, 64, v2
    v_add_u32 v3, 7168, v26
    v_add_u32 v4, 14336, v2
    v_add_u32 v5, 21504, v26
    v_and_b32 v25, 3, v22
    v_lshrrev_b32 v26, 2, v22
    v_lshl_add_u32 v27, v26, 3, v25
    v_and_b32 v26, 6, v22
    v_xor_b32 v26, v23, v26
    v_lshlrev_b32 v28, 4, v26
    v_lshl_add_u32 v6, v27, 13, v28
    v_add_u32 v7, 130048, v6
    v_add_u32 v8, 30720, v6
    v_add_u32 v9, 160768, v6
    v_mul_u32_u24 v10, 2752, v27
    v_add_u32 v10, v10, v28
    v_add_u32 v11, 43008, v10
    v_add_u32 v12, 8960, v10
    v_add_u32 v13, 51968, v10
    s_lshl_b32 s41, s32, 12
    s_lshl_b32 s35, s34, 18
    s_lshl_b32 s4, s32, 16
    s_add_u32 s35, s35, s4
    s_lshr_b32 s4, s32, 1
    s_lshl_b32 s37, s4, 18
    s_lshl_b32 s5, s33, 8
    s_add_u32 s37, s37, s5
    s_and_b32 s5, s32, 1
    s_lshl_b32 s5, s5, 7
    s_add_u32 s37, s37, s5
    s_mul_i32 s38, s4, 88064
    s_lshl_b32 s5, s42, 7
    s_add_u32 s38, s38, s5
    s_cmp_lt_u32 s42, 22
    s_cselect_b32 s38, s38, 0x7ff00000
    v_lshrrev_b32 v22, 5, v0
    v_and_b32 v23, 31, v0
    v_lshlrev_b32 v23, 4, v23
    v_lshl_add_u32 v235, v22, 10, v23
    s_lshl_b32 s49, s2, 13
    s_lshl_b32 s4, s32, 11
    s_add_u32 s49, s49, s4
    s_getpc_b64 s[92:93]
L_g1_pc:
    s_sub_u32 s92, s92, L_g1_pc-parallel_sum__compressed_kv_cla__glu_gated_reglu__prompt_kernel
    s_subb_u32 s93, s93, 0
    s_lshr_b32 s4, s2, 3
    s_lshl_b32 s4, s4, 2
    s_add_u32 s4, s4, s32
    s_lshl_b32 s4, s4, 10
    v_and_b32 v22, 7, v0
    v_lshlrev_b32 v22, 7, v22
    v_add_u32 v22, s4, v22
    v_min_u32 v22, L_attn_codeend-parallel_sum__compressed_kv_cla__glu_gated_reglu__prompt_kernel-4, v22
    global_load_dword v252, v22, s[92:93]
    s_waitcnt lgkmcnt(0)
    s_mov_b32 s16, s72
    s_and_b32 s17, s73, 0xffff
    s_mov_b32 s18, 0x400000
    s_mov_b32 s19, 0x00020000
    s_mov_b32 s12, s66
    s_and_b32 s13, s67, 0xffff
    s_mov_b32 s14, 0x200000
    s_mov_b32 s15, 0x00020000
    s_mov_b32 s24, s64
    s_and_b32 s25, s65, 0xffff
    s_mov_b32 s26, 0x200000
    s_mov_b32 s27, 0x00020000
    s_mov_b32 s8, s82
    s_and_b32 s9, s83, 0xffff
    s_mov_b32 s10, 0x6000000
    s_mov_b32 s11, 0x00020000
    s_cmp_ge_u32 s42, 22
    s_cbranch_scc1 L_g1_help
    s_add_u32 m0, s41, 98304
    s_add_u32 s48, s37, 0
    buffer_load_dwordx4 v6, s[16:19], s48 offen offset:0 lds
    buffer_load_dwordx4 v7, s[16:19], s48 offen offset:1024 lds
    buffer_load_dwordx4 v8, s[16:19], s48 offen offset:2048 lds
    buffer_load_dwordx4 v9, s[16:19], s48 offen offset:3072 lds
    s_add_u32 m0, s40, 0
    s_add_u32 s48, s35, 0
    buffer_load_dwordx4 v2, s[12:15], s48 offen offset:0 lds
    buffer_load_dwordx4 v3, s[12:15], s48 offen offset:1024 lds
    buffer_load_dwordx4 v4, s[12:15], s48 offen offset:2048 lds
    buffer_load_dwordx4 v5, s[12:15], s48 offen offset:3072 lds
    s_add_u32 m0, s40, 4096
    s_add_u32 s48, s35, 32768
    buffer_load_dwordx4 v2, s[12:15], s48 offen offset:0 lds
    buffer_load_dwordx4 v3, s[12:15], s48 offen offset:1024 lds
    buffer_load_dwordx4 v4, s[12:15], s48 offen offset:2048 lds
    buffer_load_dwordx4 v5, s[12:15], s48 offen offset:3072 lds
    s_add_u32 m0, s41, 114688
    s_add_u32 s48, s37, 524288
    buffer_load_dwordx4 v6, s[16:19], s48 offen offset:0 lds
    buffer_load_dwordx4 v7, s[16:19], s48 offen offset:1024 lds
    buffer_load_dwordx4 v8, s[16:19], s48 offen offset:2048 lds
    buffer_load_dwordx4 v9, s[16:19], s48 offen offset:3072 lds
    buffer_load_dwordx4 v[208:211], v235, s[24:27], s49 offen nt
    buffer_load_dwordx4 v[212:215], v235, s[24:27], s49 offen offset:512 nt
    s_add_u32 m0, s40, 32768
    s_add_u32 s48, s35, 128
    buffer_load_dwordx4 v2, s[12:15], s48 offen offset:0 lds
    buffer_load_dwordx4 v3, s[12:15], s48 offen offset:1024 lds
    buffer_load_dwordx4 v4, s[12:15], s48 offen offset:2048 lds
    buffer_load_dwordx4 v5, s[12:15], s48 offen offset:3072 lds
    s_add_u32 m0, s40, 36864
    s_add_u32 s48, s35, 32896
    buffer_load_dwordx4 v2, s[12:15], s48 offen offset:0 lds
    buffer_load_dwordx4 v3, s[12:15], s48 offen offset:1024 lds
    buffer_load_dwordx4 v4, s[12:15], s48 offen offset:2048 lds
    buffer_load_dwordx4 v5, s[12:15], s48 offen offset:3072 lds
    s_add_u32 m0, s41, 131072
    s_add_u32 s48, s37, 1048576
    buffer_load_dwordx4 v6, s[16:19], s48 offen offset:0 lds
    buffer_load_dwordx4 v7, s[16:19], s48 offen offset:1024 lds
    buffer_load_dwordx4 v8, s[16:19], s48 offen offset:2048 lds
    buffer_load_dwordx4 v9, s[16:19], s48 offen offset:3072 lds
    s_add_u32 m0, s40, 65536
    s_add_u32 s48, s35, 256
    buffer_load_dwordx4 v2, s[12:15], s48 offen offset:0 lds
    buffer_load_dwordx4 v3, s[12:15], s48 offen offset:1024 lds
    buffer_load_dwordx4 v4, s[12:15], s48 offen offset:2048 lds
    buffer_load_dwordx4 v5, s[12:15], s48 offen offset:3072 lds
    s_add_u32 m0, s40, 69632
    s_add_u32 s48, s35, 33024
    buffer_load_dwordx4 v2, s[12:15], s48 offen offset:0 lds
    buffer_load_dwordx4 v3, s[12:15], s48 offen offset:1024 lds
    buffer_load_dwordx4 v4, s[12:15], s48 offen offset:2048 lds
    buffer_load_dwordx4 v5, s[12:15], s48 offen offset:3072 lds
    s_add_u32 m0, s41, 147456
    s_add_u32 s48, s37, 1572864
    buffer_load_dwordx4 v6, s[16:19], s48 offen offset:0 lds
    buffer_load_dwordx4 v7, s[16:19], s48 offen offset:1024 lds
    buffer_load_dwordx4 v8, s[16:19], s48 offen offset:2048 lds
    buffer_load_dwordx4 v9, s[16:19], s48 offen offset:3072 lds
    s_bitcmp1_b32 s32, 0
    s_cselect_b32 s4, s78, s76
    s_cselect_b32 s5, s79, s77
    s_mov_b32 s56, s4
    s_and_b32 s57, s5, 0xffff
    s_mov_b32 s58, 0x158000
    s_mov_b32 s59, 0x00020000
    s_mov_b32 s20, s74
    s_and_b32 s21, s75, 0xffff
    s_mov_b32 s22, 0x400000
    s_mov_b32 s23, 0x00020000
    s_mov_b32 s60, s68
    s_and_b32 s61, s69, 0xffff
    s_mov_b32 s62, 0x400000
    s_mov_b32 s63, 0x00020000
    s_mov_b32 s28, s80
    s_and_b32 s29, s81, 0xffff
    s_mov_b32 s30, 0x100
    s_mov_b32 s31, 0x00020000
    v_mov_b32 v48, 0
    v_mov_b32 v49, 0
    v_mov_b32 v50, 0
    v_mov_b32 v51, 0
    s_lshl_b32 s4, s2, 7
    s_add_u32 s4, s4, 79233024
    buffer_store_dwordx4 v[48:51], v48, s[8:11], s4 offen sc0 sc1
    s_add_u32 s4, s4, 32768
    buffer_store_dwordx4 v[48:51], v48, s[8:11], s4 offen sc0 sc1
    s_add_u32 s4, s4, 32768
    buffer_store_dwordx4 v[48:51], v48, s[8:11], s4 offen sc0 sc1
    s_add_u32 s4, s4, 32768
    buffer_store_dwordx4 v[48:51], v48, s[8:11], s4 offen sc0 sc1
    s_sub_u32 s4, 15, s34
    s_cmp_lt_u32 s32, 2
    s_cselect_b32 s4, s34, s4
    s_lshl_b32 s4, s4, 17
    s_and_b32 s5, s32, 1
    s_lshl_b32 s5, s5, 16
    s_add_u32 s36, s4, s5
    v_lshrrev_b32 v22, 2, v0
    v_and_b32 v23, 3, v0
    v_lshlrev_b32 v23, 7, v23
    v_lshl_add_u32 v22, v22, 10, v23
    s_lshl_b32 s4, s34, 18
    s_and_b32 s5, s33, 3
    s_lshl_b32 s5, s5, 16
    s_add_u32 s4, s4, s5
    s_lshl_b32 s5, s32, 14
    s_add_u32 s4, s4, s5
    buffer_load_dword v253, v22, s[12:15], s4 offen offset:384
    buffer_load_dword v253, v22, s[12:15], s4 offen offset:512
    v_and_b32 v23, 31, v0
    v_lshlrev_b32 v23, 13, v23
    s_lshl_b32 s4, s34, 19
    s_add_u32 s4, s4, s37
    buffer_load_dword v253, v23, s[16:19], s4 offen
    v_and_b32 v22, 15, v0
    v_lshrrev_b32 v23, 4, v0
    v_lshlrev_b32 v14, 9, v23
    v_lshl_add_u32 v14, v22, 4, v14
    v_and_b32 v24, 8, v22
    v_lshl_add_u32 v15, v24, 4, v14
    v_lshrrev_b32 v24, 1, v22
    v_xor_b32 v24, v24, v23
    v_lshlrev_b32 v24, 4, v24
    v_lshl_add_u32 v24, v22, 7, v24
    s_lshr_b32 s4, s32, 1
    s_lshl_b32 s4, s4, 14
    v_add_u32 v16, s4, v24
    v_xor_b32 v17, 64, v16
    v_add_u32 v18, 65536, v16
    v_add_u32 v19, 65536, v17
    v_lshrrev_b32 v22, 5, v0
    v_bfe_u32 v23, v0, 2, 3
    v_and_b32 v24, 3, v0
    v_lshlrev_b32 v25, 10, v22
    v_lshl_add_u32 v25, v23, 7, v25
    v_lshl_add_u32 v25, v24, 3, v25
    v_lshrrev_b32 v24, 1, v23
    v_lshl_add_u32 v25, v24, 5, v25
    v_add_u32 v25, 98304, v25
    s_and_b32 s4, s32, 1
    s_lshl_b32 s5, s4, 12
    v_add_u32 v26, s5, v25
    s_lshl_b32 s5, s4, 6
    v_xor_b32 v25, s5, v25
    v_xor_b32 v192, 0, v26
    v_xor_b32 v193, 32, v26
    v_xor_b32 v194, 64, v26
    v_xor_b32 v195, 96, v26
    v_xor_b32 v196, 0, v25
    v_xor_b32 v197, 32, v25
    s_lshl_b32 s4, s33, 6
    s_lshl_b32 s5, s34, 3
    s_add_u32 s4, s4, s5
    s_lshr_b32 s5, s32, 1
    s_lshl_b32 s5, s5, 2
    s_add_u32 s4, s4, s5
    s_lshl_b32 s4, s4, 14
    s_add_u32 s4, s4, 23068672
    s_and_b32 s5, s32, 1
    s_lshl_b32 s5, s5, 12
    s_add_u32 s44, s4, s5
    s_sub_u32 s4, 15, s34
    s_cmp_lt_u32 s32, 2
    s_cselect_b32 s4, s34, s4
    s_mul_i32 s4, s4, 1409024
    s_lshl_b32 s6, s42, 11
    s_add_u32 s4, s4, s6
    s_lshr_b32 s5, s5, 2
    s_add_u32 s4, s4, s5
    s_add_u32 s4, s4, 56819712
    s_cmp_lt_u32 s42, 22
    s_cselect_b32 s45, s4, 0x7ff00000
    s_add_u32 s84, s44, 0
    s_add_u32 s85, s44, 16384
    s_add_u32 s86, s44, 32768
    s_add_u32 s87, s44, 49152
    s_add_u32 s88, s44, 8192
    s_add_u32 s89, s44, 24576
    s_add_u32 s90, s44, 40960
    s_add_u32 s91, s44, 57344
    s_waitcnt vmcnt(45)
    s_barrier
    ds_read_b64_tr_b16 v[64:65], v192 offset:0
    ds_read_b64_tr_b16 v[66:67], v192 offset:2048
    ds_read_b64_tr_b16 v[68:69], v192 offset:8192
    ds_read_b64_tr_b16 v[70:71], v192 offset:10240
    ds_read_b64_tr_b16 v[72:73], v193 offset:0
    ds_read_b64_tr_b16 v[74:75], v193 offset:2048
    ds_read_b64_tr_b16 v[76:77], v193 offset:8192
    ds_read_b64_tr_b16 v[78:79], v193 offset:10240
    ds_read_b64_tr_b16 v[80:81], v194 offset:0
    ds_read_b64_tr_b16 v[82:83], v194 offset:2048
    ds_read_b64_tr_b16 v[84:85], v194 offset:8192
    ds_read_b64_tr_b16 v[86:87], v194 offset:10240
    ds_read_b64_tr_b16 v[88:89], v195 offset:0
    ds_read_b64_tr_b16 v[90:91], v195 offset:2048
    ds_read_b64_tr_b16 v[92:93], v195 offset:8192
    ds_read_b64_tr_b16 v[94:95], v195 offset:10240
    s_waitcnt vmcnt(31)
    v_lshlrev_b32 v216, 16, v208
    v_and_b32 v217, 0xffff0000, v208
    v_lshlrev_b32 v218, 16, v209
    v_and_b32 v219, 0xffff0000, v209
    v_lshlrev_b32 v220, 16, v210
    v_and_b32 v221, 0xffff0000, v210
    v_lshlrev_b32 v222, 16, v211
    v_and_b32 v223, 0xffff0000, v211
    v_lshlrev_b32 v224, 16, v212
    v_and_b32 v225, 0xffff0000, v212
    v_lshlrev_b32 v226, 16, v213
    v_and_b32 v227, 0xffff0000, v213
    v_lshlrev_b32 v228, 16, v214
    v_and_b32 v229, 0xffff0000, v214
    v_lshlrev_b32 v230, 16, v215
    v_and_b32 v231, 0xffff0000, v215
    v_add_f32 v232, v216, v217
    v_add_f32 v233, v218, v219
    v_add_f32 v232, v232, v220
    v_add_f32 v233, v233, v221
    v_add_f32 v232, v232, v222
    v_add_f32 v233, v233, v223
    v_add_f32 v232, v232, v224
    v_add_f32 v233, v233, v225
    v_add_f32 v232, v232, v226
    v_add_f32 v233, v233, v227
    v_add_f32 v232, v232, v228
    v_add_f32 v233, v233, v229
    v_add_f32 v232, v232, v230
    v_add_f32 v233, v233, v231
    v_add_f32 v232, v232, v233
    s_nop 1
    v_add_f32_dpp v234, v232, v232 quad_perm:[1,0,3,2] row_mask:0xf bank_mask:0xf
    v_mov_b32 v232, v234
    s_nop 1
    v_add_f32_dpp v234, v232, v232 quad_perm:[2,3,0,1] row_mask:0xf bank_mask:0xf
    v_mov_b32 v232, v234
    s_nop 1
    v_add_f32_dpp v234, v232, v232 row_half_mirror row_mask:0xf bank_mask:0xf
    v_mov_b32 v232, v234
    s_nop 1
    v_add_f32_dpp v234, v232, v232 row_mirror row_mask:0xf bank_mask:0xf
    v_mov_b32 v232, v234
    s_nop 1
    v_permlane16_swap_b32 v232, v234
    s_nop 1
    v_add_f32 v232, v232, v234
    v_mul_f32 v232, 0.001953125, v232
    v_sub_f32 v208, v216, v232
    v_sub_f32 v209, v217, v232
    v_sub_f32 v210, v218, v232
    v_sub_f32 v211, v219, v232
    v_sub_f32 v212, v220, v232
    v_sub_f32 v213, v221, v232
    v_sub_f32 v214, v222, v232
    v_sub_f32 v215, v223, v232
    v_mul_f32 v233, v208, v208
    v_fmac_f32 v233, v209, v209
    v_fmac_f32 v233, v210, v210
    v_fmac_f32 v233, v211, v211
    v_fmac_f32 v233, v212, v212
    v_fmac_f32 v233, v213, v213
    v_fmac_f32 v233, v214, v214
    v_fmac_f32 v233, v215, v215
    v_sub_f32 v208, v224, v232
    v_sub_f32 v209, v225, v232
    v_sub_f32 v210, v226, v232
    v_sub_f32 v211, v227, v232
    v_sub_f32 v212, v228, v232
    v_sub_f32 v213, v229, v232
    v_sub_f32 v214, v230, v232
    v_sub_f32 v215, v231, v232
    v_fmac_f32 v233, v208, v208
    v_fmac_f32 v233, v209, v209
    v_fmac_f32 v233, v210, v210
    v_fmac_f32 v233, v211, v211
    v_fmac_f32 v233, v212, v212
    v_fmac_f32 v233, v213, v213
    v_fmac_f32 v233, v214, v214
    v_fmac_f32 v233, v215, v215
    s_nop 1
    v_add_f32_dpp v234, v233, v233 quad_perm:[1,0,3,2] row_mask:0xf bank_mask:0xf
    v_mov_b32 v233, v234
    s_nop 1
    v_add_f32_dpp v234, v233, v233 quad_perm:[2,3,0,1] row_mask:0xf bank_mask:0xf
    v_mov_b32 v233, v234
    s_nop 1
    v_add_f32_dpp v234, v233, v233 row_half_mirror row_mask:0xf bank_mask:0xf
    v_mov_b32 v233, v234
    s_nop 1
    v_add_f32_dpp v234, v233, v233 row_mirror row_mask:0xf bank_mask:0xf
    v_mov_b32 v233, v234
    s_nop 1
    v_permlane16_swap_b32 v233, v234
    s_nop 1
    v_add_f32 v233, v233, v234
    v_mul_f32 v233, 0.001953125, v233
    v_cvt_pk_bf16_f32 v234, v233, v233
    v_lshlrev_b32 v233, 16, v234
    v_add_f32 v233, 0x3727c5ac, v233
    v_cvt_pk_bf16_f32 v234, v233, v233
    v_lshlrev_b32 v233, 16, v234
    v_sqrt_f32 v233, v233
    s_nop 0
    v_cvt_pk_bf16_f32 v234, v233, v233
    v_lshlrev_b32 v233, 16, v234
    v_rcp_f32 v233, v233
    v_cvt_pk_bf16_f32 v234, v232, v232
    v_lshlrev_b32 v232, 16, v234
    v_sub_f32 v216, v216, v232
    v_sub_f32 v217, v217, v232
    v_sub_f32 v218, v218, v232
    v_sub_f32 v219, v219, v232
    v_sub_f32 v220, v220, v232
    v_sub_f32 v221, v221, v232
    v_sub_f32 v222, v222, v232
    v_sub_f32 v223, v223, v232
    v_sub_f32 v224, v224, v232
    v_sub_f32 v225, v225, v232
    v_sub_f32 v226, v226, v232
    v_sub_f32 v227, v227, v232
    v_sub_f32 v228, v228, v232
    v_sub_f32 v229, v229, v232
    v_sub_f32 v230, v230, v232
    v_sub_f32 v231, v231, v232
    v_cvt_pk_bf16_f32 v208, v216, v217
    v_cvt_pk_bf16_f32 v209, v218, v219
    v_cvt_pk_bf16_f32 v210, v220, v221
    v_cvt_pk_bf16_f32 v211, v222, v223
    v_cvt_pk_bf16_f32 v212, v224, v225
    v_cvt_pk_bf16_f32 v213, v226, v227
    v_cvt_pk_bf16_f32 v214, v228, v229
    v_cvt_pk_bf16_f32 v215, v230, v231
    v_lshlrev_b32 v216, 16, v208
    v_and_b32 v217, 0xffff0000, v208
    v_lshlrev_b32 v218, 16, v209
    v_and_b32 v219, 0xffff0000, v209
    v_lshlrev_b32 v220, 16, v210
    v_and_b32 v221, 0xffff0000, v210
    v_lshlrev_b32 v222, 16, v211
    v_and_b32 v223, 0xffff0000, v211
    v_lshlrev_b32 v224, 16, v212
    v_and_b32 v225, 0xffff0000, v212
    v_lshlrev_b32 v226, 16, v213
    v_and_b32 v227, 0xffff0000, v213
    v_lshlrev_b32 v228, 16, v214
    v_and_b32 v229, 0xffff0000, v214
    v_lshlrev_b32 v230, 16, v215
    v_and_b32 v231, 0xffff0000, v215
    v_mul_f32 v216, v216, v233
    v_mul_f32 v217, v217, v233
    v_mul_f32 v218, v218, v233
    v_mul_f32 v219, v219, v233
    v_mul_f32 v220, v220, v233
    v_mul_f32 v221, v221, v233
    v_mul_f32 v222, v222, v233
    v_mul_f32 v223, v223, v233
    v_mul_f32 v224, v224, v233
    v_mul_f32 v225, v225, v233
    v_mul_f32 v226, v226, v233
    v_mul_f32 v227, v227, v233
    v_mul_f32 v228, v228, v233
    v_mul_f32 v229, v229, v233
    v_mul_f32 v230, v230, v233
    v_mul_f32 v231, v231, v233
    v_cvt_pk_bf16_f32 v208, v216, v217
    v_cvt_pk_bf16_f32 v209, v218, v219
    v_cvt_pk_bf16_f32 v210, v220, v221
    v_cvt_pk_bf16_f32 v211, v222, v223
    v_cvt_pk_bf16_f32 v212, v224, v225
    v_cvt_pk_bf16_f32 v213, v226, v227
    v_cvt_pk_bf16_f32 v214, v228, v229
    v_cvt_pk_bf16_f32 v215, v230, v231
    buffer_store_dwordx4 v[208:211], v235, s[8:11], s49 offen sc0 sc1
    buffer_store_dwordx4 v[212:215], v235, s[8:11], s49 offen offset:512 sc0 sc1
    s_waitcnt vmcnt(35)
    s_waitcnt lgkmcnt(0)
    s_barrier
    ds_read_b128 v[32:35], v16 offset:0
    ds_read_b128 v[36:39], v17 offset:0
    s_add_u32 m0, s41, 98304
    s_add_u32 s48, s37, 2097152
    buffer_load_dwordx4 v6, s[16:19], s48 offen offset:0 lds
    buffer_load_dwordx4 v7, s[16:19], s48 offen offset:1024 lds
    buffer_load_dwordx4 v8, s[16:19], s48 offen offset:2048 lds
    buffer_load_dwordx4 v9, s[16:19], s48 offen offset:3072 lds
    s_waitcnt lgkmcnt(0)
    v_mfma_f32_16x16x32_bf16 a[0:3], v[64:67], v[32:35], 0
    ds_read_b128 v[40:43], v16 offset:2048
    v_mfma_f32_16x16x32_bf16 a[0:3], v[68:71], v[36:39], a[0:3]
    ds_read_b128 v[44:47], v17 offset:2048
    v_mfma_f32_16x16x32_bf16 a[4:7], v[72:75], v[32:35], 0
    ds_read_b64_tr_b16 v[96:97], v192 offset:16384
    v_mfma_f32_16x16x32_bf16 a[4:7], v[76:79], v[36:39], a[4:7]
    v_mfma_f32_16x16x32_bf16 a[8:11], v[80:83], v[32:35], 0
    ds_read_b64_tr_b16 v[98:99], v192 offset:18432
    v_mfma_f32_16x16x32_bf16 a[8:11], v[84:87], v[36:39], a[8:11]
    v_mfma_f32_16x16x32_bf16 a[12:15], v[88:91], v[32:35], 0
    ds_read_b64_tr_b16 v[100:101], v192 offset:24576
    v_mfma_f32_16x16x32_bf16 a[12:15], v[92:95], v[36:39], a[12:15]
    s_waitcnt lgkmcnt(3)
    v_mfma_f32_16x16x32_bf16 a[16:19], v[64:67], v[40:43], 0
    ds_read_b128 v[32:35], v16 offset:4096
    v_mfma_f32_16x16x32_bf16 a[16:19], v[68:71], v[44:47], a[16:19]
    ds_read_b128 v[36:39], v17 offset:4096
    v_mfma_f32_16x16x32_bf16 a[20:23], v[72:75], v[40:43], 0
    ds_read_b64_tr_b16 v[102:103], v192 offset:26624
    v_mfma_f32_16x16x32_bf16 a[20:23], v[76:79], v[44:47], a[20:23]
    v_mfma_f32_16x16x32_bf16 a[24:27], v[80:83], v[40:43], 0
    ds_read_b64_tr_b16 v[104:105], v193 offset:16384
    v_mfma_f32_16x16x32_bf16 a[24:27], v[84:87], v[44:47], a[24:27]
    v_mfma_f32_16x16x32_bf16 a[28:31], v[88:91], v[40:43], 0
    ds_read_b64_tr_b16 v[106:107], v193 offset:18432
    v_mfma_f32_16x16x32_bf16 a[28:31], v[92:95], v[44:47], a[28:31]
    s_waitcnt lgkmcnt(3)
    v_mfma_f32_16x16x32_bf16 a[32:35], v[64:67], v[32:35], 0
    ds_read_b128 v[40:43], v16 offset:6144
    v_mfma_f32_16x16x32_bf16 a[32:35], v[68:71], v[36:39], a[32:35]
    ds_read_b128 v[44:47], v17 offset:6144
    v_mfma_f32_16x16x32_bf16 a[36:39], v[72:75], v[32:35], 0
    ds_read_b64_tr_b16 v[108:109], v193 offset:24576
    v_mfma_f32_16x16x32_bf16 a[36:39], v[76:79], v[36:39], a[36:39]
    v_mfma_f32_16x16x32_bf16 a[40:43], v[80:83], v[32:35], 0
    v_mfma_f32_16x16x32_bf16 a[40:43], v[84:87], v[36:39], a[40:43]
    ds_read_b64_tr_b16 v[110:111], v193 offset:26624
    v_mfma_f32_16x16x32_bf16 a[44:47], v[88:91], v[32:35], 0
    v_mfma_f32_16x16x32_bf16 a[44:47], v[92:95], v[36:39], a[44:47]
    s_waitcnt lgkmcnt(2)
    v_mfma_f32_16x16x32_bf16 a[48:51], v[64:67], v[40:43], 0
    ds_read_b128 v[32:35], v16 offset:8192
    v_mfma_f32_16x16x32_bf16 a[48:51], v[68:71], v[44:47], a[48:51]
    ds_read_b128 v[36:39], v17 offset:8192
    v_mfma_f32_16x16x32_bf16 a[52:55], v[72:75], v[40:43], 0
    ds_read_b64_tr_b16 v[112:113], v194 offset:16384
    v_mfma_f32_16x16x32_bf16 a[52:55], v[76:79], v[44:47], a[52:55]
    v_mfma_f32_16x16x32_bf16 a[56:59], v[80:83], v[40:43], 0
    ds_read_b64_tr_b16 v[114:115], v194 offset:18432
    v_mfma_f32_16x16x32_bf16 a[56:59], v[84:87], v[44:47], a[56:59]
    v_mfma_f32_16x16x32_bf16 a[60:63], v[88:91], v[40:43], 0
    ds_read_b64_tr_b16 v[116:117], v194 offset:24576
    v_mfma_f32_16x16x32_bf16 a[60:63], v[92:95], v[44:47], a[60:63]
    s_waitcnt lgkmcnt(3)
    v_mfma_f32_16x16x32_bf16 a[64:67], v[64:67], v[32:35], 0
    ds_read_b128 v[40:43], v16 offset:10240
    v_mfma_f32_16x16x32_bf16 a[64:67], v[68:71], v[36:39], a[64:67]
    ds_read_b128 v[44:47], v17 offset:10240
    v_mfma_f32_16x16x32_bf16 a[68:71], v[72:75], v[32:35], 0
    ds_read_b64_tr_b16 v[118:119], v194 offset:26624
    v_mfma_f32_16x16x32_bf16 a[68:71], v[76:79], v[36:39], a[68:71]
    v_mfma_f32_16x16x32_bf16 a[72:75], v[80:83], v[32:35], 0
    ds_read_b64_tr_b16 v[120:121], v195 offset:16384
    v_mfma_f32_16x16x32_bf16 a[72:75], v[84:87], v[36:39], a[72:75]
    v_mfma_f32_16x16x32_bf16 a[76:79], v[88:91], v[32:35], 0
    ds_read_b64_tr_b16 v[122:123], v195 offset:18432
    v_mfma_f32_16x16x32_bf16 a[76:79], v[92:95], v[36:39], a[76:79]
    s_waitcnt lgkmcnt(3)
    v_mfma_f32_16x16x32_bf16 a[80:83], v[64:67], v[40:43], 0
    ds_read_b128 v[32:35], v16 offset:12288
    v_mfma_f32_16x16x32_bf16 a[80:83], v[68:71], v[44:47], a[80:83]
    ds_read_b128 v[36:39], v17 offset:12288
    v_mfma_f32_16x16x32_bf16 a[84:87], v[72:75], v[40:43], 0
    ds_read_b64_tr_b16 v[124:125], v195 offset:24576
    v_mfma_f32_16x16x32_bf16 a[84:87], v[76:79], v[44:47], a[84:87]
    v_mfma_f32_16x16x32_bf16 a[88:91], v[80:83], v[40:43], 0
    v_mfma_f32_16x16x32_bf16 a[88:91], v[84:87], v[44:47], a[88:91]
    ds_read_b64_tr_b16 v[126:127], v195 offset:26624
    v_mfma_f32_16x16x32_bf16 a[92:95], v[88:91], v[40:43], 0
    v_mfma_f32_16x16x32_bf16 a[92:95], v[92:95], v[44:47], a[92:95]
    s_waitcnt lgkmcnt(2)
    v_mfma_f32_16x16x32_bf16 a[96:99], v[64:67], v[32:35], 0
    ds_read_b128 v[40:43], v16 offset:14336
    v_mfma_f32_16x16x32_bf16 a[96:99], v[68:71], v[36:39], a[96:99]
    ds_read_b128 v[44:47], v17 offset:14336
    v_mfma_f32_16x16x32_bf16 a[100:103], v[72:75], v[32:35], 0
    v_mfma_f32_16x16x32_bf16 a[100:103], v[76:79], v[36:39], a[100:103]
    v_mfma_f32_16x16x32_bf16 a[104:107], v[80:83], v[32:35], 0
    v_mfma_f32_16x16x32_bf16 a[104:107], v[84:87], v[36:39], a[104:107]
    v_mfma_f32_16x16x32_bf16 a[108:111], v[88:91], v[32:35], 0
    v_mfma_f32_16x16x32_bf16 a[108:111], v[92:95], v[36:39], a[108:111]
    s_waitcnt lgkmcnt(0)
    v_mfma_f32_16x16x32_bf16 a[112:115], v[64:67], v[40:43], 0
    s_waitcnt vmcnt(4)
    s_barrier
    s_cmp_lg_u32 s32, 0
    s_cbranch_scc1 L_g1_ic1
    v_mov_b32 v49, 1
    s_mov_b64 exec, 1
    buffer_store_byte v49, v48, s[28:31], s2 offen sc0 sc1
    s_mov_b64 exec, -1
L_g1_ic1:
    v_mfma_f32_16x16x32_bf16 a[112:115], v[68:71], v[44:47], a[112:115]
    ds_read_b128 v[32:35], v16 offset:32768
    v_mfma_f32_16x16x32_bf16 a[116:119], v[72:75], v[40:43], 0
    ds_read_b128 v[36:39], v17 offset:32768
    v_mfma_f32_16x16x32_bf16 a[116:119], v[76:79], v[44:47], a[116:119]
    s_add_u32 m0, s40, 0
    s_add_u32 s48, s35, 384
    buffer_load_dwordx4 v2, s[12:15], s48 offen offset:0 lds
    v_mfma_f32_16x16x32_bf16 a[120:123], v[80:83], v[40:43], 0
    v_mfma_f32_16x16x32_bf16 a[120:123], v[84:87], v[44:47], a[120:123]
    v_mfma_f32_16x16x32_bf16 a[124:127], v[88:91], v[40:43], 0
    buffer_load_dwordx4 v3, s[12:15], s48 offen offset:1024 lds
    v_mfma_f32_16x16x32_bf16 a[124:127], v[92:95], v[44:47], a[124:127]
    s_waitcnt lgkmcnt(0)
    v_mfma_f32_16x16x32_bf16 a[0:3], v[96:99], v[32:35], a[0:3]
    ds_read_b128 v[40:43], v16 offset:34816
    v_mfma_f32_16x16x32_bf16 a[0:3], v[100:103], v[36:39], a[0:3]
    ds_read_b128 v[44:47], v17 offset:34816
    v_mfma_f32_16x16x32_bf16 a[4:7], v[104:107], v[32:35], a[4:7]
    ds_read_b64_tr_b16 v[64:65], v192 offset:32768
    v_mfma_f32_16x16x32_bf16 a[4:7], v[108:111], v[36:39], a[4:7]
    buffer_load_dwordx4 v4, s[12:15], s48 offen offset:2048 lds
    v_mfma_f32_16x16x32_bf16 a[8:11], v[112:115], v[32:35], a[8:11]
    ds_read_b64_tr_b16 v[66:67], v192 offset:34816
    v_mfma_f32_16x16x32_bf16 a[8:11], v[116:119], v[36:39], a[8:11]
    buffer_load_dwordx4 v5, s[12:15], s48 offen offset:3072 lds
    v_mfma_f32_16x16x32_bf16 a[12:15], v[120:123], v[32:35], a[12:15]
    ds_read_b64_tr_b16 v[68:69], v192 offset:40960
    v_mfma_f32_16x16x32_bf16 a[12:15], v[124:127], v[36:39], a[12:15]
    s_waitcnt lgkmcnt(3)
    v_mfma_f32_16x16x32_bf16 a[16:19], v[96:99], v[40:43], a[16:19]
    ds_read_b128 v[32:35], v16 offset:36864
    v_mfma_f32_16x16x32_bf16 a[16:19], v[100:103], v[44:47], a[16:19]
    ds_read_b128 v[36:39], v17 offset:36864
    v_mfma_f32_16x16x32_bf16 a[20:23], v[104:107], v[40:43], a[20:23]
    ds_read_b64_tr_b16 v[70:71], v192 offset:43008
    v_mfma_f32_16x16x32_bf16 a[20:23], v[108:111], v[44:47], a[20:23]
    s_add_u32 m0, s40, 4096
    s_add_u32 s48, s35, 33152
    buffer_load_dwordx4 v2, s[12:15], s48 offen offset:0 lds
    v_mfma_f32_16x16x32_bf16 a[24:27], v[112:115], v[40:43], a[24:27]
    ds_read_b64_tr_b16 v[72:73], v193 offset:32768
    v_mfma_f32_16x16x32_bf16 a[24:27], v[116:119], v[44:47], a[24:27]
    v_mfma_f32_16x16x32_bf16 a[28:31], v[120:123], v[40:43], a[28:31]
    ds_read_b64_tr_b16 v[74:75], v193 offset:34816
    buffer_load_dwordx4 v3, s[12:15], s48 offen offset:1024 lds
    v_mfma_f32_16x16x32_bf16 a[28:31], v[124:127], v[44:47], a[28:31]
    s_waitcnt lgkmcnt(3)
    v_mfma_f32_16x16x32_bf16 a[32:35], v[96:99], v[32:35], a[32:35]
    ds_read_b128 v[40:43], v16 offset:38912
    v_mfma_f32_16x16x32_bf16 a[32:35], v[100:103], v[36:39], a[32:35]
    ds_read_b128 v[44:47], v17 offset:38912
    v_mfma_f32_16x16x32_bf16 a[36:39], v[104:107], v[32:35], a[36:39]
    ds_read_b64_tr_b16 v[76:77], v193 offset:40960
    v_mfma_f32_16x16x32_bf16 a[36:39], v[108:111], v[36:39], a[36:39]
    buffer_load_dwordx4 v4, s[12:15], s48 offen offset:2048 lds
    v_mfma_f32_16x16x32_bf16 a[40:43], v[112:115], v[32:35], a[40:43]
    v_mfma_f32_16x16x32_bf16 a[40:43], v[116:119], v[36:39], a[40:43]
    ds_read_b64_tr_b16 v[78:79], v193 offset:43008
    buffer_load_dwordx4 v5, s[12:15], s48 offen offset:3072 lds
    v_mfma_f32_16x16x32_bf16 a[44:47], v[120:123], v[32:35], a[44:47]
    v_mfma_f32_16x16x32_bf16 a[44:47], v[124:127], v[36:39], a[44:47]
    s_waitcnt lgkmcnt(2)
    v_mfma_f32_16x16x32_bf16 a[48:51], v[96:99], v[40:43], a[48:51]
    ds_read_b128 v[32:35], v16 offset:40960
    v_mfma_f32_16x16x32_bf16 a[48:51], v[100:103], v[44:47], a[48:51]
    ds_read_b128 v[36:39], v17 offset:40960
    v_mfma_f32_16x16x32_bf16 a[52:55], v[104:107], v[40:43], a[52:55]
    ds_read_b64_tr_b16 v[80:81], v194 offset:32768
    v_mfma_f32_16x16x32_bf16 a[52:55], v[108:111], v[44:47], a[52:55]
    s_add_u32 m0, s41, 114688
    s_add_u32 s48, s37, 2621440
    buffer_load_dwordx4 v6, s[16:19], s48 offen offset:0 lds
    v_mfma_f32_16x16x32_bf16 a[56:59], v[112:115], v[40:43], a[56:59]
    ds_read_b64_tr_b16 v[82:83], v194 offset:34816
    v_mfma_f32_16x16x32_bf16 a[56:59], v[116:119], v[44:47], a[56:59]
    v_mfma_f32_16x16x32_bf16 a[60:63], v[120:123], v[40:43], a[60:63]
    ds_read_b64_tr_b16 v[84:85], v194 offset:40960
    buffer_load_dwordx4 v7, s[16:19], s48 offen offset:1024 lds
    v_mfma_f32_16x16x32_bf16 a[60:63], v[124:127], v[44:47], a[60:63]
    s_waitcnt lgkmcnt(3)
    v_mfma_f32_16x16x32_bf16 a[64:67], v[96:99], v[32:35], a[64:67]
    ds_read_b128 v[40:43], v16 offset:43008
    v_mfma_f32_16x16x32_bf16 a[64:67], v[100:103], v[36:39], a[64:67]
    ds_read_b128 v[44:47], v17 offset:43008
    v_mfma_f32_16x16x32_bf16 a[68:71], v[104:107], v[32:35], a[68:71]
    ds_read_b64_tr_b16 v[86:87], v194 offset:43008
    v_mfma_f32_16x16x32_bf16 a[68:71], v[108:111], v[36:39], a[68:71]
    buffer_load_dwordx4 v8, s[16:19], s48 offen offset:2048 lds
    v_mfma_f32_16x16x32_bf16 a[72:75], v[112:115], v[32:35], a[72:75]
    ds_read_b64_tr_b16 v[88:89], v195 offset:32768
    v_mfma_f32_16x16x32_bf16 a[72:75], v[116:119], v[36:39], a[72:75]
    buffer_load_dwordx4 v9, s[16:19], s48 offen offset:3072 lds
    v_mfma_f32_16x16x32_bf16 a[76:79], v[120:123], v[32:35], a[76:79]
    ds_read_b64_tr_b16 v[90:91], v195 offset:34816
    v_mfma_f32_16x16x32_bf16 a[76:79], v[124:127], v[36:39], a[76:79]
    s_waitcnt lgkmcnt(3)
    v_mfma_f32_16x16x32_bf16 a[80:83], v[96:99], v[40:43], a[80:83]
    ds_read_b128 v[32:35], v16 offset:45056
    v_mfma_f32_16x16x32_bf16 a[80:83], v[100:103], v[44:47], a[80:83]
    ds_read_b128 v[36:39], v17 offset:45056
    v_mfma_f32_16x16x32_bf16 a[84:87], v[104:107], v[40:43], a[84:87]
    ds_read_b64_tr_b16 v[92:93], v195 offset:40960
    v_mfma_f32_16x16x32_bf16 a[84:87], v[108:111], v[44:47], a[84:87]
    v_mfma_f32_16x16x32_bf16 a[88:91], v[112:115], v[40:43], a[88:91]
    v_mfma_f32_16x16x32_bf16 a[88:91], v[116:119], v[44:47], a[88:91]
    ds_read_b64_tr_b16 v[94:95], v195 offset:43008
    v_mfma_f32_16x16x32_bf16 a[92:95], v[120:123], v[40:43], a[92:95]
    v_mfma_f32_16x16x32_bf16 a[92:95], v[124:127], v[44:47], a[92:95]
    s_waitcnt lgkmcnt(2)
    v_mfma_f32_16x16x32_bf16 a[96:99], v[96:99], v[32:35], a[96:99]
    ds_read_b128 v[40:43], v16 offset:47104
    v_mfma_f32_16x16x32_bf16 a[96:99], v[100:103], v[36:39], a[96:99]
    ds_read_b128 v[44:47], v17 offset:47104
    v_mfma_f32_16x16x32_bf16 a[100:103], v[104:107], v[32:35], a[100:103]
    v_mfma_f32_16x16x32_bf16 a[100:103], v[108:111], v[36:39], a[100:103]
    v_mfma_f32_16x16x32_bf16 a[104:107], v[112:115], v[32:35], a[104:107]
    v_mfma_f32_16x16x32_bf16 a[104:107], v[116:119], v[36:39], a[104:107]
    v_mfma_f32_16x16x32_bf16 a[108:111], v[120:123], v[32:35], a[108:111]
    v_mfma_f32_16x16x32_bf16 a[108:111], v[124:127], v[36:39], a[108:111]
    s_waitcnt lgkmcnt(0)
    v_mfma_f32_16x16x32_bf16 a[112:115], v[96:99], v[40:43], a[112:115]
    s_waitcnt vmcnt(25)
    s_barrier
    v_mfma_f32_16x16x32_bf16 a[112:115], v[100:103], v[44:47], a[112:115]
    ds_read_b128 v[32:35], v18 offset:0
    v_mfma_f32_16x16x32_bf16 a[116:119], v[104:107], v[40:43], a[116:119]
    ds_read_b128 v[36:39], v19 offset:0
    v_mfma_f32_16x16x32_bf16 a[116:119], v[108:111], v[44:47], a[116:119]
    s_add_u32 m0, s40, 32768
    s_add_u32 s48, s35, 512
    buffer_load_dwordx4 v2, s[12:15], s48 offen offset:0 lds
    v_mfma_f32_16x16x32_bf16 a[120:123], v[112:115], v[40:43], a[120:123]
    v_mfma_f32_16x16x32_bf16 a[120:123], v[116:119], v[44:47], a[120:123]
    v_mfma_f32_16x16x32_bf16 a[124:127], v[120:123], v[40:43], a[124:127]
    buffer_load_dwordx4 v3, s[12:15], s48 offen offset:1024 lds
    v_mfma_f32_16x16x32_bf16 a[124:127], v[124:127], v[44:47], a[124:127]
    s_waitcnt lgkmcnt(0)
    v_mfma_f32_16x16x32_bf16 a[0:3], v[64:67], v[32:35], a[0:3]
    ds_read_b128 v[40:43], v18 offset:2048
    v_mfma_f32_16x16x32_bf16 a[0:3], v[68:71], v[36:39], a[0:3]
    ds_read_b128 v[44:47], v19 offset:2048
    v_mfma_f32_16x16x32_bf16 a[4:7], v[72:75], v[32:35], a[4:7]
    ds_read_b64_tr_b16 v[96:97], v192 offset:49152
    v_mfma_f32_16x16x32_bf16 a[4:7], v[76:79], v[36:39], a[4:7]
    buffer_load_dwordx4 v4, s[12:15], s48 offen offset:2048 lds
    v_mfma_f32_16x16x32_bf16 a[8:11], v[80:83], v[32:35], a[8:11]
    ds_read_b64_tr_b16 v[98:99], v192 offset:51200
    v_mfma_f32_16x16x32_bf16 a[8:11], v[84:87], v[36:39], a[8:11]
    buffer_load_dwordx4 v5, s[12:15], s48 offen offset:3072 lds
    v_mfma_f32_16x16x32_bf16 a[12:15], v[88:91], v[32:35], a[12:15]
    ds_read_b64_tr_b16 v[100:101], v192 offset:57344
    v_mfma_f32_16x16x32_bf16 a[12:15], v[92:95], v[36:39], a[12:15]
    s_waitcnt lgkmcnt(3)
    v_mfma_f32_16x16x32_bf16 a[16:19], v[64:67], v[40:43], a[16:19]
    ds_read_b128 v[32:35], v18 offset:4096
    v_mfma_f32_16x16x32_bf16 a[16:19], v[68:71], v[44:47], a[16:19]
    ds_read_b128 v[36:39], v19 offset:4096
    v_mfma_f32_16x16x32_bf16 a[20:23], v[72:75], v[40:43], a[20:23]
    ds_read_b64_tr_b16 v[102:103], v192 offset:59392
    v_mfma_f32_16x16x32_bf16 a[20:23], v[76:79], v[44:47], a[20:23]
    s_add_u32 m0, s40, 36864
    s_add_u32 s48, s35, 33280
    buffer_load_dwordx4 v2, s[12:15], s48 offen offset:0 lds
    v_mfma_f32_16x16x32_bf16 a[24:27], v[80:83], v[40:43], a[24:27]
    ds_read_b64_tr_b16 v[104:105], v193 offset:49152
    v_mfma_f32_16x16x32_bf16 a[24:27], v[84:87], v[44:47], a[24:27]
    v_mfma_f32_16x16x32_bf16 a[28:31], v[88:91], v[40:43], a[28:31]
    ds_read_b64_tr_b16 v[106:107], v193 offset:51200
    buffer_load_dwordx4 v3, s[12:15], s48 offen offset:1024 lds
    v_mfma_f32_16x16x32_bf16 a[28:31], v[92:95], v[44:47], a[28:31]
    s_waitcnt lgkmcnt(3)
    v_mfma_f32_16x16x32_bf16 a[32:35], v[64:67], v[32:35], a[32:35]
    ds_read_b128 v[40:43], v18 offset:6144
    v_mfma_f32_16x16x32_bf16 a[32:35], v[68:71], v[36:39], a[32:35]
    ds_read_b128 v[44:47], v19 offset:6144
    v_mfma_f32_16x16x32_bf16 a[36:39], v[72:75], v[32:35], a[36:39]
    ds_read_b64_tr_b16 v[108:109], v193 offset:57344
    v_mfma_f32_16x16x32_bf16 a[36:39], v[76:79], v[36:39], a[36:39]
    buffer_load_dwordx4 v4, s[12:15], s48 offen offset:2048 lds
    v_mfma_f32_16x16x32_bf16 a[40:43], v[80:83], v[32:35], a[40:43]
    v_mfma_f32_16x16x32_bf16 a[40:43], v[84:87], v[36:39], a[40:43]
    ds_read_b64_tr_b16 v[110:111], v193 offset:59392
    buffer_load_dwordx4 v5, s[12:15], s48 offen offset:3072 lds
    v_mfma_f32_16x16x32_bf16 a[44:47], v[88:91], v[32:35], a[44:47]
    v_mfma_f32_16x16x32_bf16 a[44:47], v[92:95], v[36:39], a[44:47]
    s_waitcnt lgkmcnt(2)
    v_mfma_f32_16x16x32_bf16 a[48:51], v[64:67], v[40:43], a[48:51]
    ds_read_b128 v[32:35], v18 offset:8192
    v_mfma_f32_16x16x32_bf16 a[48:51], v[68:71], v[44:47], a[48:51]
    ds_read_b128 v[36:39], v19 offset:8192
    v_mfma_f32_16x16x32_bf16 a[52:55], v[72:75], v[40:43], a[52:55]
    ds_read_b64_tr_b16 v[112:113], v194 offset:49152
    v_mfma_f32_16x16x32_bf16 a[52:55], v[76:79], v[44:47], a[52:55]
    s_add_u32 m0, s41, 131072
    s_add_u32 s48, s37, 3145728
    buffer_load_dwordx4 v6, s[16:19], s48 offen offset:0 lds
    v_mfma_f32_16x16x32_bf16 a[56:59], v[80:83], v[40:43], a[56:59]
    ds_read_b64_tr_b16 v[114:115], v194 offset:51200
    v_mfma_f32_16x16x32_bf16 a[56:59], v[84:87], v[44:47], a[56:59]
    v_mfma_f32_16x16x32_bf16 a[60:63], v[88:91], v[40:43], a[60:63]
    ds_read_b64_tr_b16 v[116:117], v194 offset:57344
    buffer_load_dwordx4 v7, s[16:19], s48 offen offset:1024 lds
    v_mfma_f32_16x16x32_bf16 a[60:63], v[92:95], v[44:47], a[60:63]
    s_waitcnt lgkmcnt(3)
    v_mfma_f32_16x16x32_bf16 a[64:67], v[64:67], v[32:35], a[64:67]
    ds_read_b128 v[40:43], v18 offset:10240
    v_mfma_f32_16x16x32_bf16 a[64:67], v[68:71], v[36:39], a[64:67]
    ds_read_b128 v[44:47], v19 offset:10240
    v_mfma_f32_16x16x32_bf16 a[68:71], v[72:75], v[32:35], a[68:71]
    ds_read_b64_tr_b16 v[118:119], v194 offset:59392
    v_mfma_f32_16x16x32_bf16 a[68:71], v[76:79], v[36:39], a[68:71]
    buffer_load_dwordx4 v8, s[16:19], s48 offen offset:2048 lds
    v_mfma_f32_16x16x32_bf16 a[72:75], v[80:83], v[32:35], a[72:75]
    ds_read_b64_tr_b16 v[120:121], v195 offset:49152
    v_mfma_f32_16x16x32_bf16 a[72:75], v[84:87], v[36:39], a[72:75]
    buffer_load_dwordx4 v9, s[16:19], s48 offen offset:3072 lds
    v_mfma_f32_16x16x32_bf16 a[76:79], v[88:91], v[32:35], a[76:79]
    ds_read_b64_tr_b16 v[122:123], v195 offset:51200
    v_mfma_f32_16x16x32_bf16 a[76:79], v[92:95], v[36:39], a[76:79]
    s_waitcnt lgkmcnt(3)
    v_mfma_f32_16x16x32_bf16 a[80:83], v[64:67], v[40:43], a[80:83]
    ds_read_b128 v[32:35], v18 offset:12288
    v_mfma_f32_16x16x32_bf16 a[80:83], v[68:71], v[44:47], a[80:83]
    ds_read_b128 v[36:39], v19 offset:12288
    v_mfma_f32_16x16x32_bf16 a[84:87], v[72:75], v[40:43], a[84:87]
    ds_read_b64_tr_b16 v[124:125], v195 offset:57344
    v_mfma_f32_16x16x32_bf16 a[84:87], v[76:79], v[44:47], a[84:87]
    v_mfma_f32_16x16x32_bf16 a[88:91], v[80:83], v[40:43], a[88:91]
    v_mfma_f32_16x16x32_bf16 a[88:91], v[84:87], v[44:47], a[88:91]
    ds_read_b64_tr_b16 v[126:127], v195 offset:59392
    v_mfma_f32_16x16x32_bf16 a[92:95], v[88:91], v[40:43], a[92:95]
    v_mfma_f32_16x16x32_bf16 a[92:95], v[92:95], v[44:47], a[92:95]
    s_waitcnt lgkmcnt(2)
    v_mfma_f32_16x16x32_bf16 a[96:99], v[64:67], v[32:35], a[96:99]
    ds_read_b128 v[40:43], v18 offset:14336
    v_mfma_f32_16x16x32_bf16 a[96:99], v[68:71], v[36:39], a[96:99]
    ds_read_b128 v[44:47], v19 offset:14336
    v_mfma_f32_16x16x32_bf16 a[100:103], v[72:75], v[32:35], a[100:103]
    v_mfma_f32_16x16x32_bf16 a[100:103], v[76:79], v[36:39], a[100:103]
    v_mfma_f32_16x16x32_bf16 a[104:107], v[80:83], v[32:35], a[104:107]
    v_mfma_f32_16x16x32_bf16 a[104:107], v[84:87], v[36:39], a[104:107]
    v_mfma_f32_16x16x32_bf16 a[108:111], v[88:91], v[32:35], a[108:111]
    v_mfma_f32_16x16x32_bf16 a[108:111], v[92:95], v[36:39], a[108:111]
    s_waitcnt lgkmcnt(0)
    v_mfma_f32_16x16x32_bf16 a[112:115], v[64:67], v[40:43], a[112:115]
    s_waitcnt vmcnt(16)
    s_barrier
    v_mfma_f32_16x16x32_bf16 a[112:115], v[68:71], v[44:47], a[112:115]
    ds_read_b128 v[32:35], v16 offset:0
    v_mfma_f32_16x16x32_bf16 a[116:119], v[72:75], v[40:43], a[116:119]
    ds_read_b128 v[36:39], v17 offset:0
    v_mfma_f32_16x16x32_bf16 a[116:119], v[76:79], v[44:47], a[116:119]
    s_add_u32 m0, s40, 65536
    s_add_u32 s48, s35, 640
    buffer_load_dwordx4 v2, s[12:15], s48 offen offset:0 lds
    v_mfma_f32_16x16x32_bf16 a[120:123], v[80:83], v[40:43], a[120:123]
    v_mfma_f32_16x16x32_bf16 a[120:123], v[84:87], v[44:47], a[120:123]
    v_mfma_f32_16x16x32_bf16 a[124:127], v[88:91], v[40:43], a[124:127]
    buffer_load_dwordx4 v3, s[12:15], s48 offen offset:1024 lds
    v_mfma_f32_16x16x32_bf16 a[124:127], v[92:95], v[44:47], a[124:127]
    s_waitcnt lgkmcnt(0)
    v_mfma_f32_16x16x32_bf16 a[0:3], v[96:99], v[32:35], a[0:3]
    ds_read_b128 v[40:43], v16 offset:2048
    v_mfma_f32_16x16x32_bf16 a[0:3], v[100:103], v[36:39], a[0:3]
    ds_read_b128 v[44:47], v17 offset:2048
    v_mfma_f32_16x16x32_bf16 a[4:7], v[104:107], v[32:35], a[4:7]
    ds_read_b64_tr_b16 v[64:65], v192 offset:0
    v_mfma_f32_16x16x32_bf16 a[4:7], v[108:111], v[36:39], a[4:7]
    buffer_load_dwordx4 v4, s[12:15], s48 offen offset:2048 lds
    v_mfma_f32_16x16x32_bf16 a[8:11], v[112:115], v[32:35], a[8:11]
    ds_read_b64_tr_b16 v[66:67], v192 offset:2048
    v_mfma_f32_16x16x32_bf16 a[8:11], v[116:119], v[36:39], a[8:11]
    buffer_load_dwordx4 v5, s[12:15], s48 offen offset:3072 lds
    v_mfma_f32_16x16x32_bf16 a[12:15], v[120:123], v[32:35], a[12:15]
    ds_read_b64_tr_b16 v[68:69], v192 offset:8192
    v_mfma_f32_16x16x32_bf16 a[12:15], v[124:127], v[36:39], a[12:15]
    s_waitcnt lgkmcnt(3)
    v_mfma_f32_16x16x32_bf16 a[16:19], v[96:99], v[40:43], a[16:19]
    ds_read_b128 v[32:35], v16 offset:4096
    v_mfma_f32_16x16x32_bf16 a[16:19], v[100:103], v[44:47], a[16:19]
    ds_read_b128 v[36:39], v17 offset:4096
    v_mfma_f32_16x16x32_bf16 a[20:23], v[104:107], v[40:43], a[20:23]
    ds_read_b64_tr_b16 v[70:71], v192 offset:10240
    v_mfma_f32_16x16x32_bf16 a[20:23], v[108:111], v[44:47], a[20:23]
    s_add_u32 m0, s40, 69632
    s_add_u32 s48, s35, 33408
    buffer_load_dwordx4 v2, s[12:15], s48 offen offset:0 lds
    v_mfma_f32_16x16x32_bf16 a[24:27], v[112:115], v[40:43], a[24:27]
    ds_read_b64_tr_b16 v[72:73], v193 offset:0
    v_mfma_f32_16x16x32_bf16 a[24:27], v[116:119], v[44:47], a[24:27]
    v_mfma_f32_16x16x32_bf16 a[28:31], v[120:123], v[40:43], a[28:31]
    ds_read_b64_tr_b16 v[74:75], v193 offset:2048
    buffer_load_dwordx4 v3, s[12:15], s48 offen offset:1024 lds
    v_mfma_f32_16x16x32_bf16 a[28:31], v[124:127], v[44:47], a[28:31]
    s_waitcnt lgkmcnt(3)
    v_mfma_f32_16x16x32_bf16 a[32:35], v[96:99], v[32:35], a[32:35]
    ds_read_b128 v[40:43], v16 offset:6144
    v_mfma_f32_16x16x32_bf16 a[32:35], v[100:103], v[36:39], a[32:35]
    ds_read_b128 v[44:47], v17 offset:6144
    v_mfma_f32_16x16x32_bf16 a[36:39], v[104:107], v[32:35], a[36:39]
    ds_read_b64_tr_b16 v[76:77], v193 offset:8192
    v_mfma_f32_16x16x32_bf16 a[36:39], v[108:111], v[36:39], a[36:39]
    buffer_load_dwordx4 v4, s[12:15], s48 offen offset:2048 lds
    v_mfma_f32_16x16x32_bf16 a[40:43], v[112:115], v[32:35], a[40:43]
    v_mfma_f32_16x16x32_bf16 a[40:43], v[116:119], v[36:39], a[40:43]
    ds_read_b64_tr_b16 v[78:79], v193 offset:10240
    buffer_load_dwordx4 v5, s[12:15], s48 offen offset:3072 lds
    v_mfma_f32_16x16x32_bf16 a[44:47], v[120:123], v[32:35], a[44:47]
    v_mfma_f32_16x16x32_bf16 a[44:47], v[124:127], v[36:39], a[44:47]
    s_waitcnt lgkmcnt(2)
    v_mfma_f32_16x16x32_bf16 a[48:51], v[96:99], v[40:43], a[48:51]
    ds_read_b128 v[32:35], v16 offset:8192
    v_mfma_f32_16x16x32_bf16 a[48:51], v[100:103], v[44:47], a[48:51]
    ds_read_b128 v[36:39], v17 offset:8192
    v_mfma_f32_16x16x32_bf16 a[52:55], v[104:107], v[40:43], a[52:55]
    ds_read_b64_tr_b16 v[80:81], v194 offset:0
    v_mfma_f32_16x16x32_bf16 a[52:55], v[108:111], v[44:47], a[52:55]
    s_add_u32 m0, s41, 147456
    s_add_u32 s48, s37, 3670016
    buffer_load_dwordx4 v6, s[16:19], s48 offen offset:0 lds
    v_mfma_f32_16x16x32_bf16 a[56:59], v[112:115], v[40:43], a[56:59]
    ds_read_b64_tr_b16 v[82:83], v194 offset:2048
    v_mfma_f32_16x16x32_bf16 a[56:59], v[116:119], v[44:47], a[56:59]
    v_mfma_f32_16x16x32_bf16 a[60:63], v[120:123], v[40:43], a[60:63]
    ds_read_b64_tr_b16 v[84:85], v194 offset:8192
    buffer_load_dwordx4 v7, s[16:19], s48 offen offset:1024 lds
    v_mfma_f32_16x16x32_bf16 a[60:63], v[124:127], v[44:47], a[60:63]
    s_waitcnt lgkmcnt(3)
    v_mfma_f32_16x16x32_bf16 a[64:67], v[96:99], v[32:35], a[64:67]
    ds_read_b128 v[40:43], v16 offset:10240
    v_mfma_f32_16x16x32_bf16 a[64:67], v[100:103], v[36:39], a[64:67]
    ds_read_b128 v[44:47], v17 offset:10240
    v_mfma_f32_16x16x32_bf16 a[68:71], v[104:107], v[32:35], a[68:71]
    ds_read_b64_tr_b16 v[86:87], v194 offset:10240
    v_mfma_f32_16x16x32_bf16 a[68:71], v[108:111], v[36:39], a[68:71]
    buffer_load_dwordx4 v8, s[16:19], s48 offen offset:2048 lds
    v_mfma_f32_16x16x32_bf16 a[72:75], v[112:115], v[32:35], a[72:75]
    ds_read_b64_tr_b16 v[88:89], v195 offset:0
    v_mfma_f32_16x16x32_bf16 a[72:75], v[116:119], v[36:39], a[72:75]
    buffer_load_dwordx4 v9, s[16:19], s48 offen offset:3072 lds
    v_mfma_f32_16x16x32_bf16 a[76:79], v[120:123], v[32:35], a[76:79]
    ds_read_b64_tr_b16 v[90:91], v195 offset:2048
    v_mfma_f32_16x16x32_bf16 a[76:79], v[124:127], v[36:39], a[76:79]
    s_waitcnt lgkmcnt(3)
    v_mfma_f32_16x16x32_bf16 a[80:83], v[96:99], v[40:43], a[80:83]
    ds_read_b128 v[32:35], v16 offset:12288
    v_mfma_f32_16x16x32_bf16 a[80:83], v[100:103], v[44:47], a[80:83]
    ds_read_b128 v[36:39], v17 offset:12288
    v_mfma_f32_16x16x32_bf16 a[84:87], v[104:107], v[40:43], a[84:87]
    ds_read_b64_tr_b16 v[92:93], v195 offset:8192
    v_mfma_f32_16x16x32_bf16 a[84:87], v[108:111], v[44:47], a[84:87]
    v_mfma_f32_16x16x32_bf16 a[88:91], v[112:115], v[40:43], a[88:91]
    v_mfma_f32_16x16x32_bf16 a[88:91], v[116:119], v[44:47], a[88:91]
    ds_read_b64_tr_b16 v[94:95], v195 offset:10240
    v_mfma_f32_16x16x32_bf16 a[92:95], v[120:123], v[40:43], a[92:95]
    v_mfma_f32_16x16x32_bf16 a[92:95], v[124:127], v[44:47], a[92:95]
    s_waitcnt lgkmcnt(2)
    v_mfma_f32_16x16x32_bf16 a[96:99], v[96:99], v[32:35], a[96:99]
    ds_read_b128 v[40:43], v16 offset:14336
    v_mfma_f32_16x16x32_bf16 a[96:99], v[100:103], v[36:39], a[96:99]
    ds_read_b128 v[44:47], v17 offset:14336
    v_mfma_f32_16x16x32_bf16 a[100:103], v[104:107], v[32:35], a[100:103]
    v_mfma_f32_16x16x32_bf16 a[100:103], v[108:111], v[36:39], a[100:103]
    v_mfma_f32_16x16x32_bf16 a[104:107], v[112:115], v[32:35], a[104:107]
    v_mfma_f32_16x16x32_bf16 a[104:107], v[116:119], v[36:39], a[104:107]
    v_mfma_f32_16x16x32_bf16 a[108:111], v[120:123], v[32:35], a[108:111]
    v_mfma_f32_16x16x32_bf16 a[108:111], v[124:127], v[36:39], a[108:111]
    s_waitcnt lgkmcnt(0)
    v_mfma_f32_16x16x32_bf16 a[112:115], v[96:99], v[40:43], a[112:115]
    s_waitcnt vmcnt(16)
    s_barrier
    v_mfma_f32_16x16x32_bf16 a[112:115], v[100:103], v[44:47], a[112:115]
    ds_read_b128 v[32:35], v16 offset:32768
    v_mfma_f32_16x16x32_bf16 a[116:119], v[104:107], v[40:43], a[116:119]
    ds_read_b128 v[36:39], v17 offset:32768
    v_mfma_f32_16x16x32_bf16 a[116:119], v[108:111], v[44:47], a[116:119]
    s_add_u32 m0, s40, 0
    s_add_u32 s48, s35, 768
    buffer_load_dwordx4 v2, s[12:15], s48 offen offset:0 lds
    v_mfma_f32_16x16x32_bf16 a[120:123], v[112:115], v[40:43], a[120:123]
    v_mfma_f32_16x16x32_bf16 a[120:123], v[116:119], v[44:47], a[120:123]
    v_mfma_f32_16x16x32_bf16 a[124:127], v[120:123], v[40:43], a[124:127]
    buffer_load_dwordx4 v3, s[12:15], s48 offen offset:1024 lds
    v_mfma_f32_16x16x32_bf16 a[124:127], v[124:127], v[44:47], a[124:127]
    s_waitcnt lgkmcnt(0)
    v_mfma_f32_16x16x32_bf16 a[0:3], v[64:67], v[32:35], a[0:3]
    ds_read_b128 v[40:43], v16 offset:34816
    v_mfma_f32_16x16x32_bf16 a[0:3], v[68:71], v[36:39], a[0:3]
    ds_read_b128 v[44:47], v17 offset:34816
    v_mfma_f32_16x16x32_bf16 a[4:7], v[72:75], v[32:35], a[4:7]
    ds_read_b64_tr_b16 v[96:97], v192 offset:16384
    v_mfma_f32_16x16x32_bf16 a[4:7], v[76:79], v[36:39], a[4:7]
    buffer_load_dwordx4 v4, s[12:15], s48 offen offset:2048 lds
    v_mfma_f32_16x16x32_bf16 a[8:11], v[80:83], v[32:35], a[8:11]
    ds_read_b64_tr_b16 v[98:99], v192 offset:18432
    v_mfma_f32_16x16x32_bf16 a[8:11], v[84:87], v[36:39], a[8:11]
    buffer_load_dwordx4 v5, s[12:15], s48 offen offset:3072 lds
    v_mfma_f32_16x16x32_bf16 a[12:15], v[88:91], v[32:35], a[12:15]
    ds_read_b64_tr_b16 v[100:101], v192 offset:24576
    v_mfma_f32_16x16x32_bf16 a[12:15], v[92:95], v[36:39], a[12:15]
    s_waitcnt lgkmcnt(3)
    v_mfma_f32_16x16x32_bf16 a[16:19], v[64:67], v[40:43], a[16:19]
    ds_read_b128 v[32:35], v16 offset:36864
    v_mfma_f32_16x16x32_bf16 a[16:19], v[68:71], v[44:47], a[16:19]
    ds_read_b128 v[36:39], v17 offset:36864
    s_and_b32 s4, s2, 31
    v_and_b32 v22, 7, v0
    v_lshlrev_b32 v22, 5, v22
    v_mfma_f32_16x16x32_bf16 a[20:23], v[72:75], v[40:43], a[20:23]
    ds_read_b64_tr_b16 v[102:103], v192 offset:26624
    v_add_u32 v22, s4, v22
    v_lshlrev_b32 v202, 7, v22
    v_mfma_f32_16x16x32_bf16 a[20:23], v[76:79], v[44:47], a[20:23]
    s_add_u32 m0, s40, 4096
    s_add_u32 s48, s35, 33536
    buffer_load_dwordx4 v2, s[12:15], s48 offen offset:0 lds
    s_cmp_eq_u32 s32, 0
    s_mov_b32 s5, 0x7ff00000
    s_cselect_b32 s52, 79298560, s5
    s_cselect_b32 s51, 0, s5
    v_mfma_f32_16x16x32_bf16 a[24:27], v[80:83], v[40:43], a[24:27]
    ds_read_b64_tr_b16 v[104:105], v193 offset:16384
    s_lshl_b32 s53, s2, 7
    v_mfma_f32_16x16x32_bf16 a[24:27], v[84:87], v[44:47], a[24:27]
    s_lshl_b32 s5, s32, 2
    s_add_u32 s53, s53, s5
    v_mfma_f32_16x16x32_bf16 a[28:31], v[88:91], v[40:43], a[28:31]
    ds_read_b64_tr_b16 v[106:107], v193 offset:18432
    buffer_load_dwordx4 v3, s[12:15], s48 offen offset:1024 lds
    s_add_u32 s55, s53, 79331328
    s_add_u32 s53, s53, 79298560
    v_mfma_f32_16x16x32_bf16 a[28:31], v[92:95], v[44:47], a[28:31]
    v_mov_b32 v49, 1
    v_lshlrev_b32 v52, 2, v0
    s_waitcnt lgkmcnt(3)
    v_mfma_f32_16x16x32_bf16 a[32:35], v[64:67], v[32:35], a[32:35]
    ds_read_b128 v[40:43], v16 offset:38912
    v_mfma_f32_16x16x32_bf16 a[32:35], v[68:71], v[36:39], a[32:35]
    ds_read_b128 v[44:47], v17 offset:38912
    v_mfma_f32_16x16x32_bf16 a[36:39], v[72:75], v[32:35], a[36:39]
    ds_read_b64_tr_b16 v[108:109], v193 offset:24576
    v_mfma_f32_16x16x32_bf16 a[36:39], v[76:79], v[36:39], a[36:39]
    buffer_load_dwordx4 v4, s[12:15], s48 offen offset:2048 lds
    v_mfma_f32_16x16x32_bf16 a[40:43], v[80:83], v[32:35], a[40:43]
    v_mfma_f32_16x16x32_bf16 a[40:43], v[84:87], v[36:39], a[40:43]
    ds_read_b64_tr_b16 v[110:111], v193 offset:26624
    buffer_load_dwordx4 v5, s[12:15], s48 offen offset:3072 lds
    v_mfma_f32_16x16x32_bf16 a[44:47], v[88:91], v[32:35], a[44:47]
    v_mfma_f32_16x16x32_bf16 a[44:47], v[92:95], v[36:39], a[44:47]
    s_waitcnt lgkmcnt(2)
    v_mfma_f32_16x16x32_bf16 a[48:51], v[64:67], v[40:43], a[48:51]
    ds_read_b128 v[32:35], v16 offset:40960
    v_mfma_f32_16x16x32_bf16 a[48:51], v[68:71], v[44:47], a[48:51]
    ds_read_b128 v[36:39], v17 offset:40960
    v_mfma_f32_16x16x32_bf16 a[52:55], v[72:75], v[40:43], a[52:55]
    ds_read_b64_tr_b16 v[112:113], v194 offset:16384
    v_mfma_f32_16x16x32_bf16 a[52:55], v[76:79], v[44:47], a[52:55]
    s_add_u32 m0, s41, 98304
    s_add_u32 s48, s37, 0
    buffer_load_dwordx4 v6, s[20:23], s48 offen offset:0 lds
    v_mfma_f32_16x16x32_bf16 a[56:59], v[80:83], v[40:43], a[56:59]
    ds_read_b64_tr_b16 v[114:115], v194 offset:18432
    v_mfma_f32_16x16x32_bf16 a[56:59], v[84:87], v[44:47], a[56:59]
    v_mfma_f32_16x16x32_bf16 a[60:63], v[88:91], v[40:43], a[60:63]
    ds_read_b64_tr_b16 v[116:117], v194 offset:24576
    buffer_load_dwordx4 v7, s[20:23], s48 offen offset:1024 lds
    v_mfma_f32_16x16x32_bf16 a[60:63], v[92:95], v[44:47], a[60:63]
    s_waitcnt lgkmcnt(3)
    v_mfma_f32_16x16x32_bf16 a[64:67], v[64:67], v[32:35], a[64:67]
    ds_read_b128 v[40:43], v16 offset:43008
    v_mfma_f32_16x16x32_bf16 a[64:67], v[68:71], v[36:39], a[64:67]
    ds_read_b128 v[44:47], v17 offset:43008
    v_mfma_f32_16x16x32_bf16 a[68:71], v[72:75], v[32:35], a[68:71]
    ds_read_b64_tr_b16 v[118:119], v194 offset:26624
    v_mfma_f32_16x16x32_bf16 a[68:71], v[76:79], v[36:39], a[68:71]
    buffer_load_dwordx4 v8, s[20:23], s48 offen offset:2048 lds
    v_mfma_f32_16x16x32_bf16 a[72:75], v[80:83], v[32:35], a[72:75]
    ds_read_b64_tr_b16 v[120:121], v195 offset:16384
    v_mfma_f32_16x16x32_bf16 a[72:75], v[84:87], v[36:39], a[72:75]
    buffer_load_dwordx4 v9, s[20:23], s48 offen offset:3072 lds
    v_mfma_f32_16x16x32_bf16 a[76:79], v[88:91], v[32:35], a[76:79]
    ds_read_b64_tr_b16 v[122:123], v195 offset:18432
    v_mfma_f32_16x16x32_bf16 a[76:79], v[92:95], v[36:39], a[76:79]
    s_waitcnt lgkmcnt(3)
    v_mfma_f32_16x16x32_bf16 a[80:83], v[64:67], v[40:43], a[80:83]
    ds_read_b128 v[32:35], v16 offset:45056
    v_mfma_f32_16x16x32_bf16 a[80:83], v[68:71], v[44:47], a[80:83]
    ds_read_b128 v[36:39], v17 offset:45056
    v_mfma_f32_16x16x32_bf16 a[84:87], v[72:75], v[40:43], a[84:87]
    ds_read_b64_tr_b16 v[124:125], v195 offset:24576
    v_mfma_f32_16x16x32_bf16 a[84:87], v[76:79], v[44:47], a[84:87]
    v_mfma_f32_16x16x32_bf16 a[88:91], v[80:83], v[40:43], a[88:91]
    v_mfma_f32_16x16x32_bf16 a[88:91], v[84:87], v[44:47], a[88:91]
    ds_read_b64_tr_b16 v[126:127], v195 offset:26624
    v_mfma_f32_16x16x32_bf16 a[92:95], v[88:91], v[40:43], a[92:95]
    v_mfma_f32_16x16x32_bf16 a[92:95], v[92:95], v[44:47], a[92:95]
    s_waitcnt lgkmcnt(2)
    v_mfma_f32_16x16x32_bf16 a[96:99], v[64:67], v[32:35], a[96:99]
    ds_read_b128 v[40:43], v16 offset:47104
    v_mfma_f32_16x16x32_bf16 a[96:99], v[68:71], v[36:39], a[96:99]
    ds_read_b128 v[44:47], v17 offset:47104
    v_mfma_f32_16x16x32_bf16 a[100:103], v[72:75], v[32:35], a[100:103]
    v_mfma_f32_16x16x32_bf16 a[100:103], v[76:79], v[36:39], a[100:103]
    v_mfma_f32_16x16x32_bf16 a[104:107], v[80:83], v[32:35], a[104:107]
    v_mfma_f32_16x16x32_bf16 a[104:107], v[84:87], v[36:39], a[104:107]
    v_mfma_f32_16x16x32_bf16 a[108:111], v[88:91], v[32:35], a[108:111]
    v_mfma_f32_16x16x32_bf16 a[108:111], v[92:95], v[36:39], a[108:111]
    s_waitcnt lgkmcnt(0)
    v_mfma_f32_16x16x32_bf16 a[112:115], v[64:67], v[40:43], a[112:115]
    s_waitcnt vmcnt(16)
    s_barrier
    v_mfma_f32_16x16x32_bf16 a[112:115], v[68:71], v[44:47], a[112:115]
    ds_read_b128 v[32:35], v18 offset:0
    v_mfma_f32_16x16x32_bf16 a[116:119], v[72:75], v[40:43], a[116:119]
    ds_read_b128 v[36:39], v19 offset:0
    v_mfma_f32_16x16x32_bf16 a[116:119], v[76:79], v[44:47], a[116:119]
    s_add_u32 m0, s40, 32768
    s_add_u32 s48, s35, 896
    buffer_load_dwordx4 v2, s[12:15], s48 offen offset:0 lds
    v_mfma_f32_16x16x32_bf16 a[120:123], v[80:83], v[40:43], a[120:123]
    v_mfma_f32_16x16x32_bf16 a[120:123], v[84:87], v[44:47], a[120:123]
    v_mfma_f32_16x16x32_bf16 a[124:127], v[88:91], v[40:43], a[124:127]
    buffer_load_dwordx4 v3, s[12:15], s48 offen offset:1024 lds
    v_mfma_f32_16x16x32_bf16 a[124:127], v[92:95], v[44:47], a[124:127]
    s_waitcnt lgkmcnt(0)
    v_mfma_f32_16x16x32_bf16 a[0:3], v[96:99], v[32:35], a[0:3]
    ds_read_b128 v[40:43], v18 offset:2048
    v_mfma_f32_16x16x32_bf16 a[0:3], v[100:103], v[36:39], a[0:3]
    ds_read_b128 v[44:47], v19 offset:2048
    v_mfma_f32_16x16x32_bf16 a[4:7], v[104:107], v[32:35], a[4:7]
    ds_read_b64_tr_b16 v[64:65], v192 offset:32768
    v_mfma_f32_16x16x32_bf16 a[4:7], v[108:111], v[36:39], a[4:7]
    buffer_load_dwordx4 v4, s[12:15], s48 offen offset:2048 lds
    v_mfma_f32_16x16x32_bf16 a[8:11], v[112:115], v[32:35], a[8:11]
    ds_read_b64_tr_b16 v[66:67], v192 offset:34816
    v_mfma_f32_16x16x32_bf16 a[8:11], v[116:119], v[36:39], a[8:11]
    buffer_load_dwordx4 v5, s[12:15], s48 offen offset:3072 lds
    v_mfma_f32_16x16x32_bf16 a[12:15], v[120:123], v[32:35], a[12:15]
    ds_read_b64_tr_b16 v[68:69], v192 offset:40960
    v_mfma_f32_16x16x32_bf16 a[12:15], v[124:127], v[36:39], a[12:15]
    s_waitcnt lgkmcnt(3)
    v_mfma_f32_16x16x32_bf16 a[16:19], v[96:99], v[40:43], a[16:19]
    ds_read_b128 v[32:35], v18 offset:4096
    v_mfma_f32_16x16x32_bf16 a[16:19], v[100:103], v[44:47], a[16:19]
    ds_read_b128 v[36:39], v19 offset:4096
    v_mfma_f32_16x16x32_bf16 a[20:23], v[104:107], v[40:43], a[20:23]
    ds_read_b64_tr_b16 v[70:71], v192 offset:43008
    v_mfma_f32_16x16x32_bf16 a[20:23], v[108:111], v[44:47], a[20:23]
    s_add_u32 m0, s40, 36864
    s_add_u32 s48, s35, 33664
    buffer_load_dwordx4 v2, s[12:15], s48 offen offset:0 lds
    v_mfma_f32_16x16x32_bf16 a[24:27], v[112:115], v[40:43], a[24:27]
    ds_read_b64_tr_b16 v[72:73], v193 offset:32768
    v_mfma_f32_16x16x32_bf16 a[24:27], v[116:119], v[44:47], a[24:27]
    v_mfma_f32_16x16x32_bf16 a[28:31], v[120:123], v[40:43], a[28:31]
    ds_read_b64_tr_b16 v[74:75], v193 offset:34816
    buffer_load_dwordx4 v3, s[12:15], s48 offen offset:1024 lds
    v_mfma_f32_16x16x32_bf16 a[28:31], v[124:127], v[44:47], a[28:31]
    s_waitcnt lgkmcnt(3)
    v_mfma_f32_16x16x32_bf16 a[32:35], v[96:99], v[32:35], a[32:35]
    ds_read_b128 v[40:43], v18 offset:6144
    v_mfma_f32_16x16x32_bf16 a[32:35], v[100:103], v[36:39], a[32:35]
    ds_read_b128 v[44:47], v19 offset:6144
    v_mfma_f32_16x16x32_bf16 a[36:39], v[104:107], v[32:35], a[36:39]
    ds_read_b64_tr_b16 v[76:77], v193 offset:40960
    v_mfma_f32_16x16x32_bf16 a[36:39], v[108:111], v[36:39], a[36:39]
    buffer_load_dwordx4 v4, s[12:15], s48 offen offset:2048 lds
    v_mfma_f32_16x16x32_bf16 a[40:43], v[112:115], v[32:35], a[40:43]
    v_mfma_f32_16x16x32_bf16 a[40:43], v[116:119], v[36:39], a[40:43]
    ds_read_b64_tr_b16 v[78:79], v193 offset:43008
    buffer_load_dwordx4 v5, s[12:15], s48 offen offset:3072 lds
    v_mfma_f32_16x16x32_bf16 a[44:47], v[120:123], v[32:35], a[44:47]
    v_mfma_f32_16x16x32_bf16 a[44:47], v[124:127], v[36:39], a[44:47]
    s_waitcnt lgkmcnt(2)
    v_mfma_f32_16x16x32_bf16 a[48:51], v[96:99], v[40:43], a[48:51]
    ds_read_b128 v[32:35], v18 offset:8192
    v_mfma_f32_16x16x32_bf16 a[48:51], v[100:103], v[44:47], a[48:51]
    ds_read_b128 v[36:39], v19 offset:8192
    v_mfma_f32_16x16x32_bf16 a[52:55], v[104:107], v[40:43], a[52:55]
    ds_read_b64_tr_b16 v[80:81], v194 offset:32768
    v_mfma_f32_16x16x32_bf16 a[52:55], v[108:111], v[44:47], a[52:55]
    s_add_u32 m0, s41, 114688
    s_add_u32 s48, s37, 524288
    buffer_load_dwordx4 v6, s[20:23], s48 offen offset:0 lds
    v_mfma_f32_16x16x32_bf16 a[56:59], v[112:115], v[40:43], a[56:59]
    ds_read_b64_tr_b16 v[82:83], v194 offset:34816
    v_mfma_f32_16x16x32_bf16 a[56:59], v[116:119], v[44:47], a[56:59]
    v_mfma_f32_16x16x32_bf16 a[60:63], v[120:123], v[40:43], a[60:63]
    ds_read_b64_tr_b16 v[84:85], v194 offset:40960
    buffer_load_dwordx4 v7, s[20:23], s48 offen offset:1024 lds
    v_mfma_f32_16x16x32_bf16 a[60:63], v[124:127], v[44:47], a[60:63]
    s_waitcnt lgkmcnt(3)
    v_mfma_f32_16x16x32_bf16 a[64:67], v[96:99], v[32:35], a[64:67]
    ds_read_b128 v[40:43], v18 offset:10240
    v_mfma_f32_16x16x32_bf16 a[64:67], v[100:103], v[36:39], a[64:67]
    ds_read_b128 v[44:47], v19 offset:10240
    v_mfma_f32_16x16x32_bf16 a[68:71], v[104:107], v[32:35], a[68:71]
    ds_read_b64_tr_b16 v[86:87], v194 offset:43008
    v_mfma_f32_16x16x32_bf16 a[68:71], v[108:111], v[36:39], a[68:71]
    buffer_load_dwordx4 v8, s[20:23], s48 offen offset:2048 lds
    v_mfma_f32_16x16x32_bf16 a[72:75], v[112:115], v[32:35], a[72:75]
    ds_read_b64_tr_b16 v[88:89], v195 offset:32768
    v_mfma_f32_16x16x32_bf16 a[72:75], v[116:119], v[36:39], a[72:75]
    buffer_load_dwordx4 v9, s[20:23], s48 offen offset:3072 lds
    v_mfma_f32_16x16x32_bf16 a[76:79], v[120:123], v[32:35], a[76:79]
    ds_read_b64_tr_b16 v[90:91], v195 offset:34816
    v_mfma_f32_16x16x32_bf16 a[76:79], v[124:127], v[36:39], a[76:79]
    s_waitcnt lgkmcnt(3)
    v_mfma_f32_16x16x32_bf16 a[80:83], v[96:99], v[40:43], a[80:83]
    ds_read_b128 v[32:35], v18 offset:12288
    v_mfma_f32_16x16x32_bf16 a[80:83], v[100:103], v[44:47], a[80:83]
    ds_read_b128 v[36:39], v19 offset:12288
    v_mfma_f32_16x16x32_bf16 a[84:87], v[104:107], v[40:43], a[84:87]
    ds_read_b64_tr_b16 v[92:93], v195 offset:40960
    v_mfma_f32_16x16x32_bf16 a[84:87], v[108:111], v[44:47], a[84:87]
    v_mfma_f32_16x16x32_bf16 a[88:91], v[112:115], v[40:43], a[88:91]
    v_mfma_f32_16x16x32_bf16 a[88:91], v[116:119], v[44:47], a[88:91]
    ds_read_b64_tr_b16 v[94:95], v195 offset:43008
    v_mfma_f32_16x16x32_bf16 a[92:95], v[120:123], v[40:43], a[92:95]
    v_mfma_f32_16x16x32_bf16 a[92:95], v[124:127], v[44:47], a[92:95]
    s_waitcnt lgkmcnt(2)
    v_mfma_f32_16x16x32_bf16 a[96:99], v[96:99], v[32:35], a[96:99]
    ds_read_b128 v[40:43], v18 offset:14336
    v_mfma_f32_16x16x32_bf16 a[96:99], v[100:103], v[36:39], a[96:99]
    ds_read_b128 v[44:47], v19 offset:14336
    v_mfma_f32_16x16x32_bf16 a[100:103], v[104:107], v[32:35], a[100:103]
    v_mfma_f32_16x16x32_bf16 a[100:103], v[108:111], v[36:39], a[100:103]
    v_mfma_f32_16x16x32_bf16 a[104:107], v[112:115], v[32:35], a[104:107]
    v_mfma_f32_16x16x32_bf16 a[104:107], v[116:119], v[36:39], a[104:107]
    v_mfma_f32_16x16x32_bf16 a[108:111], v[120:123], v[32:35], a[108:111]
    v_mfma_f32_16x16x32_bf16 a[108:111], v[124:127], v[36:39], a[108:111]
    s_waitcnt lgkmcnt(0)
    v_mfma_f32_16x16x32_bf16 a[112:115], v[96:99], v[40:43], a[112:115]
    s_waitcnt vmcnt(16)
    s_barrier
    v_mfma_f32_16x16x32_bf16 a[112:115], v[100:103], v[44:47], a[112:115]
    ds_read_b128 v[32:35], v16 offset:0
    v_mfma_f32_16x16x32_bf16 a[116:119], v[104:107], v[40:43], a[116:119]
    ds_read_b128 v[36:39], v17 offset:0
    v_mfma_f32_16x16x32_bf16 a[116:119], v[108:111], v[44:47], a[116:119]
    s_add_u32 m0, s40, 65536
    s_add_u32 s48, s35, 0
    buffer_load_dwordx4 v2, s[12:15], s48 offen offset:0 lds
    v_mfma_f32_16x16x32_bf16 a[120:123], v[112:115], v[40:43], a[120:123]
    v_mfma_f32_16x16x32_bf16 a[120:123], v[116:119], v[44:47], a[120:123]
    v_mfma_f32_16x16x32_bf16 a[124:127], v[120:123], v[40:43], a[124:127]
    buffer_load_dwordx4 v3, s[12:15], s48 offen offset:1024 lds
    v_mfma_f32_16x16x32_bf16 a[124:127], v[124:127], v[44:47], a[124:127]
    s_waitcnt lgkmcnt(0)
    v_mfma_f32_16x16x32_bf16 a[0:3], v[64:67], v[32:35], a[0:3]
    ds_read_b128 v[40:43], v16 offset:2048
    v_mfma_f32_16x16x32_bf16 a[0:3], v[68:71], v[36:39], a[0:3]
    ds_read_b128 v[44:47], v17 offset:2048
    v_mfma_f32_16x16x32_bf16 a[4:7], v[72:75], v[32:35], a[4:7]
    ds_read_b64_tr_b16 v[96:97], v192 offset:49152
    v_mfma_f32_16x16x32_bf16 a[4:7], v[76:79], v[36:39], a[4:7]
    buffer_load_dwordx4 v4, s[12:15], s48 offen offset:2048 lds
    v_mfma_f32_16x16x32_bf16 a[8:11], v[80:83], v[32:35], a[8:11]
    ds_read_b64_tr_b16 v[98:99], v192 offset:51200
    v_mfma_f32_16x16x32_bf16 a[8:11], v[84:87], v[36:39], a[8:11]
    buffer_load_dwordx4 v5, s[12:15], s48 offen offset:3072 lds
    v_mfma_f32_16x16x32_bf16 a[12:15], v[88:91], v[32:35], a[12:15]
    ds_read_b64_tr_b16 v[100:101], v192 offset:57344
    v_mfma_f32_16x16x32_bf16 a[12:15], v[92:95], v[36:39], a[12:15]
    s_waitcnt lgkmcnt(3)
    v_mfma_f32_16x16x32_bf16 a[16:19], v[64:67], v[40:43], a[16:19]
    ds_read_b128 v[32:35], v16 offset:4096
    v_mfma_f32_16x16x32_bf16 a[16:19], v[68:71], v[44:47], a[16:19]
    ds_read_b128 v[36:39], v17 offset:4096
    v_mfma_f32_16x16x32_bf16 a[20:23], v[72:75], v[40:43], a[20:23]
    ds_read_b64_tr_b16 v[102:103], v192 offset:59392
    v_mfma_f32_16x16x32_bf16 a[20:23], v[76:79], v[44:47], a[20:23]
    s_add_u32 m0, s40, 69632
    s_add_u32 s48, s35, 32768
    buffer_load_dwordx4 v2, s[12:15], s48 offen offset:0 lds
    v_mfma_f32_16x16x32_bf16 a[24:27], v[80:83], v[40:43], a[24:27]
    ds_read_b64_tr_b16 v[104:105], v193 offset:49152
    v_mfma_f32_16x16x32_bf16 a[24:27], v[84:87], v[44:47], a[24:27]
    v_mfma_f32_16x16x32_bf16 a[28:31], v[88:91], v[40:43], a[28:31]
    ds_read_b64_tr_b16 v[106:107], v193 offset:51200
    buffer_load_dwordx4 v3, s[12:15], s48 offen offset:1024 lds
    v_mfma_f32_16x16x32_bf16 a[28:31], v[92:95], v[44:47], a[28:31]
    s_waitcnt lgkmcnt(3)
    v_mfma_f32_16x16x32_bf16 a[32:35], v[64:67], v[32:35], a[32:35]
    ds_read_b128 v[40:43], v16 offset:6144
    v_mfma_f32_16x16x32_bf16 a[32:35], v[68:71], v[36:39], a[32:35]
    ds_read_b128 v[44:47], v17 offset:6144
    v_mfma_f32_16x16x32_bf16 a[36:39], v[72:75], v[32:35], a[36:39]
    ds_read_b64_tr_b16 v[108:109], v193 offset:57344
    v_mfma_f32_16x16x32_bf16 a[36:39], v[76:79], v[36:39], a[36:39]
    buffer_load_dwordx4 v4, s[12:15], s48 offen offset:2048 lds
    v_mfma_f32_16x16x32_bf16 a[40:43], v[80:83], v[32:35], a[40:43]
    v_mfma_f32_16x16x32_bf16 a[40:43], v[84:87], v[36:39], a[40:43]
    ds_read_b64_tr_b16 v[110:111], v193 offset:59392
    buffer_load_dwordx4 v5, s[12:15], s48 offen offset:3072 lds
    v_mfma_f32_16x16x32_bf16 a[44:47], v[88:91], v[32:35], a[44:47]
    v_mfma_f32_16x16x32_bf16 a[44:47], v[92:95], v[36:39], a[44:47]
    s_waitcnt lgkmcnt(2)
    v_mfma_f32_16x16x32_bf16 a[48:51], v[64:67], v[40:43], a[48:51]
    ds_read_b128 v[32:35], v16 offset:8192
    v_mfma_f32_16x16x32_bf16 a[48:51], v[68:71], v[44:47], a[48:51]
    ds_read_b128 v[36:39], v17 offset:8192
    v_mfma_f32_16x16x32_bf16 a[52:55], v[72:75], v[40:43], a[52:55]
    ds_read_b64_tr_b16 v[112:113], v194 offset:49152
    v_mfma_f32_16x16x32_bf16 a[52:55], v[76:79], v[44:47], a[52:55]
    s_add_u32 m0, s41, 131072
    s_add_u32 s48, s37, 1048576
    buffer_load_dwordx4 v6, s[20:23], s48 offen offset:0 lds
    v_mfma_f32_16x16x32_bf16 a[56:59], v[80:83], v[40:43], a[56:59]
    ds_read_b64_tr_b16 v[114:115], v194 offset:51200
    v_mfma_f32_16x16x32_bf16 a[56:59], v[84:87], v[44:47], a[56:59]
    v_mfma_f32_16x16x32_bf16 a[60:63], v[88:91], v[40:43], a[60:63]
    ds_read_b64_tr_b16 v[116:117], v194 offset:57344
    buffer_load_dwordx4 v7, s[20:23], s48 offen offset:1024 lds
    v_mfma_f32_16x16x32_bf16 a[60:63], v[92:95], v[44:47], a[60:63]
    s_waitcnt lgkmcnt(3)
    v_mfma_f32_16x16x32_bf16 a[64:67], v[64:67], v[32:35], a[64:67]
    ds_read_b128 v[40:43], v16 offset:10240
    v_mfma_f32_16x16x32_bf16 a[64:67], v[68:71], v[36:39], a[64:67]
    ds_read_b128 v[44:47], v17 offset:10240
    v_mfma_f32_16x16x32_bf16 a[68:71], v[72:75], v[32:35], a[68:71]
    ds_read_b64_tr_b16 v[118:119], v194 offset:59392
    v_mfma_f32_16x16x32_bf16 a[68:71], v[76:79], v[36:39], a[68:71]
    buffer_load_dwordx4 v8, s[20:23], s48 offen offset:2048 lds
    v_mfma_f32_16x16x32_bf16 a[72:75], v[80:83], v[32:35], a[72:75]
    ds_read_b64_tr_b16 v[120:121], v195 offset:49152
    v_mfma_f32_16x16x32_bf16 a[72:75], v[84:87], v[36:39], a[72:75]
    buffer_load_dwordx4 v9, s[20:23], s48 offen offset:3072 lds
    v_mfma_f32_16x16x32_bf16 a[76:79], v[88:91], v[32:35], a[76:79]
    ds_read_b64_tr_b16 v[122:123], v195 offset:51200
    v_mfma_f32_16x16x32_bf16 a[76:79], v[92:95], v[36:39], a[76:79]
    s_waitcnt lgkmcnt(3)
    v_mfma_f32_16x16x32_bf16 a[80:83], v[64:67], v[40:43], a[80:83]
    ds_read_b128 v[32:35], v16 offset:12288
    v_mfma_f32_16x16x32_bf16 a[80:83], v[68:71], v[44:47], a[80:83]
    ds_read_b128 v[36:39], v17 offset:12288
    v_mfma_f32_16x16x32_bf16 a[84:87], v[72:75], v[40:43], a[84:87]
    ds_read_b64_tr_b16 v[124:125], v195 offset:57344
    v_mfma_f32_16x16x32_bf16 a[84:87], v[76:79], v[44:47], a[84:87]
    v_mfma_f32_16x16x32_bf16 a[88:91], v[80:83], v[40:43], a[88:91]
    v_mfma_f32_16x16x32_bf16 a[88:91], v[84:87], v[44:47], a[88:91]
    ds_read_b64_tr_b16 v[126:127], v195 offset:59392
    v_mfma_f32_16x16x32_bf16 a[92:95], v[88:91], v[40:43], a[92:95]
    v_mfma_f32_16x16x32_bf16 a[92:95], v[92:95], v[44:47], a[92:95]
    s_waitcnt lgkmcnt(2)
    v_mfma_f32_16x16x32_bf16 a[96:99], v[64:67], v[32:35], a[96:99]
    ds_read_b128 v[40:43], v16 offset:14336
    v_mfma_f32_16x16x32_bf16 a[96:99], v[68:71], v[36:39], a[96:99]
    ds_read_b128 v[44:47], v17 offset:14336
    v_mfma_f32_16x16x32_bf16 a[100:103], v[72:75], v[32:35], a[100:103]
    v_mfma_f32_16x16x32_bf16 a[100:103], v[76:79], v[36:39], a[100:103]
    v_mfma_f32_16x16x32_bf16 a[104:107], v[80:83], v[32:35], a[104:107]
    v_mfma_f32_16x16x32_bf16 a[104:107], v[84:87], v[36:39], a[104:107]
    v_mfma_f32_16x16x32_bf16 a[108:111], v[88:91], v[32:35], a[108:111]
    v_mfma_f32_16x16x32_bf16 a[108:111], v[92:95], v[36:39], a[108:111]
    s_waitcnt lgkmcnt(0)
    v_mfma_f32_16x16x32_bf16 a[112:115], v[64:67], v[40:43], a[112:115]
    s_waitcnt vmcnt(16)
    s_barrier
    v_mfma_f32_16x16x32_bf16 a[112:115], v[68:71], v[44:47], a[112:115]
    ds_read_b128 v[32:35], v16 offset:32768
    v_mfma_f32_16x16x32_bf16 a[116:119], v[72:75], v[40:43], a[116:119]
    ds_read_b128 v[36:39], v17 offset:32768
    v_mfma_f32_16x16x32_bf16 a[116:119], v[76:79], v[44:47], a[116:119]
    s_add_u32 m0, s40, 0
    s_add_u32 s48, s35, 128
    buffer_load_dwordx4 v2, s[12:15], s48 offen offset:0 lds
    v_mfma_f32_16x16x32_bf16 a[120:123], v[80:83], v[40:43], a[120:123]
    v_mfma_f32_16x16x32_bf16 a[120:123], v[84:87], v[44:47], a[120:123]
    v_mfma_f32_16x16x32_bf16 a[124:127], v[88:91], v[40:43], a[124:127]
    buffer_load_dwordx4 v3, s[12:15], s48 offen offset:1024 lds
    v_mfma_f32_16x16x32_bf16 a[124:127], v[92:95], v[44:47], a[124:127]
    s_waitcnt lgkmcnt(0)
    v_mfma_f32_16x16x32_bf16 a[0:3], v[96:99], v[32:35], a[0:3]
    ds_read_b128 v[40:43], v16 offset:34816
    v_mfma_f32_16x16x32_bf16 a[0:3], v[100:103], v[36:39], a[0:3]
    ds_read_b128 v[44:47], v17 offset:34816
    v_mfma_f32_16x16x32_bf16 a[4:7], v[104:107], v[32:35], a[4:7]
    ds_read_b64_tr_b16 v[64:65], v192 offset:0
    v_mfma_f32_16x16x32_bf16 a[4:7], v[108:111], v[36:39], a[4:7]
    buffer_load_dwordx4 v4, s[12:15], s48 offen offset:2048 lds
    v_mfma_f32_16x16x32_bf16 a[8:11], v[112:115], v[32:35], a[8:11]
    ds_read_b64_tr_b16 v[66:67], v192 offset:2048
    v_mfma_f32_16x16x32_bf16 a[8:11], v[116:119], v[36:39], a[8:11]
    buffer_load_dwordx4 v5, s[12:15], s48 offen offset:3072 lds
    v_mfma_f32_16x16x32_bf16 a[12:15], v[120:123], v[32:35], a[12:15]
    ds_read_b64_tr_b16 v[68:69], v192 offset:8192
    v_mfma_f32_16x16x32_bf16 a[12:15], v[124:127], v[36:39], a[12:15]
    s_waitcnt lgkmcnt(3)
    v_mfma_f32_16x16x32_bf16 a[16:19], v[96:99], v[40:43], a[16:19]
    ds_read_b128 v[32:35], v16 offset:36864
    v_mfma_f32_16x16x32_bf16 a[16:19], v[100:103], v[44:47], a[16:19]
    ds_read_b128 v[36:39], v17 offset:36864
    v_mfma_f32_16x16x32_bf16 a[20:23], v[104:107], v[40:43], a[20:23]
    ds_read_b64_tr_b16 v[70:71], v192 offset:10240
    v_mfma_f32_16x16x32_bf16 a[20:23], v[108:111], v[44:47], a[20:23]
    s_add_u32 m0, s40, 4096
    s_add_u32 s48, s35, 32896
    buffer_load_dwordx4 v2, s[12:15], s48 offen offset:0 lds
    v_mfma_f32_16x16x32_bf16 a[24:27], v[112:115], v[40:43], a[24:27]
    ds_read_b64_tr_b16 v[72:73], v193 offset:0
    v_mfma_f32_16x16x32_bf16 a[24:27], v[116:119], v[44:47], a[24:27]
    v_mfma_f32_16x16x32_bf16 a[28:31], v[120:123], v[40:43], a[28:31]
    ds_read_b64_tr_b16 v[74:75], v193 offset:2048
    buffer_load_dwordx4 v3, s[12:15], s48 offen offset:1024 lds
    v_mfma_f32_16x16x32_bf16 a[28:31], v[124:127], v[44:47], a[28:31]
    s_waitcnt lgkmcnt(3)
    v_mfma_f32_16x16x32_bf16 a[32:35], v[96:99], v[32:35], a[32:35]
    ds_read_b128 v[40:43], v16 offset:38912
    v_mfma_f32_16x16x32_bf16 a[32:35], v[100:103], v[36:39], a[32:35]
    ds_read_b128 v[44:47], v17 offset:38912
    v_mfma_f32_16x16x32_bf16 a[36:39], v[104:107], v[32:35], a[36:39]
    ds_read_b64_tr_b16 v[76:77], v193 offset:8192
    v_mfma_f32_16x16x32_bf16 a[36:39], v[108:111], v[36:39], a[36:39]
    buffer_load_dwordx4 v4, s[12:15], s48 offen offset:2048 lds
    v_mfma_f32_16x16x32_bf16 a[40:43], v[112:115], v[32:35], a[40:43]
    v_mfma_f32_16x16x32_bf16 a[40:43], v[116:119], v[36:39], a[40:43]
    ds_read_b64_tr_b16 v[78:79], v193 offset:10240
    buffer_load_dwordx4 v5, s[12:15], s48 offen offset:3072 lds
    v_mfma_f32_16x16x32_bf16 a[44:47], v[120:123], v[32:35], a[44:47]
    v_mfma_f32_16x16x32_bf16 a[44:47], v[124:127], v[36:39], a[44:47]
    s_waitcnt lgkmcnt(2)
    v_mfma_f32_16x16x32_bf16 a[48:51], v[96:99], v[40:43], a[48:51]
    ds_read_b128 v[32:35], v16 offset:40960
    v_mfma_f32_16x16x32_bf16 a[48:51], v[100:103], v[44:47], a[48:51]
    ds_read_b128 v[36:39], v17 offset:40960
    v_mfma_f32_16x16x32_bf16 a[52:55], v[104:107], v[40:43], a[52:55]
    ds_read_b64_tr_b16 v[80:81], v194 offset:0
    v_mfma_f32_16x16x32_bf16 a[52:55], v[108:111], v[44:47], a[52:55]
    s_add_u32 m0, s41, 147456
    s_add_u32 s48, s37, 1572864
    buffer_load_dwordx4 v6, s[20:23], s48 offen offset:0 lds
    v_mfma_f32_16x16x32_bf16 a[56:59], v[112:115], v[40:43], a[56:59]
    ds_read_b64_tr_b16 v[82:83], v194 offset:2048
    v_mfma_f32_16x16x32_bf16 a[56:59], v[116:119], v[44:47], a[56:59]
    v_mfma_f32_16x16x32_bf16 a[60:63], v[120:123], v[40:43], a[60:63]
    ds_read_b64_tr_b16 v[84:85], v194 offset:8192
    buffer_load_dwordx4 v7, s[20:23], s48 offen offset:1024 lds
    v_mfma_f32_16x16x32_bf16 a[60:63], v[124:127], v[44:47], a[60:63]
    s_waitcnt lgkmcnt(3)
    v_mfma_f32_16x16x32_bf16 a[64:67], v[96:99], v[32:35], a[64:67]
    ds_read_b128 v[40:43], v16 offset:43008
    v_mfma_f32_16x16x32_bf16 a[64:67], v[100:103], v[36:39], a[64:67]
    ds_read_b128 v[44:47], v17 offset:43008
    v_mfma_f32_16x16x32_bf16 a[68:71], v[104:107], v[32:35], a[68:71]
    ds_read_b64_tr_b16 v[86:87], v194 offset:10240
    v_mfma_f32_16x16x32_bf16 a[68:71], v[108:111], v[36:39], a[68:71]
    buffer_load_dwordx4 v8, s[20:23], s48 offen offset:2048 lds
    v_mfma_f32_16x16x32_bf16 a[72:75], v[112:115], v[32:35], a[72:75]
    ds_read_b64_tr_b16 v[88:89], v195 offset:0
    v_mfma_f32_16x16x32_bf16 a[72:75], v[116:119], v[36:39], a[72:75]
    buffer_load_dwordx4 v9, s[20:23], s48 offen offset:3072 lds
    v_mfma_f32_16x16x32_bf16 a[76:79], v[120:123], v[32:35], a[76:79]
    ds_read_b64_tr_b16 v[90:91], v195 offset:2048
    v_mfma_f32_16x16x32_bf16 a[76:79], v[124:127], v[36:39], a[76:79]
    s_waitcnt lgkmcnt(3)
    v_mfma_f32_16x16x32_bf16 a[80:83], v[96:99], v[40:43], a[80:83]
    ds_read_b128 v[32:35], v16 offset:45056
    v_mfma_f32_16x16x32_bf16 a[80:83], v[100:103], v[44:47], a[80:83]
    ds_read_b128 v[36:39], v17 offset:45056
    v_mfma_f32_16x16x32_bf16 a[84:87], v[104:107], v[40:43], a[84:87]
    ds_read_b64_tr_b16 v[92:93], v195 offset:8192
    v_mfma_f32_16x16x32_bf16 a[84:87], v[108:111], v[44:47], a[84:87]
    v_mfma_f32_16x16x32_bf16 a[88:91], v[112:115], v[40:43], a[88:91]
    v_mfma_f32_16x16x32_bf16 a[88:91], v[116:119], v[44:47], a[88:91]
    ds_read_b64_tr_b16 v[94:95], v195 offset:10240
    v_mfma_f32_16x16x32_bf16 a[92:95], v[120:123], v[40:43], a[92:95]
    v_mfma_f32_16x16x32_bf16 a[92:95], v[124:127], v[44:47], a[92:95]
    s_waitcnt lgkmcnt(2)
    v_mfma_f32_16x16x32_bf16 a[96:99], v[96:99], v[32:35], a[96:99]
    ds_read_b128 v[40:43], v16 offset:47104
    v_mfma_f32_16x16x32_bf16 a[96:99], v[100:103], v[36:39], a[96:99]
    ds_read_b128 v[44:47], v17 offset:47104
    v_mfma_f32_16x16x32_bf16 a[100:103], v[104:107], v[32:35], a[100:103]
    v_mfma_f32_16x16x32_bf16 a[100:103], v[108:111], v[36:39], a[100:103]
    v_mfma_f32_16x16x32_bf16 a[104:107], v[112:115], v[32:35], a[104:107]
    v_mfma_f32_16x16x32_bf16 a[104:107], v[116:119], v[36:39], a[104:107]
    v_mfma_f32_16x16x32_bf16 a[108:111], v[120:123], v[32:35], a[108:111]
    v_mfma_f32_16x16x32_bf16 a[108:111], v[124:127], v[36:39], a[108:111]
    s_waitcnt lgkmcnt(0)
    v_mfma_f32_16x16x32_bf16 a[112:115], v[96:99], v[40:43], a[112:115]
    s_waitcnt vmcnt(16)
    s_barrier
    v_mfma_f32_16x16x32_bf16 a[112:115], v[100:103], v[44:47], a[112:115]
    ds_read_b128 v[32:35], v18 offset:0
    v_mfma_f32_16x16x32_bf16 a[116:119], v[104:107], v[40:43], a[116:119]
    ds_read_b128 v[36:39], v19 offset:0
    v_mfma_f32_16x16x32_bf16 a[116:119], v[108:111], v[44:47], a[116:119]
    s_add_u32 m0, s40, 32768
    s_add_u32 s48, s35, 256
    buffer_load_dwordx4 v2, s[12:15], s48 offen offset:0 lds
    v_mfma_f32_16x16x32_bf16 a[120:123], v[112:115], v[40:43], a[120:123]
    v_mfma_f32_16x16x32_bf16 a[120:123], v[116:119], v[44:47], a[120:123]
    v_mfma_f32_16x16x32_bf16 a[124:127], v[120:123], v[40:43], a[124:127]
    buffer_load_dwordx4 v3, s[12:15], s48 offen offset:1024 lds
    v_mfma_f32_16x16x32_bf16 a[124:127], v[124:127], v[44:47], a[124:127]
    s_waitcnt lgkmcnt(0)
    v_mfma_f32_16x16x32_bf16 a[128:131], v[32:35], v[64:67], 0
    ds_read_b128 v[40:43], v18 offset:2048
    v_mfma_f32_16x16x32_bf16 a[128:131], v[36:39], v[68:71], a[128:131]
    ds_read_b128 v[44:47], v19 offset:2048
    v_mfma_f32_16x16x32_bf16 a[132:135], v[32:35], v[72:75], 0
    ds_read_b64_tr_b16 v[96:97], v192 offset:16384
    v_mfma_f32_16x16x32_bf16 a[132:135], v[36:39], v[76:79], a[132:135]
    buffer_load_dwordx4 v4, s[12:15], s48 offen offset:2048 lds
    v_mfma_f32_16x16x32_bf16 a[136:139], v[32:35], v[80:83], 0
    ds_read_b64_tr_b16 v[98:99], v192 offset:18432
    v_mfma_f32_16x16x32_bf16 a[136:139], v[36:39], v[84:87], a[136:139]
    buffer_load_dwordx4 v5, s[12:15], s48 offen offset:3072 lds
    v_mfma_f32_16x16x32_bf16 a[140:143], v[32:35], v[88:91], 0
    ds_read_b64_tr_b16 v[100:101], v192 offset:24576
    v_mfma_f32_16x16x32_bf16 a[140:143], v[36:39], v[92:95], a[140:143]
    s_waitcnt lgkmcnt(3)
    v_mfma_f32_16x16x32_bf16 a[144:147], v[40:43], v[64:67], 0
    ds_read_b128 v[32:35], v18 offset:4096
    v_mfma_f32_16x16x32_bf16 a[144:147], v[44:47], v[68:71], a[144:147]
    ds_read_b128 v[36:39], v19 offset:4096
    v_accvgpr_read_b32 v208, a0
    v_mfma_f32_16x16x32_bf16 a[148:151], v[40:43], v[72:75], 0
    ds_read_b64_tr_b16 v[102:103], v192 offset:26624
    v_accvgpr_read_b32 v209, a1
    v_mfma_f32_16x16x32_bf16 a[148:151], v[44:47], v[76:79], a[148:151]
    s_add_u32 m0, s40, 36864
    s_add_u32 s48, s35, 33024
    buffer_load_dwordx4 v2, s[12:15], s48 offen offset:0 lds
    v_accvgpr_read_b32 v210, a2
    v_mfma_f32_16x16x32_bf16 a[152:155], v[40:43], v[80:83], 0
    ds_read_b64_tr_b16 v[104:105], v193 offset:16384
    v_accvgpr_read_b32 v211, a3
    v_mfma_f32_16x16x32_bf16 a[152:155], v[44:47], v[84:87], a[152:155]
    v_accvgpr_read_b32 v212, a4
    v_mfma_f32_16x16x32_bf16 a[156:159], v[40:43], v[88:91], 0
    ds_read_b64_tr_b16 v[106:107], v193 offset:18432
    buffer_load_dwordx4 v3, s[12:15], s48 offen offset:1024 lds
    v_accvgpr_read_b32 v213, a5
    v_mfma_f32_16x16x32_bf16 a[156:159], v[44:47], v[92:95], a[156:159]
    s_waitcnt lgkmcnt(3)
    v_mfma_f32_16x16x32_bf16 a[160:163], v[32:35], v[64:67], 0
    ds_read_b128 v[40:43], v18 offset:6144
    v_mfma_f32_16x16x32_bf16 a[160:163], v[36:39], v[68:71], a[160:163]
    ds_read_b128 v[44:47], v19 offset:6144
    v_accvgpr_read_b32 v214, a6
    v_mfma_f32_16x16x32_bf16 a[164:167], v[32:35], v[72:75], 0
    ds_read_b64_tr_b16 v[108:109], v193 offset:24576
    v_accvgpr_read_b32 v215, a7
    v_mfma_f32_16x16x32_bf16 a[164:167], v[36:39], v[76:79], a[164:167]
    buffer_load_dwordx4 v4, s[12:15], s48 offen offset:2048 lds
    v_cvt_pk_bf16_f32 v216, v208, v209
    v_mfma_f32_16x16x32_bf16 a[168:171], v[32:35], v[80:83], 0
    v_cvt_pk_bf16_f32 v217, v210, v211
    v_mfma_f32_16x16x32_bf16 a[168:171], v[36:39], v[84:87], a[168:171]
    ds_read_b64_tr_b16 v[110:111], v193 offset:26624
    buffer_load_dwordx4 v5, s[12:15], s48 offen offset:3072 lds
    v_cvt_pk_bf16_f32 v218, v212, v213
    v_mfma_f32_16x16x32_bf16 a[172:175], v[32:35], v[88:91], 0
    v_cvt_pk_bf16_f32 v219, v214, v215
    v_mfma_f32_16x16x32_bf16 a[172:175], v[36:39], v[92:95], a[172:175]
    s_waitcnt lgkmcnt(2)
    v_mfma_f32_16x16x32_bf16 a[176:179], v[40:43], v[64:67], 0
    ds_read_b128 v[32:35], v18 offset:8192
    buffer_store_dwordx4 v[216:219], v15, s[8:11], s84 offen offset:0 sc0 sc1
    v_mfma_f32_16x16x32_bf16 a[176:179], v[44:47], v[68:71], a[176:179]
    ds_read_b128 v[36:39], v19 offset:8192
    v_mfma_f32_16x16x32_bf16 a[180:183], v[40:43], v[72:75], 0
    ds_read_b64_tr_b16 v[112:113], v194 offset:16384
    v_mfma_f32_16x16x32_bf16 a[180:183], v[44:47], v[76:79], a[180:183]
    s_add_u32 m0, s41, 98304
    s_add_u32 s48, s37, 2097152
    buffer_load_dwordx4 v6, s[20:23], s48 offen offset:0 lds
    v_mfma_f32_16x16x32_bf16 a[184:187], v[40:43], v[80:83], 0
    ds_read_b64_tr_b16 v[114:115], v194 offset:18432
    v_mfma_f32_16x16x32_bf16 a[184:187], v[44:47], v[84:87], a[184:187]
    v_mfma_f32_16x16x32_bf16 a[188:191], v[40:43], v[88:91], 0
    ds_read_b64_tr_b16 v[116:117], v194 offset:24576
    buffer_load_dwordx4 v7, s[20:23], s48 offen offset:1024 lds
    v_mfma_f32_16x16x32_bf16 a[188:191], v[44:47], v[92:95], a[188:191]
    s_waitcnt lgkmcnt(3)
    v_mfma_f32_16x16x32_bf16 a[192:195], v[32:35], v[64:67], 0
    ds_read_b128 v[40:43], v18 offset:10240
    v_mfma_f32_16x16x32_bf16 a[192:195], v[36:39], v[68:71], a[192:195]
    ds_read_b128 v[44:47], v19 offset:10240
    v_accvgpr_read_b32 v220, a8
    v_mfma_f32_16x16x32_bf16 a[196:199], v[32:35], v[72:75], 0
    ds_read_b64_tr_b16 v[118:119], v194 offset:26624
    v_accvgpr_read_b32 v221, a9
    v_mfma_f32_16x16x32_bf16 a[196:199], v[36:39], v[76:79], a[196:199]
    buffer_load_dwordx4 v8, s[20:23], s48 offen offset:2048 lds
    v_accvgpr_read_b32 v222, a10
    v_mfma_f32_16x16x32_bf16 a[200:203], v[32:35], v[80:83], 0
    ds_read_b64_tr_b16 v[120:121], v195 offset:16384
    v_accvgpr_read_b32 v223, a11
    v_mfma_f32_16x16x32_bf16 a[200:203], v[36:39], v[84:87], a[200:203]
    buffer_load_dwordx4 v9, s[20:23], s48 offen offset:3072 lds
    v_accvgpr_read_b32 v224, a12
    v_mfma_f32_16x16x32_bf16 a[204:207], v[32:35], v[88:91], 0
    ds_read_b64_tr_b16 v[122:123], v195 offset:18432
    v_accvgpr_read_b32 v225, a13
    v_mfma_f32_16x16x32_bf16 a[204:207], v[36:39], v[92:95], a[204:207]
    s_waitcnt lgkmcnt(3)
    v_mfma_f32_16x16x32_bf16 a[208:211], v[40:43], v[64:67], 0
    ds_read_b128 v[32:35], v18 offset:12288
    v_mfma_f32_16x16x32_bf16 a[208:211], v[44:47], v[68:71], a[208:211]
    ds_read_b128 v[36:39], v19 offset:12288
    v_accvgpr_read_b32 v226, a14
    v_mfma_f32_16x16x32_bf16 a[212:215], v[40:43], v[72:75], 0
    ds_read_b64_tr_b16 v[124:125], v195 offset:24576
    v_accvgpr_read_b32 v227, a15
    v_mfma_f32_16x16x32_bf16 a[212:215], v[44:47], v[76:79], a[212:215]
    v_cvt_pk_bf16_f32 v228, v220, v221
    v_mfma_f32_16x16x32_bf16 a[216:219], v[40:43], v[80:83], 0
    v_cvt_pk_bf16_f32 v229, v222, v223
    v_mfma_f32_16x16x32_bf16 a[216:219], v[44:47], v[84:87], a[216:219]
    ds_read_b64_tr_b16 v[126:127], v195 offset:26624
    v_cvt_pk_bf16_f32 v230, v224, v225
    v_mfma_f32_16x16x32_bf16 a[220:223], v[40:43], v[88:91], 0
    v_cvt_pk_bf16_f32 v231, v226, v227
    v_mfma_f32_16x16x32_bf16 a[220:223], v[44:47], v[92:95], a[220:223]
    s_waitcnt lgkmcnt(2)
    v_mfma_f32_16x16x32_bf16 a[224:227], v[32:35], v[64:67], 0
    ds_read_b128 v[40:43], v18 offset:14336
    buffer_store_dwordx4 v[228:231], v15, s[8:11], s84 offen offset:2048 sc0 sc1
    v_mfma_f32_16x16x32_bf16 a[224:227], v[36:39], v[68:71], a[224:227]
    ds_read_b128 v[44:47], v19 offset:14336
    v_mfma_f32_16x16x32_bf16 a[228:231], v[32:35], v[72:75], 0
    v_mfma_f32_16x16x32_bf16 a[228:231], v[36:39], v[76:79], a[228:231]
    v_mfma_f32_16x16x32_bf16 a[232:235], v[32:35], v[80:83], 0
    v_mfma_f32_16x16x32_bf16 a[232:235], v[36:39], v[84:87], a[232:235]
    v_mfma_f32_16x16x32_bf16 a[236:239], v[32:35], v[88:91], 0
    v_mfma_f32_16x16x32_bf16 a[236:239], v[36:39], v[92:95], a[236:239]
    s_waitcnt lgkmcnt(0)
    v_mfma_f32_16x16x32_bf16 a[240:243], v[40:43], v[64:67], 0
    s_waitcnt vmcnt(18)
    s_barrier
    v_mfma_f32_16x16x32_bf16 a[240:243], v[44:47], v[68:71], a[240:243]
    ds_read_b128 v[32:35], v16 offset:0
    v_accvgpr_read_b32 v208, a16
    v_mfma_f32_16x16x32_bf16 a[244:247], v[40:43], v[72:75], 0
    ds_read_b128 v[36:39], v17 offset:0
    v_accvgpr_read_b32 v209, a17
    v_mfma_f32_16x16x32_bf16 a[244:247], v[44:47], v[76:79], a[244:247]
    s_add_u32 m0, s40, 65536
    s_add_u32 s48, s35, 384
    buffer_load_dwordx4 v2, s[12:15], s48 offen offset:0 lds
    v_accvgpr_read_b32 v210, a18
    v_mfma_f32_16x16x32_bf16 a[248:251], v[40:43], v[80:83], 0
    v_accvgpr_read_b32 v211, a19
    v_mfma_f32_16x16x32_bf16 a[248:251], v[44:47], v[84:87], a[248:251]
    v_accvgpr_read_b32 v212, a20
    v_mfma_f32_16x16x32_bf16 a[252:255], v[40:43], v[88:91], 0
    buffer_load_dwordx4 v3, s[12:15], s48 offen offset:1024 lds
    v_accvgpr_read_b32 v213, a21
    v_mfma_f32_16x16x32_bf16 a[252:255], v[44:47], v[92:95], a[252:255]
    s_waitcnt lgkmcnt(0)
    v_mfma_f32_16x16x32_bf16 a[128:131], v[32:35], v[96:99], a[128:131]
    ds_read_b128 v[40:43], v16 offset:2048
    v_mfma_f32_16x16x32_bf16 a[128:131], v[36:39], v[100:103], a[128:131]
    ds_read_b128 v[44:47], v17 offset:2048
    v_accvgpr_read_b32 v214, a22
    v_mfma_f32_16x16x32_bf16 a[132:135], v[32:35], v[104:107], a[132:135]
    ds_read_b64_tr_b16 v[64:65], v192 offset:32768
    v_accvgpr_read_b32 v215, a23
    v_mfma_f32_16x16x32_bf16 a[132:135], v[36:39], v[108:111], a[132:135]
    buffer_load_dwordx4 v4, s[12:15], s48 offen offset:2048 lds
    v_cvt_pk_bf16_f32 v216, v208, v209
    v_mfma_f32_16x16x32_bf16 a[136:139], v[32:35], v[112:115], a[136:139]
    ds_read_b64_tr_b16 v[66:67], v192 offset:34816
    v_cvt_pk_bf16_f32 v217, v210, v211
    v_mfma_f32_16x16x32_bf16 a[136:139], v[36:39], v[116:119], a[136:139]
    buffer_load_dwordx4 v5, s[12:15], s48 offen offset:3072 lds
    v_cvt_pk_bf16_f32 v218, v212, v213
    v_mfma_f32_16x16x32_bf16 a[140:143], v[32:35], v[120:123], a[140:143]
    ds_read_b64_tr_b16 v[68:69], v192 offset:40960
    v_cvt_pk_bf16_f32 v219, v214, v215
    v_mfma_f32_16x16x32_bf16 a[140:143], v[36:39], v[124:127], a[140:143]
    s_waitcnt lgkmcnt(3)
    v_mfma_f32_16x16x32_bf16 a[144:147], v[40:43], v[96:99], a[144:147]
    ds_read_b128 v[32:35], v16 offset:4096
    buffer_store_dwordx4 v[216:219], v15, s[8:11], s84 offen offset:128 sc0 sc1
    v_mfma_f32_16x16x32_bf16 a[144:147], v[44:47], v[100:103], a[144:147]
    ds_read_b128 v[36:39], v17 offset:4096
    v_mfma_f32_16x16x32_bf16 a[148:151], v[40:43], v[104:107], a[148:151]
    ds_read_b64_tr_b16 v[70:71], v192 offset:43008
    v_mfma_f32_16x16x32_bf16 a[148:151], v[44:47], v[108:111], a[148:151]
    s_add_u32 m0, s40, 69632
    s_add_u32 s48, s35, 33152
    buffer_load_dwordx4 v2, s[12:15], s48 offen offset:0 lds
    v_mfma_f32_16x16x32_bf16 a[152:155], v[40:43], v[112:115], a[152:155]
    ds_read_b64_tr_b16 v[72:73], v193 offset:32768
    v_mfma_f32_16x16x32_bf16 a[152:155], v[44:47], v[116:119], a[152:155]
    v_mfma_f32_16x16x32_bf16 a[156:159], v[40:43], v[120:123], a[156:159]
    ds_read_b64_tr_b16 v[74:75], v193 offset:34816
    buffer_load_dwordx4 v3, s[12:15], s48 offen offset:1024 lds
    v_mfma_f32_16x16x32_bf16 a[156:159], v[44:47], v[124:127], a[156:159]
    s_waitcnt lgkmcnt(3)
    v_mfma_f32_16x16x32_bf16 a[160:163], v[32:35], v[96:99], a[160:163]
    ds_read_b128 v[40:43], v16 offset:6144
    v_mfma_f32_16x16x32_bf16 a[160:163], v[36:39], v[100:103], a[160:163]
    ds_read_b128 v[44:47], v17 offset:6144
    v_accvgpr_read_b32 v220, a24
    v_mfma_f32_16x16x32_bf16 a[164:167], v[32:35], v[104:107], a[164:167]
    ds_read_b64_tr_b16 v[76:77], v193 offset:40960
    v_accvgpr_read_b32 v221, a25
    v_mfma_f32_16x16x32_bf16 a[164:167], v[36:39], v[108:111], a[164:167]
    buffer_load_dwordx4 v4, s[12:15], s48 offen offset:2048 lds
    v_accvgpr_read_b32 v222, a26
    v_mfma_f32_16x16x32_bf16 a[168:171], v[32:35], v[112:115], a[168:171]
    v_accvgpr_read_b32 v223, a27
    v_mfma_f32_16x16x32_bf16 a[168:171], v[36:39], v[116:119], a[168:171]
    ds_read_b64_tr_b16 v[78:79], v193 offset:43008
    buffer_load_dwordx4 v5, s[12:15], s48 offen offset:3072 lds
    v_accvgpr_read_b32 v224, a28
    v_mfma_f32_16x16x32_bf16 a[172:175], v[32:35], v[120:123], a[172:175]
    v_accvgpr_read_b32 v225, a29
    v_mfma_f32_16x16x32_bf16 a[172:175], v[36:39], v[124:127], a[172:175]
    s_waitcnt lgkmcnt(2)
    v_mfma_f32_16x16x32_bf16 a[176:179], v[40:43], v[96:99], a[176:179]
    ds_read_b128 v[32:35], v16 offset:8192
    v_mfma_f32_16x16x32_bf16 a[176:179], v[44:47], v[100:103], a[176:179]
    ds_read_b128 v[36:39], v17 offset:8192
    v_accvgpr_read_b32 v226, a30
    v_mfma_f32_16x16x32_bf16 a[180:183], v[40:43], v[104:107], a[180:183]
    ds_read_b64_tr_b16 v[80:81], v194 offset:32768
    v_accvgpr_read_b32 v227, a31
    v_mfma_f32_16x16x32_bf16 a[180:183], v[44:47], v[108:111], a[180:183]
    s_add_u32 m0, s41, 114688
    s_add_u32 s48, s37, 2621440
    buffer_load_dwordx4 v6, s[20:23], s48 offen offset:0 lds
    v_cvt_pk_bf16_f32 v228, v220, v221
    v_mfma_f32_16x16x32_bf16 a[184:187], v[40:43], v[112:115], a[184:187]
    ds_read_b64_tr_b16 v[82:83], v194 offset:34816
    v_cvt_pk_bf16_f32 v229, v222, v223
    v_mfma_f32_16x16x32_bf16 a[184:187], v[44:47], v[116:119], a[184:187]
    v_cvt_pk_bf16_f32 v230, v224, v225
    v_mfma_f32_16x16x32_bf16 a[188:191], v[40:43], v[120:123], a[188:191]
    ds_read_b64_tr_b16 v[84:85], v194 offset:40960
    buffer_load_dwordx4 v7, s[20:23], s48 offen offset:1024 lds
    v_cvt_pk_bf16_f32 v231, v226, v227
    v_mfma_f32_16x16x32_bf16 a[188:191], v[44:47], v[124:127], a[188:191]
    s_waitcnt lgkmcnt(3)
    v_mfma_f32_16x16x32_bf16 a[192:195], v[32:35], v[96:99], a[192:195]
    ds_read_b128 v[40:43], v16 offset:10240
    buffer_store_dwordx4 v[228:231], v15, s[8:11], s84 offen offset:2176 sc0 sc1
    v_mfma_f32_16x16x32_bf16 a[192:195], v[36:39], v[100:103], a[192:195]
    ds_read_b128 v[44:47], v17 offset:10240
    v_mfma_f32_16x16x32_bf16 a[196:199], v[32:35], v[104:107], a[196:199]
    ds_read_b64_tr_b16 v[86:87], v194 offset:43008
    v_mfma_f32_16x16x32_bf16 a[196:199], v[36:39], v[108:111], a[196:199]
    buffer_load_dwordx4 v8, s[20:23], s48 offen offset:2048 lds
    v_mfma_f32_16x16x32_bf16 a[200:203], v[32:35], v[112:115], a[200:203]
    ds_read_b64_tr_b16 v[88:89], v195 offset:32768
    v_mfma_f32_16x16x32_bf16 a[200:203], v[36:39], v[116:119], a[200:203]
    buffer_load_dwordx4 v9, s[20:23], s48 offen offset:3072 lds
    v_mfma_f32_16x16x32_bf16 a[204:207], v[32:35], v[120:123], a[204:207]
    ds_read_b64_tr_b16 v[90:91], v195 offset:34816
    v_mfma_f32_16x16x32_bf16 a[204:207], v[36:39], v[124:127], a[204:207]
    s_waitcnt lgkmcnt(3)
    v_mfma_f32_16x16x32_bf16 a[208:211], v[40:43], v[96:99], a[208:211]
    ds_read_b128 v[32:35], v16 offset:12288
    v_mfma_f32_16x16x32_bf16 a[208:211], v[44:47], v[100:103], a[208:211]
    ds_read_b128 v[36:39], v17 offset:12288
    v_accvgpr_read_b32 v208, a32
    v_mfma_f32_16x16x32_bf16 a[212:215], v[40:43], v[104:107], a[212:215]
    ds_read_b64_tr_b16 v[92:93], v195 offset:40960
    v_accvgpr_read_b32 v209, a33
    v_mfma_f32_16x16x32_bf16 a[212:215], v[44:47], v[108:111], a[212:215]
    v_accvgpr_read_b32 v210, a34
    v_mfma_f32_16x16x32_bf16 a[216:219], v[40:43], v[112:115], a[216:219]
    v_accvgpr_read_b32 v211, a35
    v_mfma_f32_16x16x32_bf16 a[216:219], v[44:47], v[116:119], a[216:219]
    ds_read_b64_tr_b16 v[94:95], v195 offset:43008
    v_accvgpr_read_b32 v212, a36
    v_mfma_f32_16x16x32_bf16 a[220:223], v[40:43], v[120:123], a[220:223]
    v_accvgpr_read_b32 v213, a37
    v_mfma_f32_16x16x32_bf16 a[220:223], v[44:47], v[124:127], a[220:223]
    s_waitcnt lgkmcnt(2)
    v_mfma_f32_16x16x32_bf16 a[224:227], v[32:35], v[96:99], a[224:227]
    ds_read_b128 v[40:43], v16 offset:14336
    v_mfma_f32_16x16x32_bf16 a[224:227], v[36:39], v[100:103], a[224:227]
    ds_read_b128 v[44:47], v17 offset:14336
    v_accvgpr_read_b32 v214, a38
    v_mfma_f32_16x16x32_bf16 a[228:231], v[32:35], v[104:107], a[228:231]
    v_accvgpr_read_b32 v215, a39
    v_mfma_f32_16x16x32_bf16 a[228:231], v[36:39], v[108:111], a[228:231]
    v_cvt_pk_bf16_f32 v216, v208, v209
    v_mfma_f32_16x16x32_bf16 a[232:235], v[32:35], v[112:115], a[232:235]
    v_cvt_pk_bf16_f32 v217, v210, v211
    v_mfma_f32_16x16x32_bf16 a[232:235], v[36:39], v[116:119], a[232:235]
    v_cvt_pk_bf16_f32 v218, v212, v213
    v_mfma_f32_16x16x32_bf16 a[236:239], v[32:35], v[120:123], a[236:239]
    v_cvt_pk_bf16_f32 v219, v214, v215
    v_mfma_f32_16x16x32_bf16 a[236:239], v[36:39], v[124:127], a[236:239]
    s_waitcnt lgkmcnt(0)
    v_mfma_f32_16x16x32_bf16 a[240:243], v[40:43], v[96:99], a[240:243]
    s_waitcnt vmcnt(20)
    s_barrier
    buffer_store_dwordx4 v[216:219], v15, s[8:11], s85 offen offset:0 sc0 sc1
    v_mfma_f32_16x16x32_bf16 a[240:243], v[44:47], v[100:103], a[240:243]
    ds_read_b128 v[32:35], v16 offset:32768
    v_mfma_f32_16x16x32_bf16 a[244:247], v[40:43], v[104:107], a[244:247]
    ds_read_b128 v[36:39], v17 offset:32768
    v_mfma_f32_16x16x32_bf16 a[244:247], v[44:47], v[108:111], a[244:247]
    s_add_u32 m0, s40, 0
    s_add_u32 s48, s35, 512
    buffer_load_dwordx4 v2, s[12:15], s48 offen offset:0 lds
    v_mfma_f32_16x16x32_bf16 a[248:251], v[40:43], v[112:115], a[248:251]
    v_mfma_f32_16x16x32_bf16 a[248:251], v[44:47], v[116:119], a[248:251]
    v_mfma_f32_16x16x32_bf16 a[252:255], v[40:43], v[120:123], a[252:255]
    buffer_load_dwordx4 v3, s[12:15], s48 offen offset:1024 lds
    v_mfma_f32_16x16x32_bf16 a[252:255], v[44:47], v[124:127], a[252:255]
    s_waitcnt lgkmcnt(0)
    v_mfma_f32_16x16x32_bf16 a[128:131], v[32:35], v[64:67], a[128:131]
    ds_read_b128 v[40:43], v16 offset:34816
    v_mfma_f32_16x16x32_bf16 a[128:131], v[36:39], v[68:71], a[128:131]
    ds_read_b128 v[44:47], v17 offset:34816
    v_accvgpr_read_b32 v220, a40
    v_mfma_f32_16x16x32_bf16 a[132:135], v[32:35], v[72:75], a[132:135]
    ds_read_b64_tr_b16 v[96:97], v192 offset:49152
    v_accvgpr_read_b32 v221, a41
    v_mfma_f32_16x16x32_bf16 a[132:135], v[36:39], v[76:79], a[132:135]
    buffer_load_dwordx4 v4, s[12:15], s48 offen offset:2048 lds
    v_accvgpr_read_b32 v222, a42
    v_mfma_f32_16x16x32_bf16 a[136:139], v[32:35], v[80:83], a[136:139]
    ds_read_b64_tr_b16 v[98:99], v192 offset:51200
    v_accvgpr_read_b32 v223, a43
    v_mfma_f32_16x16x32_bf16 a[136:139], v[36:39], v[84:87], a[136:139]
    buffer_load_dwordx4 v5, s[12:15], s48 offen offset:3072 lds
    v_accvgpr_read_b32 v224, a44
    v_mfma_f32_16x16x32_bf16 a[140:143], v[32:35], v[88:91], a[140:143]
    ds_read_b64_tr_b16 v[100:101], v192 offset:57344
    v_accvgpr_read_b32 v225, a45
    v_mfma_f32_16x16x32_bf16 a[140:143], v[36:39], v[92:95], a[140:143]
    s_waitcnt lgkmcnt(3)
    v_mfma_f32_16x16x32_bf16 a[144:147], v[40:43], v[64:67], a[144:147]
    ds_read_b128 v[32:35], v16 offset:36864
    v_mfma_f32_16x16x32_bf16 a[144:147], v[44:47], v[68:71], a[144:147]
    ds_read_b128 v[36:39], v17 offset:36864
    v_accvgpr_read_b32 v226, a46
    v_mfma_f32_16x16x32_bf16 a[148:151], v[40:43], v[72:75], a[148:151]
    ds_read_b64_tr_b16 v[102:103], v192 offset:59392
    v_accvgpr_read_b32 v227, a47
    v_mfma_f32_16x16x32_bf16 a[148:151], v[44:47], v[76:79], a[148:151]
    s_add_u32 m0, s40, 4096
    s_add_u32 s48, s35, 33280
    buffer_load_dwordx4 v2, s[12:15], s48 offen offset:0 lds
    v_cvt_pk_bf16_f32 v228, v220, v221
    v_mfma_f32_16x16x32_bf16 a[152:155], v[40:43], v[80:83], a[152:155]
    ds_read_b64_tr_b16 v[104:105], v193 offset:49152
    v_cvt_pk_bf16_f32 v229, v222, v223
    v_mfma_f32_16x16x32_bf16 a[152:155], v[44:47], v[84:87], a[152:155]
    v_cvt_pk_bf16_f32 v230, v224, v225
    v_mfma_f32_16x16x32_bf16 a[156:159], v[40:43], v[88:91], a[156:159]
    ds_read_b64_tr_b16 v[106:107], v193 offset:51200
    buffer_load_dwordx4 v3, s[12:15], s48 offen offset:1024 lds
    v_cvt_pk_bf16_f32 v231, v226, v227
    v_mfma_f32_16x16x32_bf16 a[156:159], v[44:47], v[92:95], a[156:159]
    s_waitcnt lgkmcnt(3)
    v_mfma_f32_16x16x32_bf16 a[160:163], v[32:35], v[64:67], a[160:163]
    ds_read_b128 v[40:43], v16 offset:38912
    buffer_store_dwordx4 v[228:231], v15, s[8:11], s85 offen offset:2048 sc0 sc1
    v_mfma_f32_16x16x32_bf16 a[160:163], v[36:39], v[68:71], a[160:163]
    ds_read_b128 v[44:47], v17 offset:38912
    v_mfma_f32_16x16x32_bf16 a[164:167], v[32:35], v[72:75], a[164:167]
    ds_read_b64_tr_b16 v[108:109], v193 offset:57344
    v_mfma_f32_16x16x32_bf16 a[164:167], v[36:39], v[76:79], a[164:167]
    buffer_load_dwordx4 v4, s[12:15], s48 offen offset:2048 lds
    v_mfma_f32_16x16x32_bf16 a[168:171], v[32:35], v[80:83], a[168:171]
    v_mfma_f32_16x16x32_bf16 a[168:171], v[36:39], v[84:87], a[168:171]
    ds_read_b64_tr_b16 v[110:111], v193 offset:59392
    buffer_load_dwordx4 v5, s[12:15], s48 offen offset:3072 lds
    v_mfma_f32_16x16x32_bf16 a[172:175], v[32:35], v[88:91], a[172:175]
    v_mfma_f32_16x16x32_bf16 a[172:175], v[36:39], v[92:95], a[172:175]
    s_waitcnt lgkmcnt(2)
    v_mfma_f32_16x16x32_bf16 a[176:179], v[40:43], v[64:67], a[176:179]
    ds_read_b128 v[32:35], v16 offset:40960
    v_mfma_f32_16x16x32_bf16 a[176:179], v[44:47], v[68:71], a[176:179]
    ds_read_b128 v[36:39], v17 offset:40960
    v_accvgpr_read_b32 v208, a48
    v_mfma_f32_16x16x32_bf16 a[180:183], v[40:43], v[72:75], a[180:183]
    ds_read_b64_tr_b16 v[112:113], v194 offset:49152
    v_accvgpr_read_b32 v209, a49
    v_mfma_f32_16x16x32_bf16 a[180:183], v[44:47], v[76:79], a[180:183]
    s_add_u32 m0, s41, 131072
    s_add_u32 s48, s37, 3145728
    buffer_load_dwordx4 v6, s[20:23], s48 offen offset:0 lds
    v_accvgpr_read_b32 v210, a50
    v_mfma_f32_16x16x32_bf16 a[184:187], v[40:43], v[80:83], a[184:187]
    ds_read_b64_tr_b16 v[114:115], v194 offset:51200
    v_accvgpr_read_b32 v211, a51
    v_mfma_f32_16x16x32_bf16 a[184:187], v[44:47], v[84:87], a[184:187]
    v_accvgpr_read_b32 v212, a52
    v_mfma_f32_16x16x32_bf16 a[188:191], v[40:43], v[88:91], a[188:191]
    ds_read_b64_tr_b16 v[116:117], v194 offset:57344
    buffer_load_dwordx4 v7, s[20:23], s48 offen offset:1024 lds
    v_accvgpr_read_b32 v213, a53
    v_mfma_f32_16x16x32_bf16 a[188:191], v[44:47], v[92:95], a[188:191]
    s_waitcnt lgkmcnt(3)
    v_mfma_f32_16x16x32_bf16 a[192:195], v[32:35], v[64:67], a[192:195]
    ds_read_b128 v[40:43], v16 offset:43008
    v_mfma_f32_16x16x32_bf16 a[192:195], v[36:39], v[68:71], a[192:195]
    ds_read_b128 v[44:47], v17 offset:43008
    v_accvgpr_read_b32 v214, a54
    v_mfma_f32_16x16x32_bf16 a[196:199], v[32:35], v[72:75], a[196:199]
    ds_read_b64_tr_b16 v[118:119], v194 offset:59392
    v_accvgpr_read_b32 v215, a55
    v_mfma_f32_16x16x32_bf16 a[196:199], v[36:39], v[76:79], a[196:199]
    buffer_load_dwordx4 v8, s[20:23], s48 offen offset:2048 lds
    v_cvt_pk_bf16_f32 v216, v208, v209
    v_mfma_f32_16x16x32_bf16 a[200:203], v[32:35], v[80:83], a[200:203]
    ds_read_b64_tr_b16 v[120:121], v195 offset:49152
    v_cvt_pk_bf16_f32 v217, v210, v211
    v_mfma_f32_16x16x32_bf16 a[200:203], v[36:39], v[84:87], a[200:203]
    buffer_load_dwordx4 v9, s[20:23], s48 offen offset:3072 lds
    v_cvt_pk_bf16_f32 v218, v212, v213
    v_mfma_f32_16x16x32_bf16 a[204:207], v[32:35], v[88:91], a[204:207]
    ds_read_b64_tr_b16 v[122:123], v195 offset:51200
    v_cvt_pk_bf16_f32 v219, v214, v215
    v_mfma_f32_16x16x32_bf16 a[204:207], v[36:39], v[92:95], a[204:207]
    s_waitcnt lgkmcnt(3)
    v_mfma_f32_16x16x32_bf16 a[208:211], v[40:43], v[64:67], a[208:211]
    ds_read_b128 v[32:35], v16 offset:45056
    buffer_store_dwordx4 v[216:219], v15, s[8:11], s85 offen offset:128 sc0 sc1
    v_mfma_f32_16x16x32_bf16 a[208:211], v[44:47], v[68:71], a[208:211]
    ds_read_b128 v[36:39], v17 offset:45056
    v_mfma_f32_16x16x32_bf16 a[212:215], v[40:43], v[72:75], a[212:215]
    ds_read_b64_tr_b16 v[124:125], v195 offset:57344
    v_mfma_f32_16x16x32_bf16 a[212:215], v[44:47], v[76:79], a[212:215]
    v_mfma_f32_16x16x32_bf16 a[216:219], v[40:43], v[80:83], a[216:219]
    v_mfma_f32_16x16x32_bf16 a[216:219], v[44:47], v[84:87], a[216:219]
    ds_read_b64_tr_b16 v[126:127], v195 offset:59392
    v_mfma_f32_16x16x32_bf16 a[220:223], v[40:43], v[88:91], a[220:223]
    v_mfma_f32_16x16x32_bf16 a[220:223], v[44:47], v[92:95], a[220:223]
    s_waitcnt lgkmcnt(2)
    v_mfma_f32_16x16x32_bf16 a[224:227], v[32:35], v[64:67], a[224:227]
    ds_read_b128 v[40:43], v16 offset:47104
    v_mfma_f32_16x16x32_bf16 a[224:227], v[36:39], v[68:71], a[224:227]
    ds_read_b128 v[44:47], v17 offset:47104
    v_accvgpr_read_b32 v220, a56
    v_mfma_f32_16x16x32_bf16 a[228:231], v[32:35], v[72:75], a[228:231]
    v_accvgpr_read_b32 v221, a57
    v_mfma_f32_16x16x32_bf16 a[228:231], v[36:39], v[76:79], a[228:231]
    v_accvgpr_read_b32 v222, a58
    v_mfma_f32_16x16x32_bf16 a[232:235], v[32:35], v[80:83], a[232:235]
    v_accvgpr_read_b32 v223, a59
    v_mfma_f32_16x16x32_bf16 a[232:235], v[36:39], v[84:87], a[232:235]
    v_accvgpr_read_b32 v224, a60
    v_mfma_f32_16x16x32_bf16 a[236:239], v[32:35], v[88:91], a[236:239]
    v_accvgpr_read_b32 v225, a61
    v_mfma_f32_16x16x32_bf16 a[236:239], v[36:39], v[92:95], a[236:239]
    s_waitcnt lgkmcnt(0)
    v_mfma_f32_16x16x32_bf16 a[240:243], v[40:43], v[64:67], a[240:243]
    s_waitcnt vmcnt(20)
    s_barrier
    v_mfma_f32_16x16x32_bf16 a[240:243], v[44:47], v[68:71], a[240:243]
    ds_read_b128 v[32:35], v18 offset:0
    v_accvgpr_read_b32 v226, a62
    v_mfma_f32_16x16x32_bf16 a[244:247], v[40:43], v[72:75], a[244:247]
    ds_read_b128 v[36:39], v19 offset:0
    v_accvgpr_read_b32 v227, a63
    v_mfma_f32_16x16x32_bf16 a[244:247], v[44:47], v[76:79], a[244:247]
    s_add_u32 m0, s40, 32768
    s_add_u32 s48, s35, 640
    buffer_load_dwordx4 v2, s[12:15], s48 offen offset:0 lds
    v_cvt_pk_bf16_f32 v228, v220, v221
    v_mfma_f32_16x16x32_bf16 a[248:251], v[40:43], v[80:83], a[248:251]
    v_cvt_pk_bf16_f32 v229, v222, v223
    v_mfma_f32_16x16x32_bf16 a[248:251], v[44:47], v[84:87], a[248:251]
    v_cvt_pk_bf16_f32 v230, v224, v225
    v_mfma_f32_16x16x32_bf16 a[252:255], v[40:43], v[88:91], a[252:255]
    buffer_load_dwordx4 v3, s[12:15], s48 offen offset:1024 lds
    v_cvt_pk_bf16_f32 v231, v226, v227
    v_mfma_f32_16x16x32_bf16 a[252:255], v[44:47], v[92:95], a[252:255]
    s_waitcnt lgkmcnt(0)
    v_mfma_f32_16x16x32_bf16 a[128:131], v[32:35], v[96:99], a[128:131]
    ds_read_b128 v[40:43], v18 offset:2048
    buffer_store_dwordx4 v[228:231], v15, s[8:11], s85 offen offset:2176 sc0 sc1
    v_mfma_f32_16x16x32_bf16 a[128:131], v[36:39], v[100:103], a[128:131]
    ds_read_b128 v[44:47], v19 offset:2048
    v_mfma_f32_16x16x32_bf16 a[132:135], v[32:35], v[104:107], a[132:135]
    ds_read_b64_tr_b16 v[64:65], v192 offset:0
    v_mfma_f32_16x16x32_bf16 a[132:135], v[36:39], v[108:111], a[132:135]
    buffer_load_dwordx4 v4, s[12:15], s48 offen offset:2048 lds
    v_mfma_f32_16x16x32_bf16 a[136:139], v[32:35], v[112:115], a[136:139]
    ds_read_b64_tr_b16 v[66:67], v192 offset:2048
    v_mfma_f32_16x16x32_bf16 a[136:139], v[36:39], v[116:119], a[136:139]
    buffer_load_dwordx4 v5, s[12:15], s48 offen offset:3072 lds
    v_mfma_f32_16x16x32_bf16 a[140:143], v[32:35], v[120:123], a[140:143]
    ds_read_b64_tr_b16 v[68:69], v192 offset:8192
    v_mfma_f32_16x16x32_bf16 a[140:143], v[36:39], v[124:127], a[140:143]
    s_waitcnt lgkmcnt(3)
    v_mfma_f32_16x16x32_bf16 a[144:147], v[40:43], v[96:99], a[144:147]
    ds_read_b128 v[32:35], v18 offset:4096
    v_mfma_f32_16x16x32_bf16 a[144:147], v[44:47], v[100:103], a[144:147]
    ds_read_b128 v[36:39], v19 offset:4096
    v_accvgpr_read_b32 v208, a64
    v_mfma_f32_16x16x32_bf16 a[148:151], v[40:43], v[104:107], a[148:151]
    ds_read_b64_tr_b16 v[70:71], v192 offset:10240
    v_accvgpr_read_b32 v209, a65
    v_mfma_f32_16x16x32_bf16 a[148:151], v[44:47], v[108:111], a[148:151]
    s_add_u32 m0, s40, 36864
    s_add_u32 s48, s35, 33408
    buffer_load_dwordx4 v2, s[12:15], s48 offen offset:0 lds
    v_accvgpr_read_b32 v210, a66
    v_mfma_f32_16x16x32_bf16 a[152:155], v[40:43], v[112:115], a[152:155]
    ds_read_b64_tr_b16 v[72:73], v193 offset:0
    v_accvgpr_read_b32 v211, a67
    v_mfma_f32_16x16x32_bf16 a[152:155], v[44:47], v[116:119], a[152:155]
    v_accvgpr_read_b32 v212, a68
    v_mfma_f32_16x16x32_bf16 a[156:159], v[40:43], v[120:123], a[156:159]
    ds_read_b64_tr_b16 v[74:75], v193 offset:2048
    buffer_load_dwordx4 v3, s[12:15], s48 offen offset:1024 lds
    v_accvgpr_read_b32 v213, a69
    v_mfma_f32_16x16x32_bf16 a[156:159], v[44:47], v[124:127], a[156:159]
    s_waitcnt lgkmcnt(3)
    v_mfma_f32_16x16x32_bf16 a[160:163], v[32:35], v[96:99], a[160:163]
    ds_read_b128 v[40:43], v18 offset:6144
    v_mfma_f32_16x16x32_bf16 a[160:163], v[36:39], v[100:103], a[160:163]
    ds_read_b128 v[44:47], v19 offset:6144
    v_accvgpr_read_b32 v214, a70
    v_mfma_f32_16x16x32_bf16 a[164:167], v[32:35], v[104:107], a[164:167]
    ds_read_b64_tr_b16 v[76:77], v193 offset:8192
    v_accvgpr_read_b32 v215, a71
    v_mfma_f32_16x16x32_bf16 a[164:167], v[36:39], v[108:111], a[164:167]
    buffer_load_dwordx4 v4, s[12:15], s48 offen offset:2048 lds
    v_cvt_pk_bf16_f32 v216, v208, v209
    v_mfma_f32_16x16x32_bf16 a[168:171], v[32:35], v[112:115], a[168:171]
    v_cvt_pk_bf16_f32 v217, v210, v211
    v_mfma_f32_16x16x32_bf16 a[168:171], v[36:39], v[116:119], a[168:171]
    ds_read_b64_tr_b16 v[78:79], v193 offset:10240
    buffer_load_dwordx4 v5, s[12:15], s48 offen offset:3072 lds
    buffer_load_dword v203, v52, s[28:31], s51 offen sc1
    v_cvt_pk_bf16_f32 v218, v212, v213
    v_mfma_f32_16x16x32_bf16 a[172:175], v[32:35], v[120:123], a[172:175]
    v_cvt_pk_bf16_f32 v219, v214, v215
    v_mfma_f32_16x16x32_bf16 a[172:175], v[36:39], v[124:127], a[172:175]
    s_waitcnt lgkmcnt(2)
    v_mfma_f32_16x16x32_bf16 a[176:179], v[40:43], v[96:99], a[176:179]
    ds_read_b128 v[32:35], v18 offset:8192
    buffer_store_dwordx4 v[216:219], v15, s[8:11], s86 offen offset:0 sc0 sc1
    v_mfma_f32_16x16x32_bf16 a[176:179], v[44:47], v[100:103], a[176:179]
    ds_read_b128 v[36:39], v19 offset:8192
    v_mfma_f32_16x16x32_bf16 a[180:183], v[40:43], v[104:107], a[180:183]
    ds_read_b64_tr_b16 v[80:81], v194 offset:0
    v_mfma_f32_16x16x32_bf16 a[180:183], v[44:47], v[108:111], a[180:183]
    s_add_u32 m0, s41, 147456
    s_add_u32 s48, s37, 3670016
    buffer_load_dwordx4 v6, s[20:23], s48 offen offset:0 lds
    v_mfma_f32_16x16x32_bf16 a[184:187], v[40:43], v[112:115], a[184:187]
    ds_read_b64_tr_b16 v[82:83], v194 offset:2048
    v_mfma_f32_16x16x32_bf16 a[184:187], v[44:47], v[116:119], a[184:187]
    v_mfma_f32_16x16x32_bf16 a[188:191], v[40:43], v[120:123], a[188:191]
    ds_read_b64_tr_b16 v[84:85], v194 offset:8192
    buffer_load_dwordx4 v7, s[20:23], s48 offen offset:1024 lds
    v_mfma_f32_16x16x32_bf16 a[188:191], v[44:47], v[124:127], a[188:191]
    s_waitcnt lgkmcnt(3)
    v_mfma_f32_16x16x32_bf16 a[192:195], v[32:35], v[96:99], a[192:195]
    ds_read_b128 v[40:43], v18 offset:10240
    v_mfma_f32_16x16x32_bf16 a[192:195], v[36:39], v[100:103], a[192:195]
    ds_read_b128 v[44:47], v19 offset:10240
    v_accvgpr_read_b32 v220, a72
    v_mfma_f32_16x16x32_bf16 a[196:199], v[32:35], v[104:107], a[196:199]
    ds_read_b64_tr_b16 v[86:87], v194 offset:10240
    v_accvgpr_read_b32 v221, a73
    v_mfma_f32_16x16x32_bf16 a[196:199], v[36:39], v[108:111], a[196:199]
    buffer_load_dwordx4 v8, s[20:23], s48 offen offset:2048 lds
    v_accvgpr_read_b32 v222, a74
    v_mfma_f32_16x16x32_bf16 a[200:203], v[32:35], v[112:115], a[200:203]
    ds_read_b64_tr_b16 v[88:89], v195 offset:0
    v_accvgpr_read_b32 v223, a75
    v_mfma_f32_16x16x32_bf16 a[200:203], v[36:39], v[116:119], a[200:203]
    buffer_load_dwordx4 v9, s[20:23], s48 offen offset:3072 lds
    v_accvgpr_read_b32 v224, a76
    v_mfma_f32_16x16x32_bf16 a[204:207], v[32:35], v[120:123], a[204:207]
    ds_read_b64_tr_b16 v[90:91], v195 offset:2048
    v_accvgpr_read_b32 v225, a77
    v_mfma_f32_16x16x32_bf16 a[204:207], v[36:39], v[124:127], a[204:207]
    s_waitcnt lgkmcnt(3)
    v_mfma_f32_16x16x32_bf16 a[208:211], v[40:43], v[96:99], a[208:211]
    ds_read_b128 v[32:35], v18 offset:12288
    v_mfma_f32_16x16x32_bf16 a[208:211], v[44:47], v[100:103], a[208:211]
    ds_read_b128 v[36:39], v19 offset:12288
    v_accvgpr_read_b32 v226, a78
    v_mfma_f32_16x16x32_bf16 a[212:215], v[40:43], v[104:107], a[212:215]
    ds_read_b64_tr_b16 v[92:93], v195 offset:8192
    v_accvgpr_read_b32 v227, a79
    v_mfma_f32_16x16x32_bf16 a[212:215], v[44:47], v[108:111], a[212:215]
    v_cvt_pk_bf16_f32 v228, v220, v221
    v_mfma_f32_16x16x32_bf16 a[216:219], v[40:43], v[112:115], a[216:219]
    v_cvt_pk_bf16_f32 v229, v222, v223
    v_mfma_f32_16x16x32_bf16 a[216:219], v[44:47], v[116:119], a[216:219]
    ds_read_b64_tr_b16 v[94:95], v195 offset:10240
    v_cvt_pk_bf16_f32 v230, v224, v225
    v_mfma_f32_16x16x32_bf16 a[220:223], v[40:43], v[120:123], a[220:223]
    v_cvt_pk_bf16_f32 v231, v226, v227
    v_mfma_f32_16x16x32_bf16 a[220:223], v[44:47], v[124:127], a[220:223]
    s_waitcnt lgkmcnt(2)
    v_mfma_f32_16x16x32_bf16 a[224:227], v[32:35], v[96:99], a[224:227]
    ds_read_b128 v[40:43], v18 offset:14336
    buffer_store_dwordx4 v[228:231], v15, s[8:11], s86 offen offset:2048 sc0 sc1
    v_mfma_f32_16x16x32_bf16 a[224:227], v[36:39], v[100:103], a[224:227]
    ds_read_b128 v[44:47], v19 offset:14336
    v_mfma_f32_16x16x32_bf16 a[228:231], v[32:35], v[104:107], a[228:231]
    v_mfma_f32_16x16x32_bf16 a[228:231], v[36:39], v[108:111], a[228:231]
    v_mfma_f32_16x16x32_bf16 a[232:235], v[32:35], v[112:115], a[232:235]
    v_mfma_f32_16x16x32_bf16 a[232:235], v[36:39], v[116:119], a[232:235]
    v_mfma_f32_16x16x32_bf16 a[236:239], v[32:35], v[120:123], a[236:239]
    v_mfma_f32_16x16x32_bf16 a[236:239], v[36:39], v[124:127], a[236:239]
    s_waitcnt lgkmcnt(0)
    v_mfma_f32_16x16x32_bf16 a[240:243], v[40:43], v[96:99], a[240:243]
    s_waitcnt vmcnt(21)
    s_barrier
    v_mfma_f32_16x16x32_bf16 a[240:243], v[44:47], v[100:103], a[240:243]
    ds_read_b128 v[32:35], v16 offset:0
    v_accvgpr_read_b32 v208, a80
    v_mfma_f32_16x16x32_bf16 a[244:247], v[40:43], v[104:107], a[244:247]
    ds_read_b128 v[36:39], v17 offset:0
    v_accvgpr_read_b32 v209, a81
    v_mfma_f32_16x16x32_bf16 a[244:247], v[44:47], v[108:111], a[244:247]
    s_add_u32 m0, s40, 65536
    s_add_u32 s48, s35, 768
    buffer_load_dwordx4 v2, s[12:15], s48 offen offset:0 lds
    v_accvgpr_read_b32 v210, a82
    v_mfma_f32_16x16x32_bf16 a[248:251], v[40:43], v[112:115], a[248:251]
    v_accvgpr_read_b32 v211, a83
    v_mfma_f32_16x16x32_bf16 a[248:251], v[44:47], v[116:119], a[248:251]
    v_accvgpr_read_b32 v212, a84
    v_mfma_f32_16x16x32_bf16 a[252:255], v[40:43], v[120:123], a[252:255]
    buffer_load_dwordx4 v3, s[12:15], s48 offen offset:1024 lds
    v_accvgpr_read_b32 v213, a85
    v_mfma_f32_16x16x32_bf16 a[252:255], v[44:47], v[124:127], a[252:255]
    s_waitcnt lgkmcnt(0)
    v_mfma_f32_16x16x32_bf16 a[128:131], v[32:35], v[64:67], a[128:131]
    ds_read_b128 v[40:43], v16 offset:2048
    v_mfma_f32_16x16x32_bf16 a[128:131], v[36:39], v[68:71], a[128:131]
    ds_read_b128 v[44:47], v17 offset:2048
    v_accvgpr_read_b32 v214, a86
    v_mfma_f32_16x16x32_bf16 a[132:135], v[32:35], v[72:75], a[132:135]
    ds_read_b64_tr_b16 v[96:97], v192 offset:16384
    v_accvgpr_read_b32 v215, a87
    v_mfma_f32_16x16x32_bf16 a[132:135], v[36:39], v[76:79], a[132:135]
    buffer_load_dwordx4 v4, s[12:15], s48 offen offset:2048 lds
    v_cvt_pk_bf16_f32 v216, v208, v209
    v_mfma_f32_16x16x32_bf16 a[136:139], v[32:35], v[80:83], a[136:139]
    ds_read_b64_tr_b16 v[98:99], v192 offset:18432
    v_cvt_pk_bf16_f32 v217, v210, v211
    v_mfma_f32_16x16x32_bf16 a[136:139], v[36:39], v[84:87], a[136:139]
    buffer_load_dwordx4 v5, s[12:15], s48 offen offset:3072 lds
    v_cvt_pk_bf16_f32 v218, v212, v213
    v_mfma_f32_16x16x32_bf16 a[140:143], v[32:35], v[88:91], a[140:143]
    ds_read_b64_tr_b16 v[100:101], v192 offset:24576
    v_cvt_pk_bf16_f32 v219, v214, v215
    v_mfma_f32_16x16x32_bf16 a[140:143], v[36:39], v[92:95], a[140:143]
    s_waitcnt lgkmcnt(3)
    v_mfma_f32_16x16x32_bf16 a[144:147], v[40:43], v[64:67], a[144:147]
    ds_read_b128 v[32:35], v16 offset:4096
    buffer_store_dwordx4 v[216:219], v15, s[8:11], s86 offen offset:128 sc0 sc1
    v_mfma_f32_16x16x32_bf16 a[144:147], v[44:47], v[68:71], a[144:147]
    ds_read_b128 v[36:39], v17 offset:4096
    v_mfma_f32_16x16x32_bf16 a[148:151], v[40:43], v[72:75], a[148:151]
    ds_read_b64_tr_b16 v[102:103], v192 offset:26624
    v_mfma_f32_16x16x32_bf16 a[148:151], v[44:47], v[76:79], a[148:151]
    s_add_u32 m0, s40, 69632
    s_add_u32 s48, s35, 33536
    buffer_load_dwordx4 v2, s[12:15], s48 offen offset:0 lds
    v_mfma_f32_16x16x32_bf16 a[152:155], v[40:43], v[80:83], a[152:155]
    ds_read_b64_tr_b16 v[104:105], v193 offset:16384
    v_mfma_f32_16x16x32_bf16 a[152:155], v[44:47], v[84:87], a[152:155]
    v_mfma_f32_16x16x32_bf16 a[156:159], v[40:43], v[88:91], a[156:159]
    ds_read_b64_tr_b16 v[106:107], v193 offset:18432
    buffer_load_dwordx4 v3, s[12:15], s48 offen offset:1024 lds
    v_mfma_f32_16x16x32_bf16 a[156:159], v[44:47], v[92:95], a[156:159]
    s_waitcnt lgkmcnt(3)
    v_mfma_f32_16x16x32_bf16 a[160:163], v[32:35], v[64:67], a[160:163]
    ds_read_b128 v[40:43], v16 offset:6144
    v_mfma_f32_16x16x32_bf16 a[160:163], v[36:39], v[68:71], a[160:163]
    ds_read_b128 v[44:47], v17 offset:6144
    v_accvgpr_read_b32 v220, a88
    v_mfma_f32_16x16x32_bf16 a[164:167], v[32:35], v[72:75], a[164:167]
    ds_read_b64_tr_b16 v[108:109], v193 offset:24576
    v_accvgpr_read_b32 v221, a89
    v_mfma_f32_16x16x32_bf16 a[164:167], v[36:39], v[76:79], a[164:167]
    buffer_load_dwordx4 v4, s[12:15], s48 offen offset:2048 lds
    v_accvgpr_read_b32 v222, a90
    v_mfma_f32_16x16x32_bf16 a[168:171], v[32:35], v[80:83], a[168:171]
    v_accvgpr_read_b32 v223, a91
    v_mfma_f32_16x16x32_bf16 a[168:171], v[36:39], v[84:87], a[168:171]
    ds_read_b64_tr_b16 v[110:111], v193 offset:26624
    buffer_load_dwordx4 v5, s[12:15], s48 offen offset:3072 lds
    v_accvgpr_read_b32 v224, a92
    v_mfma_f32_16x16x32_bf16 a[172:175], v[32:35], v[88:91], a[172:175]
    v_accvgpr_read_b32 v225, a93
    v_mfma_f32_16x16x32_bf16 a[172:175], v[36:39], v[92:95], a[172:175]
    s_waitcnt lgkmcnt(2)
    v_mfma_f32_16x16x32_bf16 a[176:179], v[40:43], v[64:67], a[176:179]
    ds_read_b128 v[32:35], v16 offset:8192
    v_mfma_f32_16x16x32_bf16 a[176:179], v[44:47], v[68:71], a[176:179]
    ds_read_b128 v[36:39], v17 offset:8192
    v_accvgpr_read_b32 v226, a94
    v_mfma_f32_16x16x32_bf16 a[180:183], v[40:43], v[72:75], a[180:183]
    ds_read_b64_tr_b16 v[112:113], v194 offset:16384
    v_accvgpr_read_b32 v227, a95
    v_mfma_f32_16x16x32_bf16 a[180:183], v[44:47], v[76:79], a[180:183]
    s_add_u32 m0, s41, 98304
    s_add_u32 s48, s38, 0
    buffer_load_dwordx4 v10, s[56:59], s48 offen offset:0 lds
    v_cvt_pk_bf16_f32 v228, v220, v221
    v_mfma_f32_16x16x32_bf16 a[184:187], v[40:43], v[80:83], a[184:187]
    ds_read_b64_tr_b16 v[114:115], v194 offset:18432
    v_cvt_pk_bf16_f32 v229, v222, v223
    v_mfma_f32_16x16x32_bf16 a[184:187], v[44:47], v[84:87], a[184:187]
    v_cvt_pk_bf16_f32 v230, v224, v225
    v_mfma_f32_16x16x32_bf16 a[188:191], v[40:43], v[88:91], a[188:191]
    ds_read_b64_tr_b16 v[116:117], v194 offset:24576
    buffer_load_dwordx4 v11, s[56:59], s48 offen offset:1024 lds
    v_cvt_pk_bf16_f32 v231, v226, v227
    v_mfma_f32_16x16x32_bf16 a[188:191], v[44:47], v[92:95], a[188:191]
    s_waitcnt lgkmcnt(3)
    v_mfma_f32_16x16x32_bf16 a[192:195], v[32:35], v[64:67], a[192:195]
    ds_read_b128 v[40:43], v16 offset:10240
    buffer_store_dwordx4 v[228:231], v15, s[8:11], s86 offen offset:2176 sc0 sc1
    v_mfma_f32_16x16x32_bf16 a[192:195], v[36:39], v[68:71], a[192:195]
    ds_read_b128 v[44:47], v17 offset:10240
    v_mfma_f32_16x16x32_bf16 a[196:199], v[32:35], v[72:75], a[196:199]
    ds_read_b64_tr_b16 v[118:119], v194 offset:26624
    v_mfma_f32_16x16x32_bf16 a[196:199], v[36:39], v[76:79], a[196:199]
    buffer_load_dwordx4 v12, s[56:59], s48 offen offset:2048 lds
    v_mfma_f32_16x16x32_bf16 a[200:203], v[32:35], v[80:83], a[200:203]
    ds_read_b64_tr_b16 v[120:121], v195 offset:16384
    v_mfma_f32_16x16x32_bf16 a[200:203], v[36:39], v[84:87], a[200:203]
    buffer_load_dwordx4 v13, s[56:59], s48 offen offset:3072 lds
    v_mfma_f32_16x16x32_bf16 a[204:207], v[32:35], v[88:91], a[204:207]
    ds_read_b64_tr_b16 v[122:123], v195 offset:18432
    v_mfma_f32_16x16x32_bf16 a[204:207], v[36:39], v[92:95], a[204:207]
    s_waitcnt lgkmcnt(3)
    v_mfma_f32_16x16x32_bf16 a[208:211], v[40:43], v[64:67], a[208:211]
    ds_read_b128 v[32:35], v16 offset:12288
    v_mfma_f32_16x16x32_bf16 a[208:211], v[44:47], v[68:71], a[208:211]
    ds_read_b128 v[36:39], v17 offset:12288
    v_accvgpr_read_b32 v208, a96
    v_mfma_f32_16x16x32_bf16 a[212:215], v[40:43], v[72:75], a[212:215]
    ds_read_b64_tr_b16 v[124:125], v195 offset:24576
    v_accvgpr_read_b32 v209, a97
    v_mfma_f32_16x16x32_bf16 a[212:215], v[44:47], v[76:79], a[212:215]
    v_accvgpr_read_b32 v210, a98
    v_mfma_f32_16x16x32_bf16 a[216:219], v[40:43], v[80:83], a[216:219]
    v_accvgpr_read_b32 v211, a99
    v_mfma_f32_16x16x32_bf16 a[216:219], v[44:47], v[84:87], a[216:219]
    ds_read_b64_tr_b16 v[126:127], v195 offset:26624
    v_accvgpr_read_b32 v212, a100
    v_mfma_f32_16x16x32_bf16 a[220:223], v[40:43], v[88:91], a[220:223]
    v_accvgpr_read_b32 v213, a101
    v_mfma_f32_16x16x32_bf16 a[220:223], v[44:47], v[92:95], a[220:223]
    s_waitcnt lgkmcnt(2)
    v_mfma_f32_16x16x32_bf16 a[224:227], v[32:35], v[64:67], a[224:227]
    ds_read_b128 v[40:43], v16 offset:14336
    v_mfma_f32_16x16x32_bf16 a[224:227], v[36:39], v[68:71], a[224:227]
    ds_read_b128 v[44:47], v17 offset:14336
    v_accvgpr_read_b32 v214, a102
    v_mfma_f32_16x16x32_bf16 a[228:231], v[32:35], v[72:75], a[228:231]
    v_accvgpr_read_b32 v215, a103
    v_mfma_f32_16x16x32_bf16 a[228:231], v[36:39], v[76:79], a[228:231]
    v_cvt_pk_bf16_f32 v216, v208, v209
    v_mfma_f32_16x16x32_bf16 a[232:235], v[32:35], v[80:83], a[232:235]
    v_cvt_pk_bf16_f32 v217, v210, v211
    v_mfma_f32_16x16x32_bf16 a[232:235], v[36:39], v[84:87], a[232:235]
    v_cvt_pk_bf16_f32 v218, v212, v213
    v_mfma_f32_16x16x32_bf16 a[236:239], v[32:35], v[88:91], a[236:239]
    v_cvt_pk_bf16_f32 v219, v214, v215
    v_mfma_f32_16x16x32_bf16 a[236:239], v[36:39], v[92:95], a[236:239]
    s_waitcnt lgkmcnt(0)
    v_mfma_f32_16x16x32_bf16 a[240:243], v[40:43], v[64:67], a[240:243]
    s_waitcnt vmcnt(21)
    s_barrier
    buffer_store_dwordx4 v[216:219], v15, s[8:11], s87 offen offset:0 sc0 sc1
    v_mfma_f32_16x16x32_bf16 a[240:243], v[44:47], v[68:71], a[240:243]
    ds_read_b128 v[32:35], v16 offset:32768
    v_mfma_f32_16x16x32_bf16 a[244:247], v[40:43], v[72:75], a[244:247]
    ds_read_b128 v[36:39], v17 offset:32768
    v_mfma_f32_16x16x32_bf16 a[244:247], v[44:47], v[76:79], a[244:247]
    s_add_u32 m0, s40, 0
    s_add_u32 s48, s35, 896
    buffer_load_dwordx4 v2, s[12:15], s48 offen offset:0 lds
    v_mfma_f32_16x16x32_bf16 a[248:251], v[40:43], v[80:83], a[248:251]
    v_mfma_f32_16x16x32_bf16 a[248:251], v[44:47], v[84:87], a[248:251]
    v_mfma_f32_16x16x32_bf16 a[252:255], v[40:43], v[88:91], a[252:255]
    buffer_load_dwordx4 v3, s[12:15], s48 offen offset:1024 lds
    v_mfma_f32_16x16x32_bf16 a[252:255], v[44:47], v[92:95], a[252:255]
    s_waitcnt lgkmcnt(0)
    v_mfma_f32_16x16x32_bf16 a[128:131], v[32:35], v[96:99], a[128:131]
    ds_read_b128 v[40:43], v16 offset:34816
    v_mfma_f32_16x16x32_bf16 a[128:131], v[36:39], v[100:103], a[128:131]
    ds_read_b128 v[44:47], v17 offset:34816
    v_accvgpr_read_b32 v220, a104
    v_mfma_f32_16x16x32_bf16 a[132:135], v[32:35], v[104:107], a[132:135]
    ds_read_b64_tr_b16 v[64:65], v192 offset:32768
    v_accvgpr_read_b32 v221, a105
    v_mfma_f32_16x16x32_bf16 a[132:135], v[36:39], v[108:111], a[132:135]
    buffer_load_dwordx4 v4, s[12:15], s48 offen offset:2048 lds
    v_accvgpr_read_b32 v222, a106
    v_mfma_f32_16x16x32_bf16 a[136:139], v[32:35], v[112:115], a[136:139]
    ds_read_b64_tr_b16 v[66:67], v192 offset:34816
    v_accvgpr_read_b32 v223, a107
    v_mfma_f32_16x16x32_bf16 a[136:139], v[36:39], v[116:119], a[136:139]
    buffer_load_dwordx4 v5, s[12:15], s48 offen offset:3072 lds
    v_accvgpr_read_b32 v224, a108
    v_mfma_f32_16x16x32_bf16 a[140:143], v[32:35], v[120:123], a[140:143]
    ds_read_b64_tr_b16 v[68:69], v192 offset:40960
    v_accvgpr_read_b32 v225, a109
    v_mfma_f32_16x16x32_bf16 a[140:143], v[36:39], v[124:127], a[140:143]
    s_waitcnt lgkmcnt(3)
    v_mfma_f32_16x16x32_bf16 a[144:147], v[40:43], v[96:99], a[144:147]
    ds_read_b128 v[32:35], v16 offset:36864
    v_mfma_f32_16x16x32_bf16 a[144:147], v[44:47], v[100:103], a[144:147]
    ds_read_b128 v[36:39], v17 offset:36864
    v_accvgpr_read_b32 v226, a110
    v_mfma_f32_16x16x32_bf16 a[148:151], v[40:43], v[104:107], a[148:151]
    ds_read_b64_tr_b16 v[70:71], v192 offset:43008
    v_accvgpr_read_b32 v227, a111
    v_mfma_f32_16x16x32_bf16 a[148:151], v[44:47], v[108:111], a[148:151]
    s_add_u32 m0, s40, 4096
    s_add_u32 s48, s35, 33664
    buffer_load_dwordx4 v2, s[12:15], s48 offen offset:0 lds
    v_cvt_pk_bf16_f32 v228, v220, v221
    v_mfma_f32_16x16x32_bf16 a[152:155], v[40:43], v[112:115], a[152:155]
    ds_read_b64_tr_b16 v[72:73], v193 offset:32768
    v_cvt_pk_bf16_f32 v229, v222, v223
    v_mfma_f32_16x16x32_bf16 a[152:155], v[44:47], v[116:119], a[152:155]
    v_cvt_pk_bf16_f32 v230, v224, v225
    v_mfma_f32_16x16x32_bf16 a[156:159], v[40:43], v[120:123], a[156:159]
    ds_read_b64_tr_b16 v[74:75], v193 offset:34816
    buffer_load_dwordx4 v3, s[12:15], s48 offen offset:1024 lds
    v_cvt_pk_bf16_f32 v231, v226, v227
    v_mfma_f32_16x16x32_bf16 a[156:159], v[44:47], v[124:127], a[156:159]
    s_waitcnt lgkmcnt(3)
    v_mfma_f32_16x16x32_bf16 a[160:163], v[32:35], v[96:99], a[160:163]
    ds_read_b128 v[40:43], v16 offset:38912
    buffer_store_dwordx4 v[228:231], v15, s[8:11], s87 offen offset:2048 sc0 sc1
    v_mfma_f32_16x16x32_bf16 a[160:163], v[36:39], v[100:103], a[160:163]
    ds_read_b128 v[44:47], v17 offset:38912
    v_mfma_f32_16x16x32_bf16 a[164:167], v[32:35], v[104:107], a[164:167]
    ds_read_b64_tr_b16 v[76:77], v193 offset:40960
    v_mfma_f32_16x16x32_bf16 a[164:167], v[36:39], v[108:111], a[164:167]
    buffer_load_dwordx4 v4, s[12:15], s48 offen offset:2048 lds
    v_mfma_f32_16x16x32_bf16 a[168:171], v[32:35], v[112:115], a[168:171]
    v_mfma_f32_16x16x32_bf16 a[168:171], v[36:39], v[116:119], a[168:171]
    ds_read_b64_tr_b16 v[78:79], v193 offset:43008
    buffer_load_dwordx4 v5, s[12:15], s48 offen offset:3072 lds
    v_mfma_f32_16x16x32_bf16 a[172:175], v[32:35], v[120:123], a[172:175]
    v_mfma_f32_16x16x32_bf16 a[172:175], v[36:39], v[124:127], a[172:175]
    s_waitcnt lgkmcnt(2)
    v_mfma_f32_16x16x32_bf16 a[176:179], v[40:43], v[96:99], a[176:179]
    ds_read_b128 v[32:35], v16 offset:40960
    v_mfma_f32_16x16x32_bf16 a[176:179], v[44:47], v[100:103], a[176:179]
    ds_read_b128 v[36:39], v17 offset:40960
    v_accvgpr_read_b32 v208, a112
    v_mfma_f32_16x16x32_bf16 a[180:183], v[40:43], v[104:107], a[180:183]
    ds_read_b64_tr_b16 v[80:81], v194 offset:32768
    v_accvgpr_read_b32 v209, a113
    v_mfma_f32_16x16x32_bf16 a[180:183], v[44:47], v[108:111], a[180:183]
    s_add_u32 m0, s41, 114688
    s_add_u32 s48, s38, 176128
    buffer_load_dwordx4 v10, s[56:59], s48 offen offset:0 lds
    v_accvgpr_read_b32 v210, a114
    v_mfma_f32_16x16x32_bf16 a[184:187], v[40:43], v[112:115], a[184:187]
    ds_read_b64_tr_b16 v[82:83], v194 offset:34816
    v_accvgpr_read_b32 v211, a115
    v_mfma_f32_16x16x32_bf16 a[184:187], v[44:47], v[116:119], a[184:187]
    v_accvgpr_read_b32 v212, a116
    v_mfma_f32_16x16x32_bf16 a[188:191], v[40:43], v[120:123], a[188:191]
    ds_read_b64_tr_b16 v[84:85], v194 offset:40960
    buffer_load_dwordx4 v11, s[56:59], s48 offen offset:1024 lds
    v_accvgpr_read_b32 v213, a117
    v_mfma_f32_16x16x32_bf16 a[188:191], v[44:47], v[124:127], a[188:191]
    s_waitcnt lgkmcnt(3)
    v_mfma_f32_16x16x32_bf16 a[192:195], v[32:35], v[96:99], a[192:195]
    ds_read_b128 v[40:43], v16 offset:43008
    v_mfma_f32_16x16x32_bf16 a[192:195], v[36:39], v[100:103], a[192:195]
    ds_read_b128 v[44:47], v17 offset:43008
    v_accvgpr_read_b32 v214, a118
    v_mfma_f32_16x16x32_bf16 a[196:199], v[32:35], v[104:107], a[196:199]
    ds_read_b64_tr_b16 v[86:87], v194 offset:43008
    v_accvgpr_read_b32 v215, a119
    v_mfma_f32_16x16x32_bf16 a[196:199], v[36:39], v[108:111], a[196:199]
    buffer_load_dwordx4 v12, s[56:59], s48 offen offset:2048 lds
    v_cvt_pk_bf16_f32 v216, v208, v209
    v_mfma_f32_16x16x32_bf16 a[200:203], v[32:35], v[112:115], a[200:203]
    ds_read_b64_tr_b16 v[88:89], v195 offset:32768
    v_cvt_pk_bf16_f32 v217, v210, v211
    v_mfma_f32_16x16x32_bf16 a[200:203], v[36:39], v[116:119], a[200:203]
    buffer_load_dwordx4 v13, s[56:59], s48 offen offset:3072 lds
    v_cvt_pk_bf16_f32 v218, v212, v213
    v_mfma_f32_16x16x32_bf16 a[204:207], v[32:35], v[120:123], a[204:207]
    ds_read_b64_tr_b16 v[90:91], v195 offset:34816
    v_cvt_pk_bf16_f32 v219, v214, v215
    v_mfma_f32_16x16x32_bf16 a[204:207], v[36:39], v[124:127], a[204:207]
    s_waitcnt lgkmcnt(3)
    v_mfma_f32_16x16x32_bf16 a[208:211], v[40:43], v[96:99], a[208:211]
    ds_read_b128 v[32:35], v16 offset:45056
    buffer_store_dwordx4 v[216:219], v15, s[8:11], s87 offen offset:128 sc0 sc1
    v_mfma_f32_16x16x32_bf16 a[208:211], v[44:47], v[100:103], a[208:211]
    ds_read_b128 v[36:39], v17 offset:45056
    v_mfma_f32_16x16x32_bf16 a[212:215], v[40:43], v[104:107], a[212:215]
    ds_read_b64_tr_b16 v[92:93], v195 offset:40960
    v_mfma_f32_16x16x32_bf16 a[212:215], v[44:47], v[108:111], a[212:215]
    v_mfma_f32_16x16x32_bf16 a[216:219], v[40:43], v[112:115], a[216:219]
    v_mfma_f32_16x16x32_bf16 a[216:219], v[44:47], v[116:119], a[216:219]
    ds_read_b64_tr_b16 v[94:95], v195 offset:43008
    v_mfma_f32_16x16x32_bf16 a[220:223], v[40:43], v[120:123], a[220:223]
    v_mfma_f32_16x16x32_bf16 a[220:223], v[44:47], v[124:127], a[220:223]
    s_waitcnt lgkmcnt(2)
    v_mfma_f32_16x16x32_bf16 a[224:227], v[32:35], v[96:99], a[224:227]
    ds_read_b128 v[40:43], v16 offset:47104
    v_mfma_f32_16x16x32_bf16 a[224:227], v[36:39], v[100:103], a[224:227]
    ds_read_b128 v[44:47], v17 offset:47104
    v_accvgpr_read_b32 v220, a120
    v_mfma_f32_16x16x32_bf16 a[228:231], v[32:35], v[104:107], a[228:231]
    v_accvgpr_read_b32 v221, a121
    v_mfma_f32_16x16x32_bf16 a[228:231], v[36:39], v[108:111], a[228:231]
    v_accvgpr_read_b32 v222, a122
    v_mfma_f32_16x16x32_bf16 a[232:235], v[32:35], v[112:115], a[232:235]
    v_accvgpr_read_b32 v223, a123
    v_mfma_f32_16x16x32_bf16 a[232:235], v[36:39], v[116:119], a[232:235]
    v_accvgpr_read_b32 v224, a124
    v_mfma_f32_16x16x32_bf16 a[236:239], v[32:35], v[120:123], a[236:239]
    v_accvgpr_read_b32 v225, a125
    v_mfma_f32_16x16x32_bf16 a[236:239], v[36:39], v[124:127], a[236:239]
    s_waitcnt vmcnt(35)
    s_cmp_lg_u32 s32, 0
    s_cbranch_scc1 L_g1_cc2g
    s_mov_b32 s7, 0
L_g1_cc2:
    v_cmp_ne_u32 vcc, 0x01010101, v203
    s_add_u32 s7, s7, 1
    s_cbranch_vccz L_g1_cc2g
    s_sleep 8
    buffer_load_dword v203, v52, s[28:31], 0 offen sc0 sc1
    s_waitcnt vmcnt(0)
    s_cmp_lt_u32 s7, 0x20000
    s_cbranch_scc1 L_g1_cc2
L_g1_cc2g:
    s_waitcnt lgkmcnt(0)
    v_mfma_f32_16x16x32_bf16 a[240:243], v[40:43], v[96:99], a[240:243]
    s_waitcnt vmcnt(20)
    s_barrier
    v_mfma_f32_16x16x32_bf16 a[240:243], v[44:47], v[100:103], a[240:243]
    ds_read_b128 v[32:35], v18 offset:0
    v_accvgpr_read_b32 v226, a126
    v_mfma_f32_16x16x32_bf16 a[244:247], v[40:43], v[104:107], a[244:247]
    ds_read_b128 v[36:39], v19 offset:0
    v_accvgpr_read_b32 v227, a127
    v_mfma_f32_16x16x32_bf16 a[244:247], v[44:47], v[108:111], a[244:247]
    s_add_u32 m0, s40, 32768
    s_add_u32 s48, s36, 0
    buffer_load_dwordx4 v2, s[8:11], s48 offen offset:0 sc1 lds
    v_cvt_pk_bf16_f32 v228, v220, v221
    v_mfma_f32_16x16x32_bf16 a[248:251], v[40:43], v[112:115], a[248:251]
    v_cvt_pk_bf16_f32 v229, v222, v223
    v_mfma_f32_16x16x32_bf16 a[248:251], v[44:47], v[116:119], a[248:251]
    v_cvt_pk_bf16_f32 v230, v224, v225
    v_mfma_f32_16x16x32_bf16 a[252:255], v[40:43], v[120:123], a[252:255]
    buffer_load_dwordx4 v3, s[8:11], s48 offen offset:1024 sc1 lds
    v_cvt_pk_bf16_f32 v231, v226, v227
    v_mfma_f32_16x16x32_bf16 a[252:255], v[44:47], v[124:127], a[252:255]
    s_waitcnt lgkmcnt(0)
    v_mfma_f32_16x16x32_bf16 a[128:131], v[32:35], v[64:67], a[128:131]
    ds_read_b128 v[40:43], v18 offset:2048
    buffer_store_dwordx4 v[228:231], v15, s[8:11], s87 offen offset:2176 sc0 sc1
    v_mfma_f32_16x16x32_bf16 a[128:131], v[36:39], v[68:71], a[128:131]
    ds_read_b128 v[44:47], v19 offset:2048
    v_mfma_f32_16x16x32_bf16 a[132:135], v[32:35], v[72:75], a[132:135]
    ds_read_b64_tr_b16 v[96:97], v192 offset:49152
    v_mfma_f32_16x16x32_bf16 a[132:135], v[36:39], v[76:79], a[132:135]
    buffer_load_dwordx4 v4, s[8:11], s48 offen offset:2048 sc1 lds
    v_mfma_f32_16x16x32_bf16 a[136:139], v[32:35], v[80:83], a[136:139]
    ds_read_b64_tr_b16 v[98:99], v192 offset:51200
    v_mfma_f32_16x16x32_bf16 a[136:139], v[36:39], v[84:87], a[136:139]
    buffer_load_dwordx4 v5, s[8:11], s48 offen offset:3072 sc1 lds
    v_mfma_f32_16x16x32_bf16 a[140:143], v[32:35], v[88:91], a[140:143]
    ds_read_b64_tr_b16 v[100:101], v192 offset:57344
    v_mfma_f32_16x16x32_bf16 a[140:143], v[36:39], v[92:95], a[140:143]
    s_waitcnt lgkmcnt(3)
    v_mfma_f32_16x16x32_bf16 a[144:147], v[40:43], v[64:67], a[144:147]
    ds_read_b128 v[32:35], v18 offset:4096
    v_mfma_f32_16x16x32_bf16 a[144:147], v[44:47], v[68:71], a[144:147]
    ds_read_b128 v[36:39], v19 offset:4096
    v_mfma_f32_16x16x32_bf16 a[148:151], v[40:43], v[72:75], a[148:151]
    ds_read_b64_tr_b16 v[102:103], v192 offset:59392
    v_mfma_f32_16x16x32_bf16 a[148:151], v[44:47], v[76:79], a[148:151]
    s_add_u32 m0, s40, 36864
    s_add_u32 s48, s36, 32768
    buffer_load_dwordx4 v2, s[8:11], s48 offen offset:0 sc1 lds
    v_mfma_f32_16x16x32_bf16 a[152:155], v[40:43], v[80:83], a[152:155]
    ds_read_b64_tr_b16 v[104:105], v193 offset:49152
    v_mfma_f32_16x16x32_bf16 a[152:155], v[44:47], v[84:87], a[152:155]
    v_mfma_f32_16x16x32_bf16 a[156:159], v[40:43], v[88:91], a[156:159]
    ds_read_b64_tr_b16 v[106:107], v193 offset:51200
    buffer_load_dwordx4 v3, s[8:11], s48 offen offset:1024 sc1 lds
    v_mfma_f32_16x16x32_bf16 a[156:159], v[44:47], v[92:95], a[156:159]
    s_waitcnt lgkmcnt(3)
    v_mfma_f32_16x16x32_bf16 a[160:163], v[32:35], v[64:67], a[160:163]
    ds_read_b128 v[40:43], v18 offset:6144
    v_mfma_f32_16x16x32_bf16 a[160:163], v[36:39], v[68:71], a[160:163]
    ds_read_b128 v[44:47], v19 offset:6144
    v_mfma_f32_16x16x32_bf16 a[164:167], v[32:35], v[72:75], a[164:167]
    ds_read_b64_tr_b16 v[108:109], v193 offset:57344
    v_mfma_f32_16x16x32_bf16 a[164:167], v[36:39], v[76:79], a[164:167]
    buffer_load_dwordx4 v4, s[8:11], s48 offen offset:2048 sc1 lds
    v_mfma_f32_16x16x32_bf16 a[168:171], v[32:35], v[80:83], a[168:171]
    v_mfma_f32_16x16x32_bf16 a[168:171], v[36:39], v[84:87], a[168:171]
    ds_read_b64_tr_b16 v[110:111], v193 offset:59392
    buffer_load_dwordx4 v5, s[8:11], s48 offen offset:3072 sc1 lds
    v_mfma_f32_16x16x32_bf16 a[172:175], v[32:35], v[88:91], a[172:175]
    v_mfma_f32_16x16x32_bf16 a[172:175], v[36:39], v[92:95], a[172:175]
    s_waitcnt lgkmcnt(2)
    v_mfma_f32_16x16x32_bf16 a[176:179], v[40:43], v[64:67], a[176:179]
    ds_read_b128 v[32:35], v18 offset:8192
    v_mfma_f32_16x16x32_bf16 a[176:179], v[44:47], v[68:71], a[176:179]
    ds_read_b128 v[36:39], v19 offset:8192
    v_mfma_f32_16x16x32_bf16 a[180:183], v[40:43], v[72:75], a[180:183]
    ds_read_b64_tr_b16 v[112:113], v194 offset:49152
    v_mfma_f32_16x16x32_bf16 a[180:183], v[44:47], v[76:79], a[180:183]
    s_add_u32 m0, s41, 131072
    s_add_u32 s48, s38, 352256
    buffer_load_dwordx4 v10, s[56:59], s48 offen offset:0 lds
    v_mfma_f32_16x16x32_bf16 a[184:187], v[40:43], v[80:83], a[184:187]
    ds_read_b64_tr_b16 v[114:115], v194 offset:51200
    v_mfma_f32_16x16x32_bf16 a[184:187], v[44:47], v[84:87], a[184:187]
    v_mfma_f32_16x16x32_bf16 a[188:191], v[40:43], v[88:91], a[188:191]
    ds_read_b64_tr_b16 v[116:117], v194 offset:57344
    buffer_load_dwordx4 v11, s[56:59], s48 offen offset:1024 lds
    v_mfma_f32_16x16x32_bf16 a[188:191], v[44:47], v[92:95], a[188:191]
    s_waitcnt lgkmcnt(3)
    v_mfma_f32_16x16x32_bf16 a[192:195], v[32:35], v[64:67], a[192:195]
    ds_read_b128 v[40:43], v18 offset:10240
    v_mfma_f32_16x16x32_bf16 a[192:195], v[36:39], v[68:71], a[192:195]
    ds_read_b128 v[44:47], v19 offset:10240
    v_mfma_f32_16x16x32_bf16 a[196:199], v[32:35], v[72:75], a[196:199]
    ds_read_b64_tr_b16 v[118:119], v194 offset:59392
    v_mfma_f32_16x16x32_bf16 a[196:199], v[36:39], v[76:79], a[196:199]
    buffer_load_dwordx4 v12, s[56:59], s48 offen offset:2048 lds
    v_mfma_f32_16x16x32_bf16 a[200:203], v[32:35], v[80:83], a[200:203]
    ds_read_b64_tr_b16 v[120:121], v195 offset:49152
    v_mfma_f32_16x16x32_bf16 a[200:203], v[36:39], v[84:87], a[200:203]
    buffer_load_dwordx4 v13, s[56:59], s48 offen offset:3072 lds
    v_mfma_f32_16x16x32_bf16 a[204:207], v[32:35], v[88:91], a[204:207]
    ds_read_b64_tr_b16 v[122:123], v195 offset:51200
    v_mfma_f32_16x16x32_bf16 a[204:207], v[36:39], v[92:95], a[204:207]
    s_waitcnt lgkmcnt(3)
    v_mfma_f32_16x16x32_bf16 a[208:211], v[40:43], v[64:67], a[208:211]
    ds_read_b128 v[32:35], v18 offset:12288
    v_mfma_f32_16x16x32_bf16 a[208:211], v[44:47], v[68:71], a[208:211]
    ds_read_b128 v[36:39], v19 offset:12288
    v_mfma_f32_16x16x32_bf16 a[212:215], v[40:43], v[72:75], a[212:215]
    ds_read_b64_tr_b16 v[124:125], v195 offset:57344
    v_mfma_f32_16x16x32_bf16 a[212:215], v[44:47], v[76:79], a[212:215]
    v_mfma_f32_16x16x32_bf16 a[216:219], v[40:43], v[80:83], a[216:219]
    v_mfma_f32_16x16x32_bf16 a[216:219], v[44:47], v[84:87], a[216:219]
    ds_read_b64_tr_b16 v[126:127], v195 offset:59392
    v_mfma_f32_16x16x32_bf16 a[220:223], v[40:43], v[88:91], a[220:223]
    v_mfma_f32_16x16x32_bf16 a[220:223], v[44:47], v[92:95], a[220:223]
    s_waitcnt lgkmcnt(2)
    v_mfma_f32_16x16x32_bf16 a[224:227], v[32:35], v[64:67], a[224:227]
    ds_read_b128 v[40:43], v18 offset:14336
    v_mfma_f32_16x16x32_bf16 a[224:227], v[36:39], v[68:71], a[224:227]
    ds_read_b128 v[44:47], v19 offset:14336
    v_mfma_f32_16x16x32_bf16 a[228:231], v[32:35], v[72:75], a[228:231]
    v_mfma_f32_16x16x32_bf16 a[228:231], v[36:39], v[76:79], a[228:231]
    v_mfma_f32_16x16x32_bf16 a[232:235], v[32:35], v[80:83], a[232:235]
    v_mfma_f32_16x16x32_bf16 a[232:235], v[36:39], v[84:87], a[232:235]
    v_mfma_f32_16x16x32_bf16 a[236:239], v[32:35], v[88:91], a[236:239]
    v_mfma_f32_16x16x32_bf16 a[236:239], v[36:39], v[92:95], a[236:239]
    s_waitcnt lgkmcnt(0)
    v_mfma_f32_16x16x32_bf16 a[240:243], v[40:43], v[64:67], a[240:243]
    s_waitcnt vmcnt(18)
    s_barrier
    v_mfma_f32_16x16x32_bf16 a[240:243], v[44:47], v[68:71], a[240:243]
    ds_read_b128 v[32:35], v16 offset:0
    v_mfma_f32_16x16x32_bf16 a[244:247], v[40:43], v[72:75], a[244:247]
    ds_read_b128 v[36:39], v17 offset:0
    v_mfma_f32_16x16x32_bf16 a[244:247], v[44:47], v[76:79], a[244:247]
    s_add_u32 m0, s40, 65536
    s_add_u32 s48, s36, 128
    buffer_load_dwordx4 v2, s[8:11], s48 offen offset:0 sc1 lds
    v_mfma_f32_16x16x32_bf16 a[248:251], v[40:43], v[80:83], a[248:251]
    v_mfma_f32_16x16x32_bf16 a[248:251], v[44:47], v[84:87], a[248:251]
    v_mfma_f32_16x16x32_bf16 a[252:255], v[40:43], v[88:91], a[252:255]
    buffer_load_dwordx4 v3, s[8:11], s48 offen offset:1024 sc1 lds
    v_mfma_f32_16x16x32_bf16 a[252:255], v[44:47], v[92:95], a[252:255]
    s_waitcnt lgkmcnt(0)
    v_mfma_f32_16x16x32_bf16 a[128:131], v[32:35], v[96:99], a[128:131]
    ds_read_b128 v[40:43], v16 offset:2048
    v_mfma_f32_16x16x32_bf16 a[128:131], v[36:39], v[100:103], a[128:131]
    ds_read_b128 v[44:47], v17 offset:2048
    v_mfma_f32_16x16x32_bf16 a[132:135], v[32:35], v[104:107], a[132:135]
    ds_read_b64_tr_b16 v[64:65], v196 offset:0
    v_mfma_f32_16x16x32_bf16 a[132:135], v[36:39], v[108:111], a[132:135]
    buffer_load_dwordx4 v4, s[8:11], s48 offen offset:2048 sc1 lds
    v_mfma_f32_16x16x32_bf16 a[136:139], v[32:35], v[112:115], a[136:139]
    ds_read_b64_tr_b16 v[66:67], v196 offset:2048
    v_mfma_f32_16x16x32_bf16 a[136:139], v[36:39], v[116:119], a[136:139]
    buffer_load_dwordx4 v5, s[8:11], s48 offen offset:3072 sc1 lds
    v_mfma_f32_16x16x32_bf16 a[140:143], v[32:35], v[120:123], a[140:143]
    ds_read_b64_tr_b16 v[68:69], v196 offset:8192
    v_mfma_f32_16x16x32_bf16 a[140:143], v[36:39], v[124:127], a[140:143]
    s_waitcnt lgkmcnt(3)
    v_mfma_f32_16x16x32_bf16 a[144:147], v[40:43], v[96:99], a[144:147]
    ds_read_b128 v[32:35], v16 offset:4096
    v_mfma_f32_16x16x32_bf16 a[144:147], v[44:47], v[100:103], a[144:147]
    ds_read_b128 v[36:39], v17 offset:4096
    v_mfma_f32_16x16x32_bf16 a[148:151], v[40:43], v[104:107], a[148:151]
    ds_read_b64_tr_b16 v[70:71], v196 offset:10240
    v_mfma_f32_16x16x32_bf16 a[148:151], v[44:47], v[108:111], a[148:151]
    s_add_u32 m0, s40, 69632
    s_add_u32 s48, s36, 32896
    buffer_load_dwordx4 v2, s[8:11], s48 offen offset:0 sc1 lds
    v_mfma_f32_16x16x32_bf16 a[152:155], v[40:43], v[112:115], a[152:155]
    ds_read_b64_tr_b16 v[72:73], v197 offset:0
    v_mfma_f32_16x16x32_bf16 a[152:155], v[44:47], v[116:119], a[152:155]
    v_mfma_f32_16x16x32_bf16 a[156:159], v[40:43], v[120:123], a[156:159]
    ds_read_b64_tr_b16 v[74:75], v197 offset:2048
    buffer_load_dwordx4 v3, s[8:11], s48 offen offset:1024 sc1 lds
    v_mfma_f32_16x16x32_bf16 a[156:159], v[44:47], v[124:127], a[156:159]
    s_waitcnt lgkmcnt(3)
    v_mfma_f32_16x16x32_bf16 a[160:163], v[32:35], v[96:99], a[160:163]
    ds_read_b128 v[40:43], v16 offset:6144
    v_mfma_f32_16x16x32_bf16 a[160:163], v[36:39], v[100:103], a[160:163]
    ds_read_b128 v[44:47], v17 offset:6144
    v_mfma_f32_16x16x32_bf16 a[164:167], v[32:35], v[104:107], a[164:167]
    ds_read_b64_tr_b16 v[76:77], v197 offset:8192
    v_mfma_f32_16x16x32_bf16 a[164:167], v[36:39], v[108:111], a[164:167]
    buffer_load_dwordx4 v4, s[8:11], s48 offen offset:2048 sc1 lds
    v_mfma_f32_16x16x32_bf16 a[168:171], v[32:35], v[112:115], a[168:171]
    v_mfma_f32_16x16x32_bf16 a[168:171], v[36:39], v[116:119], a[168:171]
    ds_read_b64_tr_b16 v[78:79], v197 offset:10240
    buffer_load_dwordx4 v5, s[8:11], s48 offen offset:3072 sc1 lds
    v_mfma_f32_16x16x32_bf16 a[172:175], v[32:35], v[120:123], a[172:175]
    v_mfma_f32_16x16x32_bf16 a[172:175], v[36:39], v[124:127], a[172:175]
    s_waitcnt lgkmcnt(2)
    v_mfma_f32_16x16x32_bf16 a[176:179], v[40:43], v[96:99], a[176:179]
    ds_read_b128 v[32:35], v16 offset:8192
    v_mfma_f32_16x16x32_bf16 a[176:179], v[44:47], v[100:103], a[176:179]
    ds_read_b128 v[36:39], v17 offset:8192
    v_mfma_f32_16x16x32_bf16 a[180:183], v[40:43], v[104:107], a[180:183]
    ds_read_b64_tr_b16 v[80:81], v196 offset:4096
    v_mfma_f32_16x16x32_bf16 a[180:183], v[44:47], v[108:111], a[180:183]
    s_add_u32 m0, s41, 147456
    s_add_u32 s48, s38, 528384
    buffer_load_dwordx4 v10, s[56:59], s48 offen offset:0 lds
    v_mfma_f32_16x16x32_bf16 a[184:187], v[40:43], v[112:115], a[184:187]
    ds_read_b64_tr_b16 v[82:83], v196 offset:6144
    v_mfma_f32_16x16x32_bf16 a[184:187], v[44:47], v[116:119], a[184:187]
    v_mfma_f32_16x16x32_bf16 a[188:191], v[40:43], v[120:123], a[188:191]
    ds_read_b64_tr_b16 v[84:85], v196 offset:12288
    buffer_load_dwordx4 v11, s[56:59], s48 offen offset:1024 lds
    v_mfma_f32_16x16x32_bf16 a[188:191], v[44:47], v[124:127], a[188:191]
    s_waitcnt lgkmcnt(3)
    v_mfma_f32_16x16x32_bf16 a[192:195], v[32:35], v[96:99], a[192:195]
    ds_read_b128 v[40:43], v16 offset:10240
    v_mfma_f32_16x16x32_bf16 a[192:195], v[36:39], v[100:103], a[192:195]
    ds_read_b128 v[44:47], v17 offset:10240
    v_mfma_f32_16x16x32_bf16 a[196:199], v[32:35], v[104:107], a[196:199]
    ds_read_b64_tr_b16 v[86:87], v196 offset:14336
    v_mfma_f32_16x16x32_bf16 a[196:199], v[36:39], v[108:111], a[196:199]
    buffer_load_dwordx4 v12, s[56:59], s48 offen offset:2048 lds
    v_mfma_f32_16x16x32_bf16 a[200:203], v[32:35], v[112:115], a[200:203]
    ds_read_b64_tr_b16 v[88:89], v197 offset:4096
    v_mfma_f32_16x16x32_bf16 a[200:203], v[36:39], v[116:119], a[200:203]
    buffer_load_dwordx4 v13, s[56:59], s48 offen offset:3072 lds
    v_mfma_f32_16x16x32_bf16 a[204:207], v[32:35], v[120:123], a[204:207]
    ds_read_b64_tr_b16 v[90:91], v197 offset:6144
    v_mfma_f32_16x16x32_bf16 a[204:207], v[36:39], v[124:127], a[204:207]
    s_waitcnt lgkmcnt(3)
    v_mfma_f32_16x16x32_bf16 a[208:211], v[40:43], v[96:99], a[208:211]
    ds_read_b128 v[32:35], v16 offset:12288
    v_mfma_f32_16x16x32_bf16 a[208:211], v[44:47], v[100:103], a[208:211]
    ds_read_b128 v[36:39], v17 offset:12288
    v_mfma_f32_16x16x32_bf16 a[212:215], v[40:43], v[104:107], a[212:215]
    ds_read_b64_tr_b16 v[92:93], v197 offset:12288
    v_mfma_f32_16x16x32_bf16 a[212:215], v[44:47], v[108:111], a[212:215]
    v_mfma_f32_16x16x32_bf16 a[216:219], v[40:43], v[112:115], a[216:219]
    v_mfma_f32_16x16x32_bf16 a[216:219], v[44:47], v[116:119], a[216:219]
    ds_read_b64_tr_b16 v[94:95], v197 offset:14336
    v_mfma_f32_16x16x32_bf16 a[220:223], v[40:43], v[120:123], a[220:223]
    v_mfma_f32_16x16x32_bf16 a[220:223], v[44:47], v[124:127], a[220:223]
    s_waitcnt lgkmcnt(2)
    v_mfma_f32_16x16x32_bf16 a[224:227], v[32:35], v[96:99], a[224:227]
    ds_read_b128 v[40:43], v16 offset:14336
    v_mfma_f32_16x16x32_bf16 a[224:227], v[36:39], v[100:103], a[224:227]
    ds_read_b128 v[44:47], v17 offset:14336
    v_mfma_f32_16x16x32_bf16 a[228:231], v[32:35], v[104:107], a[228:231]
    v_mfma_f32_16x16x32_bf16 a[228:231], v[36:39], v[108:111], a[228:231]
    v_mfma_f32_16x16x32_bf16 a[232:235], v[32:35], v[112:115], a[232:235]
    v_mfma_f32_16x16x32_bf16 a[232:235], v[36:39], v[116:119], a[232:235]
    v_mfma_f32_16x16x32_bf16 a[236:239], v[32:35], v[120:123], a[236:239]
    v_mfma_f32_16x16x32_bf16 a[236:239], v[36:39], v[124:127], a[236:239]
    s_waitcnt lgkmcnt(0)
    v_mfma_f32_16x16x32_bf16 a[240:243], v[40:43], v[96:99], a[240:243]
    s_waitcnt vmcnt(16)
    s_barrier
    v_mfma_f32_16x16x32_bf16 a[240:243], v[44:47], v[100:103], a[240:243]
    ds_read_b128 v[32:35], v16 offset:32768
    v_mfma_f32_16x16x32_bf16 a[244:247], v[40:43], v[104:107], a[244:247]
    ds_read_b128 v[36:39], v17 offset:32768
    v_mfma_f32_16x16x32_bf16 a[244:247], v[44:47], v[108:111], a[244:247]
    s_add_u32 m0, s40, 0
    s_add_u32 s48, s36, 256
    buffer_load_dwordx4 v2, s[8:11], s48 offen offset:0 sc1 lds
    v_mfma_f32_16x16x32_bf16 a[248:251], v[40:43], v[112:115], a[248:251]
    v_mfma_f32_16x16x32_bf16 a[248:251], v[44:47], v[116:119], a[248:251]
    v_mfma_f32_16x16x32_bf16 a[252:255], v[40:43], v[120:123], a[252:255]
    buffer_load_dwordx4 v3, s[8:11], s48 offen offset:1024 sc1 lds
    v_mfma_f32_16x16x32_bf16 a[252:255], v[44:47], v[124:127], a[252:255]
    s_waitcnt lgkmcnt(0)
    v_mfma_f32_16x16x32_bf16 a[0:3], v[64:67], v[32:35], 0
    ds_read_b128 v[40:43], v16 offset:34816
    v_mfma_f32_16x16x32_bf16 a[0:3], v[68:71], v[36:39], a[0:3]
    ds_read_b128 v[44:47], v17 offset:34816
    v_mfma_f32_16x16x32_bf16 a[4:7], v[72:75], v[32:35], 0
    ds_read_b64_tr_b16 v[96:97], v196 offset:16384
    v_mfma_f32_16x16x32_bf16 a[4:7], v[76:79], v[36:39], a[4:7]
    buffer_load_dwordx4 v4, s[8:11], s48 offen offset:2048 sc1 lds
    v_mfma_f32_16x16x32_bf16 a[8:11], v[80:83], v[32:35], 0
    ds_read_b64_tr_b16 v[98:99], v196 offset:18432
    v_mfma_f32_16x16x32_bf16 a[8:11], v[84:87], v[36:39], a[8:11]
    buffer_load_dwordx4 v5, s[8:11], s48 offen offset:3072 sc1 lds
    v_mfma_f32_16x16x32_bf16 a[12:15], v[88:91], v[32:35], 0
    ds_read_b64_tr_b16 v[100:101], v196 offset:24576
    v_mfma_f32_16x16x32_bf16 a[12:15], v[92:95], v[36:39], a[12:15]
    s_waitcnt lgkmcnt(3)
    v_mfma_f32_16x16x32_bf16 a[16:19], v[64:67], v[40:43], 0
    ds_read_b128 v[32:35], v16 offset:36864
    v_mfma_f32_16x16x32_bf16 a[16:19], v[68:71], v[44:47], a[16:19]
    ds_read_b128 v[36:39], v17 offset:36864
    v_accvgpr_read_b32 v208, a128
    v_mfma_f32_16x16x32_bf16 a[20:23], v[72:75], v[40:43], 0
    ds_read_b64_tr_b16 v[102:103], v196 offset:26624
    v_accvgpr_read_b32 v209, a129
    v_mfma_f32_16x16x32_bf16 a[20:23], v[76:79], v[44:47], a[20:23]
    s_add_u32 m0, s40, 4096
    s_add_u32 s48, s36, 33024
    buffer_load_dwordx4 v2, s[8:11], s48 offen offset:0 sc1 lds
    v_accvgpr_read_b32 v210, a130
    v_mfma_f32_16x16x32_bf16 a[24:27], v[80:83], v[40:43], 0
    ds_read_b64_tr_b16 v[104:105], v197 offset:16384
    v_accvgpr_read_b32 v211, a131
    v_mfma_f32_16x16x32_bf16 a[24:27], v[84:87], v[44:47], a[24:27]
    v_accvgpr_read_b32 v212, a144
    v_mfma_f32_16x16x32_bf16 a[28:31], v[88:91], v[40:43], 0
    ds_read_b64_tr_b16 v[106:107], v197 offset:18432
    buffer_load_dwordx4 v3, s[8:11], s48 offen offset:1024 sc1 lds
    v_accvgpr_read_b32 v213, a145
    v_mfma_f32_16x16x32_bf16 a[28:31], v[92:95], v[44:47], a[28:31]
    s_waitcnt lgkmcnt(3)
    v_mfma_f32_16x16x32_bf16 a[32:35], v[64:67], v[32:35], 0
    ds_read_b128 v[40:43], v16 offset:38912
    v_mfma_f32_16x16x32_bf16 a[32:35], v[68:71], v[36:39], a[32:35]
    ds_read_b128 v[44:47], v17 offset:38912
    v_accvgpr_read_b32 v214, a146
    v_mfma_f32_16x16x32_bf16 a[36:39], v[72:75], v[32:35], 0
    ds_read_b64_tr_b16 v[108:109], v197 offset:24576
    v_accvgpr_read_b32 v215, a147
    v_mfma_f32_16x16x32_bf16 a[36:39], v[76:79], v[36:39], a[36:39]
    buffer_load_dwordx4 v4, s[8:11], s48 offen offset:2048 sc1 lds
    v_cvt_pk_bf16_f32 v216, v208, v209
    v_mfma_f32_16x16x32_bf16 a[40:43], v[80:83], v[32:35], 0
    v_cvt_pk_bf16_f32 v217, v210, v211
    v_mfma_f32_16x16x32_bf16 a[40:43], v[84:87], v[36:39], a[40:43]
    ds_read_b64_tr_b16 v[110:111], v197 offset:26624
    buffer_load_dwordx4 v5, s[8:11], s48 offen offset:3072 sc1 lds
    v_cvt_pk_bf16_f32 v218, v212, v213
    v_mfma_f32_16x16x32_bf16 a[44:47], v[88:91], v[32:35], 0
    v_cvt_pk_bf16_f32 v219, v214, v215
    v_mfma_f32_16x16x32_bf16 a[44:47], v[92:95], v[36:39], a[44:47]
    s_waitcnt lgkmcnt(2)
    v_mfma_f32_16x16x32_bf16 a[48:51], v[64:67], v[40:43], 0
    ds_read_b128 v[32:35], v16 offset:40960
    buffer_store_dwordx4 v[216:219], v14, s[8:11], s88 offen offset:0 sc0 sc1
    v_mfma_f32_16x16x32_bf16 a[48:51], v[68:71], v[44:47], a[48:51]
    ds_read_b128 v[36:39], v17 offset:40960
    v_mfma_f32_16x16x32_bf16 a[52:55], v[72:75], v[40:43], 0
    ds_read_b64_tr_b16 v[112:113], v196 offset:20480
    v_mfma_f32_16x16x32_bf16 a[52:55], v[76:79], v[44:47], a[52:55]
    s_add_u32 m0, s41, 98304
    s_add_u32 s48, s38, 704512
    buffer_load_dwordx4 v10, s[56:59], s48 offen offset:0 lds
    v_mfma_f32_16x16x32_bf16 a[56:59], v[80:83], v[40:43], 0
    ds_read_b64_tr_b16 v[114:115], v196 offset:22528
    v_mfma_f32_16x16x32_bf16 a[56:59], v[84:87], v[44:47], a[56:59]
    v_mfma_f32_16x16x32_bf16 a[60:63], v[88:91], v[40:43], 0
    ds_read_b64_tr_b16 v[116:117], v196 offset:28672
    buffer_load_dwordx4 v11, s[56:59], s48 offen offset:1024 lds
    v_mfma_f32_16x16x32_bf16 a[60:63], v[92:95], v[44:47], a[60:63]
    s_waitcnt lgkmcnt(3)
    v_mfma_f32_16x16x32_bf16 a[64:67], v[64:67], v[32:35], 0
    ds_read_b128 v[40:43], v16 offset:43008
    v_mfma_f32_16x16x32_bf16 a[64:67], v[68:71], v[36:39], a[64:67]
    ds_read_b128 v[44:47], v17 offset:43008
    v_accvgpr_read_b32 v220, a132
    v_mfma_f32_16x16x32_bf16 a[68:71], v[72:75], v[32:35], 0
    ds_read_b64_tr_b16 v[118:119], v196 offset:30720
    v_accvgpr_read_b32 v221, a133
    v_mfma_f32_16x16x32_bf16 a[68:71], v[76:79], v[36:39], a[68:71]
    buffer_load_dwordx4 v12, s[56:59], s48 offen offset:2048 lds
    v_accvgpr_read_b32 v222, a134
    v_mfma_f32_16x16x32_bf16 a[72:75], v[80:83], v[32:35], 0
    ds_read_b64_tr_b16 v[120:121], v197 offset:20480
    v_accvgpr_read_b32 v223, a135
    v_mfma_f32_16x16x32_bf16 a[72:75], v[84:87], v[36:39], a[72:75]
    buffer_load_dwordx4 v13, s[56:59], s48 offen offset:3072 lds
    v_accvgpr_read_b32 v224, a148
    v_mfma_f32_16x16x32_bf16 a[76:79], v[88:91], v[32:35], 0
    ds_read_b64_tr_b16 v[122:123], v197 offset:22528
    v_accvgpr_read_b32 v225, a149
    v_mfma_f32_16x16x32_bf16 a[76:79], v[92:95], v[36:39], a[76:79]
    s_waitcnt lgkmcnt(3)
    v_mfma_f32_16x16x32_bf16 a[80:83], v[64:67], v[40:43], 0
    ds_read_b128 v[32:35], v16 offset:45056
    v_mfma_f32_16x16x32_bf16 a[80:83], v[68:71], v[44:47], a[80:83]
    ds_read_b128 v[36:39], v17 offset:45056
    v_accvgpr_read_b32 v226, a150
    v_mfma_f32_16x16x32_bf16 a[84:87], v[72:75], v[40:43], 0
    ds_read_b64_tr_b16 v[124:125], v197 offset:28672
    v_accvgpr_read_b32 v227, a151
    v_mfma_f32_16x16x32_bf16 a[84:87], v[76:79], v[44:47], a[84:87]
    v_cvt_pk_bf16_f32 v228, v220, v221
    v_mfma_f32_16x16x32_bf16 a[88:91], v[80:83], v[40:43], 0
    v_cvt_pk_bf16_f32 v229, v222, v223
    v_mfma_f32_16x16x32_bf16 a[88:91], v[84:87], v[44:47], a[88:91]
    ds_read_b64_tr_b16 v[126:127], v197 offset:30720
    v_cvt_pk_bf16_f32 v230, v224, v225
    v_mfma_f32_16x16x32_bf16 a[92:95], v[88:91], v[40:43], 0
    v_cvt_pk_bf16_f32 v231, v226, v227
    v_mfma_f32_16x16x32_bf16 a[92:95], v[92:95], v[44:47], a[92:95]
    s_waitcnt lgkmcnt(2)
    v_mfma_f32_16x16x32_bf16 a[96:99], v[64:67], v[32:35], 0
    ds_read_b128 v[40:43], v16 offset:47104
    buffer_store_dwordx4 v[228:231], v14, s[8:11], s88 offen offset:256 sc0 sc1
    v_mfma_f32_16x16x32_bf16 a[96:99], v[68:71], v[36:39], a[96:99]
    ds_read_b128 v[44:47], v17 offset:47104
    v_mfma_f32_16x16x32_bf16 a[100:103], v[72:75], v[32:35], 0
    v_mfma_f32_16x16x32_bf16 a[100:103], v[76:79], v[36:39], a[100:103]
    v_mfma_f32_16x16x32_bf16 a[104:107], v[80:83], v[32:35], 0
    v_mfma_f32_16x16x32_bf16 a[104:107], v[84:87], v[36:39], a[104:107]
    v_mfma_f32_16x16x32_bf16 a[108:111], v[88:91], v[32:35], 0
    v_mfma_f32_16x16x32_bf16 a[108:111], v[92:95], v[36:39], a[108:111]
    s_waitcnt lgkmcnt(0)
    v_mfma_f32_16x16x32_bf16 a[112:115], v[64:67], v[40:43], 0
    s_waitcnt vmcnt(18)
    s_barrier
    v_mfma_f32_16x16x32_bf16 a[112:115], v[68:71], v[44:47], a[112:115]
    ds_read_b128 v[32:35], v18 offset:0
    v_accvgpr_read_b32 v208, a136
    v_mfma_f32_16x16x32_bf16 a[116:119], v[72:75], v[40:43], 0
    ds_read_b128 v[36:39], v19 offset:0
    v_accvgpr_read_b32 v209, a137
    v_mfma_f32_16x16x32_bf16 a[116:119], v[76:79], v[44:47], a[116:119]
    s_add_u32 m0, s40, 32768
    s_add_u32 s48, s36, 384
    buffer_load_dwordx4 v2, s[8:11], s48 offen offset:0 sc1 lds
    v_accvgpr_read_b32 v210, a138
    v_mfma_f32_16x16x32_bf16 a[120:123], v[80:83], v[40:43], 0
    v_accvgpr_read_b32 v211, a139
    v_mfma_f32_16x16x32_bf16 a[120:123], v[84:87], v[44:47], a[120:123]
    v_accvgpr_read_b32 v212, a152
    v_mfma_f32_16x16x32_bf16 a[124:127], v[88:91], v[40:43], 0
    buffer_load_dwordx4 v3, s[8:11], s48 offen offset:1024 sc1 lds
    v_accvgpr_read_b32 v213, a153
    v_mfma_f32_16x16x32_bf16 a[124:127], v[92:95], v[44:47], a[124:127]
    s_waitcnt lgkmcnt(0)
    v_mfma_f32_16x16x32_bf16 a[0:3], v[96:99], v[32:35], a[0:3]
    ds_read_b128 v[40:43], v18 offset:2048
    v_mfma_f32_16x16x32_bf16 a[0:3], v[100:103], v[36:39], a[0:3]
    ds_read_b128 v[44:47], v19 offset:2048
    v_accvgpr_read_b32 v214, a154
    v_mfma_f32_16x16x32_bf16 a[4:7], v[104:107], v[32:35], a[4:7]
    ds_read_b64_tr_b16 v[64:65], v196 offset:32768
    v_accvgpr_read_b32 v215, a155
    v_mfma_f32_16x16x32_bf16 a[4:7], v[108:111], v[36:39], a[4:7]
    buffer_load_dwordx4 v4, s[8:11], s48 offen offset:2048 sc1 lds
    v_cvt_pk_bf16_f32 v216, v208, v209
    v_mfma_f32_16x16x32_bf16 a[8:11], v[112:115], v[32:35], a[8:11]
    ds_read_b64_tr_b16 v[66:67], v196 offset:34816
    v_cvt_pk_bf16_f32 v217, v210, v211
    v_mfma_f32_16x16x32_bf16 a[8:11], v[116:119], v[36:39], a[8:11]
    buffer_load_dwordx4 v5, s[8:11], s48 offen offset:3072 sc1 lds
    v_cvt_pk_bf16_f32 v218, v212, v213
    v_mfma_f32_16x16x32_bf16 a[12:15], v[120:123], v[32:35], a[12:15]
    ds_read_b64_tr_b16 v[68:69], v196 offset:40960
    v_cvt_pk_bf16_f32 v219, v214, v215
    v_mfma_f32_16x16x32_bf16 a[12:15], v[124:127], v[36:39], a[12:15]
    s_waitcnt lgkmcnt(3)
    v_mfma_f32_16x16x32_bf16 a[16:19], v[96:99], v[40:43], a[16:19]
    ds_read_b128 v[32:35], v18 offset:4096
    buffer_store_dwordx4 v[216:219], v14, s[8:11], s88 offen offset:2048 sc0 sc1
    v_mfma_f32_16x16x32_bf16 a[16:19], v[100:103], v[44:47], a[16:19]
    ds_read_b128 v[36:39], v19 offset:4096
    v_mfma_f32_16x16x32_bf16 a[20:23], v[104:107], v[40:43], a[20:23]
    ds_read_b64_tr_b16 v[70:71], v196 offset:43008
    v_mfma_f32_16x16x32_bf16 a[20:23], v[108:111], v[44:47], a[20:23]
    s_add_u32 m0, s40, 36864
    s_add_u32 s48, s36, 33152
    buffer_load_dwordx4 v2, s[8:11], s48 offen offset:0 sc1 lds
    v_mfma_f32_16x16x32_bf16 a[24:27], v[112:115], v[40:43], a[24:27]
    ds_read_b64_tr_b16 v[72:73], v197 offset:32768
    v_mfma_f32_16x16x32_bf16 a[24:27], v[116:119], v[44:47], a[24:27]
    v_mfma_f32_16x16x32_bf16 a[28:31], v[120:123], v[40:43], a[28:31]
    ds_read_b64_tr_b16 v[74:75], v197 offset:34816
    buffer_load_dwordx4 v3, s[8:11], s48 offen offset:1024 sc1 lds
    v_mfma_f32_16x16x32_bf16 a[28:31], v[124:127], v[44:47], a[28:31]
    s_waitcnt lgkmcnt(3)
    v_mfma_f32_16x16x32_bf16 a[32:35], v[96:99], v[32:35], a[32:35]
    ds_read_b128 v[40:43], v18 offset:6144
    v_mfma_f32_16x16x32_bf16 a[32:35], v[100:103], v[36:39], a[32:35]
    ds_read_b128 v[44:47], v19 offset:6144
    v_accvgpr_read_b32 v220, a140
    v_mfma_f32_16x16x32_bf16 a[36:39], v[104:107], v[32:35], a[36:39]
    ds_read_b64_tr_b16 v[76:77], v197 offset:40960
    v_accvgpr_read_b32 v221, a141
    v_mfma_f32_16x16x32_bf16 a[36:39], v[108:111], v[36:39], a[36:39]
    buffer_load_dwordx4 v4, s[8:11], s48 offen offset:2048 sc1 lds
    v_accvgpr_read_b32 v222, a142
    v_mfma_f32_16x16x32_bf16 a[40:43], v[112:115], v[32:35], a[40:43]
    v_accvgpr_read_b32 v223, a143
    v_mfma_f32_16x16x32_bf16 a[40:43], v[116:119], v[36:39], a[40:43]
    ds_read_b64_tr_b16 v[78:79], v197 offset:43008
    buffer_load_dwordx4 v5, s[8:11], s48 offen offset:3072 sc1 lds
    v_accvgpr_read_b32 v224, a156
    v_mfma_f32_16x16x32_bf16 a[44:47], v[120:123], v[32:35], a[44:47]
    v_accvgpr_read_b32 v225, a157
    v_mfma_f32_16x16x32_bf16 a[44:47], v[124:127], v[36:39], a[44:47]
    s_waitcnt lgkmcnt(2)
    v_mfma_f32_16x16x32_bf16 a[48:51], v[96:99], v[40:43], a[48:51]
    ds_read_b128 v[32:35], v18 offset:8192
    v_mfma_f32_16x16x32_bf16 a[48:51], v[100:103], v[44:47], a[48:51]
    ds_read_b128 v[36:39], v19 offset:8192
    v_accvgpr_read_b32 v226, a158
    v_mfma_f32_16x16x32_bf16 a[52:55], v[104:107], v[40:43], a[52:55]
    ds_read_b64_tr_b16 v[80:81], v196 offset:36864
    v_accvgpr_read_b32 v227, a159
    v_mfma_f32_16x16x32_bf16 a[52:55], v[108:111], v[44:47], a[52:55]
    s_add_u32 m0, s41, 114688
    s_add_u32 s48, s38, 880640
    buffer_load_dwordx4 v10, s[56:59], s48 offen offset:0 lds
    v_cvt_pk_bf16_f32 v228, v220, v221
    v_mfma_f32_16x16x32_bf16 a[56:59], v[112:115], v[40:43], a[56:59]
    ds_read_b64_tr_b16 v[82:83], v196 offset:38912
    v_cvt_pk_bf16_f32 v229, v222, v223
    v_mfma_f32_16x16x32_bf16 a[56:59], v[116:119], v[44:47], a[56:59]
    v_cvt_pk_bf16_f32 v230, v224, v225
    v_mfma_f32_16x16x32_bf16 a[60:63], v[120:123], v[40:43], a[60:63]
    ds_read_b64_tr_b16 v[84:85], v196 offset:45056
    buffer_load_dwordx4 v11, s[56:59], s48 offen offset:1024 lds
    v_cvt_pk_bf16_f32 v231, v226, v227
    v_mfma_f32_16x16x32_bf16 a[60:63], v[124:127], v[44:47], a[60:63]
    s_waitcnt lgkmcnt(3)
    v_mfma_f32_16x16x32_bf16 a[64:67], v[96:99], v[32:35], a[64:67]
    ds_read_b128 v[40:43], v18 offset:10240
    buffer_store_dwordx4 v[228:231], v14, s[8:11], s88 offen offset:2304 sc0 sc1
    v_mfma_f32_16x16x32_bf16 a[64:67], v[100:103], v[36:39], a[64:67]
    ds_read_b128 v[44:47], v19 offset:10240
    v_mfma_f32_16x16x32_bf16 a[68:71], v[104:107], v[32:35], a[68:71]
    ds_read_b64_tr_b16 v[86:87], v196 offset:47104
    v_mfma_f32_16x16x32_bf16 a[68:71], v[108:111], v[36:39], a[68:71]
    buffer_load_dwordx4 v12, s[56:59], s48 offen offset:2048 lds
    v_mfma_f32_16x16x32_bf16 a[72:75], v[112:115], v[32:35], a[72:75]
    ds_read_b64_tr_b16 v[88:89], v197 offset:36864
    v_mfma_f32_16x16x32_bf16 a[72:75], v[116:119], v[36:39], a[72:75]
    buffer_load_dwordx4 v13, s[56:59], s48 offen offset:3072 lds
    v_mfma_f32_16x16x32_bf16 a[76:79], v[120:123], v[32:35], a[76:79]
    ds_read_b64_tr_b16 v[90:91], v197 offset:38912
    v_mfma_f32_16x16x32_bf16 a[76:79], v[124:127], v[36:39], a[76:79]
    s_waitcnt lgkmcnt(3)
    v_mfma_f32_16x16x32_bf16 a[80:83], v[96:99], v[40:43], a[80:83]
    ds_read_b128 v[32:35], v18 offset:12288
    v_mfma_f32_16x16x32_bf16 a[80:83], v[100:103], v[44:47], a[80:83]
    ds_read_b128 v[36:39], v19 offset:12288
    v_accvgpr_read_b32 v208, a160
    v_mfma_f32_16x16x32_bf16 a[84:87], v[104:107], v[40:43], a[84:87]
    ds_read_b64_tr_b16 v[92:93], v197 offset:45056
    v_accvgpr_read_b32 v209, a161
    v_mfma_f32_16x16x32_bf16 a[84:87], v[108:111], v[44:47], a[84:87]
    v_accvgpr_read_b32 v210, a162
    v_mfma_f32_16x16x32_bf16 a[88:91], v[112:115], v[40:43], a[88:91]
    v_accvgpr_read_b32 v211, a163
    v_mfma_f32_16x16x32_bf16 a[88:91], v[116:119], v[44:47], a[88:91]
    ds_read_b64_tr_b16 v[94:95], v197 offset:47104
    v_accvgpr_read_b32 v212, a176
    v_mfma_f32_16x16x32_bf16 a[92:95], v[120:123], v[40:43], a[92:95]
    v_accvgpr_read_b32 v213, a177
    v_mfma_f32_16x16x32_bf16 a[92:95], v[124:127], v[44:47], a[92:95]
    s_waitcnt lgkmcnt(2)
    v_mfma_f32_16x16x32_bf16 a[96:99], v[96:99], v[32:35], a[96:99]
    ds_read_b128 v[40:43], v18 offset:14336
    v_mfma_f32_16x16x32_bf16 a[96:99], v[100:103], v[36:39], a[96:99]
    ds_read_b128 v[44:47], v19 offset:14336
    v_accvgpr_read_b32 v214, a178
    v_mfma_f32_16x16x32_bf16 a[100:103], v[104:107], v[32:35], a[100:103]
    v_accvgpr_read_b32 v215, a179
    v_mfma_f32_16x16x32_bf16 a[100:103], v[108:111], v[36:39], a[100:103]
    v_cvt_pk_bf16_f32 v216, v208, v209
    v_mfma_f32_16x16x32_bf16 a[104:107], v[112:115], v[32:35], a[104:107]
    v_cvt_pk_bf16_f32 v217, v210, v211
    v_mfma_f32_16x16x32_bf16 a[104:107], v[116:119], v[36:39], a[104:107]
    v_cvt_pk_bf16_f32 v218, v212, v213
    v_mfma_f32_16x16x32_bf16 a[108:111], v[120:123], v[32:35], a[108:111]
    v_cvt_pk_bf16_f32 v219, v214, v215
    v_mfma_f32_16x16x32_bf16 a[108:111], v[124:127], v[36:39], a[108:111]
    s_waitcnt lgkmcnt(0)
    v_mfma_f32_16x16x32_bf16 a[112:115], v[96:99], v[40:43], a[112:115]
    s_waitcnt vmcnt(20)
    s_barrier
    buffer_store_dwordx4 v[216:219], v14, s[8:11], s89 offen offset:0 sc0 sc1
    v_mfma_f32_16x16x32_bf16 a[112:115], v[100:103], v[44:47], a[112:115]
    ds_read_b128 v[32:35], v16 offset:0
    v_mfma_f32_16x16x32_bf16 a[116:119], v[104:107], v[40:43], a[116:119]
    ds_read_b128 v[36:39], v17 offset:0
    v_mfma_f32_16x16x32_bf16 a[116:119], v[108:111], v[44:47], a[116:119]
    s_add_u32 m0, s40, 65536
    s_add_u32 s48, s36, 512
    buffer_load_dwordx4 v2, s[8:11], s48 offen offset:0 sc1 lds
    v_mfma_f32_16x16x32_bf16 a[120:123], v[112:115], v[40:43], a[120:123]
    v_mfma_f32_16x16x32_bf16 a[120:123], v[116:119], v[44:47], a[120:123]
    v_mfma_f32_16x16x32_bf16 a[124:127], v[120:123], v[40:43], a[124:127]
    buffer_load_dwordx4 v3, s[8:11], s48 offen offset:1024 sc1 lds
    v_mfma_f32_16x16x32_bf16 a[124:127], v[124:127], v[44:47], a[124:127]
    s_waitcnt lgkmcnt(0)
    v_mfma_f32_16x16x32_bf16 a[0:3], v[64:67], v[32:35], a[0:3]
    ds_read_b128 v[40:43], v16 offset:2048
    v_mfma_f32_16x16x32_bf16 a[0:3], v[68:71], v[36:39], a[0:3]
    ds_read_b128 v[44:47], v17 offset:2048
    v_accvgpr_read_b32 v220, a164
    v_mfma_f32_16x16x32_bf16 a[4:7], v[72:75], v[32:35], a[4:7]
    ds_read_b64_tr_b16 v[96:97], v196 offset:49152
    v_accvgpr_read_b32 v221, a165
    v_mfma_f32_16x16x32_bf16 a[4:7], v[76:79], v[36:39], a[4:7]
    buffer_load_dwordx4 v4, s[8:11], s48 offen offset:2048 sc1 lds
    v_accvgpr_read_b32 v222, a166
    v_mfma_f32_16x16x32_bf16 a[8:11], v[80:83], v[32:35], a[8:11]
    ds_read_b64_tr_b16 v[98:99], v196 offset:51200
    v_accvgpr_read_b32 v223, a167
    v_mfma_f32_16x16x32_bf16 a[8:11], v[84:87], v[36:39], a[8:11]
    buffer_load_dwordx4 v5, s[8:11], s48 offen offset:3072 sc1 lds
    v_accvgpr_read_b32 v224, a180
    v_mfma_f32_16x16x32_bf16 a[12:15], v[88:91], v[32:35], a[12:15]
    ds_read_b64_tr_b16 v[100:101], v196 offset:57344
    v_accvgpr_read_b32 v225, a181
    v_mfma_f32_16x16x32_bf16 a[12:15], v[92:95], v[36:39], a[12:15]
    s_waitcnt lgkmcnt(3)
    v_mfma_f32_16x16x32_bf16 a[16:19], v[64:67], v[40:43], a[16:19]
    ds_read_b128 v[32:35], v16 offset:4096
    v_mfma_f32_16x16x32_bf16 a[16:19], v[68:71], v[44:47], a[16:19]
    ds_read_b128 v[36:39], v17 offset:4096
    v_accvgpr_read_b32 v226, a182
    v_mfma_f32_16x16x32_bf16 a[20:23], v[72:75], v[40:43], a[20:23]
    ds_read_b64_tr_b16 v[102:103], v196 offset:59392
    v_accvgpr_read_b32 v227, a183
    v_mfma_f32_16x16x32_bf16 a[20:23], v[76:79], v[44:47], a[20:23]
    s_add_u32 m0, s40, 69632
    s_add_u32 s48, s36, 33280
    buffer_load_dwordx4 v2, s[8:11], s48 offen offset:0 sc1 lds
    v_cvt_pk_bf16_f32 v228, v220, v221
    v_mfma_f32_16x16x32_bf16 a[24:27], v[80:83], v[40:43], a[24:27]
    ds_read_b64_tr_b16 v[104:105], v197 offset:49152
    v_cvt_pk_bf16_f32 v229, v222, v223
    v_mfma_f32_16x16x32_bf16 a[24:27], v[84:87], v[44:47], a[24:27]
    v_cvt_pk_bf16_f32 v230, v224, v225
    v_mfma_f32_16x16x32_bf16 a[28:31], v[88:91], v[40:43], a[28:31]
    ds_read_b64_tr_b16 v[106:107], v197 offset:51200
    buffer_load_dwordx4 v3, s[8:11], s48 offen offset:1024 sc1 lds
    v_cvt_pk_bf16_f32 v231, v226, v227
    v_mfma_f32_16x16x32_bf16 a[28:31], v[92:95], v[44:47], a[28:31]
    s_waitcnt lgkmcnt(3)
    v_mfma_f32_16x16x32_bf16 a[32:35], v[64:67], v[32:35], a[32:35]
    ds_read_b128 v[40:43], v16 offset:6144
    buffer_store_dwordx4 v[228:231], v14, s[8:11], s89 offen offset:256 sc0 sc1
    v_mfma_f32_16x16x32_bf16 a[32:35], v[68:71], v[36:39], a[32:35]
    ds_read_b128 v[44:47], v17 offset:6144
    v_mfma_f32_16x16x32_bf16 a[36:39], v[72:75], v[32:35], a[36:39]
    ds_read_b64_tr_b16 v[108:109], v197 offset:57344
    v_mfma_f32_16x16x32_bf16 a[36:39], v[76:79], v[36:39], a[36:39]
    buffer_load_dwordx4 v4, s[8:11], s48 offen offset:2048 sc1 lds
    v_mfma_f32_16x16x32_bf16 a[40:43], v[80:83], v[32:35], a[40:43]
    v_mfma_f32_16x16x32_bf16 a[40:43], v[84:87], v[36:39], a[40:43]
    ds_read_b64_tr_b16 v[110:111], v197 offset:59392
    buffer_load_dwordx4 v5, s[8:11], s48 offen offset:3072 sc1 lds
    v_mfma_f32_16x16x32_bf16 a[44:47], v[88:91], v[32:35], a[44:47]
    v_mfma_f32_16x16x32_bf16 a[44:47], v[92:95], v[36:39], a[44:47]
    s_waitcnt lgkmcnt(2)
    v_mfma_f32_16x16x32_bf16 a[48:51], v[64:67], v[40:43], a[48:51]
    ds_read_b128 v[32:35], v16 offset:8192
    v_mfma_f32_16x16x32_bf16 a[48:51], v[68:71], v[44:47], a[48:51]
    ds_read_b128 v[36:39], v17 offset:8192
    v_accvgpr_read_b32 v208, a168
    v_mfma_f32_16x16x32_bf16 a[52:55], v[72:75], v[40:43], a[52:55]
    ds_read_b64_tr_b16 v[112:113], v196 offset:53248
    v_accvgpr_read_b32 v209, a169
    v_mfma_f32_16x16x32_bf16 a[52:55], v[76:79], v[44:47], a[52:55]
    s_add_u32 m0, s41, 131072
    s_add_u32 s48, s38, 1056768
    buffer_load_dwordx4 v10, s[56:59], s48 offen offset:0 lds
    v_accvgpr_read_b32 v210, a170
    v_mfma_f32_16x16x32_bf16 a[56:59], v[80:83], v[40:43], a[56:59]
    ds_read_b64_tr_b16 v[114:115], v196 offset:55296
    v_accvgpr_read_b32 v211, a171
    v_mfma_f32_16x16x32_bf16 a[56:59], v[84:87], v[44:47], a[56:59]
    v_accvgpr_read_b32 v212, a184
    v_mfma_f32_16x16x32_bf16 a[60:63], v[88:91], v[40:43], a[60:63]
    ds_read_b64_tr_b16 v[116:117], v196 offset:61440
    buffer_load_dwordx4 v11, s[56:59], s48 offen offset:1024 lds
    v_accvgpr_read_b32 v213, a185
    v_mfma_f32_16x16x32_bf16 a[60:63], v[92:95], v[44:47], a[60:63]
    s_waitcnt lgkmcnt(3)
    v_mfma_f32_16x16x32_bf16 a[64:67], v[64:67], v[32:35], a[64:67]
    ds_read_b128 v[40:43], v16 offset:10240
    v_mfma_f32_16x16x32_bf16 a[64:67], v[68:71], v[36:39], a[64:67]
    ds_read_b128 v[44:47], v17 offset:10240
    v_accvgpr_read_b32 v214, a186
    v_mfma_f32_16x16x32_bf16 a[68:71], v[72:75], v[32:35], a[68:71]
    ds_read_b64_tr_b16 v[118:119], v196 offset:63488
    v_accvgpr_read_b32 v215, a187
    v_mfma_f32_16x16x32_bf16 a[68:71], v[76:79], v[36:39], a[68:71]
    buffer_load_dwordx4 v12, s[56:59], s48 offen offset:2048 lds
    v_cvt_pk_bf16_f32 v216, v208, v209
    v_mfma_f32_16x16x32_bf16 a[72:75], v[80:83], v[32:35], a[72:75]
    ds_read_b64_tr_b16 v[120:121], v197 offset:53248
    v_cvt_pk_bf16_f32 v217, v210, v211
    v_mfma_f32_16x16x32_bf16 a[72:75], v[84:87], v[36:39], a[72:75]
    buffer_load_dwordx4 v13, s[56:59], s48 offen offset:3072 lds
    v_cvt_pk_bf16_f32 v218, v212, v213
    v_mfma_f32_16x16x32_bf16 a[76:79], v[88:91], v[32:35], a[76:79]
    ds_read_b64_tr_b16 v[122:123], v197 offset:55296
    v_cvt_pk_bf16_f32 v219, v214, v215
    v_mfma_f32_16x16x32_bf16 a[76:79], v[92:95], v[36:39], a[76:79]
    s_waitcnt lgkmcnt(3)
    v_mfma_f32_16x16x32_bf16 a[80:83], v[64:67], v[40:43], a[80:83]
    ds_read_b128 v[32:35], v16 offset:12288
    buffer_store_dwordx4 v[216:219], v14, s[8:11], s89 offen offset:2048 sc0 sc1
    v_mfma_f32_16x16x32_bf16 a[80:83], v[68:71], v[44:47], a[80:83]
    ds_read_b128 v[36:39], v17 offset:12288
    v_mfma_f32_16x16x32_bf16 a[84:87], v[72:75], v[40:43], a[84:87]
    ds_read_b64_tr_b16 v[124:125], v197 offset:61440
    v_mfma_f32_16x16x32_bf16 a[84:87], v[76:79], v[44:47], a[84:87]
    v_mfma_f32_16x16x32_bf16 a[88:91], v[80:83], v[40:43], a[88:91]
    v_mfma_f32_16x16x32_bf16 a[88:91], v[84:87], v[44:47], a[88:91]
    ds_read_b64_tr_b16 v[126:127], v197 offset:63488
    v_mfma_f32_16x16x32_bf16 a[92:95], v[88:91], v[40:43], a[92:95]
    v_mfma_f32_16x16x32_bf16 a[92:95], v[92:95], v[44:47], a[92:95]
    s_waitcnt lgkmcnt(2)
    v_mfma_f32_16x16x32_bf16 a[96:99], v[64:67], v[32:35], a[96:99]
    ds_read_b128 v[40:43], v16 offset:14336
    v_mfma_f32_16x16x32_bf16 a[96:99], v[68:71], v[36:39], a[96:99]
    ds_read_b128 v[44:47], v17 offset:14336
    v_accvgpr_read_b32 v220, a172
    v_mfma_f32_16x16x32_bf16 a[100:103], v[72:75], v[32:35], a[100:103]
    v_accvgpr_read_b32 v221, a173
    v_mfma_f32_16x16x32_bf16 a[100:103], v[76:79], v[36:39], a[100:103]
    v_accvgpr_read_b32 v222, a174
    v_mfma_f32_16x16x32_bf16 a[104:107], v[80:83], v[32:35], a[104:107]
    v_accvgpr_read_b32 v223, a175
    v_mfma_f32_16x16x32_bf16 a[104:107], v[84:87], v[36:39], a[104:107]
    v_accvgpr_read_b32 v224, a188
    v_mfma_f32_16x16x32_bf16 a[108:111], v[88:91], v[32:35], a[108:111]
    v_accvgpr_read_b32 v225, a189
    v_mfma_f32_16x16x32_bf16 a[108:111], v[92:95], v[36:39], a[108:111]
    s_waitcnt lgkmcnt(0)
    v_mfma_f32_16x16x32_bf16 a[112:115], v[64:67], v[40:43], a[112:115]
    s_waitcnt vmcnt(20)
    s_barrier
    v_mfma_f32_16x16x32_bf16 a[112:115], v[68:71], v[44:47], a[112:115]
    ds_read_b128 v[32:35], v16 offset:32768
    v_accvgpr_read_b32 v226, a190
    v_mfma_f32_16x16x32_bf16 a[116:119], v[72:75], v[40:43], a[116:119]
    ds_read_b128 v[36:39], v17 offset:32768
    v_accvgpr_read_b32 v227, a191
    v_mfma_f32_16x16x32_bf16 a[116:119], v[76:79], v[44:47], a[116:119]
    s_add_u32 m0, s40, 0
    s_add_u32 s48, s36, 640
    buffer_load_dwordx4 v2, s[8:11], s48 offen offset:0 sc1 lds
    v_cvt_pk_bf16_f32 v228, v220, v221
    v_mfma_f32_16x16x32_bf16 a[120:123], v[80:83], v[40:43], a[120:123]
    v_cvt_pk_bf16_f32 v229, v222, v223
    v_mfma_f32_16x16x32_bf16 a[120:123], v[84:87], v[44:47], a[120:123]
    v_cvt_pk_bf16_f32 v230, v224, v225
    v_mfma_f32_16x16x32_bf16 a[124:127], v[88:91], v[40:43], a[124:127]
    buffer_load_dwordx4 v3, s[8:11], s48 offen offset:1024 sc1 lds
    v_cvt_pk_bf16_f32 v231, v226, v227
    v_mfma_f32_16x16x32_bf16 a[124:127], v[92:95], v[44:47], a[124:127]
    s_waitcnt lgkmcnt(0)
    v_mfma_f32_16x16x32_bf16 a[0:3], v[96:99], v[32:35], a[0:3]
    ds_read_b128 v[40:43], v16 offset:34816
    buffer_store_dwordx4 v[228:231], v14, s[8:11], s89 offen offset:2304 sc0 sc1
    v_mfma_f32_16x16x32_bf16 a[0:3], v[100:103], v[36:39], a[0:3]
    ds_read_b128 v[44:47], v17 offset:34816
    v_mfma_f32_16x16x32_bf16 a[4:7], v[104:107], v[32:35], a[4:7]
    ds_read_b64_tr_b16 v[64:65], v196 offset:0
    v_mfma_f32_16x16x32_bf16 a[4:7], v[108:111], v[36:39], a[4:7]
    buffer_load_dwordx4 v4, s[8:11], s48 offen offset:2048 sc1 lds
    v_mfma_f32_16x16x32_bf16 a[8:11], v[112:115], v[32:35], a[8:11]
    ds_read_b64_tr_b16 v[66:67], v196 offset:2048
    v_mfma_f32_16x16x32_bf16 a[8:11], v[116:119], v[36:39], a[8:11]
    buffer_load_dwordx4 v5, s[8:11], s48 offen offset:3072 sc1 lds
    v_mfma_f32_16x16x32_bf16 a[12:15], v[120:123], v[32:35], a[12:15]
    ds_read_b64_tr_b16 v[68:69], v196 offset:8192
    v_mfma_f32_16x16x32_bf16 a[12:15], v[124:127], v[36:39], a[12:15]
    s_waitcnt lgkmcnt(3)
    v_mfma_f32_16x16x32_bf16 a[16:19], v[96:99], v[40:43], a[16:19]
    ds_read_b128 v[32:35], v16 offset:36864
    v_mfma_f32_16x16x32_bf16 a[16:19], v[100:103], v[44:47], a[16:19]
    ds_read_b128 v[36:39], v17 offset:36864
    v_accvgpr_read_b32 v208, a192
    v_mfma_f32_16x16x32_bf16 a[20:23], v[104:107], v[40:43], a[20:23]
    ds_read_b64_tr_b16 v[70:71], v196 offset:10240
    v_accvgpr_read_b32 v209, a193
    v_mfma_f32_16x16x32_bf16 a[20:23], v[108:111], v[44:47], a[20:23]
    s_add_u32 m0, s40, 4096
    s_add_u32 s48, s36, 33408
    buffer_load_dwordx4 v2, s[8:11], s48 offen offset:0 sc1 lds
    v_accvgpr_read_b32 v210, a194
    v_mfma_f32_16x16x32_bf16 a[24:27], v[112:115], v[40:43], a[24:27]
    ds_read_b64_tr_b16 v[72:73], v197 offset:0
    v_accvgpr_read_b32 v211, a195
    v_mfma_f32_16x16x32_bf16 a[24:27], v[116:119], v[44:47], a[24:27]
    v_accvgpr_read_b32 v212, a208
    v_mfma_f32_16x16x32_bf16 a[28:31], v[120:123], v[40:43], a[28:31]
    ds_read_b64_tr_b16 v[74:75], v197 offset:2048
    buffer_load_dwordx4 v3, s[8:11], s48 offen offset:1024 sc1 lds
    v_accvgpr_read_b32 v213, a209
    v_mfma_f32_16x16x32_bf16 a[28:31], v[124:127], v[44:47], a[28:31]
    s_waitcnt lgkmcnt(3)
    v_mfma_f32_16x16x32_bf16 a[32:35], v[96:99], v[32:35], a[32:35]
    ds_read_b128 v[40:43], v16 offset:38912
    v_mfma_f32_16x16x32_bf16 a[32:35], v[100:103], v[36:39], a[32:35]
    ds_read_b128 v[44:47], v17 offset:38912
    v_accvgpr_read_b32 v214, a210
    v_mfma_f32_16x16x32_bf16 a[36:39], v[104:107], v[32:35], a[36:39]
    ds_read_b64_tr_b16 v[76:77], v197 offset:8192
    v_accvgpr_read_b32 v215, a211
    v_mfma_f32_16x16x32_bf16 a[36:39], v[108:111], v[36:39], a[36:39]
    buffer_load_dwordx4 v4, s[8:11], s48 offen offset:2048 sc1 lds
    v_cvt_pk_bf16_f32 v216, v208, v209
    v_mfma_f32_16x16x32_bf16 a[40:43], v[112:115], v[32:35], a[40:43]
    v_cvt_pk_bf16_f32 v217, v210, v211
    v_mfma_f32_16x16x32_bf16 a[40:43], v[116:119], v[36:39], a[40:43]
    ds_read_b64_tr_b16 v[78:79], v197 offset:10240
    buffer_load_dwordx4 v5, s[8:11], s48 offen offset:3072 sc1 lds
    v_cvt_pk_bf16_f32 v218, v212, v213
    v_mfma_f32_16x16x32_bf16 a[44:47], v[120:123], v[32:35], a[44:47]
    v_cvt_pk_bf16_f32 v219, v214, v215
    v_mfma_f32_16x16x32_bf16 a[44:47], v[124:127], v[36:39], a[44:47]
    s_waitcnt lgkmcnt(2)
    v_mfma_f32_16x16x32_bf16 a[48:51], v[96:99], v[40:43], a[48:51]
    ds_read_b128 v[32:35], v16 offset:40960
    buffer_store_dwordx4 v[216:219], v14, s[8:11], s90 offen offset:0 sc0 sc1
    v_mfma_f32_16x16x32_bf16 a[48:51], v[100:103], v[44:47], a[48:51]
    ds_read_b128 v[36:39], v17 offset:40960
    v_mfma_f32_16x16x32_bf16 a[52:55], v[104:107], v[40:43], a[52:55]
    ds_read_b64_tr_b16 v[80:81], v196 offset:4096
    v_mfma_f32_16x16x32_bf16 a[52:55], v[108:111], v[44:47], a[52:55]
    s_add_u32 m0, s41, 147456
    s_add_u32 s48, s38, 1232896
    buffer_load_dwordx4 v10, s[56:59], s48 offen offset:0 lds
    v_mfma_f32_16x16x32_bf16 a[56:59], v[112:115], v[40:43], a[56:59]
    ds_read_b64_tr_b16 v[82:83], v196 offset:6144
    v_mfma_f32_16x16x32_bf16 a[56:59], v[116:119], v[44:47], a[56:59]
    v_mfma_f32_16x16x32_bf16 a[60:63], v[120:123], v[40:43], a[60:63]
    ds_read_b64_tr_b16 v[84:85], v196 offset:12288
    buffer_load_dwordx4 v11, s[56:59], s48 offen offset:1024 lds
    v_mfma_f32_16x16x32_bf16 a[60:63], v[124:127], v[44:47], a[60:63]
    s_waitcnt lgkmcnt(3)
    v_mfma_f32_16x16x32_bf16 a[64:67], v[96:99], v[32:35], a[64:67]
    ds_read_b128 v[40:43], v16 offset:43008
    v_mfma_f32_16x16x32_bf16 a[64:67], v[100:103], v[36:39], a[64:67]
    ds_read_b128 v[44:47], v17 offset:43008
    v_accvgpr_read_b32 v220, a196
    v_mfma_f32_16x16x32_bf16 a[68:71], v[104:107], v[32:35], a[68:71]
    ds_read_b64_tr_b16 v[86:87], v196 offset:14336
    v_accvgpr_read_b32 v221, a197
    v_mfma_f32_16x16x32_bf16 a[68:71], v[108:111], v[36:39], a[68:71]
    buffer_load_dwordx4 v12, s[56:59], s48 offen offset:2048 lds
    v_accvgpr_read_b32 v222, a198
    v_mfma_f32_16x16x32_bf16 a[72:75], v[112:115], v[32:35], a[72:75]
    ds_read_b64_tr_b16 v[88:89], v197 offset:4096
    v_accvgpr_read_b32 v223, a199
    v_mfma_f32_16x16x32_bf16 a[72:75], v[116:119], v[36:39], a[72:75]
    buffer_load_dwordx4 v13, s[56:59], s48 offen offset:3072 lds
    v_accvgpr_read_b32 v224, a212
    v_mfma_f32_16x16x32_bf16 a[76:79], v[120:123], v[32:35], a[76:79]
    ds_read_b64_tr_b16 v[90:91], v197 offset:6144
    v_accvgpr_read_b32 v225, a213
    v_mfma_f32_16x16x32_bf16 a[76:79], v[124:127], v[36:39], a[76:79]
    s_waitcnt lgkmcnt(3)
    v_mfma_f32_16x16x32_bf16 a[80:83], v[96:99], v[40:43], a[80:83]
    ds_read_b128 v[32:35], v16 offset:45056
    v_mfma_f32_16x16x32_bf16 a[80:83], v[100:103], v[44:47], a[80:83]
    ds_read_b128 v[36:39], v17 offset:45056
    v_accvgpr_read_b32 v226, a214
    v_mfma_f32_16x16x32_bf16 a[84:87], v[104:107], v[40:43], a[84:87]
    ds_read_b64_tr_b16 v[92:93], v197 offset:12288
    v_accvgpr_read_b32 v227, a215
    v_mfma_f32_16x16x32_bf16 a[84:87], v[108:111], v[44:47], a[84:87]
    v_cvt_pk_bf16_f32 v228, v220, v221
    v_mfma_f32_16x16x32_bf16 a[88:91], v[112:115], v[40:43], a[88:91]
    v_cvt_pk_bf16_f32 v229, v222, v223
    v_mfma_f32_16x16x32_bf16 a[88:91], v[116:119], v[44:47], a[88:91]
    ds_read_b64_tr_b16 v[94:95], v197 offset:14336
    v_cvt_pk_bf16_f32 v230, v224, v225
    v_mfma_f32_16x16x32_bf16 a[92:95], v[120:123], v[40:43], a[92:95]
    v_cvt_pk_bf16_f32 v231, v226, v227
    v_mfma_f32_16x16x32_bf16 a[92:95], v[124:127], v[44:47], a[92:95]
    s_waitcnt lgkmcnt(2)
    v_mfma_f32_16x16x32_bf16 a[96:99], v[96:99], v[32:35], a[96:99]
    ds_read_b128 v[40:43], v16 offset:47104
    buffer_store_dwordx4 v[228:231], v14, s[8:11], s90 offen offset:256 sc0 sc1
    v_mfma_f32_16x16x32_bf16 a[96:99], v[100:103], v[36:39], a[96:99]
    ds_read_b128 v[44:47], v17 offset:47104
    v_mfma_f32_16x16x32_bf16 a[100:103], v[104:107], v[32:35], a[100:103]
    v_mfma_f32_16x16x32_bf16 a[100:103], v[108:111], v[36:39], a[100:103]
    v_mfma_f32_16x16x32_bf16 a[104:107], v[112:115], v[32:35], a[104:107]
    v_mfma_f32_16x16x32_bf16 a[104:107], v[116:119], v[36:39], a[104:107]
    v_mfma_f32_16x16x32_bf16 a[108:111], v[120:123], v[32:35], a[108:111]
    v_mfma_f32_16x16x32_bf16 a[108:111], v[124:127], v[36:39], a[108:111]
    s_waitcnt lgkmcnt(0)
    v_mfma_f32_16x16x32_bf16 a[112:115], v[96:99], v[40:43], a[112:115]
    s_waitcnt vmcnt(20)
    s_barrier
    v_mfma_f32_16x16x32_bf16 a[112:115], v[100:103], v[44:47], a[112:115]
    ds_read_b128 v[32:35], v18 offset:0
    v_accvgpr_read_b32 v208, a200
    v_mfma_f32_16x16x32_bf16 a[116:119], v[104:107], v[40:43], a[116:119]
    ds_read_b128 v[36:39], v19 offset:0
    v_accvgpr_read_b32 v209, a201
    v_mfma_f32_16x16x32_bf16 a[116:119], v[108:111], v[44:47], a[116:119]
    s_add_u32 m0, s40, 32768
    s_add_u32 s48, s36, 768
    buffer_load_dwordx4 v2, s[8:11], s48 offen offset:0 sc1 lds
    v_accvgpr_read_b32 v210, a202
    v_mfma_f32_16x16x32_bf16 a[120:123], v[112:115], v[40:43], a[120:123]
    v_accvgpr_read_b32 v211, a203
    v_mfma_f32_16x16x32_bf16 a[120:123], v[116:119], v[44:47], a[120:123]
    v_accvgpr_read_b32 v212, a216
    v_mfma_f32_16x16x32_bf16 a[124:127], v[120:123], v[40:43], a[124:127]
    buffer_load_dwordx4 v3, s[8:11], s48 offen offset:1024 sc1 lds
    v_accvgpr_read_b32 v213, a217
    v_mfma_f32_16x16x32_bf16 a[124:127], v[124:127], v[44:47], a[124:127]
    s_waitcnt lgkmcnt(0)
    v_mfma_f32_16x16x32_bf16 a[0:3], v[64:67], v[32:35], a[0:3]
    ds_read_b128 v[40:43], v18 offset:2048
    v_mfma_f32_16x16x32_bf16 a[0:3], v[68:71], v[36:39], a[0:3]
    ds_read_b128 v[44:47], v19 offset:2048
    v_accvgpr_read_b32 v214, a218
    v_mfma_f32_16x16x32_bf16 a[4:7], v[72:75], v[32:35], a[4:7]
    ds_read_b64_tr_b16 v[96:97], v196 offset:16384
    v_accvgpr_read_b32 v215, a219
    v_mfma_f32_16x16x32_bf16 a[4:7], v[76:79], v[36:39], a[4:7]
    buffer_load_dwordx4 v4, s[8:11], s48 offen offset:2048 sc1 lds
    v_cvt_pk_bf16_f32 v216, v208, v209
    v_mfma_f32_16x16x32_bf16 a[8:11], v[80:83], v[32:35], a[8:11]
    ds_read_b64_tr_b16 v[98:99], v196 offset:18432
    v_cvt_pk_bf16_f32 v217, v210, v211
    v_mfma_f32_16x16x32_bf16 a[8:11], v[84:87], v[36:39], a[8:11]
    buffer_load_dwordx4 v5, s[8:11], s48 offen offset:3072 sc1 lds
    v_cvt_pk_bf16_f32 v218, v212, v213
    v_mfma_f32_16x16x32_bf16 a[12:15], v[88:91], v[32:35], a[12:15]
    ds_read_b64_tr_b16 v[100:101], v196 offset:24576
    v_cvt_pk_bf16_f32 v219, v214, v215
    v_mfma_f32_16x16x32_bf16 a[12:15], v[92:95], v[36:39], a[12:15]
    s_waitcnt lgkmcnt(3)
    v_mfma_f32_16x16x32_bf16 a[16:19], v[64:67], v[40:43], a[16:19]
    ds_read_b128 v[32:35], v18 offset:4096
    buffer_store_dwordx4 v[216:219], v14, s[8:11], s90 offen offset:2048 sc0 sc1
    v_mfma_f32_16x16x32_bf16 a[16:19], v[68:71], v[44:47], a[16:19]
    ds_read_b128 v[36:39], v19 offset:4096
    v_mfma_f32_16x16x32_bf16 a[20:23], v[72:75], v[40:43], a[20:23]
    ds_read_b64_tr_b16 v[102:103], v196 offset:26624
    v_mfma_f32_16x16x32_bf16 a[20:23], v[76:79], v[44:47], a[20:23]
    s_add_u32 m0, s40, 36864
    s_add_u32 s48, s36, 33536
    buffer_load_dwordx4 v2, s[8:11], s48 offen offset:0 sc1 lds
    v_mfma_f32_16x16x32_bf16 a[24:27], v[80:83], v[40:43], a[24:27]
    ds_read_b64_tr_b16 v[104:105], v197 offset:16384
    v_mfma_f32_16x16x32_bf16 a[24:27], v[84:87], v[44:47], a[24:27]
    v_mfma_f32_16x16x32_bf16 a[28:31], v[88:91], v[40:43], a[28:31]
    ds_read_b64_tr_b16 v[106:107], v197 offset:18432
    buffer_load_dwordx4 v3, s[8:11], s48 offen offset:1024 sc1 lds
    v_mfma_f32_16x16x32_bf16 a[28:31], v[92:95], v[44:47], a[28:31]
    s_waitcnt lgkmcnt(3)
    v_mfma_f32_16x16x32_bf16 a[32:35], v[64:67], v[32:35], a[32:35]
    ds_read_b128 v[40:43], v18 offset:6144
    v_mfma_f32_16x16x32_bf16 a[32:35], v[68:71], v[36:39], a[32:35]
    ds_read_b128 v[44:47], v19 offset:6144
    v_accvgpr_read_b32 v220, a204
    v_mfma_f32_16x16x32_bf16 a[36:39], v[72:75], v[32:35], a[36:39]
    ds_read_b64_tr_b16 v[108:109], v197 offset:24576
    v_accvgpr_read_b32 v221, a205
    v_mfma_f32_16x16x32_bf16 a[36:39], v[76:79], v[36:39], a[36:39]
    buffer_load_dwordx4 v4, s[8:11], s48 offen offset:2048 sc1 lds
    v_accvgpr_read_b32 v222, a206
    v_mfma_f32_16x16x32_bf16 a[40:43], v[80:83], v[32:35], a[40:43]
    v_accvgpr_read_b32 v223, a207
    v_mfma_f32_16x16x32_bf16 a[40:43], v[84:87], v[36:39], a[40:43]
    ds_read_b64_tr_b16 v[110:111], v197 offset:26624
    buffer_load_dwordx4 v5, s[8:11], s48 offen offset:3072 sc1 lds
    v_accvgpr_read_b32 v224, a220
    v_mfma_f32_16x16x32_bf16 a[44:47], v[88:91], v[32:35], a[44:47]
    v_accvgpr_read_b32 v225, a221
    v_mfma_f32_16x16x32_bf16 a[44:47], v[92:95], v[36:39], a[44:47]
    s_waitcnt lgkmcnt(2)
    v_mfma_f32_16x16x32_bf16 a[48:51], v[64:67], v[40:43], a[48:51]
    ds_read_b128 v[32:35], v18 offset:8192
    v_mfma_f32_16x16x32_bf16 a[48:51], v[68:71], v[44:47], a[48:51]
    ds_read_b128 v[36:39], v19 offset:8192
    v_accvgpr_read_b32 v226, a222
    v_mfma_f32_16x16x32_bf16 a[52:55], v[72:75], v[40:43], a[52:55]
    ds_read_b64_tr_b16 v[112:113], v196 offset:20480
    v_accvgpr_read_b32 v227, a223
    v_mfma_f32_16x16x32_bf16 a[52:55], v[76:79], v[44:47], a[52:55]
    s_add_u32 m0, s41, 98304
    s_add_u32 s48, s37, 0
    buffer_load_dwordx4 v6, s[60:63], s48 offen offset:0 lds
    v_cvt_pk_bf16_f32 v228, v220, v221
    v_mfma_f32_16x16x32_bf16 a[56:59], v[80:83], v[40:43], a[56:59]
    ds_read_b64_tr_b16 v[114:115], v196 offset:22528
    v_cvt_pk_bf16_f32 v229, v222, v223
    v_mfma_f32_16x16x32_bf16 a[56:59], v[84:87], v[44:47], a[56:59]
    v_cvt_pk_bf16_f32 v230, v224, v225
    v_mfma_f32_16x16x32_bf16 a[60:63], v[88:91], v[40:43], a[60:63]
    ds_read_b64_tr_b16 v[116:117], v196 offset:28672
    buffer_load_dwordx4 v7, s[60:63], s48 offen offset:1024 lds
    v_cvt_pk_bf16_f32 v231, v226, v227
    v_mfma_f32_16x16x32_bf16 a[60:63], v[92:95], v[44:47], a[60:63]
    s_waitcnt lgkmcnt(3)
    v_mfma_f32_16x16x32_bf16 a[64:67], v[64:67], v[32:35], a[64:67]
    ds_read_b128 v[40:43], v18 offset:10240
    buffer_store_dwordx4 v[228:231], v14, s[8:11], s90 offen offset:2304 sc0 sc1
    v_mfma_f32_16x16x32_bf16 a[64:67], v[68:71], v[36:39], a[64:67]
    ds_read_b128 v[44:47], v19 offset:10240
    v_mfma_f32_16x16x32_bf16 a[68:71], v[72:75], v[32:35], a[68:71]
    ds_read_b64_tr_b16 v[118:119], v196 offset:30720
    v_mfma_f32_16x16x32_bf16 a[68:71], v[76:79], v[36:39], a[68:71]
    buffer_load_dwordx4 v8, s[60:63], s48 offen offset:2048 lds
    v_mfma_f32_16x16x32_bf16 a[72:75], v[80:83], v[32:35], a[72:75]
    ds_read_b64_tr_b16 v[120:121], v197 offset:20480
    v_mfma_f32_16x16x32_bf16 a[72:75], v[84:87], v[36:39], a[72:75]
    buffer_load_dwordx4 v9, s[60:63], s48 offen offset:3072 lds
    v_mfma_f32_16x16x32_bf16 a[76:79], v[88:91], v[32:35], a[76:79]
    ds_read_b64_tr_b16 v[122:123], v197 offset:22528
    v_mfma_f32_16x16x32_bf16 a[76:79], v[92:95], v[36:39], a[76:79]
    s_waitcnt lgkmcnt(3)
    v_mfma_f32_16x16x32_bf16 a[80:83], v[64:67], v[40:43], a[80:83]
    ds_read_b128 v[32:35], v18 offset:12288
    v_mfma_f32_16x16x32_bf16 a[80:83], v[68:71], v[44:47], a[80:83]
    ds_read_b128 v[36:39], v19 offset:12288
    v_accvgpr_read_b32 v208, a224
    v_mfma_f32_16x16x32_bf16 a[84:87], v[72:75], v[40:43], a[84:87]
    ds_read_b64_tr_b16 v[124:125], v197 offset:28672
    v_accvgpr_read_b32 v209, a225
    v_mfma_f32_16x16x32_bf16 a[84:87], v[76:79], v[44:47], a[84:87]
    v_accvgpr_read_b32 v210, a226
    v_mfma_f32_16x16x32_bf16 a[88:91], v[80:83], v[40:43], a[88:91]
    v_accvgpr_read_b32 v211, a227
    v_mfma_f32_16x16x32_bf16 a[88:91], v[84:87], v[44:47], a[88:91]
    ds_read_b64_tr_b16 v[126:127], v197 offset:30720
    v_accvgpr_read_b32 v212, a240
    v_mfma_f32_16x16x32_bf16 a[92:95], v[88:91], v[40:43], a[92:95]
    v_accvgpr_read_b32 v213, a241
    v_mfma_f32_16x16x32_bf16 a[92:95], v[92:95], v[44:47], a[92:95]
    s_waitcnt lgkmcnt(2)
    v_mfma_f32_16x16x32_bf16 a[96:99], v[64:67], v[32:35], a[96:99]
    ds_read_b128 v[40:43], v18 offset:14336
    v_mfma_f32_16x16x32_bf16 a[96:99], v[68:71], v[36:39], a[96:99]
    ds_read_b128 v[44:47], v19 offset:14336
    v_accvgpr_read_b32 v214, a242
    v_mfma_f32_16x16x32_bf16 a[100:103], v[72:75], v[32:35], a[100:103]
    v_accvgpr_read_b32 v215, a243
    v_mfma_f32_16x16x32_bf16 a[100:103], v[76:79], v[36:39], a[100:103]
    v_cvt_pk_bf16_f32 v216, v208, v209
    v_mfma_f32_16x16x32_bf16 a[104:107], v[80:83], v[32:35], a[104:107]
    v_cvt_pk_bf16_f32 v217, v210, v211
    v_mfma_f32_16x16x32_bf16 a[104:107], v[84:87], v[36:39], a[104:107]
    v_cvt_pk_bf16_f32 v218, v212, v213
    v_mfma_f32_16x16x32_bf16 a[108:111], v[88:91], v[32:35], a[108:111]
    v_cvt_pk_bf16_f32 v219, v214, v215
    v_mfma_f32_16x16x32_bf16 a[108:111], v[92:95], v[36:39], a[108:111]
    s_waitcnt lgkmcnt(0)
    v_mfma_f32_16x16x32_bf16 a[112:115], v[64:67], v[40:43], a[112:115]
    s_waitcnt vmcnt(20)
    s_barrier
    buffer_store_dwordx4 v[216:219], v14, s[8:11], s91 offen offset:0 sc0 sc1
    v_mfma_f32_16x16x32_bf16 a[112:115], v[68:71], v[44:47], a[112:115]
    ds_read_b128 v[32:35], v16 offset:0
    v_mfma_f32_16x16x32_bf16 a[116:119], v[72:75], v[40:43], a[116:119]
    ds_read_b128 v[36:39], v17 offset:0
    v_mfma_f32_16x16x32_bf16 a[116:119], v[76:79], v[44:47], a[116:119]
    s_add_u32 m0, s40, 65536
    s_add_u32 s48, s36, 896
    buffer_load_dwordx4 v2, s[8:11], s48 offen offset:0 sc1 lds
    v_mfma_f32_16x16x32_bf16 a[120:123], v[80:83], v[40:43], a[120:123]
    v_mfma_f32_16x16x32_bf16 a[120:123], v[84:87], v[44:47], a[120:123]
    v_mfma_f32_16x16x32_bf16 a[124:127], v[88:91], v[40:43], a[124:127]
    buffer_load_dwordx4 v3, s[8:11], s48 offen offset:1024 sc1 lds
    v_mfma_f32_16x16x32_bf16 a[124:127], v[92:95], v[44:47], a[124:127]
    s_waitcnt lgkmcnt(0)
    v_mfma_f32_16x16x32_bf16 a[0:3], v[96:99], v[32:35], a[0:3]
    ds_read_b128 v[40:43], v16 offset:2048
    v_mfma_f32_16x16x32_bf16 a[0:3], v[100:103], v[36:39], a[0:3]
    ds_read_b128 v[44:47], v17 offset:2048
    v_accvgpr_read_b32 v220, a228
    v_mfma_f32_16x16x32_bf16 a[4:7], v[104:107], v[32:35], a[4:7]
    ds_read_b64_tr_b16 v[64:65], v196 offset:32768
    v_accvgpr_read_b32 v221, a229
    v_mfma_f32_16x16x32_bf16 a[4:7], v[108:111], v[36:39], a[4:7]
    buffer_load_dwordx4 v4, s[8:11], s48 offen offset:2048 sc1 lds
    v_accvgpr_read_b32 v222, a230
    v_mfma_f32_16x16x32_bf16 a[8:11], v[112:115], v[32:35], a[8:11]
    ds_read_b64_tr_b16 v[66:67], v196 offset:34816
    v_accvgpr_read_b32 v223, a231
    v_mfma_f32_16x16x32_bf16 a[8:11], v[116:119], v[36:39], a[8:11]
    buffer_load_dwordx4 v5, s[8:11], s48 offen offset:3072 sc1 lds
    v_accvgpr_read_b32 v224, a244
    v_mfma_f32_16x16x32_bf16 a[12:15], v[120:123], v[32:35], a[12:15]
    ds_read_b64_tr_b16 v[68:69], v196 offset:40960
    v_accvgpr_read_b32 v225, a245
    v_mfma_f32_16x16x32_bf16 a[12:15], v[124:127], v[36:39], a[12:15]
    s_waitcnt lgkmcnt(3)
    v_mfma_f32_16x16x32_bf16 a[16:19], v[96:99], v[40:43], a[16:19]
    ds_read_b128 v[32:35], v16 offset:4096
    v_mfma_f32_16x16x32_bf16 a[16:19], v[100:103], v[44:47], a[16:19]
    ds_read_b128 v[36:39], v17 offset:4096
    v_accvgpr_read_b32 v226, a246
    v_mfma_f32_16x16x32_bf16 a[20:23], v[104:107], v[40:43], a[20:23]
    ds_read_b64_tr_b16 v[70:71], v196 offset:43008
    v_accvgpr_read_b32 v227, a247
    v_mfma_f32_16x16x32_bf16 a[20:23], v[108:111], v[44:47], a[20:23]
    s_add_u32 m0, s40, 69632
    s_add_u32 s48, s36, 33664
    buffer_load_dwordx4 v2, s[8:11], s48 offen offset:0 sc1 lds
    v_cvt_pk_bf16_f32 v228, v220, v221
    v_mfma_f32_16x16x32_bf16 a[24:27], v[112:115], v[40:43], a[24:27]
    ds_read_b64_tr_b16 v[72:73], v197 offset:32768
    v_cvt_pk_bf16_f32 v229, v222, v223
    v_mfma_f32_16x16x32_bf16 a[24:27], v[116:119], v[44:47], a[24:27]
    v_cvt_pk_bf16_f32 v230, v224, v225
    v_mfma_f32_16x16x32_bf16 a[28:31], v[120:123], v[40:43], a[28:31]
    ds_read_b64_tr_b16 v[74:75], v197 offset:34816
    buffer_load_dwordx4 v3, s[8:11], s48 offen offset:1024 sc1 lds
    v_cvt_pk_bf16_f32 v231, v226, v227
    v_mfma_f32_16x16x32_bf16 a[28:31], v[124:127], v[44:47], a[28:31]
    s_waitcnt lgkmcnt(3)
    v_mfma_f32_16x16x32_bf16 a[32:35], v[96:99], v[32:35], a[32:35]
    ds_read_b128 v[40:43], v16 offset:6144
    buffer_store_dwordx4 v[228:231], v14, s[8:11], s91 offen offset:256 sc0 sc1
    v_mfma_f32_16x16x32_bf16 a[32:35], v[100:103], v[36:39], a[32:35]
    ds_read_b128 v[44:47], v17 offset:6144
    v_mfma_f32_16x16x32_bf16 a[36:39], v[104:107], v[32:35], a[36:39]
    ds_read_b64_tr_b16 v[76:77], v197 offset:40960
    v_mfma_f32_16x16x32_bf16 a[36:39], v[108:111], v[36:39], a[36:39]
    buffer_load_dwordx4 v4, s[8:11], s48 offen offset:2048 sc1 lds
    v_mfma_f32_16x16x32_bf16 a[40:43], v[112:115], v[32:35], a[40:43]
    v_mfma_f32_16x16x32_bf16 a[40:43], v[116:119], v[36:39], a[40:43]
    ds_read_b64_tr_b16 v[78:79], v197 offset:43008
    buffer_load_dwordx4 v5, s[8:11], s48 offen offset:3072 sc1 lds
    v_mfma_f32_16x16x32_bf16 a[44:47], v[120:123], v[32:35], a[44:47]
    v_mfma_f32_16x16x32_bf16 a[44:47], v[124:127], v[36:39], a[44:47]
    s_waitcnt lgkmcnt(2)
    v_mfma_f32_16x16x32_bf16 a[48:51], v[96:99], v[40:43], a[48:51]
    ds_read_b128 v[32:35], v16 offset:8192
    v_mfma_f32_16x16x32_bf16 a[48:51], v[100:103], v[44:47], a[48:51]
    ds_read_b128 v[36:39], v17 offset:8192
    v_accvgpr_read_b32 v208, a232
    v_mfma_f32_16x16x32_bf16 a[52:55], v[104:107], v[40:43], a[52:55]
    ds_read_b64_tr_b16 v[80:81], v196 offset:36864
    v_accvgpr_read_b32 v209, a233
    v_mfma_f32_16x16x32_bf16 a[52:55], v[108:111], v[44:47], a[52:55]
    s_add_u32 m0, s41, 114688
    s_add_u32 s48, s37, 524288
    buffer_load_dwordx4 v6, s[60:63], s48 offen offset:0 lds
    v_accvgpr_read_b32 v210, a234
    v_mfma_f32_16x16x32_bf16 a[56:59], v[112:115], v[40:43], a[56:59]
    ds_read_b64_tr_b16 v[82:83], v196 offset:38912
    v_accvgpr_read_b32 v211, a235
    v_mfma_f32_16x16x32_bf16 a[56:59], v[116:119], v[44:47], a[56:59]
    v_accvgpr_read_b32 v212, a248
    v_mfma_f32_16x16x32_bf16 a[60:63], v[120:123], v[40:43], a[60:63]
    ds_read_b64_tr_b16 v[84:85], v196 offset:45056
    buffer_load_dwordx4 v7, s[60:63], s48 offen offset:1024 lds
    v_accvgpr_read_b32 v213, a249
    v_mfma_f32_16x16x32_bf16 a[60:63], v[124:127], v[44:47], a[60:63]
    s_waitcnt lgkmcnt(3)
    v_mfma_f32_16x16x32_bf16 a[64:67], v[96:99], v[32:35], a[64:67]
    ds_read_b128 v[40:43], v16 offset:10240
    v_mfma_f32_16x16x32_bf16 a[64:67], v[100:103], v[36:39], a[64:67]
    ds_read_b128 v[44:47], v17 offset:10240
    v_accvgpr_read_b32 v214, a250
    v_mfma_f32_16x16x32_bf16 a[68:71], v[104:107], v[32:35], a[68:71]
    ds_read_b64_tr_b16 v[86:87], v196 offset:47104
    v_accvgpr_read_b32 v215, a251
    v_mfma_f32_16x16x32_bf16 a[68:71], v[108:111], v[36:39], a[68:71]
    buffer_load_dwordx4 v8, s[60:63], s48 offen offset:2048 lds
    v_cvt_pk_bf16_f32 v216, v208, v209
    v_mfma_f32_16x16x32_bf16 a[72:75], v[112:115], v[32:35], a[72:75]
    ds_read_b64_tr_b16 v[88:89], v197 offset:36864
    v_cvt_pk_bf16_f32 v217, v210, v211
    v_mfma_f32_16x16x32_bf16 a[72:75], v[116:119], v[36:39], a[72:75]
    buffer_load_dwordx4 v9, s[60:63], s48 offen offset:3072 lds
    v_cvt_pk_bf16_f32 v218, v212, v213
    v_mfma_f32_16x16x32_bf16 a[76:79], v[120:123], v[32:35], a[76:79]
    ds_read_b64_tr_b16 v[90:91], v197 offset:38912
    v_cvt_pk_bf16_f32 v219, v214, v215
    v_mfma_f32_16x16x32_bf16 a[76:79], v[124:127], v[36:39], a[76:79]
    s_waitcnt lgkmcnt(3)
    v_mfma_f32_16x16x32_bf16 a[80:83], v[96:99], v[40:43], a[80:83]
    ds_read_b128 v[32:35], v16 offset:12288
    buffer_store_dwordx4 v[216:219], v14, s[8:11], s91 offen offset:2048 sc0 sc1
    v_mfma_f32_16x16x32_bf16 a[80:83], v[100:103], v[44:47], a[80:83]
    ds_read_b128 v[36:39], v17 offset:12288
    v_mfma_f32_16x16x32_bf16 a[84:87], v[104:107], v[40:43], a[84:87]
    ds_read_b64_tr_b16 v[92:93], v197 offset:45056
    v_mfma_f32_16x16x32_bf16 a[84:87], v[108:111], v[44:47], a[84:87]
    v_mfma_f32_16x16x32_bf16 a[88:91], v[112:115], v[40:43], a[88:91]
    v_mfma_f32_16x16x32_bf16 a[88:91], v[116:119], v[44:47], a[88:91]
    ds_read_b64_tr_b16 v[94:95], v197 offset:47104
    v_mfma_f32_16x16x32_bf16 a[92:95], v[120:123], v[40:43], a[92:95]
    v_mfma_f32_16x16x32_bf16 a[92:95], v[124:127], v[44:47], a[92:95]
    s_waitcnt lgkmcnt(2)
    v_mfma_f32_16x16x32_bf16 a[96:99], v[96:99], v[32:35], a[96:99]
    ds_read_b128 v[40:43], v16 offset:14336
    v_mfma_f32_16x16x32_bf16 a[96:99], v[100:103], v[36:39], a[96:99]
    ds_read_b128 v[44:47], v17 offset:14336
    v_accvgpr_read_b32 v220, a236
    v_mfma_f32_16x16x32_bf16 a[100:103], v[104:107], v[32:35], a[100:103]
    v_accvgpr_read_b32 v221, a237
    v_mfma_f32_16x16x32_bf16 a[100:103], v[108:111], v[36:39], a[100:103]
    v_accvgpr_read_b32 v222, a238
    v_mfma_f32_16x16x32_bf16 a[104:107], v[112:115], v[32:35], a[104:107]
    v_accvgpr_read_b32 v223, a239
    v_mfma_f32_16x16x32_bf16 a[104:107], v[116:119], v[36:39], a[104:107]
    v_accvgpr_read_b32 v224, a252
    v_mfma_f32_16x16x32_bf16 a[108:111], v[120:123], v[32:35], a[108:111]
    v_accvgpr_read_b32 v225, a253
    v_mfma_f32_16x16x32_bf16 a[108:111], v[124:127], v[36:39], a[108:111]
    s_waitcnt lgkmcnt(0)
    v_mfma_f32_16x16x32_bf16 a[112:115], v[96:99], v[40:43], a[112:115]
    s_waitcnt vmcnt(20)
    s_barrier
    v_mfma_f32_16x16x32_bf16 a[112:115], v[100:103], v[44:47], a[112:115]
    ds_read_b128 v[32:35], v16 offset:32768
    v_accvgpr_read_b32 v226, a254
    v_mfma_f32_16x16x32_bf16 a[116:119], v[104:107], v[40:43], a[116:119]
    ds_read_b128 v[36:39], v17 offset:32768
    v_accvgpr_read_b32 v227, a255
    v_mfma_f32_16x16x32_bf16 a[116:119], v[108:111], v[44:47], a[116:119]
    s_add_u32 m0, s40, 0
    s_add_u32 s48, s36, 0
    buffer_load_dwordx4 v2, s[8:11], s48 offen offset:0 sc1 lds
    v_cvt_pk_bf16_f32 v228, v220, v221
    v_mfma_f32_16x16x32_bf16 a[120:123], v[112:115], v[40:43], a[120:123]
    v_cvt_pk_bf16_f32 v229, v222, v223
    v_mfma_f32_16x16x32_bf16 a[120:123], v[116:119], v[44:47], a[120:123]
    v_cvt_pk_bf16_f32 v230, v224, v225
    v_mfma_f32_16x16x32_bf16 a[124:127], v[120:123], v[40:43], a[124:127]
    buffer_load_dwordx4 v3, s[8:11], s48 offen offset:1024 sc1 lds
    v_cvt_pk_bf16_f32 v231, v226, v227
    v_mfma_f32_16x16x32_bf16 a[124:127], v[124:127], v[44:47], a[124:127]
    s_waitcnt lgkmcnt(0)
    v_mfma_f32_16x16x32_bf16 a[0:3], v[64:67], v[32:35], a[0:3]
    ds_read_b128 v[40:43], v16 offset:34816
    buffer_store_dwordx4 v[228:231], v14, s[8:11], s91 offen offset:2304 sc0 sc1
    v_mfma_f32_16x16x32_bf16 a[0:3], v[68:71], v[36:39], a[0:3]
    ds_read_b128 v[44:47], v17 offset:34816
    v_mfma_f32_16x16x32_bf16 a[4:7], v[72:75], v[32:35], a[4:7]
    ds_read_b64_tr_b16 v[96:97], v196 offset:49152
    v_mfma_f32_16x16x32_bf16 a[4:7], v[76:79], v[36:39], a[4:7]
    buffer_load_dwordx4 v4, s[8:11], s48 offen offset:2048 sc1 lds
    v_mfma_f32_16x16x32_bf16 a[8:11], v[80:83], v[32:35], a[8:11]
    ds_read_b64_tr_b16 v[98:99], v196 offset:51200
    v_mfma_f32_16x16x32_bf16 a[8:11], v[84:87], v[36:39], a[8:11]
    buffer_load_dwordx4 v5, s[8:11], s48 offen offset:3072 sc1 lds
    v_mfma_f32_16x16x32_bf16 a[12:15], v[88:91], v[32:35], a[12:15]
    ds_read_b64_tr_b16 v[100:101], v196 offset:57344
    v_mfma_f32_16x16x32_bf16 a[12:15], v[92:95], v[36:39], a[12:15]
    s_waitcnt lgkmcnt(3)
    v_mfma_f32_16x16x32_bf16 a[16:19], v[64:67], v[40:43], a[16:19]
    ds_read_b128 v[32:35], v16 offset:36864
    v_mfma_f32_16x16x32_bf16 a[16:19], v[68:71], v[44:47], a[16:19]
    ds_read_b128 v[36:39], v17 offset:36864
    v_mfma_f32_16x16x32_bf16 a[20:23], v[72:75], v[40:43], a[20:23]
    ds_read_b64_tr_b16 v[102:103], v196 offset:59392
    v_mfma_f32_16x16x32_bf16 a[20:23], v[76:79], v[44:47], a[20:23]
    s_add_u32 m0, s40, 4096
    s_add_u32 s48, s36, 32768
    buffer_load_dwordx4 v2, s[8:11], s48 offen offset:0 sc1 lds
    v_mfma_f32_16x16x32_bf16 a[24:27], v[80:83], v[40:43], a[24:27]
    ds_read_b64_tr_b16 v[104:105], v197 offset:49152
    v_mfma_f32_16x16x32_bf16 a[24:27], v[84:87], v[44:47], a[24:27]
    v_mfma_f32_16x16x32_bf16 a[28:31], v[88:91], v[40:43], a[28:31]
    ds_read_b64_tr_b16 v[106:107], v197 offset:51200
    buffer_load_dwordx4 v3, s[8:11], s48 offen offset:1024 sc1 lds
    v_mfma_f32_16x16x32_bf16 a[28:31], v[92:95], v[44:47], a[28:31]
    s_waitcnt lgkmcnt(3)
    v_mfma_f32_16x16x32_bf16 a[32:35], v[64:67], v[32:35], a[32:35]
    ds_read_b128 v[40:43], v16 offset:38912
    v_mfma_f32_16x16x32_bf16 a[32:35], v[68:71], v[36:39], a[32:35]
    ds_read_b128 v[44:47], v17 offset:38912
    v_mfma_f32_16x16x32_bf16 a[36:39], v[72:75], v[32:35], a[36:39]
    ds_read_b64_tr_b16 v[108:109], v197 offset:57344
    v_mfma_f32_16x16x32_bf16 a[36:39], v[76:79], v[36:39], a[36:39]
    buffer_load_dwordx4 v4, s[8:11], s48 offen offset:2048 sc1 lds
    v_mfma_f32_16x16x32_bf16 a[40:43], v[80:83], v[32:35], a[40:43]
    v_mfma_f32_16x16x32_bf16 a[40:43], v[84:87], v[36:39], a[40:43]
    ds_read_b64_tr_b16 v[110:111], v197 offset:59392
    buffer_load_dwordx4 v5, s[8:11], s48 offen offset:3072 sc1 lds
    v_mfma_f32_16x16x32_bf16 a[44:47], v[88:91], v[32:35], a[44:47]
    v_mfma_f32_16x16x32_bf16 a[44:47], v[92:95], v[36:39], a[44:47]
    s_waitcnt lgkmcnt(2)
    v_mfma_f32_16x16x32_bf16 a[48:51], v[64:67], v[40:43], a[48:51]
    ds_read_b128 v[32:35], v16 offset:40960
    v_mfma_f32_16x16x32_bf16 a[48:51], v[68:71], v[44:47], a[48:51]
    ds_read_b128 v[36:39], v17 offset:40960
    v_mfma_f32_16x16x32_bf16 a[52:55], v[72:75], v[40:43], a[52:55]
    ds_read_b64_tr_b16 v[112:113], v196 offset:53248
    v_mfma_f32_16x16x32_bf16 a[52:55], v[76:79], v[44:47], a[52:55]
    s_add_u32 m0, s41, 131072
    s_add_u32 s48, s37, 1048576
    buffer_load_dwordx4 v6, s[60:63], s48 offen offset:0 lds
    v_mfma_f32_16x16x32_bf16 a[56:59], v[80:83], v[40:43], a[56:59]
    ds_read_b64_tr_b16 v[114:115], v196 offset:55296
    v_mfma_f32_16x16x32_bf16 a[56:59], v[84:87], v[44:47], a[56:59]
    v_mfma_f32_16x16x32_bf16 a[60:63], v[88:91], v[40:43], a[60:63]
    ds_read_b64_tr_b16 v[116:117], v196 offset:61440
    buffer_load_dwordx4 v7, s[60:63], s48 offen offset:1024 lds
    v_mfma_f32_16x16x32_bf16 a[60:63], v[92:95], v[44:47], a[60:63]
    s_waitcnt lgkmcnt(3)
    v_mfma_f32_16x16x32_bf16 a[64:67], v[64:67], v[32:35], a[64:67]
    ds_read_b128 v[40:43], v16 offset:43008
    v_mfma_f32_16x16x32_bf16 a[64:67], v[68:71], v[36:39], a[64:67]
    ds_read_b128 v[44:47], v17 offset:43008
    v_mfma_f32_16x16x32_bf16 a[68:71], v[72:75], v[32:35], a[68:71]
    ds_read_b64_tr_b16 v[118:119], v196 offset:63488
    v_mfma_f32_16x16x32_bf16 a[68:71], v[76:79], v[36:39], a[68:71]
    buffer_load_dwordx4 v8, s[60:63], s48 offen offset:2048 lds
    v_mfma_f32_16x16x32_bf16 a[72:75], v[80:83], v[32:35], a[72:75]
    ds_read_b64_tr_b16 v[120:121], v197 offset:53248
    v_mfma_f32_16x16x32_bf16 a[72:75], v[84:87], v[36:39], a[72:75]
    buffer_load_dwordx4 v9, s[60:63], s48 offen offset:3072 lds
    v_mfma_f32_16x16x32_bf16 a[76:79], v[88:91], v[32:35], a[76:79]
    ds_read_b64_tr_b16 v[122:123], v197 offset:55296
    v_mfma_f32_16x16x32_bf16 a[76:79], v[92:95], v[36:39], a[76:79]
    s_waitcnt lgkmcnt(3)
    v_mfma_f32_16x16x32_bf16 a[80:83], v[64:67], v[40:43], a[80:83]
    ds_read_b128 v[32:35], v16 offset:45056
    v_mfma_f32_16x16x32_bf16 a[80:83], v[68:71], v[44:47], a[80:83]
    ds_read_b128 v[36:39], v17 offset:45056
    v_mfma_f32_16x16x32_bf16 a[84:87], v[72:75], v[40:43], a[84:87]
    ds_read_b64_tr_b16 v[124:125], v197 offset:61440
    v_mfma_f32_16x16x32_bf16 a[84:87], v[76:79], v[44:47], a[84:87]
    v_mfma_f32_16x16x32_bf16 a[88:91], v[80:83], v[40:43], a[88:91]
    v_mfma_f32_16x16x32_bf16 a[88:91], v[84:87], v[44:47], a[88:91]
    ds_read_b64_tr_b16 v[126:127], v197 offset:63488
    v_mfma_f32_16x16x32_bf16 a[92:95], v[88:91], v[40:43], a[92:95]
    v_mfma_f32_16x16x32_bf16 a[92:95], v[92:95], v[44:47], a[92:95]
    s_waitcnt lgkmcnt(2)
    v_mfma_f32_16x16x32_bf16 a[96:99], v[64:67], v[32:35], a[96:99]
    ds_read_b128 v[40:43], v16 offset:47104
    v_mfma_f32_16x16x32_bf16 a[96:99], v[68:71], v[36:39], a[96:99]
    ds_read_b128 v[44:47], v17 offset:47104
    v_mfma_f32_16x16x32_bf16 a[100:103], v[72:75], v[32:35], a[100:103]
    v_mfma_f32_16x16x32_bf16 a[100:103], v[76:79], v[36:39], a[100:103]
    v_mfma_f32_16x16x32_bf16 a[104:107], v[80:83], v[32:35], a[104:107]
    v_mfma_f32_16x16x32_bf16 a[104:107], v[84:87], v[36:39], a[104:107]
    v_mfma_f32_16x16x32_bf16 a[108:111], v[88:91], v[32:35], a[108:111]
    v_mfma_f32_16x16x32_bf16 a[108:111], v[92:95], v[36:39], a[108:111]
    s_waitcnt lgkmcnt(0)
    v_mfma_f32_16x16x32_bf16 a[112:115], v[64:67], v[40:43], a[112:115]
    s_waitcnt vmcnt(18)
    s_barrier
    v_mfma_f32_16x16x32_bf16 a[112:115], v[68:71], v[44:47], a[112:115]
    ds_read_b128 v[32:35], v18 offset:0
    v_mfma_f32_16x16x32_bf16 a[116:119], v[72:75], v[40:43], a[116:119]
    ds_read_b128 v[36:39], v19 offset:0
    v_mfma_f32_16x16x32_bf16 a[116:119], v[76:79], v[44:47], a[116:119]
    s_add_u32 m0, s40, 32768
    s_add_u32 s48, s36, 128
    buffer_load_dwordx4 v2, s[8:11], s48 offen offset:0 sc1 lds
    v_mfma_f32_16x16x32_bf16 a[120:123], v[80:83], v[40:43], a[120:123]
    v_mfma_f32_16x16x32_bf16 a[120:123], v[84:87], v[44:47], a[120:123]
    v_mfma_f32_16x16x32_bf16 a[124:127], v[88:91], v[40:43], a[124:127]
    buffer_load_dwordx4 v3, s[8:11], s48 offen offset:1024 sc1 lds
    v_mfma_f32_16x16x32_bf16 a[124:127], v[92:95], v[44:47], a[124:127]
    s_waitcnt lgkmcnt(0)
    v_mfma_f32_16x16x32_bf16 a[0:3], v[96:99], v[32:35], a[0:3]
    ds_read_b128 v[40:43], v18 offset:2048
    v_mfma_f32_16x16x32_bf16 a[0:3], v[100:103], v[36:39], a[0:3]
    ds_read_b128 v[44:47], v19 offset:2048
    v_mfma_f32_16x16x32_bf16 a[4:7], v[104:107], v[32:35], a[4:7]
    ds_read_b64_tr_b16 v[64:65], v192 offset:0
    v_mfma_f32_16x16x32_bf16 a[4:7], v[108:111], v[36:39], a[4:7]
    buffer_load_dwordx4 v4, s[8:11], s48 offen offset:2048 sc1 lds
    v_mfma_f32_16x16x32_bf16 a[8:11], v[112:115], v[32:35], a[8:11]
    ds_read_b64_tr_b16 v[66:67], v192 offset:2048
    v_mfma_f32_16x16x32_bf16 a[8:11], v[116:119], v[36:39], a[8:11]
    buffer_load_dwordx4 v5, s[8:11], s48 offen offset:3072 sc1 lds
    v_mfma_f32_16x16x32_bf16 a[12:15], v[120:123], v[32:35], a[12:15]
    ds_read_b64_tr_b16 v[68:69], v192 offset:8192
    v_mfma_f32_16x16x32_bf16 a[12:15], v[124:127], v[36:39], a[12:15]
    s_waitcnt lgkmcnt(3)
    v_mfma_f32_16x16x32_bf16 a[16:19], v[96:99], v[40:43], a[16:19]
    ds_read_b128 v[32:35], v18 offset:4096
    v_mfma_f32_16x16x32_bf16 a[16:19], v[100:103], v[44:47], a[16:19]
    ds_read_b128 v[36:39], v19 offset:4096
    v_mfma_f32_16x16x32_bf16 a[20:23], v[104:107], v[40:43], a[20:23]
    ds_read_b64_tr_b16 v[70:71], v192 offset:10240
    v_mfma_f32_16x16x32_bf16 a[20:23], v[108:111], v[44:47], a[20:23]
    s_add_u32 m0, s40, 36864
    s_add_u32 s48, s36, 32896
    buffer_load_dwordx4 v2, s[8:11], s48 offen offset:0 sc1 lds
    v_mfma_f32_16x16x32_bf16 a[24:27], v[112:115], v[40:43], a[24:27]
    ds_read_b64_tr_b16 v[72:73], v193 offset:0
    v_mfma_f32_16x16x32_bf16 a[24:27], v[116:119], v[44:47], a[24:27]
    v_mfma_f32_16x16x32_bf16 a[28:31], v[120:123], v[40:43], a[28:31]
    ds_read_b64_tr_b16 v[74:75], v193 offset:2048
    buffer_load_dwordx4 v3, s[8:11], s48 offen offset:1024 sc1 lds
    v_mfma_f32_16x16x32_bf16 a[28:31], v[124:127], v[44:47], a[28:31]
    s_waitcnt lgkmcnt(3)
    v_mfma_f32_16x16x32_bf16 a[32:35], v[96:99], v[32:35], a[32:35]
    ds_read_b128 v[40:43], v18 offset:6144
    v_mfma_f32_16x16x32_bf16 a[32:35], v[100:103], v[36:39], a[32:35]
    ds_read_b128 v[44:47], v19 offset:6144
    v_mfma_f32_16x16x32_bf16 a[36:39], v[104:107], v[32:35], a[36:39]
    ds_read_b64_tr_b16 v[76:77], v193 offset:8192
    v_mfma_f32_16x16x32_bf16 a[36:39], v[108:111], v[36:39], a[36:39]
    buffer_load_dwordx4 v4, s[8:11], s48 offen offset:2048 sc1 lds
    v_mfma_f32_16x16x32_bf16 a[40:43], v[112:115], v[32:35], a[40:43]
    v_mfma_f32_16x16x32_bf16 a[40:43], v[116:119], v[36:39], a[40:43]
    ds_read_b64_tr_b16 v[78:79], v193 offset:10240
    buffer_load_dwordx4 v5, s[8:11], s48 offen offset:3072 sc1 lds
    v_mfma_f32_16x16x32_bf16 a[44:47], v[120:123], v[32:35], a[44:47]
    v_mfma_f32_16x16x32_bf16 a[44:47], v[124:127], v[36:39], a[44:47]
    s_waitcnt lgkmcnt(2)
    v_mfma_f32_16x16x32_bf16 a[48:51], v[96:99], v[40:43], a[48:51]
    ds_read_b128 v[32:35], v18 offset:8192
    v_mfma_f32_16x16x32_bf16 a[48:51], v[100:103], v[44:47], a[48:51]
    ds_read_b128 v[36:39], v19 offset:8192
    v_mfma_f32_16x16x32_bf16 a[52:55], v[104:107], v[40:43], a[52:55]
    ds_read_b64_tr_b16 v[80:81], v194 offset:0
    v_mfma_f32_16x16x32_bf16 a[52:55], v[108:111], v[44:47], a[52:55]
    s_add_u32 m0, s41, 147456
    s_add_u32 s48, s37, 1572864
    buffer_load_dwordx4 v6, s[60:63], s48 offen offset:0 lds
    v_mfma_f32_16x16x32_bf16 a[56:59], v[112:115], v[40:43], a[56:59]
    ds_read_b64_tr_b16 v[82:83], v194 offset:2048
    v_mfma_f32_16x16x32_bf16 a[56:59], v[116:119], v[44:47], a[56:59]
    v_mfma_f32_16x16x32_bf16 a[60:63], v[120:123], v[40:43], a[60:63]
    ds_read_b64_tr_b16 v[84:85], v194 offset:8192
    buffer_load_dwordx4 v7, s[60:63], s48 offen offset:1024 lds
    v_mfma_f32_16x16x32_bf16 a[60:63], v[124:127], v[44:47], a[60:63]
    s_waitcnt vmcnt(20)
    s_mov_b64 exec, 1
    buffer_store_dword v49, v48, s[8:11], s53 offen sc0 sc1
    s_mov_b64 exec, -1
    s_waitcnt lgkmcnt(3)
    v_mfma_f32_16x16x32_bf16 a[64:67], v[96:99], v[32:35], a[64:67]
    ds_read_b128 v[40:43], v18 offset:10240
    v_mfma_f32_16x16x32_bf16 a[64:67], v[100:103], v[36:39], a[64:67]
    ds_read_b128 v[44:47], v19 offset:10240
    s_add_u32 s84, s45, 0
    s_add_u32 s85, s45, 176128
    v_mfma_f32_16x16x32_bf16 a[68:71], v[104:107], v[32:35], a[68:71]
    ds_read_b64_tr_b16 v[86:87], v194 offset:10240
    s_add_u32 s86, s45, 352256
    v_mfma_f32_16x16x32_bf16 a[68:71], v[108:111], v[36:39], a[68:71]
    buffer_load_dwordx4 v8, s[60:63], s48 offen offset:2048 lds
    s_add_u32 s87, s45, 528384
    v_mfma_f32_16x16x32_bf16 a[72:75], v[112:115], v[32:35], a[72:75]
    ds_read_b64_tr_b16 v[88:89], v195 offset:0
    s_add_u32 s88, s45, 704512
    v_mfma_f32_16x16x32_bf16 a[72:75], v[116:119], v[36:39], a[72:75]
    buffer_load_dwordx4 v9, s[60:63], s48 offen offset:3072 lds
    s_add_u32 s89, s45, 880640
    v_mfma_f32_16x16x32_bf16 a[76:79], v[120:123], v[32:35], a[76:79]
    ds_read_b64_tr_b16 v[90:91], v195 offset:2048
    s_add_u32 s90, s45, 1056768
    v_mfma_f32_16x16x32_bf16 a[76:79], v[124:127], v[36:39], a[76:79]
    s_add_u32 s91, s45, 1232896
    s_waitcnt lgkmcnt(3)
    v_mfma_f32_16x16x32_bf16 a[80:83], v[96:99], v[40:43], a[80:83]
    ds_read_b128 v[32:35], v18 offset:12288
    v_mfma_f32_16x16x32_bf16 a[80:83], v[100:103], v[44:47], a[80:83]
    ds_read_b128 v[36:39], v19 offset:12288
    v_mfma_f32_16x16x32_bf16 a[84:87], v[104:107], v[40:43], a[84:87]
    ds_read_b64_tr_b16 v[92:93], v195 offset:8192
    v_mfma_f32_16x16x32_bf16 a[84:87], v[108:111], v[44:47], a[84:87]
    v_mfma_f32_16x16x32_bf16 a[88:91], v[112:115], v[40:43], a[88:91]
    s_mov_b32 s54, 0x3e0293ee
    s_and_b32 s6, s32, 1
    s_lshl_b32 s6, s6, 12
    v_add_u32 v22, s6, v14
    s_cmp_lt_u32 s32, 2
    s_mov_b32 s5, 114688
    s_cselect_b32 s4, 16384, s5
    v_add_u32 v50, s4, v22
    s_mov_b32 s5, 131072
    s_cselect_b32 s4, 81920, s5
    v_add_u32 v51, s4, v22
    v_mfma_f32_16x16x32_bf16 a[88:91], v[116:119], v[44:47], a[88:91]
    ds_read_b64_tr_b16 v[94:95], v195 offset:10240
    v_mfma_f32_16x16x32_bf16 a[92:95], v[120:123], v[40:43], a[92:95]
    v_mfma_f32_16x16x32_bf16 a[92:95], v[124:127], v[44:47], a[92:95]
    s_waitcnt lgkmcnt(2)
    v_mfma_f32_16x16x32_bf16 a[96:99], v[96:99], v[32:35], a[96:99]
    ds_read_b128 v[40:43], v18 offset:14336
    v_mfma_f32_16x16x32_bf16 a[96:99], v[100:103], v[36:39], a[96:99]
    ds_read_b128 v[44:47], v19 offset:14336
    v_mfma_f32_16x16x32_bf16 a[100:103], v[104:107], v[32:35], a[100:103]
    v_mfma_f32_16x16x32_bf16 a[100:103], v[108:111], v[36:39], a[100:103]
    v_mfma_f32_16x16x32_bf16 a[104:107], v[112:115], v[32:35], a[104:107]
    v_mfma_f32_16x16x32_bf16 a[104:107], v[116:119], v[36:39], a[104:107]
    v_mfma_f32_16x16x32_bf16 a[108:111], v[120:123], v[32:35], a[108:111]
    v_mfma_f32_16x16x32_bf16 a[108:111], v[124:127], v[36:39], a[108:111]
    s_waitcnt lgkmcnt(0)
    v_mfma_f32_16x16x32_bf16 a[112:115], v[96:99], v[40:43], a[112:115]
    s_waitcnt vmcnt(17)
    s_barrier
    v_mfma_f32_16x16x32_bf16 a[112:115], v[100:103], v[44:47], a[112:115]
    ds_read_b128 v[32:35], v16 offset:0
    v_mfma_f32_16x16x32_bf16 a[116:119], v[104:107], v[40:43], a[116:119]
    ds_read_b128 v[36:39], v17 offset:0
    v_mfma_f32_16x16x32_bf16 a[116:119], v[108:111], v[44:47], a[116:119]
    s_add_u32 m0, s40, 65536
    s_add_u32 s48, s36, 256
    buffer_load_dwordx4 v2, s[8:11], s48 offen offset:0 sc1 lds
    v_mfma_f32_16x16x32_bf16 a[120:123], v[112:115], v[40:43], a[120:123]
    v_mfma_f32_16x16x32_bf16 a[120:123], v[116:119], v[44:47], a[120:123]
    v_mfma_f32_16x16x32_bf16 a[124:127], v[120:123], v[40:43], a[124:127]
    buffer_load_dwordx4 v3, s[8:11], s48 offen offset:1024 sc1 lds
    v_mfma_f32_16x16x32_bf16 a[124:127], v[124:127], v[44:47], a[124:127]
    s_waitcnt lgkmcnt(0)
    v_mfma_f32_16x16x32_bf16 a[128:131], v[64:67], v[32:35], 0
    ds_read_b128 v[40:43], v16 offset:2048
    v_mfma_f32_16x16x32_bf16 a[128:131], v[68:71], v[36:39], a[128:131]
    ds_read_b128 v[44:47], v17 offset:2048
    v_mfma_f32_16x16x32_bf16 a[132:135], v[72:75], v[32:35], 0
    ds_read_b64_tr_b16 v[96:97], v192 offset:16384
    v_mfma_f32_16x16x32_bf16 a[132:135], v[76:79], v[36:39], a[132:135]
    buffer_load_dwordx4 v4, s[8:11], s48 offen offset:2048 sc1 lds
    v_mfma_f32_16x16x32_bf16 a[136:139], v[80:83], v[32:35], 0
    ds_read_b64_tr_b16 v[98:99], v192 offset:18432
    v_mfma_f32_16x16x32_bf16 a[136:139], v[84:87], v[36:39], a[136:139]
    buffer_load_dwordx4 v5, s[8:11], s48 offen offset:3072 sc1 lds
    v_mfma_f32_16x16x32_bf16 a[140:143], v[88:91], v[32:35], 0
    ds_read_b64_tr_b16 v[100:101], v192 offset:24576
    v_mfma_f32_16x16x32_bf16 a[140:143], v[92:95], v[36:39], a[140:143]
    s_waitcnt lgkmcnt(3)
    v_mfma_f32_16x16x32_bf16 a[144:147], v[64:67], v[40:43], 0
    ds_read_b128 v[32:35], v16 offset:4096
    v_mfma_f32_16x16x32_bf16 a[144:147], v[68:71], v[44:47], a[144:147]
    ds_read_b128 v[36:39], v17 offset:4096
    v_accvgpr_read_b32 v208, a0
    v_accvgpr_read_b32 v209, a1
    v_mfma_f32_16x16x32_bf16 a[148:151], v[72:75], v[40:43], 0
    ds_read_b64_tr_b16 v[102:103], v192 offset:26624
    v_accvgpr_read_b32 v210, a2
    v_mfma_f32_16x16x32_bf16 a[148:151], v[76:79], v[44:47], a[148:151]
    s_add_u32 m0, s40, 69632
    s_add_u32 s48, s36, 33024
    buffer_load_dwordx4 v2, s[8:11], s48 offen offset:0 sc1 lds
    v_accvgpr_read_b32 v211, a3
    v_mfma_f32_16x16x32_bf16 a[152:155], v[80:83], v[40:43], 0
    ds_read_b64_tr_b16 v[104:105], v193 offset:16384
    v_accvgpr_read_b32 v212, a4
    v_accvgpr_read_b32 v213, a5
    v_mfma_f32_16x16x32_bf16 a[152:155], v[84:87], v[44:47], a[152:155]
    v_accvgpr_read_b32 v214, a6
    v_mfma_f32_16x16x32_bf16 a[156:159], v[88:91], v[40:43], 0
    ds_read_b64_tr_b16 v[106:107], v193 offset:18432
    buffer_load_dwordx4 v3, s[8:11], s48 offen offset:1024 sc1 lds
    v_accvgpr_read_b32 v215, a7
    v_mfma_f32_16x16x32_bf16 a[156:159], v[92:95], v[44:47], a[156:159]
    v_accvgpr_read_b32 v216, a8
    s_waitcnt lgkmcnt(3)
    v_mfma_f32_16x16x32_bf16 a[160:163], v[64:67], v[32:35], 0
    ds_read_b128 v[40:43], v16 offset:6144
    v_mfma_f32_16x16x32_bf16 a[160:163], v[68:71], v[36:39], a[160:163]
    ds_read_b128 v[44:47], v17 offset:6144
    v_accvgpr_read_b32 v217, a9
    v_accvgpr_read_b32 v218, a10
    v_mfma_f32_16x16x32_bf16 a[164:167], v[72:75], v[32:35], 0
    ds_read_b64_tr_b16 v[108:109], v193 offset:24576
    v_accvgpr_read_b32 v219, a11
    v_mfma_f32_16x16x32_bf16 a[164:167], v[76:79], v[36:39], a[164:167]
    buffer_load_dwordx4 v4, s[8:11], s48 offen offset:2048 sc1 lds
    v_accvgpr_read_b32 v220, a12
    v_mfma_f32_16x16x32_bf16 a[168:171], v[80:83], v[32:35], 0
    v_accvgpr_read_b32 v221, a13
    v_accvgpr_read_b32 v222, a14
    v_mfma_f32_16x16x32_bf16 a[168:171], v[84:87], v[36:39], a[168:171]
    ds_read_b64_tr_b16 v[110:111], v193 offset:26624
    buffer_load_dwordx4 v5, s[8:11], s48 offen offset:3072 sc1 lds
    v_accvgpr_read_b32 v223, a15
    v_mfma_f32_16x16x32_bf16 a[172:175], v[88:91], v[32:35], 0
    v_max_f32 v208, 0, v208
    v_mfma_f32_16x16x32_bf16 a[172:175], v[92:95], v[36:39], a[172:175]
    v_max_f32 v209, 0, v209
    s_waitcnt lgkmcnt(2)
    v_mfma_f32_16x16x32_bf16 a[176:179], v[64:67], v[40:43], 0
    ds_read_b128 v[32:35], v16 offset:8192
    v_mfma_f32_16x16x32_bf16 a[176:179], v[68:71], v[44:47], a[176:179]
    ds_read_b128 v[36:39], v17 offset:8192
    v_max_f32 v210, 0, v210
    v_max_f32 v211, 0, v211
    v_mfma_f32_16x16x32_bf16 a[180:183], v[72:75], v[40:43], 0
    ds_read_b64_tr_b16 v[112:113], v194 offset:16384
    v_max_f32 v212, 0, v212
    v_mfma_f32_16x16x32_bf16 a[180:183], v[76:79], v[44:47], a[180:183]
    s_add_u32 m0, s41, 98304
    s_add_u32 s48, s37, 2097152
    buffer_load_dwordx4 v6, s[60:63], s48 offen offset:0 lds
    v_max_f32 v213, 0, v213
    v_mfma_f32_16x16x32_bf16 a[184:187], v[80:83], v[40:43], 0
    ds_read_b64_tr_b16 v[114:115], v194 offset:18432
    v_max_f32 v214, 0, v214
    v_max_f32 v215, 0, v215
    v_mfma_f32_16x16x32_bf16 a[184:187], v[84:87], v[44:47], a[184:187]
    v_mul_f32 v208, v208, v216
    v_mfma_f32_16x16x32_bf16 a[188:191], v[88:91], v[40:43], 0
    ds_read_b64_tr_b16 v[116:117], v194 offset:24576
    buffer_load_dwordx4 v7, s[60:63], s48 offen offset:1024 lds
    v_mul_f32 v209, v209, v217
    v_mfma_f32_16x16x32_bf16 a[188:191], v[92:95], v[44:47], a[188:191]
    v_mul_f32 v210, v210, v218
    s_waitcnt lgkmcnt(3)
    v_mfma_f32_16x16x32_bf16 a[192:195], v[64:67], v[32:35], 0
    ds_read_b128 v[40:43], v16 offset:10240
    v_mfma_f32_16x16x32_bf16 a[192:195], v[68:71], v[36:39], a[192:195]
    ds_read_b128 v[44:47], v17 offset:10240
    v_mul_f32 v211, v211, v219
    v_mul_f32 v212, v212, v220
    v_mfma_f32_16x16x32_bf16 a[196:199], v[72:75], v[32:35], 0
    ds_read_b64_tr_b16 v[118:119], v194 offset:26624
    v_mul_f32 v213, v213, v221
    v_mfma_f32_16x16x32_bf16 a[196:199], v[76:79], v[36:39], a[196:199]
    buffer_load_dwordx4 v8, s[60:63], s48 offen offset:2048 lds
    v_mul_f32 v214, v214, v222
    v_mfma_f32_16x16x32_bf16 a[200:203], v[80:83], v[32:35], 0
    ds_read_b64_tr_b16 v[120:121], v195 offset:16384
    v_mul_f32 v215, v215, v223
    v_cvt_pk_bf16_f32 v224, v208, v209
    v_mfma_f32_16x16x32_bf16 a[200:203], v[84:87], v[36:39], a[200:203]
    buffer_load_dwordx4 v9, s[60:63], s48 offen offset:3072 lds
    v_cvt_pk_bf16_f32 v225, v210, v211
    v_mfma_f32_16x16x32_bf16 a[204:207], v[88:91], v[32:35], 0
    ds_read_b64_tr_b16 v[122:123], v195 offset:18432
    v_cvt_pk_bf16_f32 v226, v212, v213
    v_mfma_f32_16x16x32_bf16 a[204:207], v[92:95], v[36:39], a[204:207]
    v_cvt_pk_bf16_f32 v227, v214, v215
    s_waitcnt lgkmcnt(3)
    v_mfma_f32_16x16x32_bf16 a[208:211], v[64:67], v[40:43], 0
    ds_read_b128 v[32:35], v16 offset:12288
    buffer_store_dwordx4 v[224:227], v1, s[8:11], s84 offen sc0 sc1
    v_mfma_f32_16x16x32_bf16 a[208:211], v[68:71], v[44:47], a[208:211]
    ds_read_b128 v[36:39], v17 offset:12288
    v_mfma_f32_16x16x32_bf16 a[212:215], v[72:75], v[40:43], 0
    ds_read_b64_tr_b16 v[124:125], v195 offset:24576
    v_mfma_f32_16x16x32_bf16 a[212:215], v[76:79], v[44:47], a[212:215]
    v_mfma_f32_16x16x32_bf16 a[216:219], v[80:83], v[40:43], 0
    v_mfma_f32_16x16x32_bf16 a[216:219], v[84:87], v[44:47], a[216:219]
    ds_read_b64_tr_b16 v[126:127], v195 offset:26624
    v_mfma_f32_16x16x32_bf16 a[220:223], v[88:91], v[40:43], 0
    v_mfma_f32_16x16x32_bf16 a[220:223], v[92:95], v[44:47], a[220:223]
    s_waitcnt lgkmcnt(2)
    v_mfma_f32_16x16x32_bf16 a[224:227], v[64:67], v[32:35], 0
    ds_read_b128 v[40:43], v16 offset:14336
    v_mfma_f32_16x16x32_bf16 a[224:227], v[68:71], v[36:39], a[224:227]
    ds_read_b128 v[44:47], v17 offset:14336
    v_accvgpr_read_b32 v228, a16
    v_accvgpr_read_b32 v229, a17
    v_mfma_f32_16x16x32_bf16 a[228:231], v[72:75], v[32:35], 0
    v_accvgpr_read_b32 v230, a18
    v_mfma_f32_16x16x32_bf16 a[228:231], v[76:79], v[36:39], a[228:231]
    v_accvgpr_read_b32 v231, a19
    v_mfma_f32_16x16x32_bf16 a[232:235], v[80:83], v[32:35], 0
    v_accvgpr_read_b32 v232, a20
    v_accvgpr_read_b32 v233, a21
    v_mfma_f32_16x16x32_bf16 a[232:235], v[84:87], v[36:39], a[232:235]
    v_accvgpr_read_b32 v234, a22
    v_mfma_f32_16x16x32_bf16 a[236:239], v[88:91], v[32:35], 0
    v_accvgpr_read_b32 v235, a23
    v_mfma_f32_16x16x32_bf16 a[236:239], v[92:95], v[36:39], a[236:239]
    v_accvgpr_read_b32 v236, a24
    s_waitcnt lgkmcnt(0)
    v_mfma_f32_16x16x32_bf16 a[240:243], v[64:67], v[40:43], 0
    s_waitcnt vmcnt(18)
    s_barrier
    v_mfma_f32_16x16x32_bf16 a[240:243], v[68:71], v[44:47], a[240:243]
    ds_read_b128 v[32:35], v16 offset:32768
    v_accvgpr_read_b32 v237, a25
    v_accvgpr_read_b32 v238, a26
    v_mfma_f32_16x16x32_bf16 a[244:247], v[72:75], v[40:43], 0
    ds_read_b128 v[36:39], v17 offset:32768
    v_accvgpr_read_b32 v239, a27
    v_mfma_f32_16x16x32_bf16 a[244:247], v[76:79], v[44:47], a[244:247]
    s_add_u32 m0, s40, 0
    s_add_u32 s48, s36, 384
    buffer_load_dwordx4 v2, s[8:11], s48 offen offset:0 sc1 lds
    v_accvgpr_read_b32 v240, a28
    v_mfma_f32_16x16x32_bf16 a[248:251], v[80:83], v[40:43], 0
    v_accvgpr_read_b32 v241, a29
    v_accvgpr_read_b32 v242, a30
    v_mfma_f32_16x16x32_bf16 a[248:251], v[84:87], v[44:47], a[248:251]
    v_accvgpr_read_b32 v243, a31
    v_mfma_f32_16x16x32_bf16 a[252:255], v[88:91], v[40:43], 0
    buffer_load_dwordx4 v3, s[8:11], s48 offen offset:1024 sc1 lds
    v_max_f32 v228, 0, v228
    v_mfma_f32_16x16x32_bf16 a[252:255], v[92:95], v[44:47], a[252:255]
    v_max_f32 v229, 0, v229
    s_waitcnt lgkmcnt(0)
    v_mfma_f32_16x16x32_bf16 a[128:131], v[96:99], v[32:35], a[128:131]
    ds_read_b128 v[40:43], v16 offset:34816
    v_mfma_f32_16x16x32_bf16 a[128:131], v[100:103], v[36:39], a[128:131]
    ds_read_b128 v[44:47], v17 offset:34816
    v_max_f32 v230, 0, v230
    v_max_f32 v231, 0, v231
    v_mfma_f32_16x16x32_bf16 a[132:135], v[104:107], v[32:35], a[132:135]
    ds_read_b64_tr_b16 v[64:65], v192 offset:32768
    v_max_f32 v232, 0, v232
    v_mfma_f32_16x16x32_bf16 a[132:135], v[108:111], v[36:39], a[132:135]
    buffer_load_dwordx4 v4, s[8:11], s48 offen offset:2048 sc1 lds
    v_max_f32 v233, 0, v233
    v_mfma_f32_16x16x32_bf16 a[136:139], v[112:115], v[32:35], a[136:139]
    ds_read_b64_tr_b16 v[66:67], v192 offset:34816
    v_max_f32 v234, 0, v234
    v_max_f32 v235, 0, v235
    v_mfma_f32_16x16x32_bf16 a[136:139], v[116:119], v[36:39], a[136:139]
    buffer_load_dwordx4 v5, s[8:11], s48 offen offset:3072 sc1 lds
    v_mul_f32 v228, v228, v236
    v_mfma_f32_16x16x32_bf16 a[140:143], v[120:123], v[32:35], a[140:143]
    ds_read_b64_tr_b16 v[68:69], v192 offset:40960
    v_mul_f32 v229, v229, v237
    v_mfma_f32_16x16x32_bf16 a[140:143], v[124:127], v[36:39], a[140:143]
    v_mul_f32 v230, v230, v238
    s_waitcnt lgkmcnt(3)
    v_mfma_f32_16x16x32_bf16 a[144:147], v[96:99], v[40:43], a[144:147]
    ds_read_b128 v[32:35], v16 offset:36864
    v_mfma_f32_16x16x32_bf16 a[144:147], v[100:103], v[44:47], a[144:147]
    ds_read_b128 v[36:39], v17 offset:36864
    v_mul_f32 v231, v231, v239
    v_mul_f32 v232, v232, v240
    v_mfma_f32_16x16x32_bf16 a[148:151], v[104:107], v[40:43], a[148:151]
    ds_read_b64_tr_b16 v[70:71], v192 offset:43008
    v_mul_f32 v233, v233, v241
    v_mfma_f32_16x16x32_bf16 a[148:151], v[108:111], v[44:47], a[148:151]
    s_add_u32 m0, s40, 4096
    s_add_u32 s48, s36, 33152
    buffer_load_dwordx4 v2, s[8:11], s48 offen offset:0 sc1 lds
    v_mul_f32 v234, v234, v242
    v_mfma_f32_16x16x32_bf16 a[152:155], v[112:115], v[40:43], a[152:155]
    ds_read_b64_tr_b16 v[72:73], v193 offset:32768
    v_mul_f32 v235, v235, v243
    v_cvt_pk_bf16_f32 v244, v228, v229
    v_mfma_f32_16x16x32_bf16 a[152:155], v[116:119], v[44:47], a[152:155]
    v_cvt_pk_bf16_f32 v245, v230, v231
    v_mfma_f32_16x16x32_bf16 a[156:159], v[120:123], v[40:43], a[156:159]
    ds_read_b64_tr_b16 v[74:75], v193 offset:34816
    buffer_load_dwordx4 v3, s[8:11], s48 offen offset:1024 sc1 lds
    v_cvt_pk_bf16_f32 v246, v232, v233
    v_mfma_f32_16x16x32_bf16 a[156:159], v[124:127], v[44:47], a[156:159]
    v_cvt_pk_bf16_f32 v247, v234, v235
    s_waitcnt lgkmcnt(3)
    v_mfma_f32_16x16x32_bf16 a[160:163], v[96:99], v[32:35], a[160:163]
    ds_read_b128 v[40:43], v16 offset:38912
    buffer_store_dwordx4 v[244:247], v1, s[8:11], s85 offen sc0 sc1
    v_mfma_f32_16x16x32_bf16 a[160:163], v[100:103], v[36:39], a[160:163]
    ds_read_b128 v[44:47], v17 offset:38912
    v_mfma_f32_16x16x32_bf16 a[164:167], v[104:107], v[32:35], a[164:167]
    ds_read_b64_tr_b16 v[76:77], v193 offset:40960
    v_mfma_f32_16x16x32_bf16 a[164:167], v[108:111], v[36:39], a[164:167]
    buffer_load_dwordx4 v4, s[8:11], s48 offen offset:2048 sc1 lds
    v_mfma_f32_16x16x32_bf16 a[168:171], v[112:115], v[32:35], a[168:171]
    v_mfma_f32_16x16x32_bf16 a[168:171], v[116:119], v[36:39], a[168:171]
    ds_read_b64_tr_b16 v[78:79], v193 offset:43008
    buffer_load_dwordx4 v5, s[8:11], s48 offen offset:3072 sc1 lds
    v_mfma_f32_16x16x32_bf16 a[172:175], v[120:123], v[32:35], a[172:175]
    v_mfma_f32_16x16x32_bf16 a[172:175], v[124:127], v[36:39], a[172:175]
    s_waitcnt lgkmcnt(2)
    v_mfma_f32_16x16x32_bf16 a[176:179], v[96:99], v[40:43], a[176:179]
    ds_read_b128 v[32:35], v16 offset:40960
    v_mfma_f32_16x16x32_bf16 a[176:179], v[100:103], v[44:47], a[176:179]
    ds_read_b128 v[36:39], v17 offset:40960
    v_accvgpr_read_b32 v208, a32
    v_accvgpr_read_b32 v209, a33
    v_mfma_f32_16x16x32_bf16 a[180:183], v[104:107], v[40:43], a[180:183]
    ds_read_b64_tr_b16 v[80:81], v194 offset:32768
    v_accvgpr_read_b32 v210, a34
    v_mfma_f32_16x16x32_bf16 a[180:183], v[108:111], v[44:47], a[180:183]
    s_add_u32 m0, s41, 114688
    s_add_u32 s48, s37, 2621440
    buffer_load_dwordx4 v6, s[60:63], s48 offen offset:0 lds
    v_accvgpr_read_b32 v211, a35
    v_mfma_f32_16x16x32_bf16 a[184:187], v[112:115], v[40:43], a[184:187]
    ds_read_b64_tr_b16 v[82:83], v194 offset:34816
    v_accvgpr_read_b32 v212, a36
    v_accvgpr_read_b32 v213, a37
    v_mfma_f32_16x16x32_bf16 a[184:187], v[116:119], v[44:47], a[184:187]
    v_accvgpr_read_b32 v214, a38
    v_mfma_f32_16x16x32_bf16 a[188:191], v[120:123], v[40:43], a[188:191]
    ds_read_b64_tr_b16 v[84:85], v194 offset:40960
    buffer_load_dwordx4 v7, s[60:63], s48 offen offset:1024 lds
    v_accvgpr_read_b32 v215, a39
    v_mfma_f32_16x16x32_bf16 a[188:191], v[124:127], v[44:47], a[188:191]
    v_accvgpr_read_b32 v216, a40
    s_waitcnt lgkmcnt(3)
    v_mfma_f32_16x16x32_bf16 a[192:195], v[96:99], v[32:35], a[192:195]
    ds_read_b128 v[40:43], v16 offset:43008
    v_mfma_f32_16x16x32_bf16 a[192:195], v[100:103], v[36:39], a[192:195]
    ds_read_b128 v[44:47], v17 offset:43008
    v_accvgpr_read_b32 v217, a41
    v_accvgpr_read_b32 v218, a42
    v_mfma_f32_16x16x32_bf16 a[196:199], v[104:107], v[32:35], a[196:199]
    ds_read_b64_tr_b16 v[86:87], v194 offset:43008
    v_accvgpr_read_b32 v219, a43
    v_mfma_f32_16x16x32_bf16 a[196:199], v[108:111], v[36:39], a[196:199]
    buffer_load_dwordx4 v8, s[60:63], s48 offen offset:2048 lds
    v_accvgpr_read_b32 v220, a44
    v_mfma_f32_16x16x32_bf16 a[200:203], v[112:115], v[32:35], a[200:203]
    ds_read_b64_tr_b16 v[88:89], v195 offset:32768
    v_accvgpr_read_b32 v221, a45
    v_accvgpr_read_b32 v222, a46
    v_mfma_f32_16x16x32_bf16 a[200:203], v[116:119], v[36:39], a[200:203]
    buffer_load_dwordx4 v9, s[60:63], s48 offen offset:3072 lds
    v_accvgpr_read_b32 v223, a47
    v_mfma_f32_16x16x32_bf16 a[204:207], v[120:123], v[32:35], a[204:207]
    ds_read_b64_tr_b16 v[90:91], v195 offset:34816
    v_max_f32 v208, 0, v208
    v_mfma_f32_16x16x32_bf16 a[204:207], v[124:127], v[36:39], a[204:207]
    v_max_f32 v209, 0, v209
    s_waitcnt lgkmcnt(3)
    v_mfma_f32_16x16x32_bf16 a[208:211], v[96:99], v[40:43], a[208:211]
    ds_read_b128 v[32:35], v16 offset:45056
    v_mfma_f32_16x16x32_bf16 a[208:211], v[100:103], v[44:47], a[208:211]
    ds_read_b128 v[36:39], v17 offset:45056
    v_max_f32 v210, 0, v210
    v_max_f32 v211, 0, v211
    v_mfma_f32_16x16x32_bf16 a[212:215], v[104:107], v[40:43], a[212:215]
    ds_read_b64_tr_b16 v[92:93], v195 offset:40960
    v_max_f32 v212, 0, v212
    v_mfma_f32_16x16x32_bf16 a[212:215], v[108:111], v[44:47], a[212:215]
    v_max_f32 v213, 0, v213
    v_mfma_f32_16x16x32_bf16 a[216:219], v[112:115], v[40:43], a[216:219]
    v_max_f32 v214, 0, v214
    v_max_f32 v215, 0, v215
    v_mfma_f32_16x16x32_bf16 a[216:219], v[116:119], v[44:47], a[216:219]
    ds_read_b64_tr_b16 v[94:95], v195 offset:43008
    v_mul_f32 v208, v208, v216
    v_mfma_f32_16x16x32_bf16 a[220:223], v[120:123], v[40:43], a[220:223]
    v_mul_f32 v209, v209, v217
    v_mfma_f32_16x16x32_bf16 a[220:223], v[124:127], v[44:47], a[220:223]
    v_mul_f32 v210, v210, v218
    s_waitcnt lgkmcnt(2)
    v_mfma_f32_16x16x32_bf16 a[224:227], v[96:99], v[32:35], a[224:227]
    ds_read_b128 v[40:43], v16 offset:47104
    v_mfma_f32_16x16x32_bf16 a[224:227], v[100:103], v[36:39], a[224:227]
    ds_read_b128 v[44:47], v17 offset:47104
    v_mul_f32 v211, v211, v219
    v_mul_f32 v212, v212, v220
    v_mfma_f32_16x16x32_bf16 a[228:231], v[104:107], v[32:35], a[228:231]
    v_mul_f32 v213, v213, v221
    v_mfma_f32_16x16x32_bf16 a[228:231], v[108:111], v[36:39], a[228:231]
    v_mul_f32 v214, v214, v222
    v_mfma_f32_16x16x32_bf16 a[232:235], v[112:115], v[32:35], a[232:235]
    v_mul_f32 v215, v215, v223
    v_cvt_pk_bf16_f32 v224, v208, v209
    v_mfma_f32_16x16x32_bf16 a[232:235], v[116:119], v[36:39], a[232:235]
    v_cvt_pk_bf16_f32 v225, v210, v211
    v_mfma_f32_16x16x32_bf16 a[236:239], v[120:123], v[32:35], a[236:239]
    v_cvt_pk_bf16_f32 v226, v212, v213
    v_mfma_f32_16x16x32_bf16 a[236:239], v[124:127], v[36:39], a[236:239]
    v_cvt_pk_bf16_f32 v227, v214, v215
    s_waitcnt lgkmcnt(0)
    v_mfma_f32_16x16x32_bf16 a[240:243], v[96:99], v[40:43], a[240:243]
    s_waitcnt vmcnt(18)
    s_barrier
    buffer_store_dwordx4 v[224:227], v1, s[8:11], s86 offen sc0 sc1
    v_mfma_f32_16x16x32_bf16 a[240:243], v[100:103], v[44:47], a[240:243]
    ds_read_b128 v[32:35], v18 offset:0
    v_mfma_f32_16x16x32_bf16 a[244:247], v[104:107], v[40:43], a[244:247]
    ds_read_b128 v[36:39], v19 offset:0
    v_mfma_f32_16x16x32_bf16 a[244:247], v[108:111], v[44:47], a[244:247]
    s_add_u32 m0, s40, 32768
    s_add_u32 s48, s36, 512
    buffer_load_dwordx4 v2, s[8:11], s48 offen offset:0 sc1 lds
    v_mfma_f32_16x16x32_bf16 a[248:251], v[112:115], v[40:43], a[248:251]
    v_mfma_f32_16x16x32_bf16 a[248:251], v[116:119], v[44:47], a[248:251]
    v_mfma_f32_16x16x32_bf16 a[252:255], v[120:123], v[40:43], a[252:255]
    buffer_load_dwordx4 v3, s[8:11], s48 offen offset:1024 sc1 lds
    v_mfma_f32_16x16x32_bf16 a[252:255], v[124:127], v[44:47], a[252:255]
    s_waitcnt lgkmcnt(0)
    v_mfma_f32_16x16x32_bf16 a[128:131], v[64:67], v[32:35], a[128:131]
    ds_read_b128 v[40:43], v18 offset:2048
    v_mfma_f32_16x16x32_bf16 a[128:131], v[68:71], v[36:39], a[128:131]
    ds_read_b128 v[44:47], v19 offset:2048
    v_accvgpr_read_b32 v228, a48
    v_accvgpr_read_b32 v229, a49
    v_mfma_f32_16x16x32_bf16 a[132:135], v[72:75], v[32:35], a[132:135]
    ds_read_b64_tr_b16 v[96:97], v192 offset:49152
    v_accvgpr_read_b32 v230, a50
    v_mfma_f32_16x16x32_bf16 a[132:135], v[76:79], v[36:39], a[132:135]
    buffer_load_dwordx4 v4, s[8:11], s48 offen offset:2048 sc1 lds
    v_accvgpr_read_b32 v231, a51
    v_mfma_f32_16x16x32_bf16 a[136:139], v[80:83], v[32:35], a[136:139]
    ds_read_b64_tr_b16 v[98:99], v192 offset:51200
    v_accvgpr_read_b32 v232, a52
    v_accvgpr_read_b32 v233, a53
    v_mfma_f32_16x16x32_bf16 a[136:139], v[84:87], v[36:39], a[136:139]
    buffer_load_dwordx4 v5, s[8:11], s48 offen offset:3072 sc1 lds
    v_accvgpr_read_b32 v234, a54
    v_mfma_f32_16x16x32_bf16 a[140:143], v[88:91], v[32:35], a[140:143]
    ds_read_b64_tr_b16 v[100:101], v192 offset:57344
    v_accvgpr_read_b32 v235, a55
    v_mfma_f32_16x16x32_bf16 a[140:143], v[92:95], v[36:39], a[140:143]
    v_accvgpr_read_b32 v236, a56
    s_waitcnt lgkmcnt(3)
    v_mfma_f32_16x16x32_bf16 a[144:147], v[64:67], v[40:43], a[144:147]
    ds_read_b128 v[32:35], v18 offset:4096
    v_mfma_f32_16x16x32_bf16 a[144:147], v[68:71], v[44:47], a[144:147]
    ds_read_b128 v[36:39], v19 offset:4096
    v_accvgpr_read_b32 v237, a57
    v_accvgpr_read_b32 v238, a58
    v_mfma_f32_16x16x32_bf16 a[148:151], v[72:75], v[40:43], a[148:151]
    ds_read_b64_tr_b16 v[102:103], v192 offset:59392
    v_accvgpr_read_b32 v239, a59
    v_mfma_f32_16x16x32_bf16 a[148:151], v[76:79], v[44:47], a[148:151]
    s_add_u32 m0, s40, 36864
    s_add_u32 s48, s36, 33280
    buffer_load_dwordx4 v2, s[8:11], s48 offen offset:0 sc1 lds
    v_accvgpr_read_b32 v240, a60
    v_mfma_f32_16x16x32_bf16 a[152:155], v[80:83], v[40:43], a[152:155]
    ds_read_b64_tr_b16 v[104:105], v193 offset:49152
    v_accvgpr_read_b32 v241, a61
    v_accvgpr_read_b32 v242, a62
    v_mfma_f32_16x16x32_bf16 a[152:155], v[84:87], v[44:47], a[152:155]
    v_accvgpr_read_b32 v243, a63
    v_mfma_f32_16x16x32_bf16 a[156:159], v[88:91], v[40:43], a[156:159]
    ds_read_b64_tr_b16 v[106:107], v193 offset:51200
    buffer_load_dwordx4 v3, s[8:11], s48 offen offset:1024 sc1 lds
    v_max_f32 v228, 0, v228
    v_mfma_f32_16x16x32_bf16 a[156:159], v[92:95], v[44:47], a[156:159]
    v_max_f32 v229, 0, v229
    s_waitcnt lgkmcnt(3)
    v_mfma_f32_16x16x32_bf16 a[160:163], v[64:67], v[32:35], a[160:163]
    ds_read_b128 v[40:43], v18 offset:6144
    v_mfma_f32_16x16x32_bf16 a[160:163], v[68:71], v[36:39], a[160:163]
    ds_read_b128 v[44:47], v19 offset:6144
    v_max_f32 v230, 0, v230
    v_max_f32 v231, 0, v231
    v_mfma_f32_16x16x32_bf16 a[164:167], v[72:75], v[32:35], a[164:167]
    ds_read_b64_tr_b16 v[108:109], v193 offset:57344
    v_max_f32 v232, 0, v232
    v_mfma_f32_16x16x32_bf16 a[164:167], v[76:79], v[36:39], a[164:167]
    buffer_load_dwordx4 v4, s[8:11], s48 offen offset:2048 sc1 lds
    v_max_f32 v233, 0, v233
    v_mfma_f32_16x16x32_bf16 a[168:171], v[80:83], v[32:35], a[168:171]
    v_max_f32 v234, 0, v234
    v_max_f32 v235, 0, v235
    v_mfma_f32_16x16x32_bf16 a[168:171], v[84:87], v[36:39], a[168:171]
    ds_read_b64_tr_b16 v[110:111], v193 offset:59392
    buffer_load_dwordx4 v5, s[8:11], s48 offen offset:3072 sc1 lds
    v_mul_f32 v228, v228, v236
    v_mfma_f32_16x16x32_bf16 a[172:175], v[88:91], v[32:35], a[172:175]
    v_mul_f32 v229, v229, v237
    v_mfma_f32_16x16x32_bf16 a[172:175], v[92:95], v[36:39], a[172:175]
    v_mul_f32 v230, v230, v238
    s_waitcnt lgkmcnt(2)
    v_mfma_f32_16x16x32_bf16 a[176:179], v[64:67], v[40:43], a[176:179]
    ds_read_b128 v[32:35], v18 offset:8192
    v_mfma_f32_16x16x32_bf16 a[176:179], v[68:71], v[44:47], a[176:179]
    ds_read_b128 v[36:39], v19 offset:8192
    v_mul_f32 v231, v231, v239
    v_mul_f32 v232, v232, v240
    v_mfma_f32_16x16x32_bf16 a[180:183], v[72:75], v[40:43], a[180:183]
    ds_read_b64_tr_b16 v[112:113], v194 offset:49152
    v_mul_f32 v233, v233, v241
    v_mfma_f32_16x16x32_bf16 a[180:183], v[76:79], v[44:47], a[180:183]
    s_add_u32 m0, s41, 131072
    s_add_u32 s48, s37, 3145728
    buffer_load_dwordx4 v6, s[60:63], s48 offen offset:0 lds
    v_mul_f32 v234, v234, v242
    v_mfma_f32_16x16x32_bf16 a[184:187], v[80:83], v[40:43], a[184:187]
    ds_read_b64_tr_b16 v[114:115], v194 offset:51200
    v_mul_f32 v235, v235, v243
    v_cvt_pk_bf16_f32 v244, v228, v229
    v_mfma_f32_16x16x32_bf16 a[184:187], v[84:87], v[44:47], a[184:187]
    v_cvt_pk_bf16_f32 v245, v230, v231
    v_mfma_f32_16x16x32_bf16 a[188:191], v[88:91], v[40:43], a[188:191]
    ds_read_b64_tr_b16 v[116:117], v194 offset:57344
    buffer_load_dwordx4 v7, s[60:63], s48 offen offset:1024 lds
    v_cvt_pk_bf16_f32 v246, v232, v233
    v_mfma_f32_16x16x32_bf16 a[188:191], v[92:95], v[44:47], a[188:191]
    v_cvt_pk_bf16_f32 v247, v234, v235
    s_waitcnt lgkmcnt(3)
    v_mfma_f32_16x16x32_bf16 a[192:195], v[64:67], v[32:35], a[192:195]
    ds_read_b128 v[40:43], v18 offset:10240
    buffer_store_dwordx4 v[244:247], v1, s[8:11], s87 offen sc0 sc1
    v_mfma_f32_16x16x32_bf16 a[192:195], v[68:71], v[36:39], a[192:195]
    ds_read_b128 v[44:47], v19 offset:10240
    v_mfma_f32_16x16x32_bf16 a[196:199], v[72:75], v[32:35], a[196:199]
    ds_read_b64_tr_b16 v[118:119], v194 offset:59392
    v_mfma_f32_16x16x32_bf16 a[196:199], v[76:79], v[36:39], a[196:199]
    buffer_load_dwordx4 v8, s[60:63], s48 offen offset:2048 lds
    v_mfma_f32_16x16x32_bf16 a[200:203], v[80:83], v[32:35], a[200:203]
    ds_read_b64_tr_b16 v[120:121], v195 offset:49152
    v_mfma_f32_16x16x32_bf16 a[200:203], v[84:87], v[36:39], a[200:203]
    buffer_load_dwordx4 v9, s[60:63], s48 offen offset:3072 lds
    v_mfma_f32_16x16x32_bf16 a[204:207], v[88:91], v[32:35], a[204:207]
    ds_read_b64_tr_b16 v[122:123], v195 offset:51200
    v_mfma_f32_16x16x32_bf16 a[204:207], v[92:95], v[36:39], a[204:207]
    s_waitcnt lgkmcnt(3)
    v_mfma_f32_16x16x32_bf16 a[208:211], v[64:67], v[40:43], a[208:211]
    ds_read_b128 v[32:35], v18 offset:12288
    v_mfma_f32_16x16x32_bf16 a[208:211], v[68:71], v[44:47], a[208:211]
    ds_read_b128 v[36:39], v19 offset:12288
    v_accvgpr_read_b32 v208, a64
    v_accvgpr_read_b32 v209, a65
    v_mfma_f32_16x16x32_bf16 a[212:215], v[72:75], v[40:43], a[212:215]
    ds_read_b64_tr_b16 v[124:125], v195 offset:57344
    v_accvgpr_read_b32 v210, a66
    v_mfma_f32_16x16x32_bf16 a[212:215], v[76:79], v[44:47], a[212:215]
    v_accvgpr_read_b32 v211, a67
    v_mfma_f32_16x16x32_bf16 a[216:219], v[80:83], v[40:43], a[216:219]
    v_accvgpr_read_b32 v212, a68
    v_accvgpr_read_b32 v213, a69
    v_mfma_f32_16x16x32_bf16 a[216:219], v[84:87], v[44:47], a[216:219]
    ds_read_b64_tr_b16 v[126:127], v195 offset:59392
    v_accvgpr_read_b32 v214, a70
    v_mfma_f32_16x16x32_bf16 a[220:223], v[88:91], v[40:43], a[220:223]
    v_accvgpr_read_b32 v215, a71
    v_mfma_f32_16x16x32_bf16 a[220:223], v[92:95], v[44:47], a[220:223]
    v_accvgpr_read_b32 v216, a72
    s_waitcnt lgkmcnt(2)
    v_mfma_f32_16x16x32_bf16 a[224:227], v[64:67], v[32:35], a[224:227]
    ds_read_b128 v[40:43], v18 offset:14336
    v_mfma_f32_16x16x32_bf16 a[224:227], v[68:71], v[36:39], a[224:227]
    ds_read_b128 v[44:47], v19 offset:14336
    v_accvgpr_read_b32 v217, a73
    v_accvgpr_read_b32 v218, a74
    v_mfma_f32_16x16x32_bf16 a[228:231], v[72:75], v[32:35], a[228:231]
    v_accvgpr_read_b32 v219, a75
    v_mfma_f32_16x16x32_bf16 a[228:231], v[76:79], v[36:39], a[228:231]
    v_accvgpr_read_b32 v220, a76
    v_mfma_f32_16x16x32_bf16 a[232:235], v[80:83], v[32:35], a[232:235]
    v_accvgpr_read_b32 v221, a77
    v_accvgpr_read_b32 v222, a78
    v_mfma_f32_16x16x32_bf16 a[232:235], v[84:87], v[36:39], a[232:235]
    v_accvgpr_read_b32 v223, a79
    v_mfma_f32_16x16x32_bf16 a[236:239], v[88:91], v[32:35], a[236:239]
    v_max_f32 v208, 0, v208
    v_mfma_f32_16x16x32_bf16 a[236:239], v[92:95], v[36:39], a[236:239]
    v_max_f32 v209, 0, v209
    s_waitcnt lgkmcnt(0)
    v_mfma_f32_16x16x32_bf16 a[240:243], v[64:67], v[40:43], a[240:243]
    s_waitcnt vmcnt(18)
    s_barrier
    v_mfma_f32_16x16x32_bf16 a[240:243], v[68:71], v[44:47], a[240:243]
    ds_read_b128 v[32:35], v16 offset:0
    v_max_f32 v210, 0, v210
    v_max_f32 v211, 0, v211
    v_mfma_f32_16x16x32_bf16 a[244:247], v[72:75], v[40:43], a[244:247]
    ds_read_b128 v[36:39], v17 offset:0
    v_max_f32 v212, 0, v212
    v_mfma_f32_16x16x32_bf16 a[244:247], v[76:79], v[44:47], a[244:247]
    s_add_u32 m0, s40, 65536
    s_add_u32 s48, s36, 640
    buffer_load_dwordx4 v2, s[8:11], s48 offen offset:0 sc1 lds
    v_max_f32 v213, 0, v213
    v_mfma_f32_16x16x32_bf16 a[248:251], v[80:83], v[40:43], a[248:251]
    v_max_f32 v214, 0, v214
    v_max_f32 v215, 0, v215
    v_mfma_f32_16x16x32_bf16 a[248:251], v[84:87], v[44:47], a[248:251]
    v_mul_f32 v208, v208, v216
    v_mfma_f32_16x16x32_bf16 a[252:255], v[88:91], v[40:43], a[252:255]
    buffer_load_dwordx4 v3, s[8:11], s48 offen offset:1024 sc1 lds
    v_mul_f32 v209, v209, v217
    v_mfma_f32_16x16x32_bf16 a[252:255], v[92:95], v[44:47], a[252:255]
    v_mul_f32 v210, v210, v218
    s_waitcnt lgkmcnt(0)
    v_mfma_f32_16x16x32_bf16 a[128:131], v[96:99], v[32:35], a[128:131]
    ds_read_b128 v[40:43], v16 offset:2048
    v_mfma_f32_16x16x32_bf16 a[128:131], v[100:103], v[36:39], a[128:131]
    ds_read_b128 v[44:47], v17 offset:2048
    v_mul_f32 v211, v211, v219
    v_mul_f32 v212, v212, v220
    v_mfma_f32_16x16x32_bf16 a[132:135], v[104:107], v[32:35], a[132:135]
    ds_read_b64_tr_b16 v[64:65], v192 offset:0
    v_mul_f32 v213, v213, v221
    v_mfma_f32_16x16x32_bf16 a[132:135], v[108:111], v[36:39], a[132:135]
    buffer_load_dwordx4 v4, s[8:11], s48 offen offset:2048 sc1 lds
    v_mul_f32 v214, v214, v222
    v_mfma_f32_16x16x32_bf16 a[136:139], v[112:115], v[32:35], a[136:139]
    ds_read_b64_tr_b16 v[66:67], v192 offset:2048
    v_mul_f32 v215, v215, v223
    v_cvt_pk_bf16_f32 v224, v208, v209
    v_mfma_f32_16x16x32_bf16 a[136:139], v[116:119], v[36:39], a[136:139]
    buffer_load_dwordx4 v5, s[8:11], s48 offen offset:3072 sc1 lds
    v_cvt_pk_bf16_f32 v225, v210, v211
    v_mfma_f32_16x16x32_bf16 a[140:143], v[120:123], v[32:35], a[140:143]
    ds_read_b64_tr_b16 v[68:69], v192 offset:8192
    v_cvt_pk_bf16_f32 v226, v212, v213
    v_mfma_f32_16x16x32_bf16 a[140:143], v[124:127], v[36:39], a[140:143]
    v_cvt_pk_bf16_f32 v227, v214, v215
    s_waitcnt lgkmcnt(3)
    v_mfma_f32_16x16x32_bf16 a[144:147], v[96:99], v[40:43], a[144:147]
    ds_read_b128 v[32:35], v16 offset:4096
    buffer_store_dwordx4 v[224:227], v1, s[8:11], s88 offen sc0 sc1
    v_mfma_f32_16x16x32_bf16 a[144:147], v[100:103], v[44:47], a[144:147]
    ds_read_b128 v[36:39], v17 offset:4096
    v_mfma_f32_16x16x32_bf16 a[148:151], v[104:107], v[40:43], a[148:151]
    ds_read_b64_tr_b16 v[70:71], v192 offset:10240
    v_mfma_f32_16x16x32_bf16 a[148:151], v[108:111], v[44:47], a[148:151]
    s_add_u32 m0, s40, 69632
    s_add_u32 s48, s36, 33408
    buffer_load_dwordx4 v2, s[8:11], s48 offen offset:0 sc1 lds
    v_mfma_f32_16x16x32_bf16 a[152:155], v[112:115], v[40:43], a[152:155]
    ds_read_b64_tr_b16 v[72:73], v193 offset:0
    v_mfma_f32_16x16x32_bf16 a[152:155], v[116:119], v[44:47], a[152:155]
    v_mfma_f32_16x16x32_bf16 a[156:159], v[120:123], v[40:43], a[156:159]
    ds_read_b64_tr_b16 v[74:75], v193 offset:2048
    buffer_load_dwordx4 v3, s[8:11], s48 offen offset:1024 sc1 lds
    v_mfma_f32_16x16x32_bf16 a[156:159], v[124:127], v[44:47], a[156:159]
    s_waitcnt lgkmcnt(3)
    v_mfma_f32_16x16x32_bf16 a[160:163], v[96:99], v[32:35], a[160:163]
    ds_read_b128 v[40:43], v16 offset:6144
    v_mfma_f32_16x16x32_bf16 a[160:163], v[100:103], v[36:39], a[160:163]
    ds_read_b128 v[44:47], v17 offset:6144
    v_accvgpr_read_b32 v228, a80
    v_accvgpr_read_b32 v229, a81
    v_mfma_f32_16x16x32_bf16 a[164:167], v[104:107], v[32:35], a[164:167]
    ds_read_b64_tr_b16 v[76:77], v193 offset:8192
    v_accvgpr_read_b32 v230, a82
    v_mfma_f32_16x16x32_bf16 a[164:167], v[108:111], v[36:39], a[164:167]
    buffer_load_dwordx4 v4, s[8:11], s48 offen offset:2048 sc1 lds
    v_accvgpr_read_b32 v231, a83
    v_mfma_f32_16x16x32_bf16 a[168:171], v[112:115], v[32:35], a[168:171]
    v_accvgpr_read_b32 v232, a84
    v_accvgpr_read_b32 v233, a85
    v_mfma_f32_16x16x32_bf16 a[168:171], v[116:119], v[36:39], a[168:171]
    ds_read_b64_tr_b16 v[78:79], v193 offset:10240
    buffer_load_dwordx4 v5, s[8:11], s48 offen offset:3072 sc1 lds
    v_accvgpr_read_b32 v234, a86
    v_mfma_f32_16x16x32_bf16 a[172:175], v[120:123], v[32:35], a[172:175]
    v_accvgpr_read_b32 v235, a87
    v_mfma_f32_16x16x32_bf16 a[172:175], v[124:127], v[36:39], a[172:175]
    v_accvgpr_read_b32 v236, a88
    s_waitcnt lgkmcnt(2)
    v_mfma_f32_16x16x32_bf16 a[176:179], v[96:99], v[40:43], a[176:179]
    ds_read_b128 v[32:35], v16 offset:8192
    v_mfma_f32_16x16x32_bf16 a[176:179], v[100:103], v[44:47], a[176:179]
    ds_read_b128 v[36:39], v17 offset:8192
    v_accvgpr_read_b32 v237, a89
    v_accvgpr_read_b32 v238, a90
    v_mfma_f32_16x16x32_bf16 a[180:183], v[104:107], v[40:43], a[180:183]
    ds_read_b64_tr_b16 v[80:81], v194 offset:0
    v_accvgpr_read_b32 v239, a91
    v_mfma_f32_16x16x32_bf16 a[180:183], v[108:111], v[44:47], a[180:183]
    s_add_u32 m0, s41, 147456
    s_add_u32 s48, s37, 3670016
    buffer_load_dwordx4 v6, s[60:63], s48 offen offset:0 lds
    v_accvgpr_read_b32 v240, a92
    v_mfma_f32_16x16x32_bf16 a[184:187], v[112:115], v[40:43], a[184:187]
    ds_read_b64_tr_b16 v[82:83], v194 offset:2048
    v_accvgpr_read_b32 v241, a93
    v_accvgpr_read_b32 v242, a94
    v_mfma_f32_16x16x32_bf16 a[184:187], v[116:119], v[44:47], a[184:187]
    v_accvgpr_read_b32 v243, a95
    v_mfma_f32_16x16x32_bf16 a[188:191], v[120:123], v[40:43], a[188:191]
    ds_read_b64_tr_b16 v[84:85], v194 offset:8192
    buffer_load_dwordx4 v7, s[60:63], s48 offen offset:1024 lds
    v_max_f32 v228, 0, v228
    v_mfma_f32_16x16x32_bf16 a[188:191], v[124:127], v[44:47], a[188:191]
    v_max_f32 v229, 0, v229
    s_waitcnt lgkmcnt(3)
    v_mfma_f32_16x16x32_bf16 a[192:195], v[96:99], v[32:35], a[192:195]
    ds_read_b128 v[40:43], v16 offset:10240
    v_mfma_f32_16x16x32_bf16 a[192:195], v[100:103], v[36:39], a[192:195]
    ds_read_b128 v[44:47], v17 offset:10240
    v_max_f32 v230, 0, v230
    v_max_f32 v231, 0, v231
    v_mfma_f32_16x16x32_bf16 a[196:199], v[104:107], v[32:35], a[196:199]
    ds_read_b64_tr_b16 v[86:87], v194 offset:10240
    v_max_f32 v232, 0, v232
    v_mfma_f32_16x16x32_bf16 a[196:199], v[108:111], v[36:39], a[196:199]
    buffer_load_dwordx4 v8, s[60:63], s48 offen offset:2048 lds
    v_max_f32 v233, 0, v233
    v_mfma_f32_16x16x32_bf16 a[200:203], v[112:115], v[32:35], a[200:203]
    ds_read_b64_tr_b16 v[88:89], v195 offset:0
    v_max_f32 v234, 0, v234
    v_max_f32 v235, 0, v235
    v_mfma_f32_16x16x32_bf16 a[200:203], v[116:119], v[36:39], a[200:203]
    buffer_load_dwordx4 v9, s[60:63], s48 offen offset:3072 lds
    v_mul_f32 v228, v228, v236
    v_mfma_f32_16x16x32_bf16 a[204:207], v[120:123], v[32:35], a[204:207]
    ds_read_b64_tr_b16 v[90:91], v195 offset:2048
    v_mul_f32 v229, v229, v237
    v_mfma_f32_16x16x32_bf16 a[204:207], v[124:127], v[36:39], a[204:207]
    v_mul_f32 v230, v230, v238
    s_waitcnt lgkmcnt(3)
    v_mfma_f32_16x16x32_bf16 a[208:211], v[96:99], v[40:43], a[208:211]
    ds_read_b128 v[32:35], v16 offset:12288
    v_mfma_f32_16x16x32_bf16 a[208:211], v[100:103], v[44:47], a[208:211]
    ds_read_b128 v[36:39], v17 offset:12288
    v_mul_f32 v231, v231, v239
    v_mul_f32 v232, v232, v240
    v_mfma_f32_16x16x32_bf16 a[212:215], v[104:107], v[40:43], a[212:215]
    ds_read_b64_tr_b16 v[92:93], v195 offset:8192
    v_mul_f32 v233, v233, v241
    v_mfma_f32_16x16x32_bf16 a[212:215], v[108:111], v[44:47], a[212:215]
    v_mul_f32 v234, v234, v242
    v_mfma_f32_16x16x32_bf16 a[216:219], v[112:115], v[40:43], a[216:219]
    v_mul_f32 v235, v235, v243
    v_cvt_pk_bf16_f32 v244, v228, v229
    v_mfma_f32_16x16x32_bf16 a[216:219], v[116:119], v[44:47], a[216:219]
    ds_read_b64_tr_b16 v[94:95], v195 offset:10240
    v_cvt_pk_bf16_f32 v245, v230, v231
    v_mfma_f32_16x16x32_bf16 a[220:223], v[120:123], v[40:43], a[220:223]
    v_cvt_pk_bf16_f32 v246, v232, v233
    v_mfma_f32_16x16x32_bf16 a[220:223], v[124:127], v[44:47], a[220:223]
    v_cvt_pk_bf16_f32 v247, v234, v235
    s_waitcnt lgkmcnt(2)
    v_mfma_f32_16x16x32_bf16 a[224:227], v[96:99], v[32:35], a[224:227]
    ds_read_b128 v[40:43], v16 offset:14336
    buffer_store_dwordx4 v[244:247], v1, s[8:11], s89 offen sc0 sc1
    v_mfma_f32_16x16x32_bf16 a[224:227], v[100:103], v[36:39], a[224:227]
    ds_read_b128 v[44:47], v17 offset:14336
    v_mfma_f32_16x16x32_bf16 a[228:231], v[104:107], v[32:35], a[228:231]
    v_mfma_f32_16x16x32_bf16 a[228:231], v[108:111], v[36:39], a[228:231]
    v_mfma_f32_16x16x32_bf16 a[232:235], v[112:115], v[32:35], a[232:235]
    v_mfma_f32_16x16x32_bf16 a[232:235], v[116:119], v[36:39], a[232:235]
    v_mfma_f32_16x16x32_bf16 a[236:239], v[120:123], v[32:35], a[236:239]
    v_mfma_f32_16x16x32_bf16 a[236:239], v[124:127], v[36:39], a[236:239]
    s_waitcnt lgkmcnt(0)
    v_mfma_f32_16x16x32_bf16 a[240:243], v[96:99], v[40:43], a[240:243]
    s_waitcnt vmcnt(19)
    s_barrier
    v_mfma_f32_16x16x32_bf16 a[240:243], v[100:103], v[44:47], a[240:243]
    ds_read_b128 v[32:35], v16 offset:32768
    v_accvgpr_read_b32 v208, a96
    v_accvgpr_read_b32 v209, a97
    v_mfma_f32_16x16x32_bf16 a[244:247], v[104:107], v[40:43], a[244:247]
    ds_read_b128 v[36:39], v17 offset:32768
    v_accvgpr_read_b32 v210, a98
    v_mfma_f32_16x16x32_bf16 a[244:247], v[108:111], v[44:47], a[244:247]
    s_add_u32 m0, s40, 0
    s_add_u32 s48, s36, 768
    buffer_load_dwordx4 v2, s[8:11], s48 offen offset:0 sc1 lds
    v_accvgpr_read_b32 v211, a99
    v_mfma_f32_16x16x32_bf16 a[248:251], v[112:115], v[40:43], a[248:251]
    v_accvgpr_read_b32 v212, a100
    v_accvgpr_read_b32 v213, a101
    v_mfma_f32_16x16x32_bf16 a[248:251], v[116:119], v[44:47], a[248:251]
    v_accvgpr_read_b32 v214, a102
    v_mfma_f32_16x16x32_bf16 a[252:255], v[120:123], v[40:43], a[252:255]
    buffer_load_dwordx4 v3, s[8:11], s48 offen offset:1024 sc1 lds
    v_accvgpr_read_b32 v215, a103
    v_mfma_f32_16x16x32_bf16 a[252:255], v[124:127], v[44:47], a[252:255]
    v_accvgpr_read_b32 v216, a104
    s_waitcnt lgkmcnt(0)
    v_mfma_f32_16x16x32_bf16 a[128:131], v[64:67], v[32:35], a[128:131]
    ds_read_b128 v[40:43], v16 offset:34816
    v_mfma_f32_16x16x32_bf16 a[128:131], v[68:71], v[36:39], a[128:131]
    ds_read_b128 v[44:47], v17 offset:34816
    v_accvgpr_read_b32 v217, a105
    v_accvgpr_read_b32 v218, a106
    v_mfma_f32_16x16x32_bf16 a[132:135], v[72:75], v[32:35], a[132:135]
    ds_read_b64_tr_b16 v[96:97], v192 offset:16384
    v_accvgpr_read_b32 v219, a107
    v_mfma_f32_16x16x32_bf16 a[132:135], v[76:79], v[36:39], a[132:135]
    buffer_load_dwordx4 v4, s[8:11], s48 offen offset:2048 sc1 lds
    v_accvgpr_read_b32 v220, a108
    v_mfma_f32_16x16x32_bf16 a[136:139], v[80:83], v[32:35], a[136:139]
    ds_read_b64_tr_b16 v[98:99], v192 offset:18432
    v_accvgpr_read_b32 v221, a109
    v_accvgpr_read_b32 v222, a110
    v_mfma_f32_16x16x32_bf16 a[136:139], v[84:87], v[36:39], a[136:139]
    buffer_load_dwordx4 v5, s[8:11], s48 offen offset:3072 sc1 lds
    v_accvgpr_read_b32 v223, a111
    v_mfma_f32_16x16x32_bf16 a[140:143], v[88:91], v[32:35], a[140:143]
    ds_read_b64_tr_b16 v[100:101], v192 offset:24576
    v_max_f32 v208, 0, v208
    v_mfma_f32_16x16x32_bf16 a[140:143], v[92:95], v[36:39], a[140:143]
    v_max_f32 v209, 0, v209
    s_waitcnt lgkmcnt(3)
    v_mfma_f32_16x16x32_bf16 a[144:147], v[64:67], v[40:43], a[144:147]
    ds_read_b128 v[32:35], v16 offset:36864
    v_mfma_f32_16x16x32_bf16 a[144:147], v[68:71], v[44:47], a[144:147]
    ds_read_b128 v[36:39], v17 offset:36864
    v_max_f32 v210, 0, v210
    v_max_f32 v211, 0, v211
    v_mfma_f32_16x16x32_bf16 a[148:151], v[72:75], v[40:43], a[148:151]
    ds_read_b64_tr_b16 v[102:103], v192 offset:26624
    v_max_f32 v212, 0, v212
    v_mfma_f32_16x16x32_bf16 a[148:151], v[76:79], v[44:47], a[148:151]
    s_add_u32 m0, s40, 4096
    s_add_u32 s48, s36, 33536
    buffer_load_dwordx4 v2, s[8:11], s48 offen offset:0 sc1 lds
    v_max_f32 v213, 0, v213
    v_mfma_f32_16x16x32_bf16 a[152:155], v[80:83], v[40:43], a[152:155]
    ds_read_b64_tr_b16 v[104:105], v193 offset:16384
    v_max_f32 v214, 0, v214
    v_max_f32 v215, 0, v215
    v_mfma_f32_16x16x32_bf16 a[152:155], v[84:87], v[44:47], a[152:155]
    v_mul_f32 v208, v208, v216
    v_mfma_f32_16x16x32_bf16 a[156:159], v[88:91], v[40:43], a[156:159]
    ds_read_b64_tr_b16 v[106:107], v193 offset:18432
    buffer_load_dwordx4 v3, s[8:11], s48 offen offset:1024 sc1 lds
    v_mul_f32 v209, v209, v217
    v_mfma_f32_16x16x32_bf16 a[156:159], v[92:95], v[44:47], a[156:159]
    v_mul_f32 v210, v210, v218
    s_waitcnt lgkmcnt(3)
    v_mfma_f32_16x16x32_bf16 a[160:163], v[64:67], v[32:35], a[160:163]
    ds_read_b128 v[40:43], v16 offset:38912
    v_mfma_f32_16x16x32_bf16 a[160:163], v[68:71], v[36:39], a[160:163]
    ds_read_b128 v[44:47], v17 offset:38912
    v_mul_f32 v211, v211, v219
    v_mul_f32 v212, v212, v220
    v_mfma_f32_16x16x32_bf16 a[164:167], v[72:75], v[32:35], a[164:167]
    ds_read_b64_tr_b16 v[108:109], v193 offset:24576
    v_mul_f32 v213, v213, v221
    v_mfma_f32_16x16x32_bf16 a[164:167], v[76:79], v[36:39], a[164:167]
    buffer_load_dwordx4 v4, s[8:11], s48 offen offset:2048 sc1 lds
    v_mul_f32 v214, v214, v222
    v_mfma_f32_16x16x32_bf16 a[168:171], v[80:83], v[32:35], a[168:171]
    v_mul_f32 v215, v215, v223
    v_cvt_pk_bf16_f32 v224, v208, v209
    v_mfma_f32_16x16x32_bf16 a[168:171], v[84:87], v[36:39], a[168:171]
    ds_read_b64_tr_b16 v[110:111], v193 offset:26624
    buffer_load_dwordx4 v5, s[8:11], s48 offen offset:3072 sc1 lds
    v_cvt_pk_bf16_f32 v225, v210, v211
    v_mfma_f32_16x16x32_bf16 a[172:175], v[88:91], v[32:35], a[172:175]
    v_cvt_pk_bf16_f32 v226, v212, v213
    v_mfma_f32_16x16x32_bf16 a[172:175], v[92:95], v[36:39], a[172:175]
    v_cvt_pk_bf16_f32 v227, v214, v215
    s_waitcnt lgkmcnt(2)
    v_mfma_f32_16x16x32_bf16 a[176:179], v[64:67], v[40:43], a[176:179]
    ds_read_b128 v[32:35], v16 offset:40960
    buffer_store_dwordx4 v[224:227], v1, s[8:11], s90 offen sc0 sc1
    v_mfma_f32_16x16x32_bf16 a[176:179], v[68:71], v[44:47], a[176:179]
    ds_read_b128 v[36:39], v17 offset:40960
    v_mfma_f32_16x16x32_bf16 a[180:183], v[72:75], v[40:43], a[180:183]
    ds_read_b64_tr_b16 v[112:113], v194 offset:16384
    v_mfma_f32_16x16x32_bf16 a[180:183], v[76:79], v[44:47], a[180:183]
    v_mfma_f32_16x16x32_bf16 a[184:187], v[80:83], v[40:43], a[184:187]
    ds_read_b64_tr_b16 v[114:115], v194 offset:18432
    v_mfma_f32_16x16x32_bf16 a[184:187], v[84:87], v[44:47], a[184:187]
    v_mfma_f32_16x16x32_bf16 a[188:191], v[88:91], v[40:43], a[188:191]
    ds_read_b64_tr_b16 v[116:117], v194 offset:24576
    v_mfma_f32_16x16x32_bf16 a[188:191], v[92:95], v[44:47], a[188:191]
    s_waitcnt lgkmcnt(3)
    v_mfma_f32_16x16x32_bf16 a[192:195], v[64:67], v[32:35], a[192:195]
    ds_read_b128 v[40:43], v16 offset:43008
    v_mfma_f32_16x16x32_bf16 a[192:195], v[68:71], v[36:39], a[192:195]
    ds_read_b128 v[44:47], v17 offset:43008
    v_accvgpr_read_b32 v228, a112
    v_accvgpr_read_b32 v229, a113
    v_mfma_f32_16x16x32_bf16 a[196:199], v[72:75], v[32:35], a[196:199]
    ds_read_b64_tr_b16 v[118:119], v194 offset:26624
    v_accvgpr_read_b32 v230, a114
    v_mfma_f32_16x16x32_bf16 a[196:199], v[76:79], v[36:39], a[196:199]
    v_accvgpr_read_b32 v231, a115
    v_mfma_f32_16x16x32_bf16 a[200:203], v[80:83], v[32:35], a[200:203]
    ds_read_b64_tr_b16 v[120:121], v195 offset:16384
    v_accvgpr_read_b32 v232, a116
    v_accvgpr_read_b32 v233, a117
    v_mfma_f32_16x16x32_bf16 a[200:203], v[84:87], v[36:39], a[200:203]
    v_accvgpr_read_b32 v234, a118
    v_mfma_f32_16x16x32_bf16 a[204:207], v[88:91], v[32:35], a[204:207]
    ds_read_b64_tr_b16 v[122:123], v195 offset:18432
    v_accvgpr_read_b32 v235, a119
    v_mfma_f32_16x16x32_bf16 a[204:207], v[92:95], v[36:39], a[204:207]
    v_accvgpr_read_b32 v236, a120
    s_waitcnt lgkmcnt(3)
    v_mfma_f32_16x16x32_bf16 a[208:211], v[64:67], v[40:43], a[208:211]
    ds_read_b128 v[32:35], v16 offset:45056
    v_mfma_f32_16x16x32_bf16 a[208:211], v[68:71], v[44:47], a[208:211]
    ds_read_b128 v[36:39], v17 offset:45056
    v_accvgpr_read_b32 v237, a121
    v_accvgpr_read_b32 v238, a122
    v_mfma_f32_16x16x32_bf16 a[212:215], v[72:75], v[40:43], a[212:215]
    ds_read_b64_tr_b16 v[124:125], v195 offset:24576
    v_accvgpr_read_b32 v239, a123
    v_mfma_f32_16x16x32_bf16 a[212:215], v[76:79], v[44:47], a[212:215]
    v_accvgpr_read_b32 v240, a124
    v_mfma_f32_16x16x32_bf16 a[216:219], v[80:83], v[40:43], a[216:219]
    v_accvgpr_read_b32 v241, a125
    v_accvgpr_read_b32 v242, a126
    v_mfma_f32_16x16x32_bf16 a[216:219], v[84:87], v[44:47], a[216:219]
    ds_read_b64_tr_b16 v[126:127], v195 offset:26624
    v_accvgpr_read_b32 v243, a127
    v_mfma_f32_16x16x32_bf16 a[220:223], v[88:91], v[40:43], a[220:223]
    v_max_f32 v228, 0, v228
    v_mfma_f32_16x16x32_bf16 a[220:223], v[92:95], v[44:47], a[220:223]
    v_max_f32 v229, 0, v229
    s_waitcnt lgkmcnt(2)
    v_mfma_f32_16x16x32_bf16 a[224:227], v[64:67], v[32:35], a[224:227]
    ds_read_b128 v[40:43], v16 offset:47104
    v_mfma_f32_16x16x32_bf16 a[224:227], v[68:71], v[36:39], a[224:227]
    ds_read_b128 v[44:47], v17 offset:47104
    v_max_f32 v230, 0, v230
    v_max_f32 v231, 0, v231
    v_mfma_f32_16x16x32_bf16 a[228:231], v[72:75], v[32:35], a[228:231]
    v_max_f32 v232, 0, v232
    v_mfma_f32_16x16x32_bf16 a[228:231], v[76:79], v[36:39], a[228:231]
    v_max_f32 v233, 0, v233
    v_mfma_f32_16x16x32_bf16 a[232:235], v[80:83], v[32:35], a[232:235]
    v_max_f32 v234, 0, v234
    v_max_f32 v235, 0, v235
    v_mfma_f32_16x16x32_bf16 a[232:235], v[84:87], v[36:39], a[232:235]
    v_mul_f32 v228, v228, v236
    v_mfma_f32_16x16x32_bf16 a[236:239], v[88:91], v[32:35], a[236:239]
    v_mul_f32 v229, v229, v237
    v_mfma_f32_16x16x32_bf16 a[236:239], v[92:95], v[36:39], a[236:239]
    v_mul_f32 v230, v230, v238
    s_waitcnt lgkmcnt(0)
    v_mfma_f32_16x16x32_bf16 a[240:243], v[64:67], v[40:43], a[240:243]
    s_waitcnt vmcnt(14)
    s_barrier
    v_mfma_f32_16x16x32_bf16 a[240:243], v[68:71], v[44:47], a[240:243]
    ds_read_b128 v[32:35], v18 offset:0
    v_mul_f32 v231, v231, v239
    v_mul_f32 v232, v232, v240
    v_mfma_f32_16x16x32_bf16 a[244:247], v[72:75], v[40:43], a[244:247]
    ds_read_b128 v[36:39], v19 offset:0
    v_mul_f32 v233, v233, v241
    v_mfma_f32_16x16x32_bf16 a[244:247], v[76:79], v[44:47], a[244:247]
    s_add_u32 m0, s40, 32768
    s_add_u32 s48, s36, 896
    buffer_load_dwordx4 v2, s[8:11], s48 offen offset:0 sc1 lds
    v_mul_f32 v234, v234, v242
    v_mfma_f32_16x16x32_bf16 a[248:251], v[80:83], v[40:43], a[248:251]
    v_mul_f32 v235, v235, v243
    v_cvt_pk_bf16_f32 v244, v228, v229
    v_mfma_f32_16x16x32_bf16 a[248:251], v[84:87], v[44:47], a[248:251]
    v_cvt_pk_bf16_f32 v245, v230, v231
    v_mfma_f32_16x16x32_bf16 a[252:255], v[88:91], v[40:43], a[252:255]
    buffer_load_dwordx4 v3, s[8:11], s48 offen offset:1024 sc1 lds
    v_cvt_pk_bf16_f32 v246, v232, v233
    v_mfma_f32_16x16x32_bf16 a[252:255], v[92:95], v[44:47], a[252:255]
    v_cvt_pk_bf16_f32 v247, v234, v235
    s_waitcnt lgkmcnt(0)
    v_mfma_f32_16x16x32_bf16 a[128:131], v[96:99], v[32:35], a[128:131]
    ds_read_b128 v[40:43], v18 offset:2048
    buffer_store_dwordx4 v[244:247], v1, s[8:11], s91 offen sc0 sc1
    v_mfma_f32_16x16x32_bf16 a[128:131], v[100:103], v[36:39], a[128:131]
    ds_read_b128 v[44:47], v19 offset:2048
    v_mfma_f32_16x16x32_bf16 a[132:135], v[104:107], v[32:35], a[132:135]
    ds_read_b64_tr_b16 v[64:65], v192 offset:32768
    v_mfma_f32_16x16x32_bf16 a[132:135], v[108:111], v[36:39], a[132:135]
    buffer_load_dwordx4 v4, s[8:11], s48 offen offset:2048 sc1 lds
    v_mfma_f32_16x16x32_bf16 a[136:139], v[112:115], v[32:35], a[136:139]
    ds_read_b64_tr_b16 v[66:67], v192 offset:34816
    v_mfma_f32_16x16x32_bf16 a[136:139], v[116:119], v[36:39], a[136:139]
    buffer_load_dwordx4 v5, s[8:11], s48 offen offset:3072 sc1 lds
    buffer_load_dwordx4 v[204:207], v202, s[8:11], s52 offen sc0 sc1
    v_mfma_f32_16x16x32_bf16 a[140:143], v[120:123], v[32:35], a[140:143]
    ds_read_b64_tr_b16 v[68:69], v192 offset:40960
    v_mfma_f32_16x16x32_bf16 a[140:143], v[124:127], v[36:39], a[140:143]
    s_waitcnt lgkmcnt(3)
    v_mfma_f32_16x16x32_bf16 a[144:147], v[96:99], v[40:43], a[144:147]
    ds_read_b128 v[32:35], v18 offset:4096
    v_mfma_f32_16x16x32_bf16 a[144:147], v[100:103], v[44:47], a[144:147]
    ds_read_b128 v[36:39], v19 offset:4096
    v_mfma_f32_16x16x32_bf16 a[148:151], v[104:107], v[40:43], a[148:151]
    ds_read_b64_tr_b16 v[70:71], v192 offset:43008
    v_mfma_f32_16x16x32_bf16 a[148:151], v[108:111], v[44:47], a[148:151]
    s_add_u32 m0, s40, 36864
    s_add_u32 s48, s36, 33664
    buffer_load_dwordx4 v2, s[8:11], s48 offen offset:0 sc1 lds
    v_mfma_f32_16x16x32_bf16 a[152:155], v[112:115], v[40:43], a[152:155]
    ds_read_b64_tr_b16 v[72:73], v193 offset:32768
    v_mfma_f32_16x16x32_bf16 a[152:155], v[116:119], v[44:47], a[152:155]
    v_mfma_f32_16x16x32_bf16 a[156:159], v[120:123], v[40:43], a[156:159]
    ds_read_b64_tr_b16 v[74:75], v193 offset:34816
    buffer_load_dwordx4 v3, s[8:11], s48 offen offset:1024 sc1 lds
    v_mfma_f32_16x16x32_bf16 a[156:159], v[124:127], v[44:47], a[156:159]
    s_waitcnt lgkmcnt(3)
    v_mfma_f32_16x16x32_bf16 a[160:163], v[96:99], v[32:35], a[160:163]
    ds_read_b128 v[40:43], v18 offset:6144
    v_mfma_f32_16x16x32_bf16 a[160:163], v[100:103], v[36:39], a[160:163]
    ds_read_b128 v[44:47], v19 offset:6144
    v_mfma_f32_16x16x32_bf16 a[164:167], v[104:107], v[32:35], a[164:167]
    ds_read_b64_tr_b16 v[76:77], v193 offset:40960
    v_mfma_f32_16x16x32_bf16 a[164:167], v[108:111], v[36:39], a[164:167]
    buffer_load_dwordx4 v4, s[8:11], s48 offen offset:2048 sc1 lds
    v_mfma_f32_16x16x32_bf16 a[168:171], v[112:115], v[32:35], a[168:171]
    v_mfma_f32_16x16x32_bf16 a[168:171], v[116:119], v[36:39], a[168:171]
    ds_read_b64_tr_b16 v[78:79], v193 offset:43008
    buffer_load_dwordx4 v5, s[8:11], s48 offen offset:3072 sc1 lds
    v_mfma_f32_16x16x32_bf16 a[172:175], v[120:123], v[32:35], a[172:175]
    v_mfma_f32_16x16x32_bf16 a[172:175], v[124:127], v[36:39], a[172:175]
    s_waitcnt lgkmcnt(2)
    v_mfma_f32_16x16x32_bf16 a[176:179], v[96:99], v[40:43], a[176:179]
    ds_read_b128 v[32:35], v18 offset:8192
    v_mfma_f32_16x16x32_bf16 a[176:179], v[100:103], v[44:47], a[176:179]
    ds_read_b128 v[36:39], v19 offset:8192
    v_mfma_f32_16x16x32_bf16 a[180:183], v[104:107], v[40:43], a[180:183]
    ds_read_b64_tr_b16 v[80:81], v194 offset:32768
    v_mfma_f32_16x16x32_bf16 a[180:183], v[108:111], v[44:47], a[180:183]
    v_mfma_f32_16x16x32_bf16 a[184:187], v[112:115], v[40:43], a[184:187]
    ds_read_b64_tr_b16 v[82:83], v194 offset:34816
    v_mfma_f32_16x16x32_bf16 a[184:187], v[116:119], v[44:47], a[184:187]
    v_mfma_f32_16x16x32_bf16 a[188:191], v[120:123], v[40:43], a[188:191]
    ds_read_b64_tr_b16 v[84:85], v194 offset:40960
    v_mfma_f32_16x16x32_bf16 a[188:191], v[124:127], v[44:47], a[188:191]
    s_waitcnt lgkmcnt(3)
    v_mfma_f32_16x16x32_bf16 a[192:195], v[96:99], v[32:35], a[192:195]
    ds_read_b128 v[40:43], v18 offset:10240
    v_mfma_f32_16x16x32_bf16 a[192:195], v[100:103], v[36:39], a[192:195]
    ds_read_b128 v[44:47], v19 offset:10240
    v_mfma_f32_16x16x32_bf16 a[196:199], v[104:107], v[32:35], a[196:199]
    ds_read_b64_tr_b16 v[86:87], v194 offset:43008
    v_mfma_f32_16x16x32_bf16 a[196:199], v[108:111], v[36:39], a[196:199]
    v_mfma_f32_16x16x32_bf16 a[200:203], v[112:115], v[32:35], a[200:203]
    ds_read_b64_tr_b16 v[88:89], v195 offset:32768
    v_mfma_f32_16x16x32_bf16 a[200:203], v[116:119], v[36:39], a[200:203]
    v_mfma_f32_16x16x32_bf16 a[204:207], v[120:123], v[32:35], a[204:207]
    ds_read_b64_tr_b16 v[90:91], v195 offset:34816
    v_mfma_f32_16x16x32_bf16 a[204:207], v[124:127], v[36:39], a[204:207]
    s_waitcnt lgkmcnt(3)
    v_mfma_f32_16x16x32_bf16 a[208:211], v[96:99], v[40:43], a[208:211]
    ds_read_b128 v[32:35], v18 offset:12288
    v_mfma_f32_16x16x32_bf16 a[208:211], v[100:103], v[44:47], a[208:211]
    ds_read_b128 v[36:39], v19 offset:12288
    v_mfma_f32_16x16x32_bf16 a[212:215], v[104:107], v[40:43], a[212:215]
    ds_read_b64_tr_b16 v[92:93], v195 offset:40960
    v_mfma_f32_16x16x32_bf16 a[212:215], v[108:111], v[44:47], a[212:215]
    v_mfma_f32_16x16x32_bf16 a[216:219], v[112:115], v[40:43], a[216:219]
    v_mfma_f32_16x16x32_bf16 a[216:219], v[116:119], v[44:47], a[216:219]
    ds_read_b64_tr_b16 v[94:95], v195 offset:43008
    v_mfma_f32_16x16x32_bf16 a[220:223], v[120:123], v[40:43], a[220:223]
    v_mfma_f32_16x16x32_bf16 a[220:223], v[124:127], v[44:47], a[220:223]
    s_waitcnt lgkmcnt(2)
    v_mfma_f32_16x16x32_bf16 a[224:227], v[96:99], v[32:35], a[224:227]
    ds_read_b128 v[40:43], v18 offset:14336
    v_mfma_f32_16x16x32_bf16 a[224:227], v[100:103], v[36:39], a[224:227]
    ds_read_b128 v[44:47], v19 offset:14336
    v_mfma_f32_16x16x32_bf16 a[228:231], v[104:107], v[32:35], a[228:231]
    v_mfma_f32_16x16x32_bf16 a[228:231], v[108:111], v[36:39], a[228:231]
    v_mfma_f32_16x16x32_bf16 a[232:235], v[112:115], v[32:35], a[232:235]
    v_mfma_f32_16x16x32_bf16 a[232:235], v[116:119], v[36:39], a[232:235]
    v_mfma_f32_16x16x32_bf16 a[236:239], v[120:123], v[32:35], a[236:239]
    v_mfma_f32_16x16x32_bf16 a[236:239], v[124:127], v[36:39], a[236:239]
    s_waitcnt lgkmcnt(0)
    v_mfma_f32_16x16x32_bf16 a[240:243], v[96:99], v[40:43], a[240:243]
    s_waitcnt vmcnt(11)
    s_barrier
    v_mfma_f32_16x16x32_bf16 a[240:243], v[100:103], v[44:47], a[240:243]
    ds_read_b128 v[32:35], v16 offset:0
    v_mfma_f32_16x16x32_bf16 a[244:247], v[104:107], v[40:43], a[244:247]
    ds_read_b128 v[36:39], v17 offset:0
    v_mfma_f32_16x16x32_bf16 a[244:247], v[108:111], v[44:47], a[244:247]
    v_mfma_f32_16x16x32_bf16 a[248:251], v[112:115], v[40:43], a[248:251]
    v_mfma_f32_16x16x32_bf16 a[248:251], v[116:119], v[44:47], a[248:251]
    v_mfma_f32_16x16x32_bf16 a[252:255], v[120:123], v[40:43], a[252:255]
    v_mfma_f32_16x16x32_bf16 a[252:255], v[124:127], v[44:47], a[252:255]
    s_waitcnt lgkmcnt(0)
    v_mfma_f32_16x16x32_bf16 a[128:131], v[64:67], v[32:35], a[128:131]
    ds_read_b128 v[40:43], v16 offset:2048
    v_mfma_f32_16x16x32_bf16 a[128:131], v[68:71], v[36:39], a[128:131]
    ds_read_b128 v[44:47], v17 offset:2048
    v_mfma_f32_16x16x32_bf16 a[132:135], v[72:75], v[32:35], a[132:135]
    ds_read_b64_tr_b16 v[96:97], v192 offset:49152
    v_mfma_f32_16x16x32_bf16 a[132:135], v[76:79], v[36:39], a[132:135]
    v_mfma_f32_16x16x32_bf16 a[136:139], v[80:83], v[32:35], a[136:139]
    ds_read_b64_tr_b16 v[98:99], v192 offset:51200
    v_mfma_f32_16x16x32_bf16 a[136:139], v[84:87], v[36:39], a[136:139]
    v_mfma_f32_16x16x32_bf16 a[140:143], v[88:91], v[32:35], a[140:143]
    ds_read_b64_tr_b16 v[100:101], v192 offset:57344
    v_mfma_f32_16x16x32_bf16 a[140:143], v[92:95], v[36:39], a[140:143]
    s_waitcnt lgkmcnt(3)
    v_mfma_f32_16x16x32_bf16 a[144:147], v[64:67], v[40:43], a[144:147]
    ds_read_b128 v[32:35], v16 offset:4096
    v_mfma_f32_16x16x32_bf16 a[144:147], v[68:71], v[44:47], a[144:147]
    ds_read_b128 v[36:39], v17 offset:4096
    v_mfma_f32_16x16x32_bf16 a[148:151], v[72:75], v[40:43], a[148:151]
    ds_read_b64_tr_b16 v[102:103], v192 offset:59392
    v_mfma_f32_16x16x32_bf16 a[148:151], v[76:79], v[44:47], a[148:151]
    v_mfma_f32_16x16x32_bf16 a[152:155], v[80:83], v[40:43], a[152:155]
    ds_read_b64_tr_b16 v[104:105], v193 offset:49152
    v_mfma_f32_16x16x32_bf16 a[152:155], v[84:87], v[44:47], a[152:155]
    v_mfma_f32_16x16x32_bf16 a[156:159], v[88:91], v[40:43], a[156:159]
    ds_read_b64_tr_b16 v[106:107], v193 offset:51200
    v_mfma_f32_16x16x32_bf16 a[156:159], v[92:95], v[44:47], a[156:159]
    s_waitcnt lgkmcnt(3)
    v_mfma_f32_16x16x32_bf16 a[160:163], v[64:67], v[32:35], a[160:163]
    ds_read_b128 v[40:43], v16 offset:6144
    v_mfma_f32_16x16x32_bf16 a[160:163], v[68:71], v[36:39], a[160:163]
    ds_read_b128 v[44:47], v17 offset:6144
    v_mfma_f32_16x16x32_bf16 a[164:167], v[72:75], v[32:35], a[164:167]
    ds_read_b64_tr_b16 v[108:109], v193 offset:57344
    v_mfma_f32_16x16x32_bf16 a[164:167], v[76:79], v[36:39], a[164:167]
    v_mfma_f32_16x16x32_bf16 a[168:171], v[80:83], v[32:35], a[168:171]
    v_mfma_f32_16x16x32_bf16 a[168:171], v[84:87], v[36:39], a[168:171]
    ds_read_b64_tr_b16 v[110:111], v193 offset:59392
    v_mfma_f32_16x16x32_bf16 a[172:175], v[88:91], v[32:35], a[172:175]
    v_mfma_f32_16x16x32_bf16 a[172:175], v[92:95], v[36:39], a[172:175]
    s_waitcnt lgkmcnt(2)
    v_mfma_f32_16x16x32_bf16 a[176:179], v[64:67], v[40:43], a[176:179]
    ds_read_b128 v[32:35], v16 offset:8192
    v_mfma_f32_16x16x32_bf16 a[176:179], v[68:71], v[44:47], a[176:179]
    ds_read_b128 v[36:39], v17 offset:8192
    v_mfma_f32_16x16x32_bf16 a[180:183], v[72:75], v[40:43], a[180:183]
    ds_read_b64_tr_b16 v[112:113], v194 offset:49152
    v_mfma_f32_16x16x32_bf16 a[180:183], v[76:79], v[44:47], a[180:183]
    v_mfma_f32_16x16x32_bf16 a[184:187], v[80:83], v[40:43], a[184:187]
    ds_read_b64_tr_b16 v[114:115], v194 offset:51200
    v_mfma_f32_16x16x32_bf16 a[184:187], v[84:87], v[44:47], a[184:187]
    v_mfma_f32_16x16x32_bf16 a[188:191], v[88:91], v[40:43], a[188:191]
    ds_read_b64_tr_b16 v[116:117], v194 offset:57344
    v_mfma_f32_16x16x32_bf16 a[188:191], v[92:95], v[44:47], a[188:191]
    s_waitcnt lgkmcnt(3)
    v_mfma_f32_16x16x32_bf16 a[192:195], v[64:67], v[32:35], a[192:195]
    ds_read_b128 v[40:43], v16 offset:10240
    v_mfma_f32_16x16x32_bf16 a[192:195], v[68:71], v[36:39], a[192:195]
    ds_read_b128 v[44:47], v17 offset:10240
    v_mfma_f32_16x16x32_bf16 a[196:199], v[72:75], v[32:35], a[196:199]
    ds_read_b64_tr_b16 v[118:119], v194 offset:59392
    v_mfma_f32_16x16x32_bf16 a[196:199], v[76:79], v[36:39], a[196:199]
    v_mfma_f32_16x16x32_bf16 a[200:203], v[80:83], v[32:35], a[200:203]
    ds_read_b64_tr_b16 v[120:121], v195 offset:49152
    v_mfma_f32_16x16x32_bf16 a[200:203], v[84:87], v[36:39], a[200:203]
    v_mfma_f32_16x16x32_bf16 a[204:207], v[88:91], v[32:35], a[204:207]
    ds_read_b64_tr_b16 v[122:123], v195 offset:51200
    v_mfma_f32_16x16x32_bf16 a[204:207], v[92:95], v[36:39], a[204:207]
    s_waitcnt lgkmcnt(3)
    v_mfma_f32_16x16x32_bf16 a[208:211], v[64:67], v[40:43], a[208:211]
    ds_read_b128 v[32:35], v16 offset:12288
    v_mfma_f32_16x16x32_bf16 a[208:211], v[68:71], v[44:47], a[208:211]
    ds_read_b128 v[36:39], v17 offset:12288
    v_mfma_f32_16x16x32_bf16 a[212:215], v[72:75], v[40:43], a[212:215]
    ds_read_b64_tr_b16 v[124:125], v195 offset:57344
    v_mfma_f32_16x16x32_bf16 a[212:215], v[76:79], v[44:47], a[212:215]
    v_mfma_f32_16x16x32_bf16 a[216:219], v[80:83], v[40:43], a[216:219]
    v_mfma_f32_16x16x32_bf16 a[216:219], v[84:87], v[44:47], a[216:219]
    ds_read_b64_tr_b16 v[126:127], v195 offset:59392
    v_mfma_f32_16x16x32_bf16 a[220:223], v[88:91], v[40:43], a[220:223]
    v_mfma_f32_16x16x32_bf16 a[220:223], v[92:95], v[44:47], a[220:223]
    s_waitcnt lgkmcnt(2)
    v_mfma_f32_16x16x32_bf16 a[224:227], v[64:67], v[32:35], a[224:227]
    ds_read_b128 v[40:43], v16 offset:14336
    v_mfma_f32_16x16x32_bf16 a[224:227], v[68:71], v[36:39], a[224:227]
    ds_read_b128 v[44:47], v17 offset:14336
    v_mfma_f32_16x16x32_bf16 a[228:231], v[72:75], v[32:35], a[228:231]
    v_mfma_f32_16x16x32_bf16 a[228:231], v[76:79], v[36:39], a[228:231]
    v_mfma_f32_16x16x32_bf16 a[232:235], v[80:83], v[32:35], a[232:235]
    v_mfma_f32_16x16x32_bf16 a[232:235], v[84:87], v[36:39], a[232:235]
    v_mfma_f32_16x16x32_bf16 a[236:239], v[88:91], v[32:35], a[236:239]
    v_mfma_f32_16x16x32_bf16 a[236:239], v[92:95], v[36:39], a[236:239]
    s_waitcnt vmcnt(4)
    s_cmp_lg_u32 s32, 0
    s_cbranch_scc1 L_g1_kv3g
    s_mov_b32 s7, 0
L_g1_kv3:
    v_and_b32 v204, v204, v205
    v_and_b32 v206, v206, v207
    v_and_b32 v204, v204, v206
    v_cmp_ne_u32 vcc, 1, v204
    s_add_u32 s7, s7, 1
    s_cbranch_vccz L_g1_kv3g
    s_sleep 2
    buffer_load_dwordx4 v[204:207], v202, s[8:11], s52 offen sc0 sc1
    s_waitcnt vmcnt(0)
    s_cmp_lt_u32 s7, 0x40000
    s_cbranch_scc1 L_g1_kv3
L_g1_kv3g:
    s_waitcnt lgkmcnt(0)
    v_mfma_f32_16x16x32_bf16 a[240:243], v[64:67], v[40:43], a[240:243]
    s_waitcnt vmcnt(0)
    s_barrier
    v_mfma_f32_16x16x32_bf16 a[240:243], v[68:71], v[44:47], a[240:243]
    ds_read_b128 v[32:35], v16 offset:32768
    v_mfma_f32_16x16x32_bf16 a[244:247], v[72:75], v[40:43], a[244:247]
    ds_read_b128 v[36:39], v17 offset:32768
    v_mfma_f32_16x16x32_bf16 a[244:247], v[76:79], v[44:47], a[244:247]
    v_mfma_f32_16x16x32_bf16 a[248:251], v[80:83], v[40:43], a[248:251]
    v_mfma_f32_16x16x32_bf16 a[248:251], v[84:87], v[44:47], a[248:251]
    v_mfma_f32_16x16x32_bf16 a[252:255], v[88:91], v[40:43], a[252:255]
    v_mfma_f32_16x16x32_bf16 a[252:255], v[92:95], v[44:47], a[252:255]
    s_waitcnt lgkmcnt(0)
    v_mfma_f32_16x16x32_bf16 a[128:131], v[96:99], v[32:35], a[128:131]
    ds_read_b128 v[40:43], v16 offset:34816
    v_mfma_f32_16x16x32_bf16 a[128:131], v[100:103], v[36:39], a[128:131]
    ds_read_b128 v[44:47], v17 offset:34816
    v_mfma_f32_16x16x32_bf16 a[132:135], v[104:107], v[32:35], a[132:135]
    s_lshl_b32 s4, s33, 20
    s_add_u32 s4, s4, 23068672
    s_add_u32 s4, s4, s41
    s_cmp_lt_u32 s32, 2
    s_cselect_b32 s5, s4, 0x7ff00000
    s_cselect_b32 s6, 16384, 0
    s_add_u32 s6, s6, s4
    s_add_u32 s7, s6, 32768
    s_add_u32 m0, s41, 98304
    s_nop 0
    buffer_load_dwordx4 v1, s[8:11], s5 offen offset:0 sc1 lds
    v_mfma_f32_16x16x32_bf16 a[132:135], v[108:111], v[36:39], a[132:135]
    v_mfma_f32_16x16x32_bf16 a[136:139], v[112:115], v[32:35], a[136:139]
    v_mfma_f32_16x16x32_bf16 a[136:139], v[116:119], v[36:39], a[136:139]
    v_mfma_f32_16x16x32_bf16 a[140:143], v[120:123], v[32:35], a[140:143]
    buffer_load_dwordx4 v1, s[8:11], s5 offen offset:1024 sc1 lds
    v_mfma_f32_16x16x32_bf16 a[140:143], v[124:127], v[36:39], a[140:143]
    buffer_load_dwordx4 v1, s[8:11], s5 offen offset:2048 sc1 lds
    buffer_load_dwordx4 v1, s[8:11], s5 offen offset:3072 sc1 lds
    s_waitcnt lgkmcnt(0)
    v_mfma_f32_16x16x32_bf16 a[144:147], v[96:99], v[40:43], a[144:147]
    ds_read_b128 v[32:35], v16 offset:36864
    v_mfma_f32_16x16x32_bf16 a[144:147], v[100:103], v[44:47], a[144:147]
    ds_read_b128 v[36:39], v17 offset:36864
    v_mfma_f32_16x16x32_bf16 a[148:151], v[104:107], v[40:43], a[148:151]
    s_add_u32 m0, s41, 0
    s_nop 0
    buffer_load_dwordx4 v1, s[8:11], s6 offen offset:0 sc1 lds
    v_mfma_f32_16x16x32_bf16 a[148:151], v[108:111], v[44:47], a[148:151]
    v_accvgpr_read_b32 v208, a128
    v_accvgpr_read_b32 v209, a129
    v_accvgpr_read_b32 v210, a130
    v_accvgpr_read_b32 v211, a131
    v_accvgpr_read_b32 v212, a132
    v_accvgpr_read_b32 v213, a133
    v_accvgpr_read_b32 v214, a134
    v_accvgpr_read_b32 v215, a135
    v_mul_f32 v208, s54, v208
    v_mul_f32 v209, s54, v209
    v_mfma_f32_16x16x32_bf16 a[152:155], v[112:115], v[40:43], a[152:155]
    v_mul_f32 v210, s54, v210
    v_mul_f32 v211, s54, v211
    v_mul_f32 v212, s54, v212
    v_mul_f32 v213, s54, v213
    v_mul_f32 v214, s54, v214
    v_mul_f32 v215, s54, v215
    v_cvt_pk_bf16_f32 v216, v208, v209
    v_cvt_pk_bf16_f32 v217, v210, v211
    v_cvt_pk_bf16_f32 v218, v212, v213
    v_cvt_pk_bf16_f32 v219, v214, v215
    v_mfma_f32_16x16x32_bf16 a[152:155], v[116:119], v[44:47], a[152:155]
    buffer_load_dwordx4 v1, s[8:11], s6 offen offset:1024 sc1 lds
    v_accvgpr_read_b32 v220, a136
    v_accvgpr_read_b32 v221, a137
    v_accvgpr_read_b32 v222, a138
    v_accvgpr_read_b32 v223, a139
    v_accvgpr_read_b32 v224, a140
    v_accvgpr_read_b32 v225, a141
    v_accvgpr_read_b32 v226, a142
    v_mfma_f32_16x16x32_bf16 a[156:159], v[120:123], v[40:43], a[156:159]
    buffer_load_dwordx4 v1, s[8:11], s6 offen offset:2048 sc1 lds
    v_accvgpr_read_b32 v227, a143
    v_mul_f32 v220, s54, v220
    v_mul_f32 v221, s54, v221
    v_mul_f32 v222, s54, v222
    v_mul_f32 v223, s54, v223
    v_mul_f32 v224, s54, v224
    v_mul_f32 v225, s54, v225
    v_mfma_f32_16x16x32_bf16 a[156:159], v[124:127], v[44:47], a[156:159]
    buffer_load_dwordx4 v1, s[8:11], s6 offen offset:3072 sc1 lds
    v_mul_f32 v226, s54, v226
    v_mul_f32 v227, s54, v227
    v_cvt_pk_bf16_f32 v228, v220, v221
    v_cvt_pk_bf16_f32 v229, v222, v223
    v_cvt_pk_bf16_f32 v230, v224, v225
    v_cvt_pk_bf16_f32 v231, v226, v227
    s_waitcnt lgkmcnt(0)
    v_mfma_f32_16x16x32_bf16 a[160:163], v[96:99], v[32:35], a[160:163]
    ds_read_b128 v[40:43], v16 offset:38912
    ds_write_b128 v50, v[216:219] offset:0
    v_mfma_f32_16x16x32_bf16 a[160:163], v[100:103], v[36:39], a[160:163]
    ds_read_b128 v[44:47], v17 offset:38912
    ds_write_b128 v50, v[228:231] offset:2048
    v_mfma_f32_16x16x32_bf16 a[164:167], v[104:107], v[32:35], a[164:167]
    s_add_u32 m0, s41, 65536
    s_nop 0
    buffer_load_dwordx4 v1, s[8:11], s7 offen offset:0 sc1 lds
    v_mfma_f32_16x16x32_bf16 a[164:167], v[108:111], v[36:39], a[164:167]
    v_accvgpr_read_b32 v232, a144
    v_accvgpr_read_b32 v233, a145
    v_accvgpr_read_b32 v234, a146
    v_accvgpr_read_b32 v235, a147
    v_accvgpr_read_b32 v236, a148
    v_accvgpr_read_b32 v237, a149
    v_accvgpr_read_b32 v238, a150
    v_accvgpr_read_b32 v239, a151
    v_mul_f32 v232, s54, v232
    v_mul_f32 v233, s54, v233
    v_mfma_f32_16x16x32_bf16 a[168:171], v[112:115], v[32:35], a[168:171]
    v_mul_f32 v234, s54, v234
    v_mul_f32 v235, s54, v235
    v_mul_f32 v236, s54, v236
    v_mul_f32 v237, s54, v237
    v_mul_f32 v238, s54, v238
    v_mul_f32 v239, s54, v239
    v_cvt_pk_bf16_f32 v240, v232, v233
    v_cvt_pk_bf16_f32 v241, v234, v235
    v_cvt_pk_bf16_f32 v242, v236, v237
    v_cvt_pk_bf16_f32 v243, v238, v239
    v_mfma_f32_16x16x32_bf16 a[168:171], v[116:119], v[36:39], a[168:171]
    buffer_load_dwordx4 v1, s[8:11], s7 offen offset:1024 sc1 lds
    v_accvgpr_read_b32 v208, a152
    v_accvgpr_read_b32 v209, a153
    v_accvgpr_read_b32 v210, a154
    v_accvgpr_read_b32 v211, a155
    v_accvgpr_read_b32 v212, a156
    v_accvgpr_read_b32 v213, a157
    v_accvgpr_read_b32 v214, a158
    v_mfma_f32_16x16x32_bf16 a[172:175], v[120:123], v[32:35], a[172:175]
    buffer_load_dwordx4 v1, s[8:11], s7 offen offset:2048 sc1 lds
    v_accvgpr_read_b32 v215, a159
    v_mul_f32 v208, s54, v208
    v_mul_f32 v209, s54, v209
    v_mul_f32 v210, s54, v210
    v_mul_f32 v211, s54, v211
    v_mul_f32 v212, s54, v212
    v_mul_f32 v213, s54, v213
    v_mfma_f32_16x16x32_bf16 a[172:175], v[124:127], v[36:39], a[172:175]
    buffer_load_dwordx4 v1, s[8:11], s7 offen offset:3072 sc1 lds
    v_mul_f32 v214, s54, v214
    v_mul_f32 v215, s54, v215
    v_cvt_pk_bf16_f32 v216, v208, v209
    v_cvt_pk_bf16_f32 v217, v210, v211
    v_cvt_pk_bf16_f32 v218, v212, v213
    v_cvt_pk_bf16_f32 v219, v214, v215
    s_waitcnt lgkmcnt(1)
    v_mfma_f32_16x16x32_bf16 a[176:179], v[96:99], v[40:43], a[176:179]
    ds_read_b128 v[32:35], v16 offset:40960
    ds_write_b128 v50, v[240:243] offset:256
    v_mfma_f32_16x16x32_bf16 a[176:179], v[100:103], v[44:47], a[176:179]
    ds_read_b128 v[36:39], v17 offset:40960
    ds_write_b128 v50, v[216:219] offset:2304
    v_mfma_f32_16x16x32_bf16 a[180:183], v[104:107], v[40:43], a[180:183]
    v_mfma_f32_16x16x32_bf16 a[180:183], v[108:111], v[44:47], a[180:183]
    v_accvgpr_read_b32 v220, a160
    v_accvgpr_read_b32 v221, a161
    v_accvgpr_read_b32 v222, a162
    v_accvgpr_read_b32 v223, a163
    v_accvgpr_read_b32 v224, a164
    v_accvgpr_read_b32 v225, a165
    v_accvgpr_read_b32 v226, a166
    v_accvgpr_read_b32 v227, a167
    v_mul_f32 v220, s54, v220
    v_mul_f32 v221, s54, v221
    v_mfma_f32_16x16x32_bf16 a[184:187], v[112:115], v[40:43], a[184:187]
    v_mul_f32 v222, s54, v222
    v_mul_f32 v223, s54, v223
    v_mul_f32 v224, s54, v224
    v_mul_f32 v225, s54, v225
    v_mul_f32 v226, s54, v226
    v_mul_f32 v227, s54, v227
    v_cvt_pk_bf16_f32 v228, v220, v221
    v_cvt_pk_bf16_f32 v229, v222, v223
    v_cvt_pk_bf16_f32 v230, v224, v225
    v_cvt_pk_bf16_f32 v231, v226, v227
    v_mfma_f32_16x16x32_bf16 a[184:187], v[116:119], v[44:47], a[184:187]
    v_accvgpr_read_b32 v232, a168
    v_accvgpr_read_b32 v233, a169
    v_accvgpr_read_b32 v234, a170
    v_accvgpr_read_b32 v235, a171
    v_accvgpr_read_b32 v236, a172
    v_accvgpr_read_b32 v237, a173
    v_accvgpr_read_b32 v238, a174
    v_mfma_f32_16x16x32_bf16 a[188:191], v[120:123], v[40:43], a[188:191]
    v_accvgpr_read_b32 v239, a175
    v_mul_f32 v232, s54, v232
    v_mul_f32 v233, s54, v233
    v_mul_f32 v234, s54, v234
    v_mul_f32 v235, s54, v235
    v_mul_f32 v236, s54, v236
    v_mul_f32 v237, s54, v237
    v_mfma_f32_16x16x32_bf16 a[188:191], v[124:127], v[44:47], a[188:191]
    v_mul_f32 v238, s54, v238
    v_mul_f32 v239, s54, v239
    v_cvt_pk_bf16_f32 v240, v232, v233
    v_cvt_pk_bf16_f32 v241, v234, v235
    v_cvt_pk_bf16_f32 v242, v236, v237
    v_cvt_pk_bf16_f32 v243, v238, v239
    s_waitcnt lgkmcnt(1)
    v_mfma_f32_16x16x32_bf16 a[192:195], v[96:99], v[32:35], a[192:195]
    ds_read_b128 v[40:43], v16 offset:43008
    ds_write_b128 v50, v[228:231] offset:8192
    v_mfma_f32_16x16x32_bf16 a[192:195], v[100:103], v[36:39], a[192:195]
    ds_read_b128 v[44:47], v17 offset:43008
    ds_write_b128 v50, v[240:243] offset:10240
    v_mfma_f32_16x16x32_bf16 a[196:199], v[104:107], v[32:35], a[196:199]
    v_mfma_f32_16x16x32_bf16 a[196:199], v[108:111], v[36:39], a[196:199]
    v_accvgpr_read_b32 v208, a176
    v_accvgpr_read_b32 v209, a177
    v_accvgpr_read_b32 v210, a178
    v_accvgpr_read_b32 v211, a179
    v_accvgpr_read_b32 v212, a180
    v_accvgpr_read_b32 v213, a181
    v_accvgpr_read_b32 v214, a182
    v_accvgpr_read_b32 v215, a183
    v_mul_f32 v208, s54, v208
    v_mul_f32 v209, s54, v209
    v_mfma_f32_16x16x32_bf16 a[200:203], v[112:115], v[32:35], a[200:203]
    v_mul_f32 v210, s54, v210
    v_mul_f32 v211, s54, v211
    v_mul_f32 v212, s54, v212
    v_mul_f32 v213, s54, v213
    v_mul_f32 v214, s54, v214
    v_mul_f32 v215, s54, v215
    v_cvt_pk_bf16_f32 v216, v208, v209
    v_cvt_pk_bf16_f32 v217, v210, v211
    v_cvt_pk_bf16_f32 v218, v212, v213
    v_cvt_pk_bf16_f32 v219, v214, v215
    v_mfma_f32_16x16x32_bf16 a[200:203], v[116:119], v[36:39], a[200:203]
    v_accvgpr_read_b32 v220, a184
    v_accvgpr_read_b32 v221, a185
    v_accvgpr_read_b32 v222, a186
    v_accvgpr_read_b32 v223, a187
    v_accvgpr_read_b32 v224, a188
    v_accvgpr_read_b32 v225, a189
    v_accvgpr_read_b32 v226, a190
    v_mfma_f32_16x16x32_bf16 a[204:207], v[120:123], v[32:35], a[204:207]
    v_accvgpr_read_b32 v227, a191
    v_mul_f32 v220, s54, v220
    v_mul_f32 v221, s54, v221
    v_mul_f32 v222, s54, v222
    v_mul_f32 v223, s54, v223
    v_mul_f32 v224, s54, v224
    v_mul_f32 v225, s54, v225
    v_mfma_f32_16x16x32_bf16 a[204:207], v[124:127], v[36:39], a[204:207]
    v_mul_f32 v226, s54, v226
    v_mul_f32 v227, s54, v227
    v_cvt_pk_bf16_f32 v228, v220, v221
    v_cvt_pk_bf16_f32 v229, v222, v223
    v_cvt_pk_bf16_f32 v230, v224, v225
    v_cvt_pk_bf16_f32 v231, v226, v227
    s_waitcnt lgkmcnt(1)
    v_mfma_f32_16x16x32_bf16 a[208:211], v[96:99], v[40:43], a[208:211]
    ds_read_b128 v[32:35], v16 offset:45056
    ds_write_b128 v50, v[216:219] offset:8448
    v_mfma_f32_16x16x32_bf16 a[208:211], v[100:103], v[44:47], a[208:211]
    ds_read_b128 v[36:39], v17 offset:45056
    ds_write_b128 v50, v[228:231] offset:10496
    v_mfma_f32_16x16x32_bf16 a[212:215], v[104:107], v[40:43], a[212:215]
    v_mfma_f32_16x16x32_bf16 a[212:215], v[108:111], v[44:47], a[212:215]
    v_accvgpr_read_b32 v232, a192
    v_accvgpr_read_b32 v233, a193
    v_accvgpr_read_b32 v234, a194
    v_accvgpr_read_b32 v235, a195
    v_accvgpr_read_b32 v236, a196
    v_accvgpr_read_b32 v237, a197
    v_accvgpr_read_b32 v238, a198
    v_accvgpr_read_b32 v239, a199
    v_mul_f32 v232, s54, v232
    v_mul_f32 v233, s54, v233
    v_mfma_f32_16x16x32_bf16 a[216:219], v[112:115], v[40:43], a[216:219]
    v_mul_f32 v234, s54, v234
    v_mul_f32 v235, s54, v235
    v_mul_f32 v236, s54, v236
    v_mul_f32 v237, s54, v237
    v_mul_f32 v238, s54, v238
    v_mul_f32 v239, s54, v239
    v_cvt_pk_bf16_f32 v240, v232, v233
    v_cvt_pk_bf16_f32 v241, v234, v235
    v_cvt_pk_bf16_f32 v242, v236, v237
    v_cvt_pk_bf16_f32 v243, v238, v239
    v_mfma_f32_16x16x32_bf16 a[216:219], v[116:119], v[44:47], a[216:219]
    v_accvgpr_read_b32 v208, a200
    v_accvgpr_read_b32 v209, a201
    v_accvgpr_read_b32 v210, a202
    v_accvgpr_read_b32 v211, a203
    v_accvgpr_read_b32 v212, a204
    v_accvgpr_read_b32 v213, a205
    v_accvgpr_read_b32 v214, a206
    v_mfma_f32_16x16x32_bf16 a[220:223], v[120:123], v[40:43], a[220:223]
    v_accvgpr_read_b32 v215, a207
    v_mul_f32 v208, s54, v208
    v_mul_f32 v209, s54, v209
    v_mul_f32 v210, s54, v210
    v_mul_f32 v211, s54, v211
    v_mul_f32 v212, s54, v212
    v_mul_f32 v213, s54, v213
    v_mfma_f32_16x16x32_bf16 a[220:223], v[124:127], v[44:47], a[220:223]
    v_mul_f32 v214, s54, v214
    v_mul_f32 v215, s54, v215
    v_cvt_pk_bf16_f32 v216, v208, v209
    v_cvt_pk_bf16_f32 v217, v210, v211
    v_cvt_pk_bf16_f32 v218, v212, v213
    v_cvt_pk_bf16_f32 v219, v214, v215
    s_waitcnt lgkmcnt(1)
    v_mfma_f32_16x16x32_bf16 a[224:227], v[96:99], v[32:35], a[224:227]
    ds_read_b128 v[40:43], v16 offset:47104
    ds_write_b128 v51, v[240:243] offset:0
    v_mfma_f32_16x16x32_bf16 a[224:227], v[100:103], v[36:39], a[224:227]
    ds_read_b128 v[44:47], v17 offset:47104
    ds_write_b128 v51, v[216:219] offset:2048
    v_mfma_f32_16x16x32_bf16 a[228:231], v[104:107], v[32:35], a[228:231]
    v_mfma_f32_16x16x32_bf16 a[228:231], v[108:111], v[36:39], a[228:231]
    v_accvgpr_read_b32 v220, a208
    v_accvgpr_read_b32 v221, a209
    v_accvgpr_read_b32 v222, a210
    v_accvgpr_read_b32 v223, a211
    v_accvgpr_read_b32 v224, a212
    v_accvgpr_read_b32 v225, a213
    v_accvgpr_read_b32 v226, a214
    v_accvgpr_read_b32 v227, a215
    v_mul_f32 v220, s54, v220
    v_mul_f32 v221, s54, v221
    v_mfma_f32_16x16x32_bf16 a[232:235], v[112:115], v[32:35], a[232:235]
    v_mul_f32 v222, s54, v222
    v_mul_f32 v223, s54, v223
    v_mul_f32 v224, s54, v224
    v_mul_f32 v225, s54, v225
    v_mul_f32 v226, s54, v226
    v_mul_f32 v227, s54, v227
    v_cvt_pk_bf16_f32 v228, v220, v221
    v_cvt_pk_bf16_f32 v229, v222, v223
    v_cvt_pk_bf16_f32 v230, v224, v225
    v_cvt_pk_bf16_f32 v231, v226, v227
    v_mfma_f32_16x16x32_bf16 a[232:235], v[116:119], v[36:39], a[232:235]
    v_accvgpr_read_b32 v232, a216
    v_accvgpr_read_b32 v233, a217
    v_accvgpr_read_b32 v234, a218
    v_accvgpr_read_b32 v235, a219
    v_accvgpr_read_b32 v236, a220
    v_accvgpr_read_b32 v237, a221
    v_accvgpr_read_b32 v238, a222
    v_mfma_f32_16x16x32_bf16 a[236:239], v[120:123], v[32:35], a[236:239]
    v_accvgpr_read_b32 v239, a223
    v_mul_f32 v232, s54, v232
    v_mul_f32 v233, s54, v233
    v_mul_f32 v234, s54, v234
    v_mul_f32 v235, s54, v235
    v_mul_f32 v236, s54, v236
    v_mul_f32 v237, s54, v237
    v_mfma_f32_16x16x32_bf16 a[236:239], v[124:127], v[36:39], a[236:239]
    v_mul_f32 v238, s54, v238
    v_mul_f32 v239, s54, v239
    v_cvt_pk_bf16_f32 v240, v232, v233
    v_cvt_pk_bf16_f32 v241, v234, v235
    v_cvt_pk_bf16_f32 v242, v236, v237
    v_cvt_pk_bf16_f32 v243, v238, v239
    s_waitcnt lgkmcnt(1)
    v_mfma_f32_16x16x32_bf16 a[240:243], v[96:99], v[40:43], a[240:243]
    ds_write_b128 v51, v[228:231] offset:256
    v_mfma_f32_16x16x32_bf16 a[240:243], v[100:103], v[44:47], a[240:243]
    ds_write_b128 v51, v[240:243] offset:2304
    v_mfma_f32_16x16x32_bf16 a[244:247], v[104:107], v[40:43], a[244:247]
    v_mfma_f32_16x16x32_bf16 a[244:247], v[108:111], v[44:47], a[244:247]
    v_mfma_f32_16x16x32_bf16 a[248:251], v[112:115], v[40:43], a[248:251]
    v_mfma_f32_16x16x32_bf16 a[248:251], v[116:119], v[44:47], a[248:251]
    v_mfma_f32_16x16x32_bf16 a[252:255], v[120:123], v[40:43], a[252:255]
    v_mfma_f32_16x16x32_bf16 a[252:255], v[124:127], v[44:47], a[252:255]
    s_nop 1
    v_accvgpr_read_b32 v208, a224
    v_accvgpr_read_b32 v209, a225
    v_accvgpr_read_b32 v210, a226
    v_accvgpr_read_b32 v211, a227
    v_accvgpr_read_b32 v212, a228
    v_accvgpr_read_b32 v213, a229
    v_accvgpr_read_b32 v214, a230
    v_accvgpr_read_b32 v215, a231
    v_mul_f32 v208, s54, v208
    v_mul_f32 v209, s54, v209
    v_mul_f32 v210, s54, v210
    v_mul_f32 v211, s54, v211
    v_mul_f32 v212, s54, v212
    v_mul_f32 v213, s54, v213
    v_mul_f32 v214, s54, v214
    v_mul_f32 v215, s54, v215
    v_cvt_pk_bf16_f32 v216, v208, v209
    v_cvt_pk_bf16_f32 v217, v210, v211
    v_cvt_pk_bf16_f32 v218, v212, v213
    v_cvt_pk_bf16_f32 v219, v214, v215
    ds_write_b128 v51, v[216:219] offset:8192
    v_accvgpr_read_b32 v220, a232
    v_accvgpr_read_b32 v221, a233
    v_accvgpr_read_b32 v222, a234
    v_accvgpr_read_b32 v223, a235
    v_accvgpr_read_b32 v224, a236
    v_accvgpr_read_b32 v225, a237
    v_accvgpr_read_b32 v226, a238
    v_accvgpr_read_b32 v227, a239
    v_mul_f32 v220, s54, v220
    v_mul_f32 v221, s54, v221
    v_mul_f32 v222, s54, v222
    v_mul_f32 v223, s54, v223
    v_mul_f32 v224, s54, v224
    v_mul_f32 v225, s54, v225
    v_mul_f32 v226, s54, v226
    v_mul_f32 v227, s54, v227
    v_cvt_pk_bf16_f32 v228, v220, v221
    v_cvt_pk_bf16_f32 v229, v222, v223
    v_cvt_pk_bf16_f32 v230, v224, v225
    v_cvt_pk_bf16_f32 v231, v226, v227
    ds_write_b128 v51, v[228:231] offset:10240
    s_nop 3
    v_accvgpr_read_b32 v232, a240
    v_accvgpr_read_b32 v233, a241
    v_accvgpr_read_b32 v234, a242
    v_accvgpr_read_b32 v235, a243
    v_accvgpr_read_b32 v236, a244
    v_accvgpr_read_b32 v237, a245
    v_accvgpr_read_b32 v238, a246
    v_accvgpr_read_b32 v239, a247
    v_mul_f32 v232, s54, v232
    v_mul_f32 v233, s54, v233
    v_mul_f32 v234, s54, v234
    v_mul_f32 v235, s54, v235
    v_mul_f32 v236, s54, v236
    v_mul_f32 v237, s54, v237
    v_mul_f32 v238, s54, v238
    v_mul_f32 v239, s54, v239
    v_cvt_pk_bf16_f32 v240, v232, v233
    v_cvt_pk_bf16_f32 v241, v234, v235
    v_cvt_pk_bf16_f32 v242, v236, v237
    v_cvt_pk_bf16_f32 v243, v238, v239
    ds_write_b128 v51, v[240:243] offset:8448
    v_accvgpr_read_b32 v208, a248
    v_accvgpr_read_b32 v209, a249
    v_accvgpr_read_b32 v210, a250
    v_accvgpr_read_b32 v211, a251
    v_accvgpr_read_b32 v212, a252
    v_accvgpr_read_b32 v213, a253
    v_accvgpr_read_b32 v214, a254
    v_accvgpr_read_b32 v215, a255
    v_mul_f32 v208, s54, v208
    v_mul_f32 v209, s54, v209
    v_mul_f32 v210, s54, v210
    v_mul_f32 v211, s54, v211
    v_mul_f32 v212, s54, v212
    v_mul_f32 v213, s54, v213
    v_mul_f32 v214, s54, v214
    v_mul_f32 v215, s54, v215
    v_cvt_pk_bf16_f32 v216, v208, v209
    v_cvt_pk_bf16_f32 v217, v210, v211
    v_cvt_pk_bf16_f32 v218, v212, v213
    v_cvt_pk_bf16_f32 v219, v214, v215
    ds_write_b128 v51, v[216:219] offset:10496
    s_waitcnt vmcnt(19)
    s_mov_b64 exec, 1
    buffer_store_dword v49, v48, s[8:11], s55 offen sc0 sc1
    s_mov_b64 exec, -1
    s_branch L_g1_done
L_g1_help:
    s_add_u32 m0, s41, 98304
    s_add_u32 s48, s37, 0
    buffer_load_dwordx4 v6, s[16:19], s48 offen offset:0 lds
    buffer_load_dwordx4 v7, s[16:19], s48 offen offset:1024 lds
    buffer_load_dwordx4 v8, s[16:19], s48 offen offset:2048 lds
    buffer_load_dwordx4 v9, s[16:19], s48 offen offset:3072 lds
    s_add_u32 m0, s40, 65536
    s_add_u32 s48, s35, 0
    buffer_load_dwordx4 v2, s[12:15], s48 offen offset:0 lds
    buffer_load_dwordx4 v3, s[12:15], s48 offen offset:1024 lds
    buffer_load_dwordx4 v4, s[12:15], s48 offen offset:2048 lds
    buffer_load_dwordx4 v5, s[12:15], s48 offen offset:3072 lds
    s_add_u32 m0, s40, 69632
    s_add_u32 s48, s35, 32768
    buffer_load_dwordx4 v2, s[12:15], s48 offen offset:0 lds
    buffer_load_dwordx4 v3, s[12:15], s48 offen offset:1024 lds
    buffer_load_dwordx4 v4, s[12:15], s48 offen offset:2048 lds
    buffer_load_dwordx4 v5, s[12:15], s48 offen offset:3072 lds
    s_add_u32 m0, s41, 114688
    s_add_u32 s48, s37, 524288
    buffer_load_dwordx4 v6, s[16:19], s48 offen offset:0 lds
    buffer_load_dwordx4 v7, s[16:19], s48 offen offset:1024 lds
    buffer_load_dwordx4 v8, s[16:19], s48 offen offset:2048 lds
    buffer_load_dwordx4 v9, s[16:19], s48 offen offset:3072 lds
    buffer_load_dwordx4 v[208:211], v235, s[24:27], s49 offen nt
    buffer_load_dwordx4 v[212:215], v235, s[24:27], s49 offen offset:512 nt
    s_add_u32 m0, s40, 0
    s_add_u32 s48, s35, 128
    buffer_load_dwordx4 v2, s[12:15], s48 offen offset:0 lds
    buffer_load_dwordx4 v3, s[12:15], s48 offen offset:1024 lds
    buffer_load_dwordx4 v4, s[12:15], s48 offen offset:2048 lds
    buffer_load_dwordx4 v5, s[12:15], s48 offen offset:3072 lds
    s_add_u32 m0, s40, 4096
    s_add_u32 s48, s35, 32896
    buffer_load_dwordx4 v2, s[12:15], s48 offen offset:0 lds
    buffer_load_dwordx4 v3, s[12:15], s48 offen offset:1024 lds
    buffer_load_dwordx4 v4, s[12:15], s48 offen offset:2048 lds
    buffer_load_dwordx4 v5, s[12:15], s48 offen offset:3072 lds
    s_add_u32 m0, s41, 131072
    s_add_u32 s48, s37, 1048576
    buffer_load_dwordx4 v6, s[16:19], s48 offen offset:0 lds
    buffer_load_dwordx4 v7, s[16:19], s48 offen offset:1024 lds
    buffer_load_dwordx4 v8, s[16:19], s48 offen offset:2048 lds
    buffer_load_dwordx4 v9, s[16:19], s48 offen offset:3072 lds
    s_add_u32 m0, s40, 32768
    s_add_u32 s48, s35, 256
    buffer_load_dwordx4 v2, s[12:15], s48 offen offset:0 lds
    buffer_load_dwordx4 v3, s[12:15], s48 offen offset:1024 lds
    buffer_load_dwordx4 v4, s[12:15], s48 offen offset:2048 lds
    buffer_load_dwordx4 v5, s[12:15], s48 offen offset:3072 lds
    s_add_u32 m0, s40, 36864
    s_add_u32 s48, s35, 33024
    buffer_load_dwordx4 v2, s[12:15], s48 offen offset:0 lds
    buffer_load_dwordx4 v3, s[12:15], s48 offen offset:1024 lds
    buffer_load_dwordx4 v4, s[12:15], s48 offen offset:2048 lds
    buffer_load_dwordx4 v5, s[12:15], s48 offen offset:3072 lds
    s_add_u32 m0, s41, 147456
    s_add_u32 s48, s37, 1572864
    buffer_load_dwordx4 v6, s[16:19], s48 offen offset:0 lds
    buffer_load_dwordx4 v7, s[16:19], s48 offen offset:1024 lds
    buffer_load_dwordx4 v8, s[16:19], s48 offen offset:2048 lds
    buffer_load_dwordx4 v9, s[16:19], s48 offen offset:3072 lds
    s_bitcmp1_b32 s32, 0
    s_cselect_b32 s4, s78, s76
    s_cselect_b32 s5, s79, s77
    s_mov_b32 s56, s4
    s_and_b32 s57, s5, 0xffff
    s_mov_b32 s58, 0x158000
    s_mov_b32 s59, 0x00020000
    s_mov_b32 s20, s74
    s_and_b32 s21, s75, 0xffff
    s_mov_b32 s22, 0x400000
    s_mov_b32 s23, 0x00020000
    s_mov_b32 s60, s68
    s_and_b32 s61, s69, 0xffff
    s_mov_b32 s62, 0x400000
    s_mov_b32 s63, 0x00020000
    s_mov_b32 s28, s80
    s_and_b32 s29, s81, 0xffff
    s_mov_b32 s30, 0x100
    s_mov_b32 s31, 0x00020000
    v_mov_b32 v48, 0
    v_mov_b32 v49, 0
    v_mov_b32 v50, 0
    v_mov_b32 v51, 0
    s_lshl_b32 s4, s2, 7
    s_add_u32 s4, s4, 79233024
    buffer_store_dwordx4 v[48:51], v48, s[8:11], s4 offen sc0 sc1
    s_add_u32 s4, s4, 32768
    buffer_store_dwordx4 v[48:51], v48, s[8:11], s4 offen sc0 sc1
    s_add_u32 s4, s4, 32768
    buffer_store_dwordx4 v[48:51], v48, s[8:11], s4 offen sc0 sc1
    s_add_u32 s4, s4, 32768
    buffer_store_dwordx4 v[48:51], v48, s[8:11], s4 offen sc0 sc1
    s_sub_u32 s4, 15, s34
    s_cmp_lt_u32 s32, 2
    s_cselect_b32 s4, s34, s4
    s_lshl_b32 s4, s4, 17
    s_and_b32 s5, s32, 1
    s_lshl_b32 s5, s5, 16
    s_add_u32 s36, s4, s5
    v_lshrrev_b32 v22, 2, v0
    v_and_b32 v23, 3, v0
    v_lshlrev_b32 v23, 7, v23
    v_lshl_add_u32 v22, v22, 10, v23
    s_lshl_b32 s4, s34, 18
    s_and_b32 s5, s33, 3
    s_lshl_b32 s5, s5, 16
    s_add_u32 s4, s4, s5
    s_lshl_b32 s5, s32, 14
    s_add_u32 s4, s4, s5
    buffer_load_dword v253, v22, s[12:15], s4 offen offset:384
    buffer_load_dword v253, v22, s[12:15], s4 offen offset:512
    v_and_b32 v23, 31, v0
    v_lshlrev_b32 v23, 13, v23
    s_lshl_b32 s4, s34, 19
    s_add_u32 s4, s4, s37
    buffer_load_dword v253, v23, s[16:19], s4 offen
    v_and_b32 v22, 15, v0
    v_lshrrev_b32 v23, 4, v0
    v_lshlrev_b32 v14, 9, v23
    v_lshl_add_u32 v14, v22, 4, v14
    v_and_b32 v24, 8, v22
    v_lshl_add_u32 v15, v24, 4, v14
    v_lshrrev_b32 v24, 1, v22
    v_xor_b32 v24, v24, v23
    v_lshlrev_b32 v24, 4, v24
    v_lshl_add_u32 v24, v22, 7, v24
    s_lshr_b32 s4, s32, 1
    s_lshl_b32 s4, s4, 14
    v_add_u32 v16, s4, v24
    v_xor_b32 v17, 64, v16
    v_add_u32 v18, 65536, v16
    v_add_u32 v19, 65536, v17
    v_lshrrev_b32 v22, 5, v0
    v_bfe_u32 v23, v0, 2, 3
    v_and_b32 v24, 3, v0
    v_lshlrev_b32 v25, 10, v22
    v_lshl_add_u32 v25, v23, 7, v25
    v_lshl_add_u32 v25, v24, 3, v25
    v_lshrrev_b32 v24, 1, v23
    v_lshl_add_u32 v25, v24, 5, v25
    v_add_u32 v25, 98304, v25
    s_and_b32 s4, s32, 1
    s_lshl_b32 s5, s4, 12
    v_add_u32 v26, s5, v25
    s_lshl_b32 s5, s4, 6
    v_xor_b32 v25, s5, v25
    v_xor_b32 v192, 0, v26
    v_xor_b32 v193, 32, v26
    v_xor_b32 v194, 64, v26
    v_xor_b32 v195, 96, v26
    v_xor_b32 v196, 0, v25
    v_xor_b32 v197, 32, v25
    s_lshl_b32 s4, s33, 6
    s_lshl_b32 s5, s34, 3
    s_add_u32 s4, s4, s5
    s_lshr_b32 s5, s32, 1
    s_lshl_b32 s5, s5, 2
    s_add_u32 s4, s4, s5
    s_lshl_b32 s4, s4, 14
    s_add_u32 s4, s4, 23068672
    s_and_b32 s5, s32, 1
    s_lshl_b32 s5, s5, 12
    s_add_u32 s44, s4, s5
    s_sub_u32 s4, 15, s34
    s_cmp_lt_u32 s32, 2
    s_cselect_b32 s4, s34, s4
    s_mul_i32 s4, s4, 1409024
    s_lshl_b32 s6, s42, 11
    s_add_u32 s4, s4, s6
    s_lshr_b32 s5, s5, 2
    s_add_u32 s4, s4, s5
    s_add_u32 s4, s4, 56819712
    s_cmp_lt_u32 s42, 22
    s_cselect_b32 s45, s4, 0x7ff00000
    s_add_u32 s84, s44, 0
    s_add_u32 s85, s44, 16384
    s_add_u32 s86, s44, 32768
    s_add_u32 s87, s44, 49152
    s_add_u32 s88, s44, 8192
    s_add_u32 s89, s44, 24576
    s_add_u32 s90, s44, 40960
    s_add_u32 s91, s44, 57344
    s_waitcnt vmcnt(45)
    s_barrier
    ds_read_b64_tr_b16 v[64:65], v192 offset:0
    ds_read_b64_tr_b16 v[66:67], v192 offset:2048
    ds_read_b64_tr_b16 v[68:69], v192 offset:8192
    ds_read_b64_tr_b16 v[70:71], v192 offset:10240
    ds_read_b64_tr_b16 v[72:73], v193 offset:0
    ds_read_b64_tr_b16 v[74:75], v193 offset:2048
    ds_read_b64_tr_b16 v[76:77], v193 offset:8192
    ds_read_b64_tr_b16 v[78:79], v193 offset:10240
    ds_read_b64_tr_b16 v[80:81], v194 offset:0
    ds_read_b64_tr_b16 v[82:83], v194 offset:2048
    ds_read_b64_tr_b16 v[84:85], v194 offset:8192
    ds_read_b64_tr_b16 v[86:87], v194 offset:10240
    ds_read_b64_tr_b16 v[88:89], v195 offset:0
    ds_read_b64_tr_b16 v[90:91], v195 offset:2048
    ds_read_b64_tr_b16 v[92:93], v195 offset:8192
    ds_read_b64_tr_b16 v[94:95], v195 offset:10240
    s_waitcnt vmcnt(31)
    v_lshlrev_b32 v216, 16, v208
    v_and_b32 v217, 0xffff0000, v208
    v_lshlrev_b32 v218, 16, v209
    v_and_b32 v219, 0xffff0000, v209
    v_lshlrev_b32 v220, 16, v210
    v_and_b32 v221, 0xffff0000, v210
    v_lshlrev_b32 v222, 16, v211
    v_and_b32 v223, 0xffff0000, v211
    v_lshlrev_b32 v224, 16, v212
    v_and_b32 v225, 0xffff0000, v212
    v_lshlrev_b32 v226, 16, v213
    v_and_b32 v227, 0xffff0000, v213
    v_lshlrev_b32 v228, 16, v214
    v_and_b32 v229, 0xffff0000, v214
    v_lshlrev_b32 v230, 16, v215
    v_and_b32 v231, 0xffff0000, v215
    v_add_f32 v232, v216, v217
    v_add_f32 v233, v218, v219
    v_add_f32 v232, v232, v220
    v_add_f32 v233, v233, v221
    v_add_f32 v232, v232, v222
    v_add_f32 v233, v233, v223
    v_add_f32 v232, v232, v224
    v_add_f32 v233, v233, v225
    v_add_f32 v232, v232, v226
    v_add_f32 v233, v233, v227
    v_add_f32 v232, v232, v228
    v_add_f32 v233, v233, v229
    v_add_f32 v232, v232, v230
    v_add_f32 v233, v233, v231
    v_add_f32 v232, v232, v233
    s_nop 1
    v_add_f32_dpp v234, v232, v232 quad_perm:[1,0,3,2] row_mask:0xf bank_mask:0xf
    v_mov_b32 v232, v234
    s_nop 1
    v_add_f32_dpp v234, v232, v232 quad_perm:[2,3,0,1] row_mask:0xf bank_mask:0xf
    v_mov_b32 v232, v234
    s_nop 1
    v_add_f32_dpp v234, v232, v232 row_half_mirror row_mask:0xf bank_mask:0xf
    v_mov_b32 v232, v234
    s_nop 1
    v_add_f32_dpp v234, v232, v232 row_mirror row_mask:0xf bank_mask:0xf
    v_mov_b32 v232, v234
    s_nop 1
    v_permlane16_swap_b32 v232, v234
    s_nop 1
    v_add_f32 v232, v232, v234
    v_mul_f32 v232, 0.001953125, v232
    v_sub_f32 v208, v216, v232
    v_sub_f32 v209, v217, v232
    v_sub_f32 v210, v218, v232
    v_sub_f32 v211, v219, v232
    v_sub_f32 v212, v220, v232
    v_sub_f32 v213, v221, v232
    v_sub_f32 v214, v222, v232
    v_sub_f32 v215, v223, v232
    v_mul_f32 v233, v208, v208
    v_fmac_f32 v233, v209, v209
    v_fmac_f32 v233, v210, v210
    v_fmac_f32 v233, v211, v211
    v_fmac_f32 v233, v212, v212
    v_fmac_f32 v233, v213, v213
    v_fmac_f32 v233, v214, v214
    v_fmac_f32 v233, v215, v215
    v_sub_f32 v208, v224, v232
    v_sub_f32 v209, v225, v232
    v_sub_f32 v210, v226, v232
    v_sub_f32 v211, v227, v232
    v_sub_f32 v212, v228, v232
    v_sub_f32 v213, v229, v232
    v_sub_f32 v214, v230, v232
    v_sub_f32 v215, v231, v232
    v_fmac_f32 v233, v208, v208
    v_fmac_f32 v233, v209, v209
    v_fmac_f32 v233, v210, v210
    v_fmac_f32 v233, v211, v211
    v_fmac_f32 v233, v212, v212
    v_fmac_f32 v233, v213, v213
    v_fmac_f32 v233, v214, v214
    v_fmac_f32 v233, v215, v215
    s_nop 1
    v_add_f32_dpp v234, v233, v233 quad_perm:[1,0,3,2] row_mask:0xf bank_mask:0xf
    v_mov_b32 v233, v234
    s_nop 1
    v_add_f32_dpp v234, v233, v233 quad_perm:[2,3,0,1] row_mask:0xf bank_mask:0xf
    v_mov_b32 v233, v234
    s_nop 1
    v_add_f32_dpp v234, v233, v233 row_half_mirror row_mask:0xf bank_mask:0xf
    v_mov_b32 v233, v234
    s_nop 1
    v_add_f32_dpp v234, v233, v233 row_mirror row_mask:0xf bank_mask:0xf
    v_mov_b32 v233, v234
    s_nop 1
    v_permlane16_swap_b32 v233, v234
    s_nop 1
    v_add_f32 v233, v233, v234
    v_mul_f32 v233, 0.001953125, v233
    v_cvt_pk_bf16_f32 v234, v233, v233
    v_lshlrev_b32 v233, 16, v234
    v_add_f32 v233, 0x3727c5ac, v233
    v_cvt_pk_bf16_f32 v234, v233, v233
    v_lshlrev_b32 v233, 16, v234
    v_sqrt_f32 v233, v233
    s_nop 0
    v_cvt_pk_bf16_f32 v234, v233, v233
    v_lshlrev_b32 v233, 16, v234
    v_rcp_f32 v233, v233
    v_cvt_pk_bf16_f32 v234, v232, v232
    v_lshlrev_b32 v232, 16, v234
    v_sub_f32 v216, v216, v232
    v_sub_f32 v217, v217, v232
    v_sub_f32 v218, v218, v232
    v_sub_f32 v219, v219, v232
    v_sub_f32 v220, v220, v232
    v_sub_f32 v221, v221, v232
    v_sub_f32 v222, v222, v232
    v_sub_f32 v223, v223, v232
    v_sub_f32 v224, v224, v232
    v_sub_f32 v225, v225, v232
    v_sub_f32 v226, v226, v232
    v_sub_f32 v227, v227, v232
    v_sub_f32 v228, v228, v232
    v_sub_f32 v229, v229, v232
    v_sub_f32 v230, v230, v232
    v_sub_f32 v231, v231, v232
    v_cvt_pk_bf16_f32 v208, v216, v217
    v_cvt_pk_bf16_f32 v209, v218, v219
    v_cvt_pk_bf16_f32 v210, v220, v221
    v_cvt_pk_bf16_f32 v211, v222, v223
    v_cvt_pk_bf16_f32 v212, v224, v225
    v_cvt_pk_bf16_f32 v213, v226, v227
    v_cvt_pk_bf16_f32 v214, v228, v229
    v_cvt_pk_bf16_f32 v215, v230, v231
    v_lshlrev_b32 v216, 16, v208
    v_and_b32 v217, 0xffff0000, v208
    v_lshlrev_b32 v218, 16, v209
    v_and_b32 v219, 0xffff0000, v209
    v_lshlrev_b32 v220, 16, v210
    v_and_b32 v221, 0xffff0000, v210
    v_lshlrev_b32 v222, 16, v211
    v_and_b32 v223, 0xffff0000, v211
    v_lshlrev_b32 v224, 16, v212
    v_and_b32 v225, 0xffff0000, v212
    v_lshlrev_b32 v226, 16, v213
    v_and_b32 v227, 0xffff0000, v213
    v_lshlrev_b32 v228, 16, v214
    v_and_b32 v229, 0xffff0000, v214
    v_lshlrev_b32 v230, 16, v215
    v_and_b32 v231, 0xffff0000, v215
    v_mul_f32 v216, v216, v233
    v_mul_f32 v217, v217, v233
    v_mul_f32 v218, v218, v233
    v_mul_f32 v219, v219, v233
    v_mul_f32 v220, v220, v233
    v_mul_f32 v221, v221, v233
    v_mul_f32 v222, v222, v233
    v_mul_f32 v223, v223, v233
    v_mul_f32 v224, v224, v233
    v_mul_f32 v225, v225, v233
    v_mul_f32 v226, v226, v233
    v_mul_f32 v227, v227, v233
    v_mul_f32 v228, v228, v233
    v_mul_f32 v229, v229, v233
    v_mul_f32 v230, v230, v233
    v_mul_f32 v231, v231, v233
    v_cvt_pk_bf16_f32 v208, v216, v217
    v_cvt_pk_bf16_f32 v209, v218, v219
    v_cvt_pk_bf16_f32 v210, v220, v221
    v_cvt_pk_bf16_f32 v211, v222, v223
    v_cvt_pk_bf16_f32 v212, v224, v225
    v_cvt_pk_bf16_f32 v213, v226, v227
    v_cvt_pk_bf16_f32 v214, v228, v229
    v_cvt_pk_bf16_f32 v215, v230, v231
    buffer_store_dwordx4 v[208:211], v235, s[8:11], s49 offen sc0 sc1
    buffer_store_dwordx4 v[212:215], v235, s[8:11], s49 offen offset:512 sc0 sc1
    s_sub_u32 s4, s42, 22
    s_lshl_b32 s4, s4, 3
    s_add_u32 s4, s4, s34
    s_lshl_b32 s4, s4, 2
    s_add_u32 s4, s4, s32
    s_lshl_b32 s4, s4, 13
    v_lshlrev_b32 v22, 7, v0
    s_add_u32 s5, s4, 2621440
    s_lshr_b32 s6, s4, 1
    s_and_b32 s6, s6, 0xffffe000
    s_add_u32 s7, s6, 1310720
    buffer_load_dword v253, v22, s[20:23], s4 offen
    buffer_load_dword v253, v22, s[20:23], s5 offen
    buffer_load_dword v253, v22, s[56:59], s6 offen
    buffer_load_dword v253, v22, s[56:59], s7 offen
    buffer_load_dword v253, v22, s[60:63], s4 offen
    buffer_load_dword v253, v22, s[60:63], s5 offen
    s_waitcnt vmcnt(41)
    s_waitcnt lgkmcnt(0)
    s_barrier
    ds_read_b128 v[32:35], v18 offset:0
    ds_read_b128 v[36:39], v19 offset:0
    s_add_u32 m0, s41, 98304
    s_add_u32 s48, s37, 2097152
    buffer_load_dwordx4 v6, s[16:19], s48 offen offset:0 lds
    buffer_load_dwordx4 v7, s[16:19], s48 offen offset:1024 lds
    buffer_load_dwordx4 v8, s[16:19], s48 offen offset:2048 lds
    buffer_load_dwordx4 v9, s[16:19], s48 offen offset:3072 lds
    s_waitcnt lgkmcnt(0)
    v_mfma_f32_16x16x32_bf16 a[0:3], v[64:67], v[32:35], 0
    ds_read_b128 v[40:43], v18 offset:2048
    v_mfma_f32_16x16x32_bf16 a[0:3], v[68:71], v[36:39], a[0:3]
    ds_read_b128 v[44:47], v19 offset:2048
    v_mfma_f32_16x16x32_bf16 a[4:7], v[72:75], v[32:35], 0
    ds_read_b64_tr_b16 v[96:97], v192 offset:16384
    v_mfma_f32_16x16x32_bf16 a[4:7], v[76:79], v[36:39], a[4:7]
    v_mfma_f32_16x16x32_bf16 a[8:11], v[80:83], v[32:35], 0
    ds_read_b64_tr_b16 v[98:99], v192 offset:18432
    v_mfma_f32_16x16x32_bf16 a[8:11], v[84:87], v[36:39], a[8:11]
    v_mfma_f32_16x16x32_bf16 a[12:15], v[88:91], v[32:35], 0
    ds_read_b64_tr_b16 v[100:101], v192 offset:24576
    v_mfma_f32_16x16x32_bf16 a[12:15], v[92:95], v[36:39], a[12:15]
    s_waitcnt lgkmcnt(3)
    v_mfma_f32_16x16x32_bf16 a[16:19], v[64:67], v[40:43], 0
    ds_read_b128 v[32:35], v18 offset:4096
    v_mfma_f32_16x16x32_bf16 a[16:19], v[68:71], v[44:47], a[16:19]
    ds_read_b128 v[36:39], v19 offset:4096
    v_mfma_f32_16x16x32_bf16 a[20:23], v[72:75], v[40:43], 0
    ds_read_b64_tr_b16 v[102:103], v192 offset:26624
    v_mfma_f32_16x16x32_bf16 a[20:23], v[76:79], v[44:47], a[20:23]
    v_mfma_f32_16x16x32_bf16 a[24:27], v[80:83], v[40:43], 0
    ds_read_b64_tr_b16 v[104:105], v193 offset:16384
    v_mfma_f32_16x16x32_bf16 a[24:27], v[84:87], v[44:47], a[24:27]
    v_mfma_f32_16x16x32_bf16 a[28:31], v[88:91], v[40:43], 0
    ds_read_b64_tr_b16 v[106:107], v193 offset:18432
    v_mfma_f32_16x16x32_bf16 a[28:31], v[92:95], v[44:47], a[28:31]
    s_waitcnt lgkmcnt(3)
    v_mfma_f32_16x16x32_bf16 a[32:35], v[64:67], v[32:35], 0
    ds_read_b128 v[40:43], v18 offset:6144
    v_mfma_f32_16x16x32_bf16 a[32:35], v[68:71], v[36:39], a[32:35]
    ds_read_b128 v[44:47], v19 offset:6144
    v_mfma_f32_16x16x32_bf16 a[36:39], v[72:75], v[32:35], 0
    ds_read_b64_tr_b16 v[108:109], v193 offset:24576
    v_mfma_f32_16x16x32_bf16 a[36:39], v[76:79], v[36:39], a[36:39]
    v_mfma_f32_16x16x32_bf16 a[40:43], v[80:83], v[32:35], 0
    v_mfma_f32_16x16x32_bf16 a[40:43], v[84:87], v[36:39], a[40:43]
    ds_read_b64_tr_b16 v[110:111], v193 offset:26624
    v_mfma_f32_16x16x32_bf16 a[44:47], v[88:91], v[32:35], 0
    v_mfma_f32_16x16x32_bf16 a[44:47], v[92:95], v[36:39], a[44:47]
    s_waitcnt lgkmcnt(2)
    v_mfma_f32_16x16x32_bf16 a[48:51], v[64:67], v[40:43], 0
    ds_read_b128 v[32:35], v18 offset:8192
    v_mfma_f32_16x16x32_bf16 a[48:51], v[68:71], v[44:47], a[48:51]
    ds_read_b128 v[36:39], v19 offset:8192
    v_mfma_f32_16x16x32_bf16 a[52:55], v[72:75], v[40:43], 0
    ds_read_b64_tr_b16 v[112:113], v194 offset:16384
    v_mfma_f32_16x16x32_bf16 a[52:55], v[76:79], v[44:47], a[52:55]
    v_mfma_f32_16x16x32_bf16 a[56:59], v[80:83], v[40:43], 0
    ds_read_b64_tr_b16 v[114:115], v194 offset:18432
    v_mfma_f32_16x16x32_bf16 a[56:59], v[84:87], v[44:47], a[56:59]
    v_mfma_f32_16x16x32_bf16 a[60:63], v[88:91], v[40:43], 0
    ds_read_b64_tr_b16 v[116:117], v194 offset:24576
    v_mfma_f32_16x16x32_bf16 a[60:63], v[92:95], v[44:47], a[60:63]
    s_waitcnt lgkmcnt(3)
    v_mfma_f32_16x16x32_bf16 a[64:67], v[64:67], v[32:35], 0
    ds_read_b128 v[40:43], v18 offset:10240
    v_mfma_f32_16x16x32_bf16 a[64:67], v[68:71], v[36:39], a[64:67]
    ds_read_b128 v[44:47], v19 offset:10240
    v_mfma_f32_16x16x32_bf16 a[68:71], v[72:75], v[32:35], 0
    ds_read_b64_tr_b16 v[118:119], v194 offset:26624
    v_mfma_f32_16x16x32_bf16 a[68:71], v[76:79], v[36:39], a[68:71]
    v_mfma_f32_16x16x32_bf16 a[72:75], v[80:83], v[32:35], 0
    ds_read_b64_tr_b16 v[120:121], v195 offset:16384
    v_mfma_f32_16x16x32_bf16 a[72:75], v[84:87], v[36:39], a[72:75]
    v_mfma_f32_16x16x32_bf16 a[76:79], v[88:91], v[32:35], 0
    ds_read_b64_tr_b16 v[122:123], v195 offset:18432
    v_mfma_f32_16x16x32_bf16 a[76:79], v[92:95], v[36:39], a[76:79]
    s_waitcnt lgkmcnt(3)
    v_mfma_f32_16x16x32_bf16 a[80:83], v[64:67], v[40:43], 0
    ds_read_b128 v[32:35], v18 offset:12288
    v_mfma_f32_16x16x32_bf16 a[80:83], v[68:71], v[44:47], a[80:83]
    ds_read_b128 v[36:39], v19 offset:12288
    v_mfma_f32_16x16x32_bf16 a[84:87], v[72:75], v[40:43], 0
    ds_read_b64_tr_b16 v[124:125], v195 offset:24576
    v_mfma_f32_16x16x32_bf16 a[84:87], v[76:79], v[44:47], a[84:87]
    v_mfma_f32_16x16x32_bf16 a[88:91], v[80:83], v[40:43], 0
    v_mfma_f32_16x16x32_bf16 a[88:91], v[84:87], v[44:47], a[88:91]
    ds_read_b64_tr_b16 v[126:127], v195 offset:26624
    v_mfma_f32_16x16x32_bf16 a[92:95], v[88:91], v[40:43], 0
    v_mfma_f32_16x16x32_bf16 a[92:95], v[92:95], v[44:47], a[92:95]
    s_waitcnt lgkmcnt(2)
    v_mfma_f32_16x16x32_bf16 a[96:99], v[64:67], v[32:35], 0
    ds_read_b128 v[40:43], v18 offset:14336
    v_mfma_f32_16x16x32_bf16 a[96:99], v[68:71], v[36:39], a[96:99]
    ds_read_b128 v[44:47], v19 offset:14336
    v_mfma_f32_16x16x32_bf16 a[100:103], v[72:75], v[32:35], 0
    v_mfma_f32_16x16x32_bf16 a[100:103], v[76:79], v[36:39], a[100:103]
    v_mfma_f32_16x16x32_bf16 a[104:107], v[80:83], v[32:35], 0
    v_mfma_f32_16x16x32_bf16 a[104:107], v[84:87], v[36:39], a[104:107]
    v_mfma_f32_16x16x32_bf16 a[108:111], v[88:91], v[32:35], 0
    v_mfma_f32_16x16x32_bf16 a[108:111], v[92:95], v[36:39], a[108:111]
    s_waitcnt lgkmcnt(0)
    v_mfma_f32_16x16x32_bf16 a[112:115], v[64:67], v[40:43], 0
    s_waitcnt vmcnt(10)
    s_barrier
    s_cmp_lg_u32 s32, 0
    s_cbranch_scc1 L_g1_ic4
    v_mov_b32 v49, 1
    s_mov_b64 exec, 1
    buffer_store_byte v49, v48, s[28:31], s2 offen sc0 sc1
    s_mov_b64 exec, -1
L_g1_ic4:
    v_mfma_f32_16x16x32_bf16 a[112:115], v[68:71], v[44:47], a[112:115]
    ds_read_b128 v[32:35], v16 offset:0
    v_mfma_f32_16x16x32_bf16 a[116:119], v[72:75], v[40:43], 0
    ds_read_b128 v[36:39], v17 offset:0
    v_mfma_f32_16x16x32_bf16 a[116:119], v[76:79], v[44:47], a[116:119]
    s_add_u32 m0, s40, 65536
    s_add_u32 s48, s35, 384
    buffer_load_dwordx4 v2, s[12:15], s48 offen offset:0 lds
    v_mfma_f32_16x16x32_bf16 a[120:123], v[80:83], v[40:43], 0
    v_mfma_f32_16x16x32_bf16 a[120:123], v[84:87], v[44:47], a[120:123]
    v_mfma_f32_16x16x32_bf16 a[124:127], v[88:91], v[40:43], 0
    buffer_load_dwordx4 v3, s[12:15], s48 offen offset:1024 lds
    v_mfma_f32_16x16x32_bf16 a[124:127], v[92:95], v[44:47], a[124:127]
    s_waitcnt lgkmcnt(0)
    v_mfma_f32_16x16x32_bf16 a[0:3], v[96:99], v[32:35], a[0:3]
    ds_read_b128 v[40:43], v16 offset:2048
    v_mfma_f32_16x16x32_bf16 a[0:3], v[100:103], v[36:39], a[0:3]
    ds_read_b128 v[44:47], v17 offset:2048
    v_mfma_f32_16x16x32_bf16 a[4:7], v[104:107], v[32:35], a[4:7]
    ds_read_b64_tr_b16 v[64:65], v192 offset:32768
    v_mfma_f32_16x16x32_bf16 a[4:7], v[108:111], v[36:39], a[4:7]
    buffer_load_dwordx4 v4, s[12:15], s48 offen offset:2048 lds
    v_mfma_f32_16x16x32_bf16 a[8:11], v[112:115], v[32:35], a[8:11]
    ds_read_b64_tr_b16 v[66:67], v192 offset:34816
    v_mfma_f32_16x16x32_bf16 a[8:11], v[116:119], v[36:39], a[8:11]
    buffer_load_dwordx4 v5, s[12:15], s48 offen offset:3072 lds
    v_mfma_f32_16x16x32_bf16 a[12:15], v[120:123], v[32:35], a[12:15]
    ds_read_b64_tr_b16 v[68:69], v192 offset:40960
    v_mfma_f32_16x16x32_bf16 a[12:15], v[124:127], v[36:39], a[12:15]
    s_waitcnt lgkmcnt(3)
    v_mfma_f32_16x16x32_bf16 a[16:19], v[96:99], v[40:43], a[16:19]
    ds_read_b128 v[32:35], v16 offset:4096
    v_mfma_f32_16x16x32_bf16 a[16:19], v[100:103], v[44:47], a[16:19]
    ds_read_b128 v[36:39], v17 offset:4096
    v_mfma_f32_16x16x32_bf16 a[20:23], v[104:107], v[40:43], a[20:23]
    ds_read_b64_tr_b16 v[70:71], v192 offset:43008
    v_mfma_f32_16x16x32_bf16 a[20:23], v[108:111], v[44:47], a[20:23]
    s_add_u32 m0, s40, 69632
    s_add_u32 s48, s35, 33152
    buffer_load_dwordx4 v2, s[12:15], s48 offen offset:0 lds
    v_mfma_f32_16x16x32_bf16 a[24:27], v[112:115], v[40:43], a[24:27]
    ds_read_b64_tr_b16 v[72:73], v193 offset:32768
    v_mfma_f32_16x16x32_bf16 a[24:27], v[116:119], v[44:47], a[24:27]
    v_mfma_f32_16x16x32_bf16 a[28:31], v[120:123], v[40:43], a[28:31]
    ds_read_b64_tr_b16 v[74:75], v193 offset:34816
    buffer_load_dwordx4 v3, s[12:15], s48 offen offset:1024 lds
    v_mfma_f32_16x16x32_bf16 a[28:31], v[124:127], v[44:47], a[28:31]
    s_waitcnt lgkmcnt(3)
    v_mfma_f32_16x16x32_bf16 a[32:35], v[96:99], v[32:35], a[32:35]
    ds_read_b128 v[40:43], v16 offset:6144
    v_mfma_f32_16x16x32_bf16 a[32:35], v[100:103], v[36:39], a[32:35]
    ds_read_b128 v[44:47], v17 offset:6144
    v_mfma_f32_16x16x32_bf16 a[36:39], v[104:107], v[32:35], a[36:39]
    ds_read_b64_tr_b16 v[76:77], v193 offset:40960
    v_mfma_f32_16x16x32_bf16 a[36:39], v[108:111], v[36:39], a[36:39]
    buffer_load_dwordx4 v4, s[12:15], s48 offen offset:2048 lds
    v_mfma_f32_16x16x32_bf16 a[40:43], v[112:115], v[32:35], a[40:43]
    v_mfma_f32_16x16x32_bf16 a[40:43], v[116:119], v[36:39], a[40:43]
    ds_read_b64_tr_b16 v[78:79], v193 offset:43008
    buffer_load_dwordx4 v5, s[12:15], s48 offen offset:3072 lds
    v_mfma_f32_16x16x32_bf16 a[44:47], v[120:123], v[32:35], a[44:47]
    v_mfma_f32_16x16x32_bf16 a[44:47], v[124:127], v[36:39], a[44:47]
    s_waitcnt lgkmcnt(2)
    v_mfma_f32_16x16x32_bf16 a[48:51], v[96:99], v[40:43], a[48:51]
    ds_read_b128 v[32:35], v16 offset:8192
    v_mfma_f32_16x16x32_bf16 a[48:51], v[100:103], v[44:47], a[48:51]
    ds_read_b128 v[36:39], v17 offset:8192
    v_mfma_f32_16x16x32_bf16 a[52:55], v[104:107], v[40:43], a[52:55]
    ds_read_b64_tr_b16 v[80:81], v194 offset:32768
    v_mfma_f32_16x16x32_bf16 a[52:55], v[108:111], v[44:47], a[52:55]
    s_add_u32 m0, s41, 114688
    s_add_u32 s48, s37, 2621440
    buffer_load_dwordx4 v6, s[16:19], s48 offen offset:0 lds
    v_mfma_f32_16x16x32_bf16 a[56:59], v[112:115], v[40:43], a[56:59]
    ds_read_b64_tr_b16 v[82:83], v194 offset:34816
    v_mfma_f32_16x16x32_bf16 a[56:59], v[116:119], v[44:47], a[56:59]
    v_mfma_f32_16x16x32_bf16 a[60:63], v[120:123], v[40:43], a[60:63]
    ds_read_b64_tr_b16 v[84:85], v194 offset:40960
    buffer_load_dwordx4 v7, s[16:19], s48 offen offset:1024 lds
    v_mfma_f32_16x16x32_bf16 a[60:63], v[124:127], v[44:47], a[60:63]
    s_waitcnt lgkmcnt(3)
    v_mfma_f32_16x16x32_bf16 a[64:67], v[96:99], v[32:35], a[64:67]
    ds_read_b128 v[40:43], v16 offset:10240
    v_mfma_f32_16x16x32_bf16 a[64:67], v[100:103], v[36:39], a[64:67]
    ds_read_b128 v[44:47], v17 offset:10240
    v_mfma_f32_16x16x32_bf16 a[68:71], v[104:107], v[32:35], a[68:71]
    ds_read_b64_tr_b16 v[86:87], v194 offset:43008
    v_mfma_f32_16x16x32_bf16 a[68:71], v[108:111], v[36:39], a[68:71]
    buffer_load_dwordx4 v8, s[16:19], s48 offen offset:2048 lds
    v_mfma_f32_16x16x32_bf16 a[72:75], v[112:115], v[32:35], a[72:75]
    ds_read_b64_tr_b16 v[88:89], v195 offset:32768
    v_mfma_f32_16x16x32_bf16 a[72:75], v[116:119], v[36:39], a[72:75]
    buffer_load_dwordx4 v9, s[16:19], s48 offen offset:3072 lds
    v_mfma_f32_16x16x32_bf16 a[76:79], v[120:123], v[32:35], a[76:79]
    ds_read_b64_tr_b16 v[90:91], v195 offset:34816
    v_mfma_f32_16x16x32_bf16 a[76:79], v[124:127], v[36:39], a[76:79]
    s_waitcnt lgkmcnt(3)
    v_mfma_f32_16x16x32_bf16 a[80:83], v[96:99], v[40:43], a[80:83]
    ds_read_b128 v[32:35], v16 offset:12288
    v_mfma_f32_16x16x32_bf16 a[80:83], v[100:103], v[44:47], a[80:83]
    ds_read_b128 v[36:39], v17 offset:12288
    v_mfma_f32_16x16x32_bf16 a[84:87], v[104:107], v[40:43], a[84:87]
    ds_read_b64_tr_b16 v[92:93], v195 offset:40960
    v_mfma_f32_16x16x32_bf16 a[84:87], v[108:111], v[44:47], a[84:87]
    v_mfma_f32_16x16x32_bf16 a[88:91], v[112:115], v[40:43], a[88:91]
    v_mfma_f32_16x16x32_bf16 a[88:91], v[116:119], v[44:47], a[88:91]
    ds_read_b64_tr_b16 v[94:95], v195 offset:43008
    v_mfma_f32_16x16x32_bf16 a[92:95], v[120:123], v[40:43], a[92:95]
    v_mfma_f32_16x16x32_bf16 a[92:95], v[124:127], v[44:47], a[92:95]
    s_waitcnt lgkmcnt(2)
    v_mfma_f32_16x16x32_bf16 a[96:99], v[96:99], v[32:35], a[96:99]
    ds_read_b128 v[40:43], v16 offset:14336
    v_mfma_f32_16x16x32_bf16 a[96:99], v[100:103], v[36:39], a[96:99]
    ds_read_b128 v[44:47], v17 offset:14336
    v_mfma_f32_16x16x32_bf16 a[100:103], v[104:107], v[32:35], a[100:103]
    v_mfma_f32_16x16x32_bf16 a[100:103], v[108:111], v[36:39], a[100:103]
    v_mfma_f32_16x16x32_bf16 a[104:107], v[112:115], v[32:35], a[104:107]
    v_mfma_f32_16x16x32_bf16 a[104:107], v[116:119], v[36:39], a[104:107]
    v_mfma_f32_16x16x32_bf16 a[108:111], v[120:123], v[32:35], a[108:111]
    v_mfma_f32_16x16x32_bf16 a[108:111], v[124:127], v[36:39], a[108:111]
    s_waitcnt lgkmcnt(0)
    v_mfma_f32_16x16x32_bf16 a[112:115], v[96:99], v[40:43], a[112:115]
    s_waitcnt vmcnt(31)
    s_barrier
    v_mfma_f32_16x16x32_bf16 a[112:115], v[100:103], v[44:47], a[112:115]
    ds_read_b128 v[32:35], v16 offset:32768
    v_mfma_f32_16x16x32_bf16 a[116:119], v[104:107], v[40:43], a[116:119]
    ds_read_b128 v[36:39], v17 offset:32768
    v_mfma_f32_16x16x32_bf16 a[116:119], v[108:111], v[44:47], a[116:119]
    s_add_u32 m0, s40, 0
    s_add_u32 s48, s35, 512
    buffer_load_dwordx4 v2, s[12:15], s48 offen offset:0 lds
    v_mfma_f32_16x16x32_bf16 a[120:123], v[112:115], v[40:43], a[120:123]
    v_mfma_f32_16x16x32_bf16 a[120:123], v[116:119], v[44:47], a[120:123]
    v_mfma_f32_16x16x32_bf16 a[124:127], v[120:123], v[40:43], a[124:127]
    buffer_load_dwordx4 v3, s[12:15], s48 offen offset:1024 lds
    v_mfma_f32_16x16x32_bf16 a[124:127], v[124:127], v[44:47], a[124:127]
    s_waitcnt lgkmcnt(0)
    v_mfma_f32_16x16x32_bf16 a[0:3], v[64:67], v[32:35], a[0:3]
    ds_read_b128 v[40:43], v16 offset:34816
    v_mfma_f32_16x16x32_bf16 a[0:3], v[68:71], v[36:39], a[0:3]
    ds_read_b128 v[44:47], v17 offset:34816
    v_mfma_f32_16x16x32_bf16 a[4:7], v[72:75], v[32:35], a[4:7]
    ds_read_b64_tr_b16 v[96:97], v192 offset:49152
    v_mfma_f32_16x16x32_bf16 a[4:7], v[76:79], v[36:39], a[4:7]
    buffer_load_dwordx4 v4, s[12:15], s48 offen offset:2048 lds
    v_mfma_f32_16x16x32_bf16 a[8:11], v[80:83], v[32:35], a[8:11]
    ds_read_b64_tr_b16 v[98:99], v192 offset:51200
    v_mfma_f32_16x16x32_bf16 a[8:11], v[84:87], v[36:39], a[8:11]
    buffer_load_dwordx4 v5, s[12:15], s48 offen offset:3072 lds
    v_mfma_f32_16x16x32_bf16 a[12:15], v[88:91], v[32:35], a[12:15]
    ds_read_b64_tr_b16 v[100:101], v192 offset:57344
    v_mfma_f32_16x16x32_bf16 a[12:15], v[92:95], v[36:39], a[12:15]
    s_waitcnt lgkmcnt(3)
    v_mfma_f32_16x16x32_bf16 a[16:19], v[64:67], v[40:43], a[16:19]
    ds_read_b128 v[32:35], v16 offset:36864
    v_mfma_f32_16x16x32_bf16 a[16:19], v[68:71], v[44:47], a[16:19]
    ds_read_b128 v[36:39], v17 offset:36864
    v_mfma_f32_16x16x32_bf16 a[20:23], v[72:75], v[40:43], a[20:23]
    ds_read_b64_tr_b16 v[102:103], v192 offset:59392
    v_mfma_f32_16x16x32_bf16 a[20:23], v[76:79], v[44:47], a[20:23]
    s_add_u32 m0, s40, 4096
    s_add_u32 s48, s35, 33280
    buffer_load_dwordx4 v2, s[12:15], s48 offen offset:0 lds
    v_mfma_f32_16x16x32_bf16 a[24:27], v[80:83], v[40:43], a[24:27]
    ds_read_b64_tr_b16 v[104:105], v193 offset:49152
    v_mfma_f32_16x16x32_bf16 a[24:27], v[84:87], v[44:47], a[24:27]
    v_mfma_f32_16x16x32_bf16 a[28:31], v[88:91], v[40:43], a[28:31]
    ds_read_b64_tr_b16 v[106:107], v193 offset:51200
    buffer_load_dwordx4 v3, s[12:15], s48 offen offset:1024 lds
    v_mfma_f32_16x16x32_bf16 a[28:31], v[92:95], v[44:47], a[28:31]
    s_waitcnt lgkmcnt(3)
    v_mfma_f32_16x16x32_bf16 a[32:35], v[64:67], v[32:35], a[32:35]
    ds_read_b128 v[40:43], v16 offset:38912
    v_mfma_f32_16x16x32_bf16 a[32:35], v[68:71], v[36:39], a[32:35]
    ds_read_b128 v[44:47], v17 offset:38912
    v_mfma_f32_16x16x32_bf16 a[36:39], v[72:75], v[32:35], a[36:39]
    ds_read_b64_tr_b16 v[108:109], v193 offset:57344
    v_mfma_f32_16x16x32_bf16 a[36:39], v[76:79], v[36:39], a[36:39]
    buffer_load_dwordx4 v4, s[12:15], s48 offen offset:2048 lds
    v_mfma_f32_16x16x32_bf16 a[40:43], v[80:83], v[32:35], a[40:43]
    v_mfma_f32_16x16x32_bf16 a[40:43], v[84:87], v[36:39], a[40:43]
    ds_read_b64_tr_b16 v[110:111], v193 offset:59392
    buffer_load_dwordx4 v5, s[12:15], s48 offen offset:3072 lds
    v_mfma_f32_16x16x32_bf16 a[44:47], v[88:91], v[32:35], a[44:47]
    v_mfma_f32_16x16x32_bf16 a[44:47], v[92:95], v[36:39], a[44:47]
    s_waitcnt lgkmcnt(2)
    v_mfma_f32_16x16x32_bf16 a[48:51], v[64:67], v[40:43], a[48:51]
    ds_read_b128 v[32:35], v16 offset:40960
    v_mfma_f32_16x16x32_bf16 a[48:51], v[68:71], v[44:47], a[48:51]
    ds_read_b128 v[36:39], v17 offset:40960
    v_mfma_f32_16x16x32_bf16 a[52:55], v[72:75], v[40:43], a[52:55]
    ds_read_b64_tr_b16 v[112:113], v194 offset:49152
    v_mfma_f32_16x16x32_bf16 a[52:55], v[76:79], v[44:47], a[52:55]
    s_add_u32 m0, s41, 131072
    s_add_u32 s48, s37, 3145728
    buffer_load_dwordx4 v6, s[16:19], s48 offen offset:0 lds
    v_mfma_f32_16x16x32_bf16 a[56:59], v[80:83], v[40:43], a[56:59]
    ds_read_b64_tr_b16 v[114:115], v194 offset:51200
    v_mfma_f32_16x16x32_bf16 a[56:59], v[84:87], v[44:47], a[56:59]
    v_mfma_f32_16x16x32_bf16 a[60:63], v[88:91], v[40:43], a[60:63]
    ds_read_b64_tr_b16 v[116:117], v194 offset:57344
    buffer_load_dwordx4 v7, s[16:19], s48 offen offset:1024 lds
    v_mfma_f32_16x16x32_bf16 a[60:63], v[92:95], v[44:47], a[60:63]
    s_waitcnt lgkmcnt(3)
    v_mfma_f32_16x16x32_bf16 a[64:67], v[64:67], v[32:35], a[64:67]
    ds_read_b128 v[40:43], v16 offset:43008
    v_mfma_f32_16x16x32_bf16 a[64:67], v[68:71], v[36:39], a[64:67]
    ds_read_b128 v[44:47], v17 offset:43008
    v_mfma_f32_16x16x32_bf16 a[68:71], v[72:75], v[32:35], a[68:71]
    ds_read_b64_tr_b16 v[118:119], v194 offset:59392
    v_mfma_f32_16x16x32_bf16 a[68:71], v[76:79], v[36:39], a[68:71]
    buffer_load_dwordx4 v8, s[16:19], s48 offen offset:2048 lds
    v_mfma_f32_16x16x32_bf16 a[72:75], v[80:83], v[32:35], a[72:75]
    ds_read_b64_tr_b16 v[120:121], v195 offset:49152
    v_mfma_f32_16x16x32_bf16 a[72:75], v[84:87], v[36:39], a[72:75]
    buffer_load_dwordx4 v9, s[16:19], s48 offen offset:3072 lds
    v_mfma_f32_16x16x32_bf16 a[76:79], v[88:91], v[32:35], a[76:79]
    ds_read_b64_tr_b16 v[122:123], v195 offset:51200
    v_mfma_f32_16x16x32_bf16 a[76:79], v[92:95], v[36:39], a[76:79]
    s_waitcnt lgkmcnt(3)
    v_mfma_f32_16x16x32_bf16 a[80:83], v[64:67], v[40:43], a[80:83]
    ds_read_b128 v[32:35], v16 offset:45056
    v_mfma_f32_16x16x32_bf16 a[80:83], v[68:71], v[44:47], a[80:83]
    ds_read_b128 v[36:39], v17 offset:45056
    v_mfma_f32_16x16x32_bf16 a[84:87], v[72:75], v[40:43], a[84:87]
    ds_read_b64_tr_b16 v[124:125], v195 offset:57344
    v_mfma_f32_16x16x32_bf16 a[84:87], v[76:79], v[44:47], a[84:87]
    v_mfma_f32_16x16x32_bf16 a[88:91], v[80:83], v[40:43], a[88:91]
    v_mfma_f32_16x16x32_bf16 a[88:91], v[84:87], v[44:47], a[88:91]
    ds_read_b64_tr_b16 v[126:127], v195 offset:59392
    v_mfma_f32_16x16x32_bf16 a[92:95], v[88:91], v[40:43], a[92:95]
    v_mfma_f32_16x16x32_bf16 a[92:95], v[92:95], v[44:47], a[92:95]
    s_waitcnt lgkmcnt(2)
    v_mfma_f32_16x16x32_bf16 a[96:99], v[64:67], v[32:35], a[96:99]
    ds_read_b128 v[40:43], v16 offset:47104
    v_mfma_f32_16x16x32_bf16 a[96:99], v[68:71], v[36:39], a[96:99]
    ds_read_b128 v[44:47], v17 offset:47104
    v_mfma_f32_16x16x32_bf16 a[100:103], v[72:75], v[32:35], a[100:103]
    v_mfma_f32_16x16x32_bf16 a[100:103], v[76:79], v[36:39], a[100:103]
    v_mfma_f32_16x16x32_bf16 a[104:107], v[80:83], v[32:35], a[104:107]
    v_mfma_f32_16x16x32_bf16 a[104:107], v[84:87], v[36:39], a[104:107]
    v_mfma_f32_16x16x32_bf16 a[108:111], v[88:91], v[32:35], a[108:111]
    v_mfma_f32_16x16x32_bf16 a[108:111], v[92:95], v[36:39], a[108:111]
    s_waitcnt lgkmcnt(0)
    v_mfma_f32_16x16x32_bf16 a[112:115], v[64:67], v[40:43], a[112:115]
    s_waitcnt vmcnt(16)
    s_barrier
    v_mfma_f32_16x16x32_bf16 a[112:115], v[68:71], v[44:47], a[112:115]
    ds_read_b128 v[32:35], v18 offset:0
    v_mfma_f32_16x16x32_bf16 a[116:119], v[72:75], v[40:43], a[116:119]
    ds_read_b128 v[36:39], v19 offset:0
    v_mfma_f32_16x16x32_bf16 a[116:119], v[76:79], v[44:47], a[116:119]
    s_add_u32 m0, s40, 32768
    s_add_u32 s48, s35, 640
    buffer_load_dwordx4 v2, s[12:15], s48 offen offset:0 lds
    v_mfma_f32_16x16x32_bf16 a[120:123], v[80:83], v[40:43], a[120:123]
    v_mfma_f32_16x16x32_bf16 a[120:123], v[84:87], v[44:47], a[120:123]
    v_mfma_f32_16x16x32_bf16 a[124:127], v[88:91], v[40:43], a[124:127]
    buffer_load_dwordx4 v3, s[12:15], s48 offen offset:1024 lds
    v_mfma_f32_16x16x32_bf16 a[124:127], v[92:95], v[44:47], a[124:127]
    s_waitcnt lgkmcnt(0)
    v_mfma_f32_16x16x32_bf16 a[0:3], v[96:99], v[32:35], a[0:3]
    ds_read_b128 v[40:43], v18 offset:2048
    v_mfma_f32_16x16x32_bf16 a[0:3], v[100:103], v[36:39], a[0:3]
    ds_read_b128 v[44:47], v19 offset:2048
    v_mfma_f32_16x16x32_bf16 a[4:7], v[104:107], v[32:35], a[4:7]
    ds_read_b64_tr_b16 v[64:65], v192 offset:0
    v_mfma_f32_16x16x32_bf16 a[4:7], v[108:111], v[36:39], a[4:7]
    buffer_load_dwordx4 v4, s[12:15], s48 offen offset:2048 lds
    v_mfma_f32_16x16x32_bf16 a[8:11], v[112:115], v[32:35], a[8:11]
    ds_read_b64_tr_b16 v[66:67], v192 offset:2048
    v_mfma_f32_16x16x32_bf16 a[8:11], v[116:119], v[36:39], a[8:11]
    buffer_load_dwordx4 v5, s[12:15], s48 offen offset:3072 lds
    v_mfma_f32_16x16x32_bf16 a[12:15], v[120:123], v[32:35], a[12:15]
    ds_read_b64_tr_b16 v[68:69], v192 offset:8192
    v_mfma_f32_16x16x32_bf16 a[12:15], v[124:127], v[36:39], a[12:15]
    s_waitcnt lgkmcnt(3)
    v_mfma_f32_16x16x32_bf16 a[16:19], v[96:99], v[40:43], a[16:19]
    ds_read_b128 v[32:35], v18 offset:4096
    v_mfma_f32_16x16x32_bf16 a[16:19], v[100:103], v[44:47], a[16:19]
    ds_read_b128 v[36:39], v19 offset:4096
    v_mfma_f32_16x16x32_bf16 a[20:23], v[104:107], v[40:43], a[20:23]
    ds_read_b64_tr_b16 v[70:71], v192 offset:10240
    v_mfma_f32_16x16x32_bf16 a[20:23], v[108:111], v[44:47], a[20:23]
    s_add_u32 m0, s40, 36864
    s_add_u32 s48, s35, 33408
    buffer_load_dwordx4 v2, s[12:15], s48 offen offset:0 lds
    v_mfma_f32_16x16x32_bf16 a[24:27], v[112:115], v[40:43], a[24:27]
    ds_read_b64_tr_b16 v[72:73], v193 offset:0
    v_mfma_f32_16x16x32_bf16 a[24:27], v[116:119], v[44:47], a[24:27]
    v_mfma_f32_16x16x32_bf16 a[28:31], v[120:123], v[40:43], a[28:31]
    ds_read_b64_tr_b16 v[74:75], v193 offset:2048
    buffer_load_dwordx4 v3, s[12:15], s48 offen offset:1024 lds
    v_mfma_f32_16x16x32_bf16 a[28:31], v[124:127], v[44:47], a[28:31]
    s_waitcnt lgkmcnt(3)
    v_mfma_f32_16x16x32_bf16 a[32:35], v[96:99], v[32:35], a[32:35]
    ds_read_b128 v[40:43], v18 offset:6144
    v_mfma_f32_16x16x32_bf16 a[32:35], v[100:103], v[36:39], a[32:35]
    ds_read_b128 v[44:47], v19 offset:6144
    v_mfma_f32_16x16x32_bf16 a[36:39], v[104:107], v[32:35], a[36:39]
    ds_read_b64_tr_b16 v[76:77], v193 offset:8192
    v_mfma_f32_16x16x32_bf16 a[36:39], v[108:111], v[36:39], a[36:39]
    buffer_load_dwordx4 v4, s[12:15], s48 offen offset:2048 lds
    v_mfma_f32_16x16x32_bf16 a[40:43], v[112:115], v[32:35], a[40:43]
    v_mfma_f32_16x16x32_bf16 a[40:43], v[116:119], v[36:39], a[40:43]
    ds_read_b64_tr_b16 v[78:79], v193 offset:10240
    buffer_load_dwordx4 v5, s[12:15], s48 offen offset:3072 lds
    v_mfma_f32_16x16x32_bf16 a[44:47], v[120:123], v[32:35], a[44:47]
    v_mfma_f32_16x16x32_bf16 a[44:47], v[124:127], v[36:39], a[44:47]
    s_waitcnt lgkmcnt(2)
    v_mfma_f32_16x16x32_bf16 a[48:51], v[96:99], v[40:43], a[48:51]
    ds_read_b128 v[32:35], v18 offset:8192
    v_mfma_f32_16x16x32_bf16 a[48:51], v[100:103], v[44:47], a[48:51]
    ds_read_b128 v[36:39], v19 offset:8192
    v_mfma_f32_16x16x32_bf16 a[52:55], v[104:107], v[40:43], a[52:55]
    ds_read_b64_tr_b16 v[80:81], v194 offset:0
    v_mfma_f32_16x16x32_bf16 a[52:55], v[108:111], v[44:47], a[52:55]
    s_add_u32 m0, s41, 147456
    s_add_u32 s48, s37, 3670016
    buffer_load_dwordx4 v6, s[16:19], s48 offen offset:0 lds
    v_mfma_f32_16x16x32_bf16 a[56:59], v[112:115], v[40:43], a[56:59]
    ds_read_b64_tr_b16 v[82:83], v194 offset:2048
    v_mfma_f32_16x16x32_bf16 a[56:59], v[116:119], v[44:47], a[56:59]
    v_mfma_f32_16x16x32_bf16 a[60:63], v[120:123], v[40:43], a[60:63]
    ds_read_b64_tr_b16 v[84:85], v194 offset:8192
    buffer_load_dwordx4 v7, s[16:19], s48 offen offset:1024 lds
    v_mfma_f32_16x16x32_bf16 a[60:63], v[124:127], v[44:47], a[60:63]
    s_waitcnt lgkmcnt(3)
    v_mfma_f32_16x16x32_bf16 a[64:67], v[96:99], v[32:35], a[64:67]
    ds_read_b128 v[40:43], v18 offset:10240
    v_mfma_f32_16x16x32_bf16 a[64:67], v[100:103], v[36:39], a[64:67]
    ds_read_b128 v[44:47], v19 offset:10240
    v_mfma_f32_16x16x32_bf16 a[68:71], v[104:107], v[32:35], a[68:71]
    ds_read_b64_tr_b16 v[86:87], v194 offset:10240
    v_mfma_f32_16x16x32_bf16 a[68:71], v[108:111], v[36:39], a[68:71]
    buffer_load_dwordx4 v8, s[16:19], s48 offen offset:2048 lds
    v_mfma_f32_16x16x32_bf16 a[72:75], v[112:115], v[32:35], a[72:75]
    ds_read_b64_tr_b16 v[88:89], v195 offset:0
    v_mfma_f32_16x16x32_bf16 a[72:75], v[116:119], v[36:39], a[72:75]
    buffer_load_dwordx4 v9, s[16:19], s48 offen offset:3072 lds
    v_mfma_f32_16x16x32_bf16 a[76:79], v[120:123], v[32:35], a[76:79]
    ds_read_b64_tr_b16 v[90:91], v195 offset:2048
    v_mfma_f32_16x16x32_bf16 a[76:79], v[124:127], v[36:39], a[76:79]
    s_waitcnt lgkmcnt(3)
    v_mfma_f32_16x16x32_bf16 a[80:83], v[96:99], v[40:43], a[80:83]
    ds_read_b128 v[32:35], v18 offset:12288
    v_mfma_f32_16x16x32_bf16 a[80:83], v[100:103], v[44:47], a[80:83]
    ds_read_b128 v[36:39], v19 offset:12288
    v_mfma_f32_16x16x32_bf16 a[84:87], v[104:107], v[40:43], a[84:87]
    ds_read_b64_tr_b16 v[92:93], v195 offset:8192
    v_mfma_f32_16x16x32_bf16 a[84:87], v[108:111], v[44:47], a[84:87]
    v_mfma_f32_16x16x32_bf16 a[88:91], v[112:115], v[40:43], a[88:91]
    v_mfma_f32_16x16x32_bf16 a[88:91], v[116:119], v[44:47], a[88:91]
    ds_read_b64_tr_b16 v[94:95], v195 offset:10240
    v_mfma_f32_16x16x32_bf16 a[92:95], v[120:123], v[40:43], a[92:95]
    v_mfma_f32_16x16x32_bf16 a[92:95], v[124:127], v[44:47], a[92:95]
    s_waitcnt lgkmcnt(2)
    v_mfma_f32_16x16x32_bf16 a[96:99], v[96:99], v[32:35], a[96:99]
    ds_read_b128 v[40:43], v18 offset:14336
    v_mfma_f32_16x16x32_bf16 a[96:99], v[100:103], v[36:39], a[96:99]
    ds_read_b128 v[44:47], v19 offset:14336
    v_mfma_f32_16x16x32_bf16 a[100:103], v[104:107], v[32:35], a[100:103]
    v_mfma_f32_16x16x32_bf16 a[100:103], v[108:111], v[36:39], a[100:103]
    v_mfma_f32_16x16x32_bf16 a[104:107], v[112:115], v[32:35], a[104:107]
    v_mfma_f32_16x16x32_bf16 a[104:107], v[116:119], v[36:39], a[104:107]
    v_mfma_f32_16x16x32_bf16 a[108:111], v[120:123], v[32:35], a[108:111]
    v_mfma_f32_16x16x32_bf16 a[108:111], v[124:127], v[36:39], a[108:111]
    s_waitcnt lgkmcnt(0)
    v_mfma_f32_16x16x32_bf16 a[112:115], v[96:99], v[40:43], a[112:115]
    s_waitcnt vmcnt(16)
    s_barrier
    v_mfma_f32_16x16x32_bf16 a[112:115], v[100:103], v[44:47], a[112:115]
    ds_read_b128 v[32:35], v16 offset:0
    v_mfma_f32_16x16x32_bf16 a[116:119], v[104:107], v[40:43], a[116:119]
    ds_read_b128 v[36:39], v17 offset:0
    v_mfma_f32_16x16x32_bf16 a[116:119], v[108:111], v[44:47], a[116:119]
    s_add_u32 m0, s40, 65536
    s_add_u32 s48, s35, 768
    buffer_load_dwordx4 v2, s[12:15], s48 offen offset:0 lds
    v_mfma_f32_16x16x32_bf16 a[120:123], v[112:115], v[40:43], a[120:123]
    v_mfma_f32_16x16x32_bf16 a[120:123], v[116:119], v[44:47], a[120:123]
    v_mfma_f32_16x16x32_bf16 a[124:127], v[120:123], v[40:43], a[124:127]
    buffer_load_dwordx4 v3, s[12:15], s48 offen offset:1024 lds
    v_mfma_f32_16x16x32_bf16 a[124:127], v[124:127], v[44:47], a[124:127]
    s_waitcnt lgkmcnt(0)
    v_mfma_f32_16x16x32_bf16 a[0:3], v[64:67], v[32:35], a[0:3]
    ds_read_b128 v[40:43], v16 offset:2048
    v_mfma_f32_16x16x32_bf16 a[0:3], v[68:71], v[36:39], a[0:3]
    ds_read_b128 v[44:47], v17 offset:2048
    v_mfma_f32_16x16x32_bf16 a[4:7], v[72:75], v[32:35], a[4:7]
    ds_read_b64_tr_b16 v[96:97], v192 offset:16384
    v_mfma_f32_16x16x32_bf16 a[4:7], v[76:79], v[36:39], a[4:7]
    buffer_load_dwordx4 v4, s[12:15], s48 offen offset:2048 lds
    v_mfma_f32_16x16x32_bf16 a[8:11], v[80:83], v[32:35], a[8:11]
    ds_read_b64_tr_b16 v[98:99], v192 offset:18432
    v_mfma_f32_16x16x32_bf16 a[8:11], v[84:87], v[36:39], a[8:11]
    buffer_load_dwordx4 v5, s[12:15], s48 offen offset:3072 lds
    v_mfma_f32_16x16x32_bf16 a[12:15], v[88:91], v[32:35], a[12:15]
    ds_read_b64_tr_b16 v[100:101], v192 offset:24576
    v_mfma_f32_16x16x32_bf16 a[12:15], v[92:95], v[36:39], a[12:15]
    s_waitcnt lgkmcnt(3)
    v_mfma_f32_16x16x32_bf16 a[16:19], v[64:67], v[40:43], a[16:19]
    ds_read_b128 v[32:35], v16 offset:4096
    v_mfma_f32_16x16x32_bf16 a[16:19], v[68:71], v[44:47], a[16:19]
    ds_read_b128 v[36:39], v17 offset:4096
    s_and_b32 s4, s2, 31
    v_and_b32 v22, 7, v0
    v_lshlrev_b32 v22, 5, v22
    v_mfma_f32_16x16x32_bf16 a[20:23], v[72:75], v[40:43], a[20:23]
    ds_read_b64_tr_b16 v[102:103], v192 offset:26624
    v_add_u32 v22, s4, v22
    v_lshlrev_b32 v202, 7, v22
    v_mfma_f32_16x16x32_bf16 a[20:23], v[76:79], v[44:47], a[20:23]
    s_add_u32 m0, s40, 69632
    s_add_u32 s48, s35, 33536
    buffer_load_dwordx4 v2, s[12:15], s48 offen offset:0 lds
    s_cmp_eq_u32 s32, 0
    s_mov_b32 s5, 0x7ff00000
    s_cselect_b32 s52, 79298560, s5
    s_cselect_b32 s51, 0, s5
    v_mfma_f32_16x16x32_bf16 a[24:27], v[80:83], v[40:43], a[24:27]
    ds_read_b64_tr_b16 v[104:105], v193 offset:16384
    s_lshl_b32 s53, s2, 7
    v_mfma_f32_16x16x32_bf16 a[24:27], v[84:87], v[44:47], a[24:27]
    s_lshl_b32 s5, s32, 2
    s_add_u32 s53, s53, s5
    v_mfma_f32_16x16x32_bf16 a[28:31], v[88:91], v[40:43], a[28:31]
    ds_read_b64_tr_b16 v[106:107], v193 offset:18432
    buffer_load_dwordx4 v3, s[12:15], s48 offen offset:1024 lds
    s_add_u32 s55, s53, 79331328
    s_add_u32 s53, s53, 79298560
    v_mfma_f32_16x16x32_bf16 a[28:31], v[92:95], v[44:47], a[28:31]
    v_mov_b32 v49, 1
    v_lshlrev_b32 v52, 2, v0
    s_waitcnt lgkmcnt(3)
    v_mfma_f32_16x16x32_bf16 a[32:35], v[64:67], v[32:35], a[32:35]
    ds_read_b128 v[40:43], v16 offset:6144
    v_mfma_f32_16x16x32_bf16 a[32:35], v[68:71], v[36:39], a[32:35]
    ds_read_b128 v[44:47], v17 offset:6144
    v_mfma_f32_16x16x32_bf16 a[36:39], v[72:75], v[32:35], a[36:39]
    ds_read_b64_tr_b16 v[108:109], v193 offset:24576
    v_mfma_f32_16x16x32_bf16 a[36:39], v[76:79], v[36:39], a[36:39]
    buffer_load_dwordx4 v4, s[12:15], s48 offen offset:2048 lds
    v_mfma_f32_16x16x32_bf16 a[40:43], v[80:83], v[32:35], a[40:43]
    v_mfma_f32_16x16x32_bf16 a[40:43], v[84:87], v[36:39], a[40:43]
    ds_read_b64_tr_b16 v[110:111], v193 offset:26624
    buffer_load_dwordx4 v5, s[12:15], s48 offen offset:3072 lds
    v_mfma_f32_16x16x32_bf16 a[44:47], v[88:91], v[32:35], a[44:47]
    v_mfma_f32_16x16x32_bf16 a[44:47], v[92:95], v[36:39], a[44:47]
    s_waitcnt lgkmcnt(2)
    v_mfma_f32_16x16x32_bf16 a[48:51], v[64:67], v[40:43], a[48:51]
    ds_read_b128 v[32:35], v16 offset:8192
    v_mfma_f32_16x16x32_bf16 a[48:51], v[68:71], v[44:47], a[48:51]
    ds_read_b128 v[36:39], v17 offset:8192
    v_mfma_f32_16x16x32_bf16 a[52:55], v[72:75], v[40:43], a[52:55]
    ds_read_b64_tr_b16 v[112:113], v194 offset:16384
    v_mfma_f32_16x16x32_bf16 a[52:55], v[76:79], v[44:47], a[52:55]
    s_add_u32 m0, s41, 98304
    s_add_u32 s48, s37, 0
    buffer_load_dwordx4 v6, s[20:23], s48 offen offset:0 lds
    v_mfma_f32_16x16x32_bf16 a[56:59], v[80:83], v[40:43], a[56:59]
    ds_read_b64_tr_b16 v[114:115], v194 offset:18432
    v_mfma_f32_16x16x32_bf16 a[56:59], v[84:87], v[44:47], a[56:59]
    v_mfma_f32_16x16x32_bf16 a[60:63], v[88:91], v[40:43], a[60:63]
    ds_read_b64_tr_b16 v[116:117], v194 offset:24576
    buffer_load_dwordx4 v7, s[20:23], s48 offen offset:1024 lds
    v_mfma_f32_16x16x32_bf16 a[60:63], v[92:95], v[44:47], a[60:63]
    s_waitcnt lgkmcnt(3)
    v_mfma_f32_16x16x32_bf16 a[64:67], v[64:67], v[32:35], a[64:67]
    ds_read_b128 v[40:43], v16 offset:10240
    v_mfma_f32_16x16x32_bf16 a[64:67], v[68:71], v[36:39], a[64:67]
    ds_read_b128 v[44:47], v17 offset:10240
    v_mfma_f32_16x16x32_bf16 a[68:71], v[72:75], v[32:35], a[68:71]
    ds_read_b64_tr_b16 v[118:119], v194 offset:26624
    v_mfma_f32_16x16x32_bf16 a[68:71], v[76:79], v[36:39], a[68:71]
    buffer_load_dwordx4 v8, s[20:23], s48 offen offset:2048 lds
    v_mfma_f32_16x16x32_bf16 a[72:75], v[80:83], v[32:35], a[72:75]
    ds_read_b64_tr_b16 v[120:121], v195 offset:16384
    v_mfma_f32_16x16x32_bf16 a[72:75], v[84:87], v[36:39], a[72:75]
    buffer_load_dwordx4 v9, s[20:23], s48 offen offset:3072 lds
    v_mfma_f32_16x16x32_bf16 a[76:79], v[88:91], v[32:35], a[76:79]
    ds_read_b64_tr_b16 v[122:123], v195 offset:18432
    v_mfma_f32_16x16x32_bf16 a[76:79], v[92:95], v[36:39], a[76:79]
    s_waitcnt lgkmcnt(3)
    v_mfma_f32_16x16x32_bf16 a[80:83], v[64:67], v[40:43], a[80:83]
    ds_read_b128 v[32:35], v16 offset:12288
    v_mfma_f32_16x16x32_bf16 a[80:83], v[68:71], v[44:47], a[80:83]
    ds_read_b128 v[36:39], v17 offset:12288
    v_mfma_f32_16x16x32_bf16 a[84:87], v[72:75], v[40:43], a[84:87]
    ds_read_b64_tr_b16 v[124:125], v195 offset:24576
    v_mfma_f32_16x16x32_bf16 a[84:87], v[76:79], v[44:47], a[84:87]
    v_mfma_f32_16x16x32_bf16 a[88:91], v[80:83], v[40:43], a[88:91]
    v_mfma_f32_16x16x32_bf16 a[88:91], v[84:87], v[44:47], a[88:91]
    ds_read_b64_tr_b16 v[126:127], v195 offset:26624
    v_mfma_f32_16x16x32_bf16 a[92:95], v[88:91], v[40:43], a[92:95]
    v_mfma_f32_16x16x32_bf16 a[92:95], v[92:95], v[44:47], a[92:95]
    s_waitcnt lgkmcnt(2)
    v_mfma_f32_16x16x32_bf16 a[96:99], v[64:67], v[32:35], a[96:99]
    ds_read_b128 v[40:43], v16 offset:14336
    v_mfma_f32_16x16x32_bf16 a[96:99], v[68:71], v[36:39], a[96:99]
    ds_read_b128 v[44:47], v17 offset:14336
    v_mfma_f32_16x16x32_bf16 a[100:103], v[72:75], v[32:35], a[100:103]
    v_mfma_f32_16x16x32_bf16 a[100:103], v[76:79], v[36:39], a[100:103]
    v_mfma_f32_16x16x32_bf16 a[104:107], v[80:83], v[32:35], a[104:107]
    v_mfma_f32_16x16x32_bf16 a[104:107], v[84:87], v[36:39], a[104:107]
    v_mfma_f32_16x16x32_bf16 a[108:111], v[88:91], v[32:35], a[108:111]
    v_mfma_f32_16x16x32_bf16 a[108:111], v[92:95], v[36:39], a[108:111]
    s_waitcnt lgkmcnt(0)
    v_mfma_f32_16x16x32_bf16 a[112:115], v[64:67], v[40:43], a[112:115]
    s_waitcnt vmcnt(16)
    s_barrier
    v_mfma_f32_16x16x32_bf16 a[112:115], v[68:71], v[44:47], a[112:115]
    ds_read_b128 v[32:35], v16 offset:32768
    v_mfma_f32_16x16x32_bf16 a[116:119], v[72:75], v[40:43], a[116:119]
    ds_read_b128 v[36:39], v17 offset:32768
    v_mfma_f32_16x16x32_bf16 a[116:119], v[76:79], v[44:47], a[116:119]
    s_add_u32 m0, s40, 0
    s_add_u32 s48, s35, 896
    buffer_load_dwordx4 v2, s[12:15], s48 offen offset:0 lds
    v_mfma_f32_16x16x32_bf16 a[120:123], v[80:83], v[40:43], a[120:123]
    v_mfma_f32_16x16x32_bf16 a[120:123], v[84:87], v[44:47], a[120:123]
    v_mfma_f32_16x16x32_bf16 a[124:127], v[88:91], v[40:43], a[124:127]
    buffer_load_dwordx4 v3, s[12:15], s48 offen offset:1024 lds
    v_mfma_f32_16x16x32_bf16 a[124:127], v[92:95], v[44:47], a[124:127]
    s_waitcnt lgkmcnt(0)
    v_mfma_f32_16x16x32_bf16 a[0:3], v[96:99], v[32:35], a[0:3]
    ds_read_b128 v[40:43], v16 offset:34816
    v_mfma_f32_16x16x32_bf16 a[0:3], v[100:103], v[36:39], a[0:3]
    ds_read_b128 v[44:47], v17 offset:34816
    v_mfma_f32_16x16x32_bf16 a[4:7], v[104:107], v[32:35], a[4:7]
    ds_read_b64_tr_b16 v[64:65], v192 offset:32768
    v_mfma_f32_16x16x32_bf16 a[4:7], v[108:111], v[36:39], a[4:7]
    buffer_load_dwordx4 v4, s[12:15], s48 offen offset:2048 lds
    v_mfma_f32_16x16x32_bf16 a[8:11], v[112:115], v[32:35], a[8:11]
    ds_read_b64_tr_b16 v[66:67], v192 offset:34816
    v_mfma_f32_16x16x32_bf16 a[8:11], v[116:119], v[36:39], a[8:11]
    buffer_load_dwordx4 v5, s[12:15], s48 offen offset:3072 lds
    v_mfma_f32_16x16x32_bf16 a[12:15], v[120:123], v[32:35], a[12:15]
    ds_read_b64_tr_b16 v[68:69], v192 offset:40960
    v_mfma_f32_16x16x32_bf16 a[12:15], v[124:127], v[36:39], a[12:15]
    s_waitcnt lgkmcnt(3)
    v_mfma_f32_16x16x32_bf16 a[16:19], v[96:99], v[40:43], a[16:19]
    ds_read_b128 v[32:35], v16 offset:36864
    v_mfma_f32_16x16x32_bf16 a[16:19], v[100:103], v[44:47], a[16:19]
    ds_read_b128 v[36:39], v17 offset:36864
    v_mfma_f32_16x16x32_bf16 a[20:23], v[104:107], v[40:43], a[20:23]
    ds_read_b64_tr_b16 v[70:71], v192 offset:43008
    v_mfma_f32_16x16x32_bf16 a[20:23], v[108:111], v[44:47], a[20:23]
    s_add_u32 m0, s40, 4096
    s_add_u32 s48, s35, 33664
    buffer_load_dwordx4 v2, s[12:15], s48 offen offset:0 lds
    v_mfma_f32_16x16x32_bf16 a[24:27], v[112:115], v[40:43], a[24:27]
    ds_read_b64_tr_b16 v[72:73], v193 offset:32768
    v_mfma_f32_16x16x32_bf16 a[24:27], v[116:119], v[44:47], a[24:27]
    v_mfma_f32_16x16x32_bf16 a[28:31], v[120:123], v[40:43], a[28:31]
    ds_read_b64_tr_b16 v[74:75], v193 offset:34816
    buffer_load_dwordx4 v3, s[12:15], s48 offen offset:1024 lds
    v_mfma_f32_16x16x32_bf16 a[28:31], v[124:127], v[44:47], a[28:31]
    s_waitcnt lgkmcnt(3)
    v_mfma_f32_16x16x32_bf16 a[32:35], v[96:99], v[32:35], a[32:35]
    ds_read_b128 v[40:43], v16 offset:38912
    v_mfma_f32_16x16x32_bf16 a[32:35], v[100:103], v[36:39], a[32:35]
    ds_read_b128 v[44:47], v17 offset:38912
    v_mfma_f32_16x16x32_bf16 a[36:39], v[104:107], v[32:35], a[36:39]
    ds_read_b64_tr_b16 v[76:77], v193 offset:40960
    v_mfma_f32_16x16x32_bf16 a[36:39], v[108:111], v[36:39], a[36:39]
    buffer_load_dwordx4 v4, s[12:15], s48 offen offset:2048 lds
    v_mfma_f32_16x16x32_bf16 a[40:43], v[112:115], v[32:35], a[40:43]
    v_mfma_f32_16x16x32_bf16 a[40:43], v[116:119], v[36:39], a[40:43]
    ds_read_b64_tr_b16 v[78:79], v193 offset:43008
    buffer_load_dwordx4 v5, s[12:15], s48 offen offset:3072 lds
    v_mfma_f32_16x16x32_bf16 a[44:47], v[120:123], v[32:35], a[44:47]
    v_mfma_f32_16x16x32_bf16 a[44:47], v[124:127], v[36:39], a[44:47]
    s_waitcnt lgkmcnt(2)
    v_mfma_f32_16x16x32_bf16 a[48:51], v[96:99], v[40:43], a[48:51]
    ds_read_b128 v[32:35], v16 offset:40960
    v_mfma_f32_16x16x32_bf16 a[48:51], v[100:103], v[44:47], a[48:51]
    ds_read_b128 v[36:39], v17 offset:40960
    v_mfma_f32_16x16x32_bf16 a[52:55], v[104:107], v[40:43], a[52:55]
    ds_read_b64_tr_b16 v[80:81], v194 offset:32768
    v_mfma_f32_16x16x32_bf16 a[52:55], v[108:111], v[44:47], a[52:55]
    s_add_u32 m0, s41, 114688
    s_add_u32 s48, s37, 524288
    buffer_load_dwordx4 v6, s[20:23], s48 offen offset:0 lds
    v_mfma_f32_16x16x32_bf16 a[56:59], v[112:115], v[40:43], a[56:59]
    ds_read_b64_tr_b16 v[82:83], v194 offset:34816
    v_mfma_f32_16x16x32_bf16 a[56:59], v[116:119], v[44:47], a[56:59]
    v_mfma_f32_16x16x32_bf16 a[60:63], v[120:123], v[40:43], a[60:63]
    ds_read_b64_tr_b16 v[84:85], v194 offset:40960
    buffer_load_dwordx4 v7, s[20:23], s48 offen offset:1024 lds
    v_mfma_f32_16x16x32_bf16 a[60:63], v[124:127], v[44:47], a[60:63]
    s_waitcnt lgkmcnt(3)
    v_mfma_f32_16x16x32_bf16 a[64:67], v[96:99], v[32:35], a[64:67]
    ds_read_b128 v[40:43], v16 offset:43008
    v_mfma_f32_16x16x32_bf16 a[64:67], v[100:103], v[36:39], a[64:67]
    ds_read_b128 v[44:47], v17 offset:43008
    v_mfma_f32_16x16x32_bf16 a[68:71], v[104:107], v[32:35], a[68:71]
    ds_read_b64_tr_b16 v[86:87], v194 offset:43008
    v_mfma_f32_16x16x32_bf16 a[68:71], v[108:111], v[36:39], a[68:71]
    buffer_load_dwordx4 v8, s[20:23], s48 offen offset:2048 lds
    v_mfma_f32_16x16x32_bf16 a[72:75], v[112:115], v[32:35], a[72:75]
    ds_read_b64_tr_b16 v[88:89], v195 offset:32768
    v_mfma_f32_16x16x32_bf16 a[72:75], v[116:119], v[36:39], a[72:75]
    buffer_load_dwordx4 v9, s[20:23], s48 offen offset:3072 lds
    v_mfma_f32_16x16x32_bf16 a[76:79], v[120:123], v[32:35], a[76:79]
    ds_read_b64_tr_b16 v[90:91], v195 offset:34816
    v_mfma_f32_16x16x32_bf16 a[76:79], v[124:127], v[36:39], a[76:79]
    s_waitcnt lgkmcnt(3)
    v_mfma_f32_16x16x32_bf16 a[80:83], v[96:99], v[40:43], a[80:83]
    ds_read_b128 v[32:35], v16 offset:45056
    v_mfma_f32_16x16x32_bf16 a[80:83], v[100:103], v[44:47], a[80:83]
    ds_read_b128 v[36:39], v17 offset:45056
    v_mfma_f32_16x16x32_bf16 a[84:87], v[104:107], v[40:43], a[84:87]
    ds_read_b64_tr_b16 v[92:93], v195 offset:40960
    v_mfma_f32_16x16x32_bf16 a[84:87], v[108:111], v[44:47], a[84:87]
    v_mfma_f32_16x16x32_bf16 a[88:91], v[112:115], v[40:43], a[88:91]
    v_mfma_f32_16x16x32_bf16 a[88:91], v[116:119], v[44:47], a[88:91]
    ds_read_b64_tr_b16 v[94:95], v195 offset:43008
    v_mfma_f32_16x16x32_bf16 a[92:95], v[120:123], v[40:43], a[92:95]
    v_mfma_f32_16x16x32_bf16 a[92:95], v[124:127], v[44:47], a[92:95]
    s_waitcnt lgkmcnt(2)
    v_mfma_f32_16x16x32_bf16 a[96:99], v[96:99], v[32:35], a[96:99]
    ds_read_b128 v[40:43], v16 offset:47104
    v_mfma_f32_16x16x32_bf16 a[96:99], v[100:103], v[36:39], a[96:99]
    ds_read_b128 v[44:47], v17 offset:47104
    v_mfma_f32_16x16x32_bf16 a[100:103], v[104:107], v[32:35], a[100:103]
    v_mfma_f32_16x16x32_bf16 a[100:103], v[108:111], v[36:39], a[100:103]
    v_mfma_f32_16x16x32_bf16 a[104:107], v[112:115], v[32:35], a[104:107]
    v_mfma_f32_16x16x32_bf16 a[104:107], v[116:119], v[36:39], a[104:107]
    v_mfma_f32_16x16x32_bf16 a[108:111], v[120:123], v[32:35], a[108:111]
    v_mfma_f32_16x16x32_bf16 a[108:111], v[124:127], v[36:39], a[108:111]
    s_waitcnt lgkmcnt(0)
    v_mfma_f32_16x16x32_bf16 a[112:115], v[96:99], v[40:43], a[112:115]
    s_waitcnt vmcnt(16)
    s_barrier
    v_mfma_f32_16x16x32_bf16 a[112:115], v[100:103], v[44:47], a[112:115]
    ds_read_b128 v[32:35], v18 offset:0
    v_mfma_f32_16x16x32_bf16 a[116:119], v[104:107], v[40:43], a[116:119]
    ds_read_b128 v[36:39], v19 offset:0
    v_mfma_f32_16x16x32_bf16 a[116:119], v[108:111], v[44:47], a[116:119]
    s_add_u32 m0, s40, 32768
    s_add_u32 s48, s35, 0
    buffer_load_dwordx4 v2, s[12:15], s48 offen offset:0 lds
    v_mfma_f32_16x16x32_bf16 a[120:123], v[112:115], v[40:43], a[120:123]
    v_mfma_f32_16x16x32_bf16 a[120:123], v[116:119], v[44:47], a[120:123]
    v_mfma_f32_16x16x32_bf16 a[124:127], v[120:123], v[40:43], a[124:127]
    buffer_load_dwordx4 v3, s[12:15], s48 offen offset:1024 lds
    v_mfma_f32_16x16x32_bf16 a[124:127], v[124:127], v[44:47], a[124:127]
    s_waitcnt lgkmcnt(0)
    v_mfma_f32_16x16x32_bf16 a[0:3], v[64:67], v[32:35], a[0:3]
    ds_read_b128 v[40:43], v18 offset:2048
    v_mfma_f32_16x16x32_bf16 a[0:3], v[68:71], v[36:39], a[0:3]
    ds_read_b128 v[44:47], v19 offset:2048
    v_mfma_f32_16x16x32_bf16 a[4:7], v[72:75], v[32:35], a[4:7]
    ds_read_b64_tr_b16 v[96:97], v192 offset:49152
    v_mfma_f32_16x16x32_bf16 a[4:7], v[76:79], v[36:39], a[4:7]
    buffer_load_dwordx4 v4, s[12:15], s48 offen offset:2048 lds
    v_mfma_f32_16x16x32_bf16 a[8:11], v[80:83], v[32:35], a[8:11]
    ds_read_b64_tr_b16 v[98:99], v192 offset:51200
    v_mfma_f32_16x16x32_bf16 a[8:11], v[84:87], v[36:39], a[8:11]
    buffer_load_dwordx4 v5, s[12:15], s48 offen offset:3072 lds
    v_mfma_f32_16x16x32_bf16 a[12:15], v[88:91], v[32:35], a[12:15]
    ds_read_b64_tr_b16 v[100:101], v192 offset:57344
    v_mfma_f32_16x16x32_bf16 a[12:15], v[92:95], v[36:39], a[12:15]
    s_waitcnt lgkmcnt(3)
    v_mfma_f32_16x16x32_bf16 a[16:19], v[64:67], v[40:43], a[16:19]
    ds_read_b128 v[32:35], v18 offset:4096
    v_mfma_f32_16x16x32_bf16 a[16:19], v[68:71], v[44:47], a[16:19]
    ds_read_b128 v[36:39], v19 offset:4096
    v_mfma_f32_16x16x32_bf16 a[20:23], v[72:75], v[40:43], a[20:23]
    ds_read_b64_tr_b16 v[102:103], v192 offset:59392
    v_mfma_f32_16x16x32_bf16 a[20:23], v[76:79], v[44:47], a[20:23]
    s_add_u32 m0, s40, 36864
    s_add_u32 s48, s35, 32768
    buffer_load_dwordx4 v2, s[12:15], s48 offen offset:0 lds
    v_mfma_f32_16x16x32_bf16 a[24:27], v[80:83], v[40:43], a[24:27]
    ds_read_b64_tr_b16 v[104:105], v193 offset:49152
    v_mfma_f32_16x16x32_bf16 a[24:27], v[84:87], v[44:47], a[24:27]
    v_mfma_f32_16x16x32_bf16 a[28:31], v[88:91], v[40:43], a[28:31]
    ds_read_b64_tr_b16 v[106:107], v193 offset:51200
    buffer_load_dwordx4 v3, s[12:15], s48 offen offset:1024 lds
    v_mfma_f32_16x16x32_bf16 a[28:31], v[92:95], v[44:47], a[28:31]
    s_waitcnt lgkmcnt(3)
    v_mfma_f32_16x16x32_bf16 a[32:35], v[64:67], v[32:35], a[32:35]
    ds_read_b128 v[40:43], v18 offset:6144
    v_mfma_f32_16x16x32_bf16 a[32:35], v[68:71], v[36:39], a[32:35]
    ds_read_b128 v[44:47], v19 offset:6144
    v_mfma_f32_16x16x32_bf16 a[36:39], v[72:75], v[32:35], a[36:39]
    ds_read_b64_tr_b16 v[108:109], v193 offset:57344
    v_mfma_f32_16x16x32_bf16 a[36:39], v[76:79], v[36:39], a[36:39]
    buffer_load_dwordx4 v4, s[12:15], s48 offen offset:2048 lds
    v_mfma_f32_16x16x32_bf16 a[40:43], v[80:83], v[32:35], a[40:43]
    v_mfma_f32_16x16x32_bf16 a[40:43], v[84:87], v[36:39], a[40:43]
    ds_read_b64_tr_b16 v[110:111], v193 offset:59392
    buffer_load_dwordx4 v5, s[12:15], s48 offen offset:3072 lds
    v_mfma_f32_16x16x32_bf16 a[44:47], v[88:91], v[32:35], a[44:47]
    v_mfma_f32_16x16x32_bf16 a[44:47], v[92:95], v[36:39], a[44:47]
    s_waitcnt lgkmcnt(2)
    v_mfma_f32_16x16x32_bf16 a[48:51], v[64:67], v[40:43], a[48:51]
    ds_read_b128 v[32:35], v18 offset:8192
    v_mfma_f32_16x16x32_bf16 a[48:51], v[68:71], v[44:47], a[48:51]
    ds_read_b128 v[36:39], v19 offset:8192
    v_mfma_f32_16x16x32_bf16 a[52:55], v[72:75], v[40:43], a[52:55]
    ds_read_b64_tr_b16 v[112:113], v194 offset:49152
    v_mfma_f32_16x16x32_bf16 a[52:55], v[76:79], v[44:47], a[52:55]
    s_add_u32 m0, s41, 131072
    s_add_u32 s48, s37, 1048576
    buffer_load_dwordx4 v6, s[20:23], s48 offen offset:0 lds
    v_mfma_f32_16x16x32_bf16 a[56:59], v[80:83], v[40:43], a[56:59]
    ds_read_b64_tr_b16 v[114:115], v194 offset:51200
    v_mfma_f32_16x16x32_bf16 a[56:59], v[84:87], v[44:47], a[56:59]
    v_mfma_f32_16x16x32_bf16 a[60:63], v[88:91], v[40:43], a[60:63]
    ds_read_b64_tr_b16 v[116:117], v194 offset:57344
    buffer_load_dwordx4 v7, s[20:23], s48 offen offset:1024 lds
    v_mfma_f32_16x16x32_bf16 a[60:63], v[92:95], v[44:47], a[60:63]
    s_waitcnt lgkmcnt(3)
    v_mfma_f32_16x16x32_bf16 a[64:67], v[64:67], v[32:35], a[64:67]
    ds_read_b128 v[40:43], v18 offset:10240
    v_mfma_f32_16x16x32_bf16 a[64:67], v[68:71], v[36:39], a[64:67]
    ds_read_b128 v[44:47], v19 offset:10240
    v_mfma_f32_16x16x32_bf16 a[68:71], v[72:75], v[32:35], a[68:71]
    ds_read_b64_tr_b16 v[118:119], v194 offset:59392
    v_mfma_f32_16x16x32_bf16 a[68:71], v[76:79], v[36:39], a[68:71]
    buffer_load_dwordx4 v8, s[20:23], s48 offen offset:2048 lds
    v_mfma_f32_16x16x32_bf16 a[72:75], v[80:83], v[32:35], a[72:75]
    ds_read_b64_tr_b16 v[120:121], v195 offset:49152
    v_mfma_f32_16x16x32_bf16 a[72:75], v[84:87], v[36:39], a[72:75]
    buffer_load_dwordx4 v9, s[20:23], s48 offen offset:3072 lds
    v_mfma_f32_16x16x32_bf16 a[76:79], v[88:91], v[32:35], a[76:79]
    ds_read_b64_tr_b16 v[122:123], v195 offset:51200
    v_mfma_f32_16x16x32_bf16 a[76:79], v[92:95], v[36:39], a[76:79]
    s_waitcnt lgkmcnt(3)
    v_mfma_f32_16x16x32_bf16 a[80:83], v[64:67], v[40:43], a[80:83]
    ds_read_b128 v[32:35], v18 offset:12288
    v_mfma_f32_16x16x32_bf16 a[80:83], v[68:71], v[44:47], a[80:83]
    ds_read_b128 v[36:39], v19 offset:12288
    v_mfma_f32_16x16x32_bf16 a[84:87], v[72:75], v[40:43], a[84:87]
    ds_read_b64_tr_b16 v[124:125], v195 offset:57344
    v_mfma_f32_16x16x32_bf16 a[84:87], v[76:79], v[44:47], a[84:87]
    v_mfma_f32_16x16x32_bf16 a[88:91], v[80:83], v[40:43], a[88:91]
    v_mfma_f32_16x16x32_bf16 a[88:91], v[84:87], v[44:47], a[88:91]
    ds_read_b64_tr_b16 v[126:127], v195 offset:59392
    v_mfma_f32_16x16x32_bf16 a[92:95], v[88:91], v[40:43], a[92:95]
    v_mfma_f32_16x16x32_bf16 a[92:95], v[92:95], v[44:47], a[92:95]
    s_waitcnt lgkmcnt(2)
    v_mfma_f32_16x16x32_bf16 a[96:99], v[64:67], v[32:35], a[96:99]
    ds_read_b128 v[40:43], v18 offset:14336
    v_mfma_f32_16x16x32_bf16 a[96:99], v[68:71], v[36:39], a[96:99]
    ds_read_b128 v[44:47], v19 offset:14336
    v_mfma_f32_16x16x32_bf16 a[100:103], v[72:75], v[32:35], a[100:103]
    v_mfma_f32_16x16x32_bf16 a[100:103], v[76:79], v[36:39], a[100:103]
    v_mfma_f32_16x16x32_bf16 a[104:107], v[80:83], v[32:35], a[104:107]
    v_mfma_f32_16x16x32_bf16 a[104:107], v[84:87], v[36:39], a[104:107]
    v_mfma_f32_16x16x32_bf16 a[108:111], v[88:91], v[32:35], a[108:111]
    v_mfma_f32_16x16x32_bf16 a[108:111], v[92:95], v[36:39], a[108:111]
    s_waitcnt lgkmcnt(0)
    v_mfma_f32_16x16x32_bf16 a[112:115], v[64:67], v[40:43], a[112:115]
    s_waitcnt vmcnt(16)
    s_barrier
    v_mfma_f32_16x16x32_bf16 a[112:115], v[68:71], v[44:47], a[112:115]
    ds_read_b128 v[32:35], v16 offset:0
    v_mfma_f32_16x16x32_bf16 a[116:119], v[72:75], v[40:43], a[116:119]
    ds_read_b128 v[36:39], v17 offset:0
    v_mfma_f32_16x16x32_bf16 a[116:119], v[76:79], v[44:47], a[116:119]
    s_add_u32 m0, s40, 65536
    s_add_u32 s48, s35, 128
    buffer_load_dwordx4 v2, s[12:15], s48 offen offset:0 lds
    v_mfma_f32_16x16x32_bf16 a[120:123], v[80:83], v[40:43], a[120:123]
    v_mfma_f32_16x16x32_bf16 a[120:123], v[84:87], v[44:47], a[120:123]
    v_mfma_f32_16x16x32_bf16 a[124:127], v[88:91], v[40:43], a[124:127]
    buffer_load_dwordx4 v3, s[12:15], s48 offen offset:1024 lds
    v_mfma_f32_16x16x32_bf16 a[124:127], v[92:95], v[44:47], a[124:127]
    s_waitcnt lgkmcnt(0)
    v_mfma_f32_16x16x32_bf16 a[0:3], v[96:99], v[32:35], a[0:3]
    ds_read_b128 v[40:43], v16 offset:2048
    v_mfma_f32_16x16x32_bf16 a[0:3], v[100:103], v[36:39], a[0:3]
    ds_read_b128 v[44:47], v17 offset:2048
    v_mfma_f32_16x16x32_bf16 a[4:7], v[104:107], v[32:35], a[4:7]
    ds_read_b64_tr_b16 v[64:65], v192 offset:0
    v_mfma_f32_16x16x32_bf16 a[4:7], v[108:111], v[36:39], a[4:7]
    buffer_load_dwordx4 v4, s[12:15], s48 offen offset:2048 lds
    v_mfma_f32_16x16x32_bf16 a[8:11], v[112:115], v[32:35], a[8:11]
    ds_read_b64_tr_b16 v[66:67], v192 offset:2048
    v_mfma_f32_16x16x32_bf16 a[8:11], v[116:119], v[36:39], a[8:11]
    buffer_load_dwordx4 v5, s[12:15], s48 offen offset:3072 lds
    v_mfma_f32_16x16x32_bf16 a[12:15], v[120:123], v[32:35], a[12:15]
    ds_read_b64_tr_b16 v[68:69], v192 offset:8192
    v_mfma_f32_16x16x32_bf16 a[12:15], v[124:127], v[36:39], a[12:15]
    s_waitcnt lgkmcnt(3)
    v_mfma_f32_16x16x32_bf16 a[16:19], v[96:99], v[40:43], a[16:19]
    ds_read_b128 v[32:35], v16 offset:4096
    v_mfma_f32_16x16x32_bf16 a[16:19], v[100:103], v[44:47], a[16:19]
    ds_read_b128 v[36:39], v17 offset:4096
    v_mfma_f32_16x16x32_bf16 a[20:23], v[104:107], v[40:43], a[20:23]
    ds_read_b64_tr_b16 v[70:71], v192 offset:10240
    v_mfma_f32_16x16x32_bf16 a[20:23], v[108:111], v[44:47], a[20:23]
    s_add_u32 m0, s40, 69632
    s_add_u32 s48, s35, 32896
    buffer_load_dwordx4 v2, s[12:15], s48 offen offset:0 lds
    v_mfma_f32_16x16x32_bf16 a[24:27], v[112:115], v[40:43], a[24:27]
    ds_read_b64_tr_b16 v[72:73], v193 offset:0
    v_mfma_f32_16x16x32_bf16 a[24:27], v[116:119], v[44:47], a[24:27]
    v_mfma_f32_16x16x32_bf16 a[28:31], v[120:123], v[40:43], a[28:31]
    ds_read_b64_tr_b16 v[74:75], v193 offset:2048
    buffer_load_dwordx4 v3, s[12:15], s48 offen offset:1024 lds
    v_mfma_f32_16x16x32_bf16 a[28:31], v[124:127], v[44:47], a[28:31]
    s_waitcnt lgkmcnt(3)
    v_mfma_f32_16x16x32_bf16 a[32:35], v[96:99], v[32:35], a[32:35]
    ds_read_b128 v[40:43], v16 offset:6144
    v_mfma_f32_16x16x32_bf16 a[32:35], v[100:103], v[36:39], a[32:35]
    ds_read_b128 v[44:47], v17 offset:6144
    v_mfma_f32_16x16x32_bf16 a[36:39], v[104:107], v[32:35], a[36:39]
    ds_read_b64_tr_b16 v[76:77], v193 offset:8192
    v_mfma_f32_16x16x32_bf16 a[36:39], v[108:111], v[36:39], a[36:39]
    buffer_load_dwordx4 v4, s[12:15], s48 offen offset:2048 lds
    v_mfma_f32_16x16x32_bf16 a[40:43], v[112:115], v[32:35], a[40:43]
    v_mfma_f32_16x16x32_bf16 a[40:43], v[116:119], v[36:39], a[40:43]
    ds_read_b64_tr_b16 v[78:79], v193 offset:10240
    buffer_load_dwordx4 v5, s[12:15], s48 offen offset:3072 lds
    v_mfma_f32_16x16x32_bf16 a[44:47], v[120:123], v[32:35], a[44:47]
    v_mfma_f32_16x16x32_bf16 a[44:47], v[124:127], v[36:39], a[44:47]
    s_waitcnt lgkmcnt(2)
    v_mfma_f32_16x16x32_bf16 a[48:51], v[96:99], v[40:43], a[48:51]
    ds_read_b128 v[32:35], v16 offset:8192
    v_mfma_f32_16x16x32_bf16 a[48:51], v[100:103], v[44:47], a[48:51]
    ds_read_b128 v[36:39], v17 offset:8192
    v_mfma_f32_16x16x32_bf16 a[52:55], v[104:107], v[40:43], a[52:55]
    ds_read_b64_tr_b16 v[80:81], v194 offset:0
    v_mfma_f32_16x16x32_bf16 a[52:55], v[108:111], v[44:47], a[52:55]
    s_add_u32 m0, s41, 147456
    s_add_u32 s48, s37, 1572864
    buffer_load_dwordx4 v6, s[20:23], s48 offen offset:0 lds
    v_mfma_f32_16x16x32_bf16 a[56:59], v[112:115], v[40:43], a[56:59]
    ds_read_b64_tr_b16 v[82:83], v194 offset:2048
    v_mfma_f32_16x16x32_bf16 a[56:59], v[116:119], v[44:47], a[56:59]
    v_mfma_f32_16x16x32_bf16 a[60:63], v[120:123], v[40:43], a[60:63]
    ds_read_b64_tr_b16 v[84:85], v194 offset:8192
    buffer_load_dwordx4 v7, s[20:23], s48 offen offset:1024 lds
    v_mfma_f32_16x16x32_bf16 a[60:63], v[124:127], v[44:47], a[60:63]
    s_waitcnt lgkmcnt(3)
    v_mfma_f32_16x16x32_bf16 a[64:67], v[96:99], v[32:35], a[64:67]
    ds_read_b128 v[40:43], v16 offset:10240
    v_mfma_f32_16x16x32_bf16 a[64:67], v[100:103], v[36:39], a[64:67]
    ds_read_b128 v[44:47], v17 offset:10240
    v_mfma_f32_16x16x32_bf16 a[68:71], v[104:107], v[32:35], a[68:71]
    ds_read_b64_tr_b16 v[86:87], v194 offset:10240
    v_mfma_f32_16x16x32_bf16 a[68:71], v[108:111], v[36:39], a[68:71]
    buffer_load_dwordx4 v8, s[20:23], s48 offen offset:2048 lds
    v_mfma_f32_16x16x32_bf16 a[72:75], v[112:115], v[32:35], a[72:75]
    ds_read_b64_tr_b16 v[88:89], v195 offset:0
    v_mfma_f32_16x16x32_bf16 a[72:75], v[116:119], v[36:39], a[72:75]
    buffer_load_dwordx4 v9, s[20:23], s48 offen offset:3072 lds
    v_mfma_f32_16x16x32_bf16 a[76:79], v[120:123], v[32:35], a[76:79]
    ds_read_b64_tr_b16 v[90:91], v195 offset:2048
    v_mfma_f32_16x16x32_bf16 a[76:79], v[124:127], v[36:39], a[76:79]
    s_waitcnt lgkmcnt(3)
    v_mfma_f32_16x16x32_bf16 a[80:83], v[96:99], v[40:43], a[80:83]
    ds_read_b128 v[32:35], v16 offset:12288
    v_mfma_f32_16x16x32_bf16 a[80:83], v[100:103], v[44:47], a[80:83]
    ds_read_b128 v[36:39], v17 offset:12288
    v_mfma_f32_16x16x32_bf16 a[84:87], v[104:107], v[40:43], a[84:87]
    ds_read_b64_tr_b16 v[92:93], v195 offset:8192
    v_mfma_f32_16x16x32_bf16 a[84:87], v[108:111], v[44:47], a[84:87]
    v_mfma_f32_16x16x32_bf16 a[88:91], v[112:115], v[40:43], a[88:91]
    v_mfma_f32_16x16x32_bf16 a[88:91], v[116:119], v[44:47], a[88:91]
    ds_read_b64_tr_b16 v[94:95], v195 offset:10240
    v_mfma_f32_16x16x32_bf16 a[92:95], v[120:123], v[40:43], a[92:95]
    v_mfma_f32_16x16x32_bf16 a[92:95], v[124:127], v[44:47], a[92:95]
    s_waitcnt lgkmcnt(2)
    v_mfma_f32_16x16x32_bf16 a[96:99], v[96:99], v[32:35], a[96:99]
    ds_read_b128 v[40:43], v16 offset:14336
    v_mfma_f32_16x16x32_bf16 a[96:99], v[100:103], v[36:39], a[96:99]
    ds_read_b128 v[44:47], v17 offset:14336
    v_mfma_f32_16x16x32_bf16 a[100:103], v[104:107], v[32:35], a[100:103]
    v_mfma_f32_16x16x32_bf16 a[100:103], v[108:111], v[36:39], a[100:103]
    v_mfma_f32_16x16x32_bf16 a[104:107], v[112:115], v[32:35], a[104:107]
    v_mfma_f32_16x16x32_bf16 a[104:107], v[116:119], v[36:39], a[104:107]
    v_mfma_f32_16x16x32_bf16 a[108:111], v[120:123], v[32:35], a[108:111]
    v_mfma_f32_16x16x32_bf16 a[108:111], v[124:127], v[36:39], a[108:111]
    s_waitcnt lgkmcnt(0)
    v_mfma_f32_16x16x32_bf16 a[112:115], v[96:99], v[40:43], a[112:115]
    s_waitcnt vmcnt(16)
    s_barrier
    v_mfma_f32_16x16x32_bf16 a[112:115], v[100:103], v[44:47], a[112:115]
    ds_read_b128 v[32:35], v16 offset:32768
    v_mfma_f32_16x16x32_bf16 a[116:119], v[104:107], v[40:43], a[116:119]
    ds_read_b128 v[36:39], v17 offset:32768
    v_mfma_f32_16x16x32_bf16 a[116:119], v[108:111], v[44:47], a[116:119]
    s_add_u32 m0, s40, 0
    s_add_u32 s48, s35, 256
    buffer_load_dwordx4 v2, s[12:15], s48 offen offset:0 lds
    v_mfma_f32_16x16x32_bf16 a[120:123], v[112:115], v[40:43], a[120:123]
    v_mfma_f32_16x16x32_bf16 a[120:123], v[116:119], v[44:47], a[120:123]
    v_mfma_f32_16x16x32_bf16 a[124:127], v[120:123], v[40:43], a[124:127]
    buffer_load_dwordx4 v3, s[12:15], s48 offen offset:1024 lds
    v_mfma_f32_16x16x32_bf16 a[124:127], v[124:127], v[44:47], a[124:127]
    s_waitcnt lgkmcnt(0)
    v_mfma_f32_16x16x32_bf16 a[128:131], v[32:35], v[64:67], 0
    ds_read_b128 v[40:43], v16 offset:34816
    v_mfma_f32_16x16x32_bf16 a[128:131], v[36:39], v[68:71], a[128:131]
    ds_read_b128 v[44:47], v17 offset:34816
    v_mfma_f32_16x16x32_bf16 a[132:135], v[32:35], v[72:75], 0
    ds_read_b64_tr_b16 v[96:97], v192 offset:16384
    v_mfma_f32_16x16x32_bf16 a[132:135], v[36:39], v[76:79], a[132:135]
    buffer_load_dwordx4 v4, s[12:15], s48 offen offset:2048 lds
    v_mfma_f32_16x16x32_bf16 a[136:139], v[32:35], v[80:83], 0
    ds_read_b64_tr_b16 v[98:99], v192 offset:18432
    v_mfma_f32_16x16x32_bf16 a[136:139], v[36:39], v[84:87], a[136:139]
    buffer_load_dwordx4 v5, s[12:15], s48 offen offset:3072 lds
    v_mfma_f32_16x16x32_bf16 a[140:143], v[32:35], v[88:91], 0
    ds_read_b64_tr_b16 v[100:101], v192 offset:24576
    v_mfma_f32_16x16x32_bf16 a[140:143], v[36:39], v[92:95], a[140:143]
    s_waitcnt lgkmcnt(3)
    v_mfma_f32_16x16x32_bf16 a[144:147], v[40:43], v[64:67], 0
    ds_read_b128 v[32:35], v16 offset:36864
    v_mfma_f32_16x16x32_bf16 a[144:147], v[44:47], v[68:71], a[144:147]
    ds_read_b128 v[36:39], v17 offset:36864
    v_accvgpr_read_b32 v208, a0
    v_mfma_f32_16x16x32_bf16 a[148:151], v[40:43], v[72:75], 0
    ds_read_b64_tr_b16 v[102:103], v192 offset:26624
    v_accvgpr_read_b32 v209, a1
    v_mfma_f32_16x16x32_bf16 a[148:151], v[44:47], v[76:79], a[148:151]
    s_add_u32 m0, s40, 4096
    s_add_u32 s48, s35, 33024
    buffer_load_dwordx4 v2, s[12:15], s48 offen offset:0 lds
    v_accvgpr_read_b32 v210, a2
    v_mfma_f32_16x16x32_bf16 a[152:155], v[40:43], v[80:83], 0
    ds_read_b64_tr_b16 v[104:105], v193 offset:16384
    v_accvgpr_read_b32 v211, a3
    v_mfma_f32_16x16x32_bf16 a[152:155], v[44:47], v[84:87], a[152:155]
    v_accvgpr_read_b32 v212, a4
    v_mfma_f32_16x16x32_bf16 a[156:159], v[40:43], v[88:91], 0
    ds_read_b64_tr_b16 v[106:107], v193 offset:18432
    buffer_load_dwordx4 v3, s[12:15], s48 offen offset:1024 lds
    v_accvgpr_read_b32 v213, a5
    v_mfma_f32_16x16x32_bf16 a[156:159], v[44:47], v[92:95], a[156:159]
    s_waitcnt lgkmcnt(3)
    v_mfma_f32_16x16x32_bf16 a[160:163], v[32:35], v[64:67], 0
    ds_read_b128 v[40:43], v16 offset:38912
    v_mfma_f32_16x16x32_bf16 a[160:163], v[36:39], v[68:71], a[160:163]
    ds_read_b128 v[44:47], v17 offset:38912
    v_accvgpr_read_b32 v214, a6
    v_mfma_f32_16x16x32_bf16 a[164:167], v[32:35], v[72:75], 0
    ds_read_b64_tr_b16 v[108:109], v193 offset:24576
    v_accvgpr_read_b32 v215, a7
    v_mfma_f32_16x16x32_bf16 a[164:167], v[36:39], v[76:79], a[164:167]
    buffer_load_dwordx4 v4, s[12:15], s48 offen offset:2048 lds
    v_cvt_pk_bf16_f32 v216, v208, v209
    v_mfma_f32_16x16x32_bf16 a[168:171], v[32:35], v[80:83], 0
    v_cvt_pk_bf16_f32 v217, v210, v211
    v_mfma_f32_16x16x32_bf16 a[168:171], v[36:39], v[84:87], a[168:171]
    ds_read_b64_tr_b16 v[110:111], v193 offset:26624
    buffer_load_dwordx4 v5, s[12:15], s48 offen offset:3072 lds
    v_cvt_pk_bf16_f32 v218, v212, v213
    v_mfma_f32_16x16x32_bf16 a[172:175], v[32:35], v[88:91], 0
    v_cvt_pk_bf16_f32 v219, v214, v215
    v_mfma_f32_16x16x32_bf16 a[172:175], v[36:39], v[92:95], a[172:175]
    s_waitcnt lgkmcnt(2)
    v_mfma_f32_16x16x32_bf16 a[176:179], v[40:43], v[64:67], 0
    ds_read_b128 v[32:35], v16 offset:40960
    buffer_store_dwordx4 v[216:219], v15, s[8:11], s84 offen offset:0 sc0 sc1
    v_mfma_f32_16x16x32_bf16 a[176:179], v[44:47], v[68:71], a[176:179]
    ds_read_b128 v[36:39], v17 offset:40960
    v_mfma_f32_16x16x32_bf16 a[180:183], v[40:43], v[72:75], 0
    ds_read_b64_tr_b16 v[112:113], v194 offset:16384
    v_mfma_f32_16x16x32_bf16 a[180:183], v[44:47], v[76:79], a[180:183]
    s_add_u32 m0, s41, 98304
    s_add_u32 s48, s37, 2097152
    buffer_load_dwordx4 v6, s[20:23], s48 offen offset:0 lds
    v_mfma_f32_16x16x32_bf16 a[184:187], v[40:43], v[80:83], 0
    ds_read_b64_tr_b16 v[114:115], v194 offset:18432
    v_mfma_f32_16x16x32_bf16 a[184:187], v[44:47], v[84:87], a[184:187]
    v_mfma_f32_16x16x32_bf16 a[188:191], v[40:43], v[88:91], 0
    ds_read_b64_tr_b16 v[116:117], v194 offset:24576
    buffer_load_dwordx4 v7, s[20:23], s48 offen offset:1024 lds
    v_mfma_f32_16x16x32_bf16 a[188:191], v[44:47], v[92:95], a[188:191]
    s_waitcnt lgkmcnt(3)
    v_mfma_f32_16x16x32_bf16 a[192:195], v[32:35], v[64:67], 0
    ds_read_b128 v[40:43], v16 offset:43008
    v_mfma_f32_16x16x32_bf16 a[192:195], v[36:39], v[68:71], a[192:195]
    ds_read_b128 v[44:47], v17 offset:43008
    v_accvgpr_read_b32 v220, a8
    v_mfma_f32_16x16x32_bf16 a[196:199], v[32:35], v[72:75], 0
    ds_read_b64_tr_b16 v[118:119], v194 offset:26624
    v_accvgpr_read_b32 v221, a9
    v_mfma_f32_16x16x32_bf16 a[196:199], v[36:39], v[76:79], a[196:199]
    buffer_load_dwordx4 v8, s[20:23], s48 offen offset:2048 lds
    v_accvgpr_read_b32 v222, a10
    v_mfma_f32_16x16x32_bf16 a[200:203], v[32:35], v[80:83], 0
    ds_read_b64_tr_b16 v[120:121], v195 offset:16384
    v_accvgpr_read_b32 v223, a11
    v_mfma_f32_16x16x32_bf16 a[200:203], v[36:39], v[84:87], a[200:203]
    buffer_load_dwordx4 v9, s[20:23], s48 offen offset:3072 lds
    v_accvgpr_read_b32 v224, a12
    v_mfma_f32_16x16x32_bf16 a[204:207], v[32:35], v[88:91], 0
    ds_read_b64_tr_b16 v[122:123], v195 offset:18432
    v_accvgpr_read_b32 v225, a13
    v_mfma_f32_16x16x32_bf16 a[204:207], v[36:39], v[92:95], a[204:207]
    s_waitcnt lgkmcnt(3)
    v_mfma_f32_16x16x32_bf16 a[208:211], v[40:43], v[64:67], 0
    ds_read_b128 v[32:35], v16 offset:45056
    v_mfma_f32_16x16x32_bf16 a[208:211], v[44:47], v[68:71], a[208:211]
    ds_read_b128 v[36:39], v17 offset:45056
    v_accvgpr_read_b32 v226, a14
    v_mfma_f32_16x16x32_bf16 a[212:215], v[40:43], v[72:75], 0
    ds_read_b64_tr_b16 v[124:125], v195 offset:24576
    v_accvgpr_read_b32 v227, a15
    v_mfma_f32_16x16x32_bf16 a[212:215], v[44:47], v[76:79], a[212:215]
    v_cvt_pk_bf16_f32 v228, v220, v221
    v_mfma_f32_16x16x32_bf16 a[216:219], v[40:43], v[80:83], 0
    v_cvt_pk_bf16_f32 v229, v222, v223
    v_mfma_f32_16x16x32_bf16 a[216:219], v[44:47], v[84:87], a[216:219]
    ds_read_b64_tr_b16 v[126:127], v195 offset:26624
    v_cvt_pk_bf16_f32 v230, v224, v225
    v_mfma_f32_16x16x32_bf16 a[220:223], v[40:43], v[88:91], 0
    v_cvt_pk_bf16_f32 v231, v226, v227
    v_mfma_f32_16x16x32_bf16 a[220:223], v[44:47], v[92:95], a[220:223]
    s_waitcnt lgkmcnt(2)
    v_mfma_f32_16x16x32_bf16 a[224:227], v[32:35], v[64:67], 0
    ds_read_b128 v[40:43], v16 offset:47104
    buffer_store_dwordx4 v[228:231], v15, s[8:11], s84 offen offset:2048 sc0 sc1
    v_mfma_f32_16x16x32_bf16 a[224:227], v[36:39], v[68:71], a[224:227]
    ds_read_b128 v[44:47], v17 offset:47104
    v_mfma_f32_16x16x32_bf16 a[228:231], v[32:35], v[72:75], 0
    v_mfma_f32_16x16x32_bf16 a[228:231], v[36:39], v[76:79], a[228:231]
    v_mfma_f32_16x16x32_bf16 a[232:235], v[32:35], v[80:83], 0
    v_mfma_f32_16x16x32_bf16 a[232:235], v[36:39], v[84:87], a[232:235]
    v_mfma_f32_16x16x32_bf16 a[236:239], v[32:35], v[88:91], 0
    v_mfma_f32_16x16x32_bf16 a[236:239], v[36:39], v[92:95], a[236:239]
    s_waitcnt lgkmcnt(0)
    v_mfma_f32_16x16x32_bf16 a[240:243], v[40:43], v[64:67], 0
    s_waitcnt vmcnt(18)
    s_barrier
    v_mfma_f32_16x16x32_bf16 a[240:243], v[44:47], v[68:71], a[240:243]
    ds_read_b128 v[32:35], v18 offset:0
    v_accvgpr_read_b32 v208, a16
    v_mfma_f32_16x16x32_bf16 a[244:247], v[40:43], v[72:75], 0
    ds_read_b128 v[36:39], v19 offset:0
    v_accvgpr_read_b32 v209, a17
    v_mfma_f32_16x16x32_bf16 a[244:247], v[44:47], v[76:79], a[244:247]
    s_add_u32 m0, s40, 32768
    s_add_u32 s48, s35, 384
    buffer_load_dwordx4 v2, s[12:15], s48 offen offset:0 lds
    v_accvgpr_read_b32 v210, a18
    v_mfma_f32_16x16x32_bf16 a[248:251], v[40:43], v[80:83], 0
    v_accvgpr_read_b32 v211, a19
    v_mfma_f32_16x16x32_bf16 a[248:251], v[44:47], v[84:87], a[248:251]
    v_accvgpr_read_b32 v212, a20
    v_mfma_f32_16x16x32_bf16 a[252:255], v[40:43], v[88:91], 0
    buffer_load_dwordx4 v3, s[12:15], s48 offen offset:1024 lds
    v_accvgpr_read_b32 v213, a21
    v_mfma_f32_16x16x32_bf16 a[252:255], v[44:47], v[92:95], a[252:255]
    s_waitcnt lgkmcnt(0)
    v_mfma_f32_16x16x32_bf16 a[128:131], v[32:35], v[96:99], a[128:131]
    ds_read_b128 v[40:43], v18 offset:2048
    v_mfma_f32_16x16x32_bf16 a[128:131], v[36:39], v[100:103], a[128:131]
    ds_read_b128 v[44:47], v19 offset:2048
    v_accvgpr_read_b32 v214, a22
    v_mfma_f32_16x16x32_bf16 a[132:135], v[32:35], v[104:107], a[132:135]
    ds_read_b64_tr_b16 v[64:65], v192 offset:32768
    v_accvgpr_read_b32 v215, a23
    v_mfma_f32_16x16x32_bf16 a[132:135], v[36:39], v[108:111], a[132:135]
    buffer_load_dwordx4 v4, s[12:15], s48 offen offset:2048 lds
    v_cvt_pk_bf16_f32 v216, v208, v209
    v_mfma_f32_16x16x32_bf16 a[136:139], v[32:35], v[112:115], a[136:139]
    ds_read_b64_tr_b16 v[66:67], v192 offset:34816
    v_cvt_pk_bf16_f32 v217, v210, v211
    v_mfma_f32_16x16x32_bf16 a[136:139], v[36:39], v[116:119], a[136:139]
    buffer_load_dwordx4 v5, s[12:15], s48 offen offset:3072 lds
    v_cvt_pk_bf16_f32 v218, v212, v213
    v_mfma_f32_16x16x32_bf16 a[140:143], v[32:35], v[120:123], a[140:143]
    ds_read_b64_tr_b16 v[68:69], v192 offset:40960
    v_cvt_pk_bf16_f32 v219, v214, v215
    v_mfma_f32_16x16x32_bf16 a[140:143], v[36:39], v[124:127], a[140:143]
    s_waitcnt lgkmcnt(3)
    v_mfma_f32_16x16x32_bf16 a[144:147], v[40:43], v[96:99], a[144:147]
    ds_read_b128 v[32:35], v18 offset:4096
    buffer_store_dwordx4 v[216:219], v15, s[8:11], s84 offen offset:128 sc0 sc1
    v_mfma_f32_16x16x32_bf16 a[144:147], v[44:47], v[100:103], a[144:147]
    ds_read_b128 v[36:39], v19 offset:4096
    v_mfma_f32_16x16x32_bf16 a[148:151], v[40:43], v[104:107], a[148:151]
    ds_read_b64_tr_b16 v[70:71], v192 offset:43008
    v_mfma_f32_16x16x32_bf16 a[148:151], v[44:47], v[108:111], a[148:151]
    s_add_u32 m0, s40, 36864
    s_add_u32 s48, s35, 33152
    buffer_load_dwordx4 v2, s[12:15], s48 offen offset:0 lds
    v_mfma_f32_16x16x32_bf16 a[152:155], v[40:43], v[112:115], a[152:155]
    ds_read_b64_tr_b16 v[72:73], v193 offset:32768
    v_mfma_f32_16x16x32_bf16 a[152:155], v[44:47], v[116:119], a[152:155]
    v_mfma_f32_16x16x32_bf16 a[156:159], v[40:43], v[120:123], a[156:159]
    ds_read_b64_tr_b16 v[74:75], v193 offset:34816
    buffer_load_dwordx4 v3, s[12:15], s48 offen offset:1024 lds
    v_mfma_f32_16x16x32_bf16 a[156:159], v[44:47], v[124:127], a[156:159]
    s_waitcnt lgkmcnt(3)
    v_mfma_f32_16x16x32_bf16 a[160:163], v[32:35], v[96:99], a[160:163]
    ds_read_b128 v[40:43], v18 offset:6144
    v_mfma_f32_16x16x32_bf16 a[160:163], v[36:39], v[100:103], a[160:163]
    ds_read_b128 v[44:47], v19 offset:6144
    v_accvgpr_read_b32 v220, a24
    v_mfma_f32_16x16x32_bf16 a[164:167], v[32:35], v[104:107], a[164:167]
    ds_read_b64_tr_b16 v[76:77], v193 offset:40960
    v_accvgpr_read_b32 v221, a25
    v_mfma_f32_16x16x32_bf16 a[164:167], v[36:39], v[108:111], a[164:167]
    buffer_load_dwordx4 v4, s[12:15], s48 offen offset:2048 lds
    v_accvgpr_read_b32 v222, a26
    v_mfma_f32_16x16x32_bf16 a[168:171], v[32:35], v[112:115], a[168:171]
    v_accvgpr_read_b32 v223, a27
    v_mfma_f32_16x16x32_bf16 a[168:171], v[36:39], v[116:119], a[168:171]
    ds_read_b64_tr_b16 v[78:79], v193 offset:43008
    buffer_load_dwordx4 v5, s[12:15], s48 offen offset:3072 lds
    v_accvgpr_read_b32 v224, a28
    v_mfma_f32_16x16x32_bf16 a[172:175], v[32:35], v[120:123], a[172:175]
    v_accvgpr_read_b32 v225, a29
    v_mfma_f32_16x16x32_bf16 a[172:175], v[36:39], v[124:127], a[172:175]
    s_waitcnt lgkmcnt(2)
    v_mfma_f32_16x16x32_bf16 a[176:179], v[40:43], v[96:99], a[176:179]
    ds_read_b128 v[32:35], v18 offset:8192
    v_mfma_f32_16x16x32_bf16 a[176:179], v[44:47], v[100:103], a[176:179]
    ds_read_b128 v[36:39], v19 offset:8192
    v_accvgpr_read_b32 v226, a30
    v_mfma_f32_16x16x32_bf16 a[180:183], v[40:43], v[104:107], a[180:183]
    ds_read_b64_tr_b16 v[80:81], v194 offset:32768
    v_accvgpr_read_b32 v227, a31
    v_mfma_f32_16x16x32_bf16 a[180:183], v[44:47], v[108:111], a[180:183]
    s_add_u32 m0, s41, 114688
    s_add_u32 s48, s37, 2621440
    buffer_load_dwordx4 v6, s[20:23], s48 offen offset:0 lds
    v_cvt_pk_bf16_f32 v228, v220, v221
    v_mfma_f32_16x16x32_bf16 a[184:187], v[40:43], v[112:115], a[184:187]
    ds_read_b64_tr_b16 v[82:83], v194 offset:34816
    v_cvt_pk_bf16_f32 v229, v222, v223
    v_mfma_f32_16x16x32_bf16 a[184:187], v[44:47], v[116:119], a[184:187]
    v_cvt_pk_bf16_f32 v230, v224, v225
    v_mfma_f32_16x16x32_bf16 a[188:191], v[40:43], v[120:123], a[188:191]
    ds_read_b64_tr_b16 v[84:85], v194 offset:40960
    buffer_load_dwordx4 v7, s[20:23], s48 offen offset:1024 lds
    v_cvt_pk_bf16_f32 v231, v226, v227
    v_mfma_f32_16x16x32_bf16 a[188:191], v[44:47], v[124:127], a[188:191]
    s_waitcnt lgkmcnt(3)
    v_mfma_f32_16x16x32_bf16 a[192:195], v[32:35], v[96:99], a[192:195]
    ds_read_b128 v[40:43], v18 offset:10240
    buffer_store_dwordx4 v[228:231], v15, s[8:11], s84 offen offset:2176 sc0 sc1
    v_mfma_f32_16x16x32_bf16 a[192:195], v[36:39], v[100:103], a[192:195]
    ds_read_b128 v[44:47], v19 offset:10240
    v_mfma_f32_16x16x32_bf16 a[196:199], v[32:35], v[104:107], a[196:199]
    ds_read_b64_tr_b16 v[86:87], v194 offset:43008
    v_mfma_f32_16x16x32_bf16 a[196:199], v[36:39], v[108:111], a[196:199]
    buffer_load_dwordx4 v8, s[20:23], s48 offen offset:2048 lds
    v_mfma_f32_16x16x32_bf16 a[200:203], v[32:35], v[112:115], a[200:203]
    ds_read_b64_tr_b16 v[88:89], v195 offset:32768
    v_mfma_f32_16x16x32_bf16 a[200:203], v[36:39], v[116:119], a[200:203]
    buffer_load_dwordx4 v9, s[20:23], s48 offen offset:3072 lds
    v_mfma_f32_16x16x32_bf16 a[204:207], v[32:35], v[120:123], a[204:207]
    ds_read_b64_tr_b16 v[90:91], v195 offset:34816
    v_mfma_f32_16x16x32_bf16 a[204:207], v[36:39], v[124:127], a[204:207]
    s_waitcnt lgkmcnt(3)
    v_mfma_f32_16x16x32_bf16 a[208:211], v[40:43], v[96:99], a[208:211]
    ds_read_b128 v[32:35], v18 offset:12288
    v_mfma_f32_16x16x32_bf16 a[208:211], v[44:47], v[100:103], a[208:211]
    ds_read_b128 v[36:39], v19 offset:12288
    v_accvgpr_read_b32 v208, a32
    v_mfma_f32_16x16x32_bf16 a[212:215], v[40:43], v[104:107], a[212:215]
    ds_read_b64_tr_b16 v[92:93], v195 offset:40960
    v_accvgpr_read_b32 v209, a33
    v_mfma_f32_16x16x32_bf16 a[212:215], v[44:47], v[108:111], a[212:215]
    v_accvgpr_read_b32 v210, a34
    v_mfma_f32_16x16x32_bf16 a[216:219], v[40:43], v[112:115], a[216:219]
    v_accvgpr_read_b32 v211, a35
    v_mfma_f32_16x16x32_bf16 a[216:219], v[44:47], v[116:119], a[216:219]
    ds_read_b64_tr_b16 v[94:95], v195 offset:43008
    v_accvgpr_read_b32 v212, a36
    v_mfma_f32_16x16x32_bf16 a[220:223], v[40:43], v[120:123], a[220:223]
    v_accvgpr_read_b32 v213, a37
    v_mfma_f32_16x16x32_bf16 a[220:223], v[44:47], v[124:127], a[220:223]
    s_waitcnt lgkmcnt(2)
    v_mfma_f32_16x16x32_bf16 a[224:227], v[32:35], v[96:99], a[224:227]
    ds_read_b128 v[40:43], v18 offset:14336
    v_mfma_f32_16x16x32_bf16 a[224:227], v[36:39], v[100:103], a[224:227]
    ds_read_b128 v[44:47], v19 offset:14336
    v_accvgpr_read_b32 v214, a38
    v_mfma_f32_16x16x32_bf16 a[228:231], v[32:35], v[104:107], a[228:231]
    v_accvgpr_read_b32 v215, a39
    v_mfma_f32_16x16x32_bf16 a[228:231], v[36:39], v[108:111], a[228:231]
    v_cvt_pk_bf16_f32 v216, v208, v209
    v_mfma_f32_16x16x32_bf16 a[232:235], v[32:35], v[112:115], a[232:235]
    v_cvt_pk_bf16_f32 v217, v210, v211
    v_mfma_f32_16x16x32_bf16 a[232:235], v[36:39], v[116:119], a[232:235]
    v_cvt_pk_bf16_f32 v218, v212, v213
    v_mfma_f32_16x16x32_bf16 a[236:239], v[32:35], v[120:123], a[236:239]
    v_cvt_pk_bf16_f32 v219, v214, v215
    v_mfma_f32_16x16x32_bf16 a[236:239], v[36:39], v[124:127], a[236:239]
    s_waitcnt lgkmcnt(0)
    v_mfma_f32_16x16x32_bf16 a[240:243], v[40:43], v[96:99], a[240:243]
    s_waitcnt vmcnt(20)
    s_barrier
    buffer_store_dwordx4 v[216:219], v15, s[8:11], s85 offen offset:0 sc0 sc1
    v_mfma_f32_16x16x32_bf16 a[240:243], v[44:47], v[100:103], a[240:243]
    ds_read_b128 v[32:35], v16 offset:0
    v_mfma_f32_16x16x32_bf16 a[244:247], v[40:43], v[104:107], a[244:247]
    ds_read_b128 v[36:39], v17 offset:0
    v_mfma_f32_16x16x32_bf16 a[244:247], v[44:47], v[108:111], a[244:247]
    s_add_u32 m0, s40, 65536
    s_add_u32 s48, s35, 512
    buffer_load_dwordx4 v2, s[12:15], s48 offen offset:0 lds
    v_mfma_f32_16x16x32_bf16 a[248:251], v[40:43], v[112:115], a[248:251]
    v_mfma_f32_16x16x32_bf16 a[248:251], v[44:47], v[116:119], a[248:251]
    v_mfma_f32_16x16x32_bf16 a[252:255], v[40:43], v[120:123], a[252:255]
    buffer_load_dwordx4 v3, s[12:15], s48 offen offset:1024 lds
    v_mfma_f32_16x16x32_bf16 a[252:255], v[44:47], v[124:127], a[252:255]
    s_waitcnt lgkmcnt(0)
    v_mfma_f32_16x16x32_bf16 a[128:131], v[32:35], v[64:67], a[128:131]
    ds_read_b128 v[40:43], v16 offset:2048
    v_mfma_f32_16x16x32_bf16 a[128:131], v[36:39], v[68:71], a[128:131]
    ds_read_b128 v[44:47], v17 offset:2048
    v_accvgpr_read_b32 v220, a40
    v_mfma_f32_16x16x32_bf16 a[132:135], v[32:35], v[72:75], a[132:135]
    ds_read_b64_tr_b16 v[96:97], v192 offset:49152
    v_accvgpr_read_b32 v221, a41
    v_mfma_f32_16x16x32_bf16 a[132:135], v[36:39], v[76:79], a[132:135]
    buffer_load_dwordx4 v4, s[12:15], s48 offen offset:2048 lds
    v_accvgpr_read_b32 v222, a42
    v_mfma_f32_16x16x32_bf16 a[136:139], v[32:35], v[80:83], a[136:139]
    ds_read_b64_tr_b16 v[98:99], v192 offset:51200
    v_accvgpr_read_b32 v223, a43
    v_mfma_f32_16x16x32_bf16 a[136:139], v[36:39], v[84:87], a[136:139]
    buffer_load_dwordx4 v5, s[12:15], s48 offen offset:3072 lds
    v_accvgpr_read_b32 v224, a44
    v_mfma_f32_16x16x32_bf16 a[140:143], v[32:35], v[88:91], a[140:143]
    ds_read_b64_tr_b16 v[100:101], v192 offset:57344
    v_accvgpr_read_b32 v225, a45
    v_mfma_f32_16x16x32_bf16 a[140:143], v[36:39], v[92:95], a[140:143]
    s_waitcnt lgkmcnt(3)
    v_mfma_f32_16x16x32_bf16 a[144:147], v[40:43], v[64:67], a[144:147]
    ds_read_b128 v[32:35], v16 offset:4096
    v_mfma_f32_16x16x32_bf16 a[144:147], v[44:47], v[68:71], a[144:147]
    ds_read_b128 v[36:39], v17 offset:4096
    v_accvgpr_read_b32 v226, a46
    v_mfma_f32_16x16x32_bf16 a[148:151], v[40:43], v[72:75], a[148:151]
    ds_read_b64_tr_b16 v[102:103], v192 offset:59392
    v_accvgpr_read_b32 v227, a47
    v_mfma_f32_16x16x32_bf16 a[148:151], v[44:47], v[76:79], a[148:151]
    s_add_u32 m0, s40, 69632
    s_add_u32 s48, s35, 33280
    buffer_load_dwordx4 v2, s[12:15], s48 offen offset:0 lds
    v_cvt_pk_bf16_f32 v228, v220, v221
    v_mfma_f32_16x16x32_bf16 a[152:155], v[40:43], v[80:83], a[152:155]
    ds_read_b64_tr_b16 v[104:105], v193 offset:49152
    v_cvt_pk_bf16_f32 v229, v222, v223
    v_mfma_f32_16x16x32_bf16 a[152:155], v[44:47], v[84:87], a[152:155]
    v_cvt_pk_bf16_f32 v230, v224, v225
    v_mfma_f32_16x16x32_bf16 a[156:159], v[40:43], v[88:91], a[156:159]
    ds_read_b64_tr_b16 v[106:107], v193 offset:51200
    buffer_load_dwordx4 v3, s[12:15], s48 offen offset:1024 lds
    v_cvt_pk_bf16_f32 v231, v226, v227
    v_mfma_f32_16x16x32_bf16 a[156:159], v[44:47], v[92:95], a[156:159]
    s_waitcnt lgkmcnt(3)
    v_mfma_f32_16x16x32_bf16 a[160:163], v[32:35], v[64:67], a[160:163]
    ds_read_b128 v[40:43], v16 offset:6144
    buffer_store_dwordx4 v[228:231], v15, s[8:11], s85 offen offset:2048 sc0 sc1
    v_mfma_f32_16x16x32_bf16 a[160:163], v[36:39], v[68:71], a[160:163]
    ds_read_b128 v[44:47], v17 offset:6144
    v_mfma_f32_16x16x32_bf16 a[164:167], v[32:35], v[72:75], a[164:167]
    ds_read_b64_tr_b16 v[108:109], v193 offset:57344
    v_mfma_f32_16x16x32_bf16 a[164:167], v[36:39], v[76:79], a[164:167]
    buffer_load_dwordx4 v4, s[12:15], s48 offen offset:2048 lds
    v_mfma_f32_16x16x32_bf16 a[168:171], v[32:35], v[80:83], a[168:171]
    v_mfma_f32_16x16x32_bf16 a[168:171], v[36:39], v[84:87], a[168:171]
    ds_read_b64_tr_b16 v[110:111], v193 offset:59392
    buffer_load_dwordx4 v5, s[12:15], s48 offen offset:3072 lds
    v_mfma_f32_16x16x32_bf16 a[172:175], v[32:35], v[88:91], a[172:175]
    v_mfma_f32_16x16x32_bf16 a[172:175], v[36:39], v[92:95], a[172:175]
    s_waitcnt lgkmcnt(2)
    v_mfma_f32_16x16x32_bf16 a[176:179], v[40:43], v[64:67], a[176:179]
    ds_read_b128 v[32:35], v16 offset:8192
    v_mfma_f32_16x16x32_bf16 a[176:179], v[44:47], v[68:71], a[176:179]
    ds_read_b128 v[36:39], v17 offset:8192
    v_accvgpr_read_b32 v208, a48
    v_mfma_f32_16x16x32_bf16 a[180:183], v[40:43], v[72:75], a[180:183]
    ds_read_b64_tr_b16 v[112:113], v194 offset:49152
    v_accvgpr_read_b32 v209, a49
    v_mfma_f32_16x16x32_bf16 a[180:183], v[44:47], v[76:79], a[180:183]
    s_add_u32 m0, s41, 131072
    s_add_u32 s48, s37, 3145728
    buffer_load_dwordx4 v6, s[20:23], s48 offen offset:0 lds
    v_accvgpr_read_b32 v210, a50
    v_mfma_f32_16x16x32_bf16 a[184:187], v[40:43], v[80:83], a[184:187]
    ds_read_b64_tr_b16 v[114:115], v194 offset:51200
    v_accvgpr_read_b32 v211, a51
    v_mfma_f32_16x16x32_bf16 a[184:187], v[44:47], v[84:87], a[184:187]
    v_accvgpr_read_b32 v212, a52
    v_mfma_f32_16x16x32_bf16 a[188:191], v[40:43], v[88:91], a[188:191]
    ds_read_b64_tr_b16 v[116:117], v194 offset:57344
    buffer_load_dwordx4 v7, s[20:23], s48 offen offset:1024 lds
    v_accvgpr_read_b32 v213, a53
    v_mfma_f32_16x16x32_bf16 a[188:191], v[44:47], v[92:95], a[188:191]
    s_waitcnt lgkmcnt(3)
    v_mfma_f32_16x16x32_bf16 a[192:195], v[32:35], v[64:67], a[192:195]
    ds_read_b128 v[40:43], v16 offset:10240
    v_mfma_f32_16x16x32_bf16 a[192:195], v[36:39], v[68:71], a[192:195]
    ds_read_b128 v[44:47], v17 offset:10240
    v_accvgpr_read_b32 v214, a54
    v_mfma_f32_16x16x32_bf16 a[196:199], v[32:35], v[72:75], a[196:199]
    ds_read_b64_tr_b16 v[118:119], v194 offset:59392
    v_accvgpr_read_b32 v215, a55
    v_mfma_f32_16x16x32_bf16 a[196:199], v[36:39], v[76:79], a[196:199]
    buffer_load_dwordx4 v8, s[20:23], s48 offen offset:2048 lds
    v_cvt_pk_bf16_f32 v216, v208, v209
    v_mfma_f32_16x16x32_bf16 a[200:203], v[32:35], v[80:83], a[200:203]
    ds_read_b64_tr_b16 v[120:121], v195 offset:49152
    v_cvt_pk_bf16_f32 v217, v210, v211
    v_mfma_f32_16x16x32_bf16 a[200:203], v[36:39], v[84:87], a[200:203]
    buffer_load_dwordx4 v9, s[20:23], s48 offen offset:3072 lds
    v_cvt_pk_bf16_f32 v218, v212, v213
    v_mfma_f32_16x16x32_bf16 a[204:207], v[32:35], v[88:91], a[204:207]
    ds_read_b64_tr_b16 v[122:123], v195 offset:51200
    v_cvt_pk_bf16_f32 v219, v214, v215
    v_mfma_f32_16x16x32_bf16 a[204:207], v[36:39], v[92:95], a[204:207]
    s_waitcnt lgkmcnt(3)
    v_mfma_f32_16x16x32_bf16 a[208:211], v[40:43], v[64:67], a[208:211]
    ds_read_b128 v[32:35], v16 offset:12288
    buffer_store_dwordx4 v[216:219], v15, s[8:11], s85 offen offset:128 sc0 sc1
    v_mfma_f32_16x16x32_bf16 a[208:211], v[44:47], v[68:71], a[208:211]
    ds_read_b128 v[36:39], v17 offset:12288
    v_mfma_f32_16x16x32_bf16 a[212:215], v[40:43], v[72:75], a[212:215]
    ds_read_b64_tr_b16 v[124:125], v195 offset:57344
    v_mfma_f32_16x16x32_bf16 a[212:215], v[44:47], v[76:79], a[212:215]
    v_mfma_f32_16x16x32_bf16 a[216:219], v[40:43], v[80:83], a[216:219]
    v_mfma_f32_16x16x32_bf16 a[216:219], v[44:47], v[84:87], a[216:219]
    ds_read_b64_tr_b16 v[126:127], v195 offset:59392
    v_mfma_f32_16x16x32_bf16 a[220:223], v[40:43], v[88:91], a[220:223]
    v_mfma_f32_16x16x32_bf16 a[220:223], v[44:47], v[92:95], a[220:223]
    s_waitcnt lgkmcnt(2)
    v_mfma_f32_16x16x32_bf16 a[224:227], v[32:35], v[64:67], a[224:227]
    ds_read_b128 v[40:43], v16 offset:14336
    v_mfma_f32_16x16x32_bf16 a[224:227], v[36:39], v[68:71], a[224:227]
    ds_read_b128 v[44:47], v17 offset:14336
    v_accvgpr_read_b32 v220, a56
    v_mfma_f32_16x16x32_bf16 a[228:231], v[32:35], v[72:75], a[228:231]
    v_accvgpr_read_b32 v221, a57
    v_mfma_f32_16x16x32_bf16 a[228:231], v[36:39], v[76:79], a[228:231]
    v_accvgpr_read_b32 v222, a58
    v_mfma_f32_16x16x32_bf16 a[232:235], v[32:35], v[80:83], a[232:235]
    v_accvgpr_read_b32 v223, a59
    v_mfma_f32_16x16x32_bf16 a[232:235], v[36:39], v[84:87], a[232:235]
    v_accvgpr_read_b32 v224, a60
    v_mfma_f32_16x16x32_bf16 a[236:239], v[32:35], v[88:91], a[236:239]
    v_accvgpr_read_b32 v225, a61
    v_mfma_f32_16x16x32_bf16 a[236:239], v[36:39], v[92:95], a[236:239]
    s_waitcnt lgkmcnt(0)
    v_mfma_f32_16x16x32_bf16 a[240:243], v[40:43], v[64:67], a[240:243]
    s_waitcnt vmcnt(20)
    s_barrier
    v_mfma_f32_16x16x32_bf16 a[240:243], v[44:47], v[68:71], a[240:243]
    ds_read_b128 v[32:35], v16 offset:32768
    v_accvgpr_read_b32 v226, a62
    v_mfma_f32_16x16x32_bf16 a[244:247], v[40:43], v[72:75], a[244:247]
    ds_read_b128 v[36:39], v17 offset:32768
    v_accvgpr_read_b32 v227, a63
    v_mfma_f32_16x16x32_bf16 a[244:247], v[44:47], v[76:79], a[244:247]
    s_add_u32 m0, s40, 0
    s_add_u32 s48, s35, 640
    buffer_load_dwordx4 v2, s[12:15], s48 offen offset:0 lds
    v_cvt_pk_bf16_f32 v228, v220, v221
    v_mfma_f32_16x16x32_bf16 a[248:251], v[40:43], v[80:83], a[248:251]
    v_cvt_pk_bf16_f32 v229, v222, v223
    v_mfma_f32_16x16x32_bf16 a[248:251], v[44:47], v[84:87], a[248:251]
    v_cvt_pk_bf16_f32 v230, v224, v225
    v_mfma_f32_16x16x32_bf16 a[252:255], v[40:43], v[88:91], a[252:255]
    buffer_load_dwordx4 v3, s[12:15], s48 offen offset:1024 lds
    v_cvt_pk_bf16_f32 v231, v226, v227
    v_mfma_f32_16x16x32_bf16 a[252:255], v[44:47], v[92:95], a[252:255]
    s_waitcnt lgkmcnt(0)
    v_mfma_f32_16x16x32_bf16 a[128:131], v[32:35], v[96:99], a[128:131]
    ds_read_b128 v[40:43], v16 offset:34816
    buffer_store_dwordx4 v[228:231], v15, s[8:11], s85 offen offset:2176 sc0 sc1
    v_mfma_f32_16x16x32_bf16 a[128:131], v[36:39], v[100:103], a[128:131]
    ds_read_b128 v[44:47], v17 offset:34816
    v_mfma_f32_16x16x32_bf16 a[132:135], v[32:35], v[104:107], a[132:135]
    ds_read_b64_tr_b16 v[64:65], v192 offset:0
    v_mfma_f32_16x16x32_bf16 a[132:135], v[36:39], v[108:111], a[132:135]
    buffer_load_dwordx4 v4, s[12:15], s48 offen offset:2048 lds
    v_mfma_f32_16x16x32_bf16 a[136:139], v[32:35], v[112:115], a[136:139]
    ds_read_b64_tr_b16 v[66:67], v192 offset:2048
    v_mfma_f32_16x16x32_bf16 a[136:139], v[36:39], v[116:119], a[136:139]
    buffer_load_dwordx4 v5, s[12:15], s48 offen offset:3072 lds
    v_mfma_f32_16x16x32_bf16 a[140:143], v[32:35], v[120:123], a[140:143]
    ds_read_b64_tr_b16 v[68:69], v192 offset:8192
    v_mfma_f32_16x16x32_bf16 a[140:143], v[36:39], v[124:127], a[140:143]
    s_waitcnt lgkmcnt(3)
    v_mfma_f32_16x16x32_bf16 a[144:147], v[40:43], v[96:99], a[144:147]
    ds_read_b128 v[32:35], v16 offset:36864
    v_mfma_f32_16x16x32_bf16 a[144:147], v[44:47], v[100:103], a[144:147]
    ds_read_b128 v[36:39], v17 offset:36864
    v_accvgpr_read_b32 v208, a64
    v_mfma_f32_16x16x32_bf16 a[148:151], v[40:43], v[104:107], a[148:151]
    ds_read_b64_tr_b16 v[70:71], v192 offset:10240
    v_accvgpr_read_b32 v209, a65
    v_mfma_f32_16x16x32_bf16 a[148:151], v[44:47], v[108:111], a[148:151]
    s_add_u32 m0, s40, 4096
    s_add_u32 s48, s35, 33408
    buffer_load_dwordx4 v2, s[12:15], s48 offen offset:0 lds
    v_accvgpr_read_b32 v210, a66
    v_mfma_f32_16x16x32_bf16 a[152:155], v[40:43], v[112:115], a[152:155]
    ds_read_b64_tr_b16 v[72:73], v193 offset:0
    v_accvgpr_read_b32 v211, a67
    v_mfma_f32_16x16x32_bf16 a[152:155], v[44:47], v[116:119], a[152:155]
    v_accvgpr_read_b32 v212, a68
    v_mfma_f32_16x16x32_bf16 a[156:159], v[40:43], v[120:123], a[156:159]
    ds_read_b64_tr_b16 v[74:75], v193 offset:2048
    buffer_load_dwordx4 v3, s[12:15], s48 offen offset:1024 lds
    v_accvgpr_read_b32 v213, a69
    v_mfma_f32_16x16x32_bf16 a[156:159], v[44:47], v[124:127], a[156:159]
    s_waitcnt lgkmcnt(3)
    v_mfma_f32_16x16x32_bf16 a[160:163], v[32:35], v[96:99], a[160:163]
    ds_read_b128 v[40:43], v16 offset:38912
    v_mfma_f32_16x16x32_bf16 a[160:163], v[36:39], v[100:103], a[160:163]
    ds_read_b128 v[44:47], v17 offset:38912
    v_accvgpr_read_b32 v214, a70
    v_mfma_f32_16x16x32_bf16 a[164:167], v[32:35], v[104:107], a[164:167]
    ds_read_b64_tr_b16 v[76:77], v193 offset:8192
    v_accvgpr_read_b32 v215, a71
    v_mfma_f32_16x16x32_bf16 a[164:167], v[36:39], v[108:111], a[164:167]
    buffer_load_dwordx4 v4, s[12:15], s48 offen offset:2048 lds
    v_cvt_pk_bf16_f32 v216, v208, v209
    v_mfma_f32_16x16x32_bf16 a[168:171], v[32:35], v[112:115], a[168:171]
    v_cvt_pk_bf16_f32 v217, v210, v211
    v_mfma_f32_16x16x32_bf16 a[168:171], v[36:39], v[116:119], a[168:171]
    ds_read_b64_tr_b16 v[78:79], v193 offset:10240
    buffer_load_dwordx4 v5, s[12:15], s48 offen offset:3072 lds
    buffer_load_dword v203, v52, s[28:31], s51 offen sc1
    v_cvt_pk_bf16_f32 v218, v212, v213
    v_mfma_f32_16x16x32_bf16 a[172:175], v[32:35], v[120:123], a[172:175]
    v_cvt_pk_bf16_f32 v219, v214, v215
    v_mfma_f32_16x16x32_bf16 a[172:175], v[36:39], v[124:127], a[172:175]
    s_waitcnt lgkmcnt(2)
    v_mfma_f32_16x16x32_bf16 a[176:179], v[40:43], v[96:99], a[176:179]
    ds_read_b128 v[32:35], v16 offset:40960
    buffer_store_dwordx4 v[216:219], v15, s[8:11], s86 offen offset:0 sc0 sc1
    v_mfma_f32_16x16x32_bf16 a[176:179], v[44:47], v[100:103], a[176:179]
    ds_read_b128 v[36:39], v17 offset:40960
    v_mfma_f32_16x16x32_bf16 a[180:183], v[40:43], v[104:107], a[180:183]
    ds_read_b64_tr_b16 v[80:81], v194 offset:0
    v_mfma_f32_16x16x32_bf16 a[180:183], v[44:47], v[108:111], a[180:183]
    s_add_u32 m0, s41, 147456
    s_add_u32 s48, s37, 3670016
    buffer_load_dwordx4 v6, s[20:23], s48 offen offset:0 lds
    v_mfma_f32_16x16x32_bf16 a[184:187], v[40:43], v[112:115], a[184:187]
    ds_read_b64_tr_b16 v[82:83], v194 offset:2048
    v_mfma_f32_16x16x32_bf16 a[184:187], v[44:47], v[116:119], a[184:187]
    v_mfma_f32_16x16x32_bf16 a[188:191], v[40:43], v[120:123], a[188:191]
    ds_read_b64_tr_b16 v[84:85], v194 offset:8192
    buffer_load_dwordx4 v7, s[20:23], s48 offen offset:1024 lds
    v_mfma_f32_16x16x32_bf16 a[188:191], v[44:47], v[124:127], a[188:191]
    s_waitcnt lgkmcnt(3)
    v_mfma_f32_16x16x32_bf16 a[192:195], v[32:35], v[96:99], a[192:195]
    ds_read_b128 v[40:43], v16 offset:43008
    v_mfma_f32_16x16x32_bf16 a[192:195], v[36:39], v[100:103], a[192:195]
    ds_read_b128 v[44:47], v17 offset:43008
    v_accvgpr_read_b32 v220, a72
    v_mfma_f32_16x16x32_bf16 a[196:199], v[32:35], v[104:107], a[196:199]
    ds_read_b64_tr_b16 v[86:87], v194 offset:10240
    v_accvgpr_read_b32 v221, a73
    v_mfma_f32_16x16x32_bf16 a[196:199], v[36:39], v[108:111], a[196:199]
    buffer_load_dwordx4 v8, s[20:23], s48 offen offset:2048 lds
    v_accvgpr_read_b32 v222, a74
    v_mfma_f32_16x16x32_bf16 a[200:203], v[32:35], v[112:115], a[200:203]
    ds_read_b64_tr_b16 v[88:89], v195 offset:0
    v_accvgpr_read_b32 v223, a75
    v_mfma_f32_16x16x32_bf16 a[200:203], v[36:39], v[116:119], a[200:203]
    buffer_load_dwordx4 v9, s[20:23], s48 offen offset:3072 lds
    v_accvgpr_read_b32 v224, a76
    v_mfma_f32_16x16x32_bf16 a[204:207], v[32:35], v[120:123], a[204:207]
    ds_read_b64_tr_b16 v[90:91], v195 offset:2048
    v_accvgpr_read_b32 v225, a77
    v_mfma_f32_16x16x32_bf16 a[204:207], v[36:39], v[124:127], a[204:207]
    s_waitcnt lgkmcnt(3)
    v_mfma_f32_16x16x32_bf16 a[208:211], v[40:43], v[96:99], a[208:211]
    ds_read_b128 v[32:35], v16 offset:45056
    v_mfma_f32_16x16x32_bf16 a[208:211], v[44:47], v[100:103], a[208:211]
    ds_read_b128 v[36:39], v17 offset:45056
    v_accvgpr_read_b32 v226, a78
    v_mfma_f32_16x16x32_bf16 a[212:215], v[40:43], v[104:107], a[212:215]
    ds_read_b64_tr_b16 v[92:93], v195 offset:8192
    v_accvgpr_read_b32 v227, a79
    v_mfma_f32_16x16x32_bf16 a[212:215], v[44:47], v[108:111], a[212:215]
    v_cvt_pk_bf16_f32 v228, v220, v221
    v_mfma_f32_16x16x32_bf16 a[216:219], v[40:43], v[112:115], a[216:219]
    v_cvt_pk_bf16_f32 v229, v222, v223
    v_mfma_f32_16x16x32_bf16 a[216:219], v[44:47], v[116:119], a[216:219]
    ds_read_b64_tr_b16 v[94:95], v195 offset:10240
    v_cvt_pk_bf16_f32 v230, v224, v225
    v_mfma_f32_16x16x32_bf16 a[220:223], v[40:43], v[120:123], a[220:223]
    v_cvt_pk_bf16_f32 v231, v226, v227
    v_mfma_f32_16x16x32_bf16 a[220:223], v[44:47], v[124:127], a[220:223]
    s_waitcnt lgkmcnt(2)
    v_mfma_f32_16x16x32_bf16 a[224:227], v[32:35], v[96:99], a[224:227]
    ds_read_b128 v[40:43], v16 offset:47104
    buffer_store_dwordx4 v[228:231], v15, s[8:11], s86 offen offset:2048 sc0 sc1
    v_mfma_f32_16x16x32_bf16 a[224:227], v[36:39], v[100:103], a[224:227]
    ds_read_b128 v[44:47], v17 offset:47104
    v_mfma_f32_16x16x32_bf16 a[228:231], v[32:35], v[104:107], a[228:231]
    v_mfma_f32_16x16x32_bf16 a[228:231], v[36:39], v[108:111], a[228:231]
    v_mfma_f32_16x16x32_bf16 a[232:235], v[32:35], v[112:115], a[232:235]
    v_mfma_f32_16x16x32_bf16 a[232:235], v[36:39], v[116:119], a[232:235]
    v_mfma_f32_16x16x32_bf16 a[236:239], v[32:35], v[120:123], a[236:239]
    v_mfma_f32_16x16x32_bf16 a[236:239], v[36:39], v[124:127], a[236:239]
    s_waitcnt lgkmcnt(0)
    v_mfma_f32_16x16x32_bf16 a[240:243], v[40:43], v[96:99], a[240:243]
    s_waitcnt vmcnt(21)
    s_barrier
    v_mfma_f32_16x16x32_bf16 a[240:243], v[44:47], v[100:103], a[240:243]
    ds_read_b128 v[32:35], v18 offset:0
    v_accvgpr_read_b32 v208, a80
    v_mfma_f32_16x16x32_bf16 a[244:247], v[40:43], v[104:107], a[244:247]
    ds_read_b128 v[36:39], v19 offset:0
    v_accvgpr_read_b32 v209, a81
    v_mfma_f32_16x16x32_bf16 a[244:247], v[44:47], v[108:111], a[244:247]
    s_add_u32 m0, s40, 32768
    s_add_u32 s48, s35, 768
    buffer_load_dwordx4 v2, s[12:15], s48 offen offset:0 lds
    v_accvgpr_read_b32 v210, a82
    v_mfma_f32_16x16x32_bf16 a[248:251], v[40:43], v[112:115], a[248:251]
    v_accvgpr_read_b32 v211, a83
    v_mfma_f32_16x16x32_bf16 a[248:251], v[44:47], v[116:119], a[248:251]
    v_accvgpr_read_b32 v212, a84
    v_mfma_f32_16x16x32_bf16 a[252:255], v[40:43], v[120:123], a[252:255]
    buffer_load_dwordx4 v3, s[12:15], s48 offen offset:1024 lds
    v_accvgpr_read_b32 v213, a85
    v_mfma_f32_16x16x32_bf16 a[252:255], v[44:47], v[124:127], a[252:255]
    s_waitcnt lgkmcnt(0)
    v_mfma_f32_16x16x32_bf16 a[128:131], v[32:35], v[64:67], a[128:131]
    ds_read_b128 v[40:43], v18 offset:2048
    v_mfma_f32_16x16x32_bf16 a[128:131], v[36:39], v[68:71], a[128:131]
    ds_read_b128 v[44:47], v19 offset:2048
    v_accvgpr_read_b32 v214, a86
    v_mfma_f32_16x16x32_bf16 a[132:135], v[32:35], v[72:75], a[132:135]
    ds_read_b64_tr_b16 v[96:97], v192 offset:16384
    v_accvgpr_read_b32 v215, a87
    v_mfma_f32_16x16x32_bf16 a[132:135], v[36:39], v[76:79], a[132:135]
    buffer_load_dwordx4 v4, s[12:15], s48 offen offset:2048 lds
    v_cvt_pk_bf16_f32 v216, v208, v209
    v_mfma_f32_16x16x32_bf16 a[136:139], v[32:35], v[80:83], a[136:139]
    ds_read_b64_tr_b16 v[98:99], v192 offset:18432
    v_cvt_pk_bf16_f32 v217, v210, v211
    v_mfma_f32_16x16x32_bf16 a[136:139], v[36:39], v[84:87], a[136:139]
    buffer_load_dwordx4 v5, s[12:15], s48 offen offset:3072 lds
    v_cvt_pk_bf16_f32 v218, v212, v213
    v_mfma_f32_16x16x32_bf16 a[140:143], v[32:35], v[88:91], a[140:143]
    ds_read_b64_tr_b16 v[100:101], v192 offset:24576
    v_cvt_pk_bf16_f32 v219, v214, v215
    v_mfma_f32_16x16x32_bf16 a[140:143], v[36:39], v[92:95], a[140:143]
    s_waitcnt lgkmcnt(3)
    v_mfma_f32_16x16x32_bf16 a[144:147], v[40:43], v[64:67], a[144:147]
    ds_read_b128 v[32:35], v18 offset:4096
    buffer_store_dwordx4 v[216:219], v15, s[8:11], s86 offen offset:128 sc0 sc1
    v_mfma_f32_16x16x32_bf16 a[144:147], v[44:47], v[68:71], a[144:147]
    ds_read_b128 v[36:39], v19 offset:4096
    v_mfma_f32_16x16x32_bf16 a[148:151], v[40:43], v[72:75], a[148:151]
    ds_read_b64_tr_b16 v[102:103], v192 offset:26624
    v_mfma_f32_16x16x32_bf16 a[148:151], v[44:47], v[76:79], a[148:151]
    s_add_u32 m0, s40, 36864
    s_add_u32 s48, s35, 33536
    buffer_load_dwordx4 v2, s[12:15], s48 offen offset:0 lds
    v_mfma_f32_16x16x32_bf16 a[152:155], v[40:43], v[80:83], a[152:155]
    ds_read_b64_tr_b16 v[104:105], v193 offset:16384
    v_mfma_f32_16x16x32_bf16 a[152:155], v[44:47], v[84:87], a[152:155]
    v_mfma_f32_16x16x32_bf16 a[156:159], v[40:43], v[88:91], a[156:159]
    ds_read_b64_tr_b16 v[106:107], v193 offset:18432
    buffer_load_dwordx4 v3, s[12:15], s48 offen offset:1024 lds
    v_mfma_f32_16x16x32_bf16 a[156:159], v[44:47], v[92:95], a[156:159]
    s_waitcnt lgkmcnt(3)
    v_mfma_f32_16x16x32_bf16 a[160:163], v[32:35], v[64:67], a[160:163]
    ds_read_b128 v[40:43], v18 offset:6144
    v_mfma_f32_16x16x32_bf16 a[160:163], v[36:39], v[68:71], a[160:163]
    ds_read_b128 v[44:47], v19 offset:6144
    v_accvgpr_read_b32 v220, a88
    v_mfma_f32_16x16x32_bf16 a[164:167], v[32:35], v[72:75], a[164:167]
    ds_read_b64_tr_b16 v[108:109], v193 offset:24576
    v_accvgpr_read_b32 v221, a89
    v_mfma_f32_16x16x32_bf16 a[164:167], v[36:39], v[76:79], a[164:167]
    buffer_load_dwordx4 v4, s[12:15], s48 offen offset:2048 lds
    v_accvgpr_read_b32 v222, a90
    v_mfma_f32_16x16x32_bf16 a[168:171], v[32:35], v[80:83], a[168:171]
    v_accvgpr_read_b32 v223, a91
    v_mfma_f32_16x16x32_bf16 a[168:171], v[36:39], v[84:87], a[168:171]
    ds_read_b64_tr_b16 v[110:111], v193 offset:26624
    buffer_load_dwordx4 v5, s[12:15], s48 offen offset:3072 lds
    v_accvgpr_read_b32 v224, a92
    v_mfma_f32_16x16x32_bf16 a[172:175], v[32:35], v[88:91], a[172:175]
    v_accvgpr_read_b32 v225, a93
    v_mfma_f32_16x16x32_bf16 a[172:175], v[36:39], v[92:95], a[172:175]
    s_waitcnt lgkmcnt(2)
    v_mfma_f32_16x16x32_bf16 a[176:179], v[40:43], v[64:67], a[176:179]
    ds_read_b128 v[32:35], v18 offset:8192
    v_mfma_f32_16x16x32_bf16 a[176:179], v[44:47], v[68:71], a[176:179]
    ds_read_b128 v[36:39], v19 offset:8192
    v_accvgpr_read_b32 v226, a94
    v_mfma_f32_16x16x32_bf16 a[180:183], v[40:43], v[72:75], a[180:183]
    ds_read_b64_tr_b16 v[112:113], v194 offset:16384
    v_accvgpr_read_b32 v227, a95
    v_mfma_f32_16x16x32_bf16 a[180:183], v[44:47], v[76:79], a[180:183]
    s_add_u32 m0, s41, 98304
    s_add_u32 s48, s37, 0
    buffer_load_dwordx4 v6, s[60:63], s48 offen offset:0 lds
    v_cvt_pk_bf16_f32 v228, v220, v221
    v_mfma_f32_16x16x32_bf16 a[184:187], v[40:43], v[80:83], a[184:187]
    ds_read_b64_tr_b16 v[114:115], v194 offset:18432
    v_cvt_pk_bf16_f32 v229, v222, v223
    v_mfma_f32_16x16x32_bf16 a[184:187], v[44:47], v[84:87], a[184:187]
    v_cvt_pk_bf16_f32 v230, v224, v225
    v_mfma_f32_16x16x32_bf16 a[188:191], v[40:43], v[88:91], a[188:191]
    ds_read_b64_tr_b16 v[116:117], v194 offset:24576
    buffer_load_dwordx4 v7, s[60:63], s48 offen offset:1024 lds
    v_cvt_pk_bf16_f32 v231, v226, v227
    v_mfma_f32_16x16x32_bf16 a[188:191], v[44:47], v[92:95], a[188:191]
    s_waitcnt lgkmcnt(3)
    v_mfma_f32_16x16x32_bf16 a[192:195], v[32:35], v[64:67], a[192:195]
    ds_read_b128 v[40:43], v18 offset:10240
    buffer_store_dwordx4 v[228:231], v15, s[8:11], s86 offen offset:2176 sc0 sc1
    v_mfma_f32_16x16x32_bf16 a[192:195], v[36:39], v[68:71], a[192:195]
    ds_read_b128 v[44:47], v19 offset:10240
    v_mfma_f32_16x16x32_bf16 a[196:199], v[32:35], v[72:75], a[196:199]
    ds_read_b64_tr_b16 v[118:119], v194 offset:26624
    v_mfma_f32_16x16x32_bf16 a[196:199], v[36:39], v[76:79], a[196:199]
    buffer_load_dwordx4 v8, s[60:63], s48 offen offset:2048 lds
    v_mfma_f32_16x16x32_bf16 a[200:203], v[32:35], v[80:83], a[200:203]
    ds_read_b64_tr_b16 v[120:121], v195 offset:16384
    v_mfma_f32_16x16x32_bf16 a[200:203], v[36:39], v[84:87], a[200:203]
    buffer_load_dwordx4 v9, s[60:63], s48 offen offset:3072 lds
    v_mfma_f32_16x16x32_bf16 a[204:207], v[32:35], v[88:91], a[204:207]
    ds_read_b64_tr_b16 v[122:123], v195 offset:18432
    v_mfma_f32_16x16x32_bf16 a[204:207], v[36:39], v[92:95], a[204:207]
    s_waitcnt lgkmcnt(3)
    v_mfma_f32_16x16x32_bf16 a[208:211], v[40:43], v[64:67], a[208:211]
    ds_read_b128 v[32:35], v18 offset:12288
    v_mfma_f32_16x16x32_bf16 a[208:211], v[44:47], v[68:71], a[208:211]
    ds_read_b128 v[36:39], v19 offset:12288
    v_accvgpr_read_b32 v208, a96
    v_mfma_f32_16x16x32_bf16 a[212:215], v[40:43], v[72:75], a[212:215]
    ds_read_b64_tr_b16 v[124:125], v195 offset:24576
    v_accvgpr_read_b32 v209, a97
    v_mfma_f32_16x16x32_bf16 a[212:215], v[44:47], v[76:79], a[212:215]
    v_accvgpr_read_b32 v210, a98
    v_mfma_f32_16x16x32_bf16 a[216:219], v[40:43], v[80:83], a[216:219]
    v_accvgpr_read_b32 v211, a99
    v_mfma_f32_16x16x32_bf16 a[216:219], v[44:47], v[84:87], a[216:219]
    ds_read_b64_tr_b16 v[126:127], v195 offset:26624
    v_accvgpr_read_b32 v212, a100
    v_mfma_f32_16x16x32_bf16 a[220:223], v[40:43], v[88:91], a[220:223]
    v_accvgpr_read_b32 v213, a101
    v_mfma_f32_16x16x32_bf16 a[220:223], v[44:47], v[92:95], a[220:223]
    s_waitcnt lgkmcnt(2)
    v_mfma_f32_16x16x32_bf16 a[224:227], v[32:35], v[64:67], a[224:227]
    ds_read_b128 v[40:43], v18 offset:14336
    v_mfma_f32_16x16x32_bf16 a[224:227], v[36:39], v[68:71], a[224:227]
    ds_read_b128 v[44:47], v19 offset:14336
    v_accvgpr_read_b32 v214, a102
    v_mfma_f32_16x16x32_bf16 a[228:231], v[32:35], v[72:75], a[228:231]
    v_accvgpr_read_b32 v215, a103
    v_mfma_f32_16x16x32_bf16 a[228:231], v[36:39], v[76:79], a[228:231]
    v_cvt_pk_bf16_f32 v216, v208, v209
    v_mfma_f32_16x16x32_bf16 a[232:235], v[32:35], v[80:83], a[232:235]
    v_cvt_pk_bf16_f32 v217, v210, v211
    v_mfma_f32_16x16x32_bf16 a[232:235], v[36:39], v[84:87], a[232:235]
    v_cvt_pk_bf16_f32 v218, v212, v213
    v_mfma_f32_16x16x32_bf16 a[236:239], v[32:35], v[88:91], a[236:239]
    v_cvt_pk_bf16_f32 v219, v214, v215
    v_mfma_f32_16x16x32_bf16 a[236:239], v[36:39], v[92:95], a[236:239]
    s_waitcnt lgkmcnt(0)
    v_mfma_f32_16x16x32_bf16 a[240:243], v[40:43], v[64:67], a[240:243]
    s_waitcnt vmcnt(21)
    s_barrier
    buffer_store_dwordx4 v[216:219], v15, s[8:11], s87 offen offset:0 sc0 sc1
    v_mfma_f32_16x16x32_bf16 a[240:243], v[44:47], v[68:71], a[240:243]
    ds_read_b128 v[32:35], v16 offset:0
    v_mfma_f32_16x16x32_bf16 a[244:247], v[40:43], v[72:75], a[244:247]
    ds_read_b128 v[36:39], v17 offset:0
    v_mfma_f32_16x16x32_bf16 a[244:247], v[44:47], v[76:79], a[244:247]
    s_add_u32 m0, s40, 65536
    s_add_u32 s48, s35, 896
    buffer_load_dwordx4 v2, s[12:15], s48 offen offset:0 lds
    v_mfma_f32_16x16x32_bf16 a[248:251], v[40:43], v[80:83], a[248:251]
    v_mfma_f32_16x16x32_bf16 a[248:251], v[44:47], v[84:87], a[248:251]
    v_mfma_f32_16x16x32_bf16 a[252:255], v[40:43], v[88:91], a[252:255]
    buffer_load_dwordx4 v3, s[12:15], s48 offen offset:1024 lds
    v_mfma_f32_16x16x32_bf16 a[252:255], v[44:47], v[92:95], a[252:255]
    s_waitcnt lgkmcnt(0)
    v_mfma_f32_16x16x32_bf16 a[128:131], v[32:35], v[96:99], a[128:131]
    ds_read_b128 v[40:43], v16 offset:2048
    v_mfma_f32_16x16x32_bf16 a[128:131], v[36:39], v[100:103], a[128:131]
    ds_read_b128 v[44:47], v17 offset:2048
    v_accvgpr_read_b32 v220, a104
    v_mfma_f32_16x16x32_bf16 a[132:135], v[32:35], v[104:107], a[132:135]
    ds_read_b64_tr_b16 v[64:65], v192 offset:32768
    v_accvgpr_read_b32 v221, a105
    v_mfma_f32_16x16x32_bf16 a[132:135], v[36:39], v[108:111], a[132:135]
    buffer_load_dwordx4 v4, s[12:15], s48 offen offset:2048 lds
    v_accvgpr_read_b32 v222, a106
    v_mfma_f32_16x16x32_bf16 a[136:139], v[32:35], v[112:115], a[136:139]
    ds_read_b64_tr_b16 v[66:67], v192 offset:34816
    v_accvgpr_read_b32 v223, a107
    v_mfma_f32_16x16x32_bf16 a[136:139], v[36:39], v[116:119], a[136:139]
    buffer_load_dwordx4 v5, s[12:15], s48 offen offset:3072 lds
    v_accvgpr_read_b32 v224, a108
    v_mfma_f32_16x16x32_bf16 a[140:143], v[32:35], v[120:123], a[140:143]
    ds_read_b64_tr_b16 v[68:69], v192 offset:40960
    v_accvgpr_read_b32 v225, a109
    v_mfma_f32_16x16x32_bf16 a[140:143], v[36:39], v[124:127], a[140:143]
    s_waitcnt lgkmcnt(3)
    v_mfma_f32_16x16x32_bf16 a[144:147], v[40:43], v[96:99], a[144:147]
    ds_read_b128 v[32:35], v16 offset:4096
    v_mfma_f32_16x16x32_bf16 a[144:147], v[44:47], v[100:103], a[144:147]
    ds_read_b128 v[36:39], v17 offset:4096
    v_accvgpr_read_b32 v226, a110
    v_mfma_f32_16x16x32_bf16 a[148:151], v[40:43], v[104:107], a[148:151]
    ds_read_b64_tr_b16 v[70:71], v192 offset:43008
    v_accvgpr_read_b32 v227, a111
    v_mfma_f32_16x16x32_bf16 a[148:151], v[44:47], v[108:111], a[148:151]
    s_add_u32 m0, s40, 69632
    s_add_u32 s48, s35, 33664
    buffer_load_dwordx4 v2, s[12:15], s48 offen offset:0 lds
    v_cvt_pk_bf16_f32 v228, v220, v221
    v_mfma_f32_16x16x32_bf16 a[152:155], v[40:43], v[112:115], a[152:155]
    ds_read_b64_tr_b16 v[72:73], v193 offset:32768
    v_cvt_pk_bf16_f32 v229, v222, v223
    v_mfma_f32_16x16x32_bf16 a[152:155], v[44:47], v[116:119], a[152:155]
    v_cvt_pk_bf16_f32 v230, v224, v225
    v_mfma_f32_16x16x32_bf16 a[156:159], v[40:43], v[120:123], a[156:159]
    ds_read_b64_tr_b16 v[74:75], v193 offset:34816
    buffer_load_dwordx4 v3, s[12:15], s48 offen offset:1024 lds
    v_cvt_pk_bf16_f32 v231, v226, v227
    v_mfma_f32_16x16x32_bf16 a[156:159], v[44:47], v[124:127], a[156:159]
    s_waitcnt lgkmcnt(3)
    v_mfma_f32_16x16x32_bf16 a[160:163], v[32:35], v[96:99], a[160:163]
    ds_read_b128 v[40:43], v16 offset:6144
    buffer_store_dwordx4 v[228:231], v15, s[8:11], s87 offen offset:2048 sc0 sc1
    v_mfma_f32_16x16x32_bf16 a[160:163], v[36:39], v[100:103], a[160:163]
    ds_read_b128 v[44:47], v17 offset:6144
    v_mfma_f32_16x16x32_bf16 a[164:167], v[32:35], v[104:107], a[164:167]
    ds_read_b64_tr_b16 v[76:77], v193 offset:40960
    v_mfma_f32_16x16x32_bf16 a[164:167], v[36:39], v[108:111], a[164:167]
    buffer_load_dwordx4 v4, s[12:15], s48 offen offset:2048 lds
    v_mfma_f32_16x16x32_bf16 a[168:171], v[32:35], v[112:115], a[168:171]
    v_mfma_f32_16x16x32_bf16 a[168:171], v[36:39], v[116:119], a[168:171]
    ds_read_b64_tr_b16 v[78:79], v193 offset:43008
    buffer_load_dwordx4 v5, s[12:15], s48 offen offset:3072 lds
    v_mfma_f32_16x16x32_bf16 a[172:175], v[32:35], v[120:123], a[172:175]
    v_mfma_f32_16x16x32_bf16 a[172:175], v[36:39], v[124:127], a[172:175]
    s_waitcnt lgkmcnt(2)
    v_mfma_f32_16x16x32_bf16 a[176:179], v[40:43], v[96:99], a[176:179]
    ds_read_b128 v[32:35], v16 offset:8192
    v_mfma_f32_16x16x32_bf16 a[176:179], v[44:47], v[100:103], a[176:179]
    ds_read_b128 v[36:39], v17 offset:8192
    v_accvgpr_read_b32 v208, a112
    v_mfma_f32_16x16x32_bf16 a[180:183], v[40:43], v[104:107], a[180:183]
    ds_read_b64_tr_b16 v[80:81], v194 offset:32768
    v_accvgpr_read_b32 v209, a113
    v_mfma_f32_16x16x32_bf16 a[180:183], v[44:47], v[108:111], a[180:183]
    s_add_u32 m0, s41, 114688
    s_add_u32 s48, s37, 524288
    buffer_load_dwordx4 v6, s[60:63], s48 offen offset:0 lds
    v_accvgpr_read_b32 v210, a114
    v_mfma_f32_16x16x32_bf16 a[184:187], v[40:43], v[112:115], a[184:187]
    ds_read_b64_tr_b16 v[82:83], v194 offset:34816
    v_accvgpr_read_b32 v211, a115
    v_mfma_f32_16x16x32_bf16 a[184:187], v[44:47], v[116:119], a[184:187]
    v_accvgpr_read_b32 v212, a116
    v_mfma_f32_16x16x32_bf16 a[188:191], v[40:43], v[120:123], a[188:191]
    ds_read_b64_tr_b16 v[84:85], v194 offset:40960
    buffer_load_dwordx4 v7, s[60:63], s48 offen offset:1024 lds
    v_accvgpr_read_b32 v213, a117
    v_mfma_f32_16x16x32_bf16 a[188:191], v[44:47], v[124:127], a[188:191]
    s_waitcnt lgkmcnt(3)
    v_mfma_f32_16x16x32_bf16 a[192:195], v[32:35], v[96:99], a[192:195]
    ds_read_b128 v[40:43], v16 offset:10240
    v_mfma_f32_16x16x32_bf16 a[192:195], v[36:39], v[100:103], a[192:195]
    ds_read_b128 v[44:47], v17 offset:10240
    v_accvgpr_read_b32 v214, a118
    v_mfma_f32_16x16x32_bf16 a[196:199], v[32:35], v[104:107], a[196:199]
    ds_read_b64_tr_b16 v[86:87], v194 offset:43008
    v_accvgpr_read_b32 v215, a119
    v_mfma_f32_16x16x32_bf16 a[196:199], v[36:39], v[108:111], a[196:199]
    buffer_load_dwordx4 v8, s[60:63], s48 offen offset:2048 lds
    v_cvt_pk_bf16_f32 v216, v208, v209
    v_mfma_f32_16x16x32_bf16 a[200:203], v[32:35], v[112:115], a[200:203]
    ds_read_b64_tr_b16 v[88:89], v195 offset:32768
    v_cvt_pk_bf16_f32 v217, v210, v211
    v_mfma_f32_16x16x32_bf16 a[200:203], v[36:39], v[116:119], a[200:203]
    buffer_load_dwordx4 v9, s[60:63], s48 offen offset:3072 lds
    v_cvt_pk_bf16_f32 v218, v212, v213
    v_mfma_f32_16x16x32_bf16 a[204:207], v[32:35], v[120:123], a[204:207]
    ds_read_b64_tr_b16 v[90:91], v195 offset:34816
    v_cvt_pk_bf16_f32 v219, v214, v215
    v_mfma_f32_16x16x32_bf16 a[204:207], v[36:39], v[124:127], a[204:207]
    s_waitcnt lgkmcnt(3)
    v_mfma_f32_16x16x32_bf16 a[208:211], v[40:43], v[96:99], a[208:211]
    ds_read_b128 v[32:35], v16 offset:12288
    buffer_store_dwordx4 v[216:219], v15, s[8:11], s87 offen offset:128 sc0 sc1
    v_mfma_f32_16x16x32_bf16 a[208:211], v[44:47], v[100:103], a[208:211]
    ds_read_b128 v[36:39], v17 offset:12288
    v_mfma_f32_16x16x32_bf16 a[212:215], v[40:43], v[104:107], a[212:215]
    ds_read_b64_tr_b16 v[92:93], v195 offset:40960
    v_mfma_f32_16x16x32_bf16 a[212:215], v[44:47], v[108:111], a[212:215]
    v_mfma_f32_16x16x32_bf16 a[216:219], v[40:43], v[112:115], a[216:219]
    v_mfma_f32_16x16x32_bf16 a[216:219], v[44:47], v[116:119], a[216:219]
    ds_read_b64_tr_b16 v[94:95], v195 offset:43008
    v_mfma_f32_16x16x32_bf16 a[220:223], v[40:43], v[120:123], a[220:223]
    v_mfma_f32_16x16x32_bf16 a[220:223], v[44:47], v[124:127], a[220:223]
    s_waitcnt lgkmcnt(2)
    v_mfma_f32_16x16x32_bf16 a[224:227], v[32:35], v[96:99], a[224:227]
    ds_read_b128 v[40:43], v16 offset:14336
    v_mfma_f32_16x16x32_bf16 a[224:227], v[36:39], v[100:103], a[224:227]
    ds_read_b128 v[44:47], v17 offset:14336
    v_accvgpr_read_b32 v220, a120
    v_mfma_f32_16x16x32_bf16 a[228:231], v[32:35], v[104:107], a[228:231]
    v_accvgpr_read_b32 v221, a121
    v_mfma_f32_16x16x32_bf16 a[228:231], v[36:39], v[108:111], a[228:231]
    v_accvgpr_read_b32 v222, a122
    v_mfma_f32_16x16x32_bf16 a[232:235], v[32:35], v[112:115], a[232:235]
    v_accvgpr_read_b32 v223, a123
    v_mfma_f32_16x16x32_bf16 a[232:235], v[36:39], v[116:119], a[232:235]
    v_accvgpr_read_b32 v224, a124
    v_mfma_f32_16x16x32_bf16 a[236:239], v[32:35], v[120:123], a[236:239]
    v_accvgpr_read_b32 v225, a125
    v_mfma_f32_16x16x32_bf16 a[236:239], v[36:39], v[124:127], a[236:239]
    s_waitcnt vmcnt(35)
    s_cmp_lg_u32 s32, 0
    s_cbranch_scc1 L_g1_cc5g
    s_mov_b32 s7, 0
L_g1_cc5:
    v_cmp_ne_u32 vcc, 0x01010101, v203
    s_add_u32 s7, s7, 1
    s_cbranch_vccz L_g1_cc5g
    s_sleep 8
    buffer_load_dword v203, v52, s[28:31], 0 offen sc0 sc1
    s_waitcnt vmcnt(0)
    s_cmp_lt_u32 s7, 0x20000
    s_cbranch_scc1 L_g1_cc5
L_g1_cc5g:
    s_waitcnt lgkmcnt(0)
    v_mfma_f32_16x16x32_bf16 a[240:243], v[40:43], v[96:99], a[240:243]
    s_waitcnt vmcnt(20)
    s_barrier
    v_mfma_f32_16x16x32_bf16 a[240:243], v[44:47], v[100:103], a[240:243]
    ds_read_b128 v[32:35], v16 offset:32768
    v_accvgpr_read_b32 v226, a126
    v_mfma_f32_16x16x32_bf16 a[244:247], v[40:43], v[104:107], a[244:247]
    ds_read_b128 v[36:39], v17 offset:32768
    v_accvgpr_read_b32 v227, a127
    v_mfma_f32_16x16x32_bf16 a[244:247], v[44:47], v[108:111], a[244:247]
    s_add_u32 m0, s40, 0
    s_add_u32 s48, s36, 0
    buffer_load_dwordx4 v2, s[8:11], s48 offen offset:0 sc1 lds
    v_cvt_pk_bf16_f32 v228, v220, v221
    v_mfma_f32_16x16x32_bf16 a[248:251], v[40:43], v[112:115], a[248:251]
    v_cvt_pk_bf16_f32 v229, v222, v223
    v_mfma_f32_16x16x32_bf16 a[248:251], v[44:47], v[116:119], a[248:251]
    v_cvt_pk_bf16_f32 v230, v224, v225
    v_mfma_f32_16x16x32_bf16 a[252:255], v[40:43], v[120:123], a[252:255]
    buffer_load_dwordx4 v3, s[8:11], s48 offen offset:1024 sc1 lds
    v_cvt_pk_bf16_f32 v231, v226, v227
    v_mfma_f32_16x16x32_bf16 a[252:255], v[44:47], v[124:127], a[252:255]
    s_waitcnt lgkmcnt(0)
    v_mfma_f32_16x16x32_bf16 a[128:131], v[32:35], v[64:67], a[128:131]
    ds_read_b128 v[40:43], v16 offset:34816
    buffer_store_dwordx4 v[228:231], v15, s[8:11], s87 offen offset:2176 sc0 sc1
    v_mfma_f32_16x16x32_bf16 a[128:131], v[36:39], v[68:71], a[128:131]
    ds_read_b128 v[44:47], v17 offset:34816
    v_mfma_f32_16x16x32_bf16 a[132:135], v[32:35], v[72:75], a[132:135]
    ds_read_b64_tr_b16 v[96:97], v192 offset:49152
    v_mfma_f32_16x16x32_bf16 a[132:135], v[36:39], v[76:79], a[132:135]
    buffer_load_dwordx4 v4, s[8:11], s48 offen offset:2048 sc1 lds
    v_mfma_f32_16x16x32_bf16 a[136:139], v[32:35], v[80:83], a[136:139]
    ds_read_b64_tr_b16 v[98:99], v192 offset:51200
    v_mfma_f32_16x16x32_bf16 a[136:139], v[36:39], v[84:87], a[136:139]
    buffer_load_dwordx4 v5, s[8:11], s48 offen offset:3072 sc1 lds
    v_mfma_f32_16x16x32_bf16 a[140:143], v[32:35], v[88:91], a[140:143]
    ds_read_b64_tr_b16 v[100:101], v192 offset:57344
    v_mfma_f32_16x16x32_bf16 a[140:143], v[36:39], v[92:95], a[140:143]
    s_waitcnt lgkmcnt(3)
    v_mfma_f32_16x16x32_bf16 a[144:147], v[40:43], v[64:67], a[144:147]
    ds_read_b128 v[32:35], v16 offset:36864
    v_mfma_f32_16x16x32_bf16 a[144:147], v[44:47], v[68:71], a[144:147]
    ds_read_b128 v[36:39], v17 offset:36864
    v_mfma_f32_16x16x32_bf16 a[148:151], v[40:43], v[72:75], a[148:151]
    ds_read_b64_tr_b16 v[102:103], v192 offset:59392
    v_mfma_f32_16x16x32_bf16 a[148:151], v[44:47], v[76:79], a[148:151]
    s_add_u32 m0, s40, 4096
    s_add_u32 s48, s36, 32768
    buffer_load_dwordx4 v2, s[8:11], s48 offen offset:0 sc1 lds
    v_mfma_f32_16x16x32_bf16 a[152:155], v[40:43], v[80:83], a[152:155]
    ds_read_b64_tr_b16 v[104:105], v193 offset:49152
    v_mfma_f32_16x16x32_bf16 a[152:155], v[44:47], v[84:87], a[152:155]
    v_mfma_f32_16x16x32_bf16 a[156:159], v[40:43], v[88:91], a[156:159]
    ds_read_b64_tr_b16 v[106:107], v193 offset:51200
    buffer_load_dwordx4 v3, s[8:11], s48 offen offset:1024 sc1 lds
    v_mfma_f32_16x16x32_bf16 a[156:159], v[44:47], v[92:95], a[156:159]
    s_waitcnt lgkmcnt(3)
    v_mfma_f32_16x16x32_bf16 a[160:163], v[32:35], v[64:67], a[160:163]
    ds_read_b128 v[40:43], v16 offset:38912
    v_mfma_f32_16x16x32_bf16 a[160:163], v[36:39], v[68:71], a[160:163]
    ds_read_b128 v[44:47], v17 offset:38912
    v_mfma_f32_16x16x32_bf16 a[164:167], v[32:35], v[72:75], a[164:167]
    ds_read_b64_tr_b16 v[108:109], v193 offset:57344
    v_mfma_f32_16x16x32_bf16 a[164:167], v[36:39], v[76:79], a[164:167]
    buffer_load_dwordx4 v4, s[8:11], s48 offen offset:2048 sc1 lds
    v_mfma_f32_16x16x32_bf16 a[168:171], v[32:35], v[80:83], a[168:171]
    v_mfma_f32_16x16x32_bf16 a[168:171], v[36:39], v[84:87], a[168:171]
    ds_read_b64_tr_b16 v[110:111], v193 offset:59392
    buffer_load_dwordx4 v5, s[8:11], s48 offen offset:3072 sc1 lds
    v_mfma_f32_16x16x32_bf16 a[172:175], v[32:35], v[88:91], a[172:175]
    v_mfma_f32_16x16x32_bf16 a[172:175], v[36:39], v[92:95], a[172:175]
    s_waitcnt lgkmcnt(2)
    v_mfma_f32_16x16x32_bf16 a[176:179], v[40:43], v[64:67], a[176:179]
    ds_read_b128 v[32:35], v16 offset:40960
    v_mfma_f32_16x16x32_bf16 a[176:179], v[44:47], v[68:71], a[176:179]
    ds_read_b128 v[36:39], v17 offset:40960
    v_mfma_f32_16x16x32_bf16 a[180:183], v[40:43], v[72:75], a[180:183]
    ds_read_b64_tr_b16 v[112:113], v194 offset:49152
    v_mfma_f32_16x16x32_bf16 a[180:183], v[44:47], v[76:79], a[180:183]
    s_add_u32 m0, s41, 131072
    s_add_u32 s48, s37, 1048576
    buffer_load_dwordx4 v6, s[60:63], s48 offen offset:0 lds
    v_mfma_f32_16x16x32_bf16 a[184:187], v[40:43], v[80:83], a[184:187]
    ds_read_b64_tr_b16 v[114:115], v194 offset:51200
    v_mfma_f32_16x16x32_bf16 a[184:187], v[44:47], v[84:87], a[184:187]
    v_mfma_f32_16x16x32_bf16 a[188:191], v[40:43], v[88:91], a[188:191]
    ds_read_b64_tr_b16 v[116:117], v194 offset:57344
    buffer_load_dwordx4 v7, s[60:63], s48 offen offset:1024 lds
    v_mfma_f32_16x16x32_bf16 a[188:191], v[44:47], v[92:95], a[188:191]
    s_waitcnt lgkmcnt(3)
    v_mfma_f32_16x16x32_bf16 a[192:195], v[32:35], v[64:67], a[192:195]
    ds_read_b128 v[40:43], v16 offset:43008
    v_mfma_f32_16x16x32_bf16 a[192:195], v[36:39], v[68:71], a[192:195]
    ds_read_b128 v[44:47], v17 offset:43008
    v_mfma_f32_16x16x32_bf16 a[196:199], v[32:35], v[72:75], a[196:199]
    ds_read_b64_tr_b16 v[118:119], v194 offset:59392
    v_mfma_f32_16x16x32_bf16 a[196:199], v[36:39], v[76:79], a[196:199]
    buffer_load_dwordx4 v8, s[60:63], s48 offen offset:2048 lds
    v_mfma_f32_16x16x32_bf16 a[200:203], v[32:35], v[80:83], a[200:203]
    ds_read_b64_tr_b16 v[120:121], v195 offset:49152
    v_mfma_f32_16x16x32_bf16 a[200:203], v[36:39], v[84:87], a[200:203]
    buffer_load_dwordx4 v9, s[60:63], s48 offen offset:3072 lds
    v_mfma_f32_16x16x32_bf16 a[204:207], v[32:35], v[88:91], a[204:207]
    ds_read_b64_tr_b16 v[122:123], v195 offset:51200
    v_mfma_f32_16x16x32_bf16 a[204:207], v[36:39], v[92:95], a[204:207]
    s_waitcnt lgkmcnt(3)
    v_mfma_f32_16x16x32_bf16 a[208:211], v[40:43], v[64:67], a[208:211]
    ds_read_b128 v[32:35], v16 offset:45056
    v_mfma_f32_16x16x32_bf16 a[208:211], v[44:47], v[68:71], a[208:211]
    ds_read_b128 v[36:39], v17 offset:45056
    v_mfma_f32_16x16x32_bf16 a[212:215], v[40:43], v[72:75], a[212:215]
    ds_read_b64_tr_b16 v[124:125], v195 offset:57344
    v_mfma_f32_16x16x32_bf16 a[212:215], v[44:47], v[76:79], a[212:215]
    v_mfma_f32_16x16x32_bf16 a[216:219], v[40:43], v[80:83], a[216:219]
    v_mfma_f32_16x16x32_bf16 a[216:219], v[44:47], v[84:87], a[216:219]
    ds_read_b64_tr_b16 v[126:127], v195 offset:59392
    v_mfma_f32_16x16x32_bf16 a[220:223], v[40:43], v[88:91], a[220:223]
    v_mfma_f32_16x16x32_bf16 a[220:223], v[44:47], v[92:95], a[220:223]
    s_waitcnt lgkmcnt(2)
    v_mfma_f32_16x16x32_bf16 a[224:227], v[32:35], v[64:67], a[224:227]
    ds_read_b128 v[40:43], v16 offset:47104
    v_mfma_f32_16x16x32_bf16 a[224:227], v[36:39], v[68:71], a[224:227]
    ds_read_b128 v[44:47], v17 offset:47104
    v_mfma_f32_16x16x32_bf16 a[228:231], v[32:35], v[72:75], a[228:231]
    v_mfma_f32_16x16x32_bf16 a[228:231], v[36:39], v[76:79], a[228:231]
    v_mfma_f32_16x16x32_bf16 a[232:235], v[32:35], v[80:83], a[232:235]
    v_mfma_f32_16x16x32_bf16 a[232:235], v[36:39], v[84:87], a[232:235]
    v_mfma_f32_16x16x32_bf16 a[236:239], v[32:35], v[88:91], a[236:239]
    v_mfma_f32_16x16x32_bf16 a[236:239], v[36:39], v[92:95], a[236:239]
    s_waitcnt lgkmcnt(0)
    v_mfma_f32_16x16x32_bf16 a[240:243], v[40:43], v[64:67], a[240:243]
    s_waitcnt vmcnt(18)
    s_barrier
    v_mfma_f32_16x16x32_bf16 a[240:243], v[44:47], v[68:71], a[240:243]
    ds_read_b128 v[32:35], v18 offset:0
    v_mfma_f32_16x16x32_bf16 a[244:247], v[40:43], v[72:75], a[244:247]
    ds_read_b128 v[36:39], v19 offset:0
    v_mfma_f32_16x16x32_bf16 a[244:247], v[44:47], v[76:79], a[244:247]
    s_add_u32 m0, s40, 32768
    s_add_u32 s48, s36, 128
    buffer_load_dwordx4 v2, s[8:11], s48 offen offset:0 sc1 lds
    v_mfma_f32_16x16x32_bf16 a[248:251], v[40:43], v[80:83], a[248:251]
    v_mfma_f32_16x16x32_bf16 a[248:251], v[44:47], v[84:87], a[248:251]
    v_mfma_f32_16x16x32_bf16 a[252:255], v[40:43], v[88:91], a[252:255]
    buffer_load_dwordx4 v3, s[8:11], s48 offen offset:1024 sc1 lds
    v_mfma_f32_16x16x32_bf16 a[252:255], v[44:47], v[92:95], a[252:255]
    s_waitcnt lgkmcnt(0)
    v_mfma_f32_16x16x32_bf16 a[128:131], v[32:35], v[96:99], a[128:131]
    ds_read_b128 v[40:43], v18 offset:2048
    v_mfma_f32_16x16x32_bf16 a[128:131], v[36:39], v[100:103], a[128:131]
    ds_read_b128 v[44:47], v19 offset:2048
    v_mfma_f32_16x16x32_bf16 a[132:135], v[32:35], v[104:107], a[132:135]
    ds_read_b64_tr_b16 v[64:65], v192 offset:0
    v_mfma_f32_16x16x32_bf16 a[132:135], v[36:39], v[108:111], a[132:135]
    buffer_load_dwordx4 v4, s[8:11], s48 offen offset:2048 sc1 lds
    v_mfma_f32_16x16x32_bf16 a[136:139], v[32:35], v[112:115], a[136:139]
    ds_read_b64_tr_b16 v[66:67], v192 offset:2048
    v_mfma_f32_16x16x32_bf16 a[136:139], v[36:39], v[116:119], a[136:139]
    buffer_load_dwordx4 v5, s[8:11], s48 offen offset:3072 sc1 lds
    v_mfma_f32_16x16x32_bf16 a[140:143], v[32:35], v[120:123], a[140:143]
    ds_read_b64_tr_b16 v[68:69], v192 offset:8192
    v_mfma_f32_16x16x32_bf16 a[140:143], v[36:39], v[124:127], a[140:143]
    s_waitcnt lgkmcnt(3)
    v_mfma_f32_16x16x32_bf16 a[144:147], v[40:43], v[96:99], a[144:147]
    ds_read_b128 v[32:35], v18 offset:4096
    v_mfma_f32_16x16x32_bf16 a[144:147], v[44:47], v[100:103], a[144:147]
    ds_read_b128 v[36:39], v19 offset:4096
    v_mfma_f32_16x16x32_bf16 a[148:151], v[40:43], v[104:107], a[148:151]
    ds_read_b64_tr_b16 v[70:71], v192 offset:10240
    v_mfma_f32_16x16x32_bf16 a[148:151], v[44:47], v[108:111], a[148:151]
    s_add_u32 m0, s40, 36864
    s_add_u32 s48, s36, 32896
    buffer_load_dwordx4 v2, s[8:11], s48 offen offset:0 sc1 lds
    v_mfma_f32_16x16x32_bf16 a[152:155], v[40:43], v[112:115], a[152:155]
    ds_read_b64_tr_b16 v[72:73], v193 offset:0
    v_mfma_f32_16x16x32_bf16 a[152:155], v[44:47], v[116:119], a[152:155]
    v_mfma_f32_16x16x32_bf16 a[156:159], v[40:43], v[120:123], a[156:159]
    ds_read_b64_tr_b16 v[74:75], v193 offset:2048
    buffer_load_dwordx4 v3, s[8:11], s48 offen offset:1024 sc1 lds
    v_mfma_f32_16x16x32_bf16 a[156:159], v[44:47], v[124:127], a[156:159]
    s_waitcnt lgkmcnt(3)
    v_mfma_f32_16x16x32_bf16 a[160:163], v[32:35], v[96:99], a[160:163]
    ds_read_b128 v[40:43], v18 offset:6144
    v_mfma_f32_16x16x32_bf16 a[160:163], v[36:39], v[100:103], a[160:163]
    ds_read_b128 v[44:47], v19 offset:6144
    v_mfma_f32_16x16x32_bf16 a[164:167], v[32:35], v[104:107], a[164:167]
    ds_read_b64_tr_b16 v[76:77], v193 offset:8192
    v_mfma_f32_16x16x32_bf16 a[164:167], v[36:39], v[108:111], a[164:167]
    buffer_load_dwordx4 v4, s[8:11], s48 offen offset:2048 sc1 lds
    v_mfma_f32_16x16x32_bf16 a[168:171], v[32:35], v[112:115], a[168:171]
    v_mfma_f32_16x16x32_bf16 a[168:171], v[36:39], v[116:119], a[168:171]
    ds_read_b64_tr_b16 v[78:79], v193 offset:10240
    buffer_load_dwordx4 v5, s[8:11], s48 offen offset:3072 sc1 lds
    v_mfma_f32_16x16x32_bf16 a[172:175], v[32:35], v[120:123], a[172:175]
    v_mfma_f32_16x16x32_bf16 a[172:175], v[36:39], v[124:127], a[172:175]
    s_waitcnt lgkmcnt(2)
    v_mfma_f32_16x16x32_bf16 a[176:179], v[40:43], v[96:99], a[176:179]
    ds_read_b128 v[32:35], v18 offset:8192
    v_mfma_f32_16x16x32_bf16 a[176:179], v[44:47], v[100:103], a[176:179]
    ds_read_b128 v[36:39], v19 offset:8192
    v_mfma_f32_16x16x32_bf16 a[180:183], v[40:43], v[104:107], a[180:183]
    ds_read_b64_tr_b16 v[80:81], v194 offset:0
    v_mfma_f32_16x16x32_bf16 a[180:183], v[44:47], v[108:111], a[180:183]
    s_add_u32 m0, s41, 147456
    s_add_u32 s48, s37, 1572864
    buffer_load_dwordx4 v6, s[60:63], s48 offen offset:0 lds
    v_mfma_f32_16x16x32_bf16 a[184:187], v[40:43], v[112:115], a[184:187]
    ds_read_b64_tr_b16 v[82:83], v194 offset:2048
    v_mfma_f32_16x16x32_bf16 a[184:187], v[44:47], v[116:119], a[184:187]
    v_mfma_f32_16x16x32_bf16 a[188:191], v[40:43], v[120:123], a[188:191]
    ds_read_b64_tr_b16 v[84:85], v194 offset:8192
    buffer_load_dwordx4 v7, s[60:63], s48 offen offset:1024 lds
    v_mfma_f32_16x16x32_bf16 a[188:191], v[44:47], v[124:127], a[188:191]
    s_waitcnt lgkmcnt(3)
    v_mfma_f32_16x16x32_bf16 a[192:195], v[32:35], v[96:99], a[192:195]
    ds_read_b128 v[40:43], v18 offset:10240
    v_mfma_f32_16x16x32_bf16 a[192:195], v[36:39], v[100:103], a[192:195]
    ds_read_b128 v[44:47], v19 offset:10240
    v_mfma_f32_16x16x32_bf16 a[196:199], v[32:35], v[104:107], a[196:199]
    ds_read_b64_tr_b16 v[86:87], v194 offset:10240
    v_mfma_f32_16x16x32_bf16 a[196:199], v[36:39], v[108:111], a[196:199]
    buffer_load_dwordx4 v8, s[60:63], s48 offen offset:2048 lds
    v_mfma_f32_16x16x32_bf16 a[200:203], v[32:35], v[112:115], a[200:203]
    ds_read_b64_tr_b16 v[88:89], v195 offset:0
    v_mfma_f32_16x16x32_bf16 a[200:203], v[36:39], v[116:119], a[200:203]
    buffer_load_dwordx4 v9, s[60:63], s48 offen offset:3072 lds
    v_mfma_f32_16x16x32_bf16 a[204:207], v[32:35], v[120:123], a[204:207]
    ds_read_b64_tr_b16 v[90:91], v195 offset:2048
    v_mfma_f32_16x16x32_bf16 a[204:207], v[36:39], v[124:127], a[204:207]
    s_waitcnt lgkmcnt(3)
    v_mfma_f32_16x16x32_bf16 a[208:211], v[40:43], v[96:99], a[208:211]
    ds_read_b128 v[32:35], v18 offset:12288
    v_mfma_f32_16x16x32_bf16 a[208:211], v[44:47], v[100:103], a[208:211]
    ds_read_b128 v[36:39], v19 offset:12288
    v_mfma_f32_16x16x32_bf16 a[212:215], v[40:43], v[104:107], a[212:215]
    ds_read_b64_tr_b16 v[92:93], v195 offset:8192
    v_mfma_f32_16x16x32_bf16 a[212:215], v[44:47], v[108:111], a[212:215]
    v_mfma_f32_16x16x32_bf16 a[216:219], v[40:43], v[112:115], a[216:219]
    s_mov_b32 s54, 0x3e0293ee
    s_and_b32 s6, s32, 1
    s_lshl_b32 s6, s6, 12
    v_add_u32 v22, s6, v14
    s_cmp_lt_u32 s32, 2
    s_mov_b32 s5, 114688
    s_cselect_b32 s4, 16384, s5
    v_add_u32 v50, s4, v22
    s_mov_b32 s5, 131072
    s_cselect_b32 s4, 81920, s5
    v_add_u32 v51, s4, v22
    v_mfma_f32_16x16x32_bf16 a[216:219], v[44:47], v[116:119], a[216:219]
    ds_read_b64_tr_b16 v[94:95], v195 offset:10240
    v_mfma_f32_16x16x32_bf16 a[220:223], v[40:43], v[120:123], a[220:223]
    v_mfma_f32_16x16x32_bf16 a[220:223], v[44:47], v[124:127], a[220:223]
    s_waitcnt lgkmcnt(2)
    v_mfma_f32_16x16x32_bf16 a[224:227], v[32:35], v[96:99], a[224:227]
    ds_read_b128 v[40:43], v18 offset:14336
    v_mfma_f32_16x16x32_bf16 a[224:227], v[36:39], v[100:103], a[224:227]
    ds_read_b128 v[44:47], v19 offset:14336
    v_mfma_f32_16x16x32_bf16 a[228:231], v[32:35], v[104:107], a[228:231]
    v_mfma_f32_16x16x32_bf16 a[228:231], v[36:39], v[108:111], a[228:231]
    v_mfma_f32_16x16x32_bf16 a[232:235], v[32:35], v[112:115], a[232:235]
    v_mfma_f32_16x16x32_bf16 a[232:235], v[36:39], v[116:119], a[232:235]
    v_mfma_f32_16x16x32_bf16 a[236:239], v[32:35], v[120:123], a[236:239]
    v_mfma_f32_16x16x32_bf16 a[236:239], v[36:39], v[124:127], a[236:239]
    s_waitcnt lgkmcnt(0)
    v_mfma_f32_16x16x32_bf16 a[240:243], v[40:43], v[96:99], a[240:243]
    s_waitcnt vmcnt(16)
    s_barrier
    v_mfma_f32_16x16x32_bf16 a[240:243], v[44:47], v[100:103], a[240:243]
    ds_read_b128 v[32:35], v16 offset:0
    v_mfma_f32_16x16x32_bf16 a[244:247], v[40:43], v[104:107], a[244:247]
    ds_read_b128 v[36:39], v17 offset:0
    v_mfma_f32_16x16x32_bf16 a[244:247], v[44:47], v[108:111], a[244:247]
    s_add_u32 m0, s40, 65536
    s_add_u32 s48, s36, 256
    buffer_load_dwordx4 v2, s[8:11], s48 offen offset:0 sc1 lds
    v_mfma_f32_16x16x32_bf16 a[248:251], v[40:43], v[112:115], a[248:251]
    v_mfma_f32_16x16x32_bf16 a[248:251], v[44:47], v[116:119], a[248:251]
    v_mfma_f32_16x16x32_bf16 a[252:255], v[40:43], v[120:123], a[252:255]
    buffer_load_dwordx4 v3, s[8:11], s48 offen offset:1024 sc1 lds
    v_mfma_f32_16x16x32_bf16 a[252:255], v[44:47], v[124:127], a[252:255]
    s_waitcnt lgkmcnt(0)
    v_mfma_f32_16x16x32_bf16 a[0:3], v[64:67], v[32:35], 0
    ds_read_b128 v[40:43], v16 offset:2048
    v_mfma_f32_16x16x32_bf16 a[0:3], v[68:71], v[36:39], a[0:3]
    ds_read_b128 v[44:47], v17 offset:2048
    v_mfma_f32_16x16x32_bf16 a[4:7], v[72:75], v[32:35], 0
    ds_read_b64_tr_b16 v[96:97], v192 offset:16384
    v_mfma_f32_16x16x32_bf16 a[4:7], v[76:79], v[36:39], a[4:7]
    buffer_load_dwordx4 v4, s[8:11], s48 offen offset:2048 sc1 lds
    v_mfma_f32_16x16x32_bf16 a[8:11], v[80:83], v[32:35], 0
    ds_read_b64_tr_b16 v[98:99], v192 offset:18432
    v_mfma_f32_16x16x32_bf16 a[8:11], v[84:87], v[36:39], a[8:11]
    buffer_load_dwordx4 v5, s[8:11], s48 offen offset:3072 sc1 lds
    v_mfma_f32_16x16x32_bf16 a[12:15], v[88:91], v[32:35], 0
    ds_read_b64_tr_b16 v[100:101], v192 offset:24576
    v_mfma_f32_16x16x32_bf16 a[12:15], v[92:95], v[36:39], a[12:15]
    s_waitcnt lgkmcnt(3)
    v_mfma_f32_16x16x32_bf16 a[16:19], v[64:67], v[40:43], 0
    ds_read_b128 v[32:35], v16 offset:4096
    v_mfma_f32_16x16x32_bf16 a[16:19], v[68:71], v[44:47], a[16:19]
    ds_read_b128 v[36:39], v17 offset:4096
    v_accvgpr_read_b32 v208, a128
    v_mfma_f32_16x16x32_bf16 a[20:23], v[72:75], v[40:43], 0
    ds_read_b64_tr_b16 v[102:103], v192 offset:26624
    v_accvgpr_read_b32 v209, a129
    v_mfma_f32_16x16x32_bf16 a[20:23], v[76:79], v[44:47], a[20:23]
    s_add_u32 m0, s40, 69632
    s_add_u32 s48, s36, 33024
    buffer_load_dwordx4 v2, s[8:11], s48 offen offset:0 sc1 lds
    v_accvgpr_read_b32 v210, a130
    v_mfma_f32_16x16x32_bf16 a[24:27], v[80:83], v[40:43], 0
    ds_read_b64_tr_b16 v[104:105], v193 offset:16384
    v_accvgpr_read_b32 v211, a131
    v_mfma_f32_16x16x32_bf16 a[24:27], v[84:87], v[44:47], a[24:27]
    v_accvgpr_read_b32 v212, a144
    v_mfma_f32_16x16x32_bf16 a[28:31], v[88:91], v[40:43], 0
    ds_read_b64_tr_b16 v[106:107], v193 offset:18432
    buffer_load_dwordx4 v3, s[8:11], s48 offen offset:1024 sc1 lds
    v_accvgpr_read_b32 v213, a145
    v_mfma_f32_16x16x32_bf16 a[28:31], v[92:95], v[44:47], a[28:31]
    s_waitcnt lgkmcnt(3)
    v_mfma_f32_16x16x32_bf16 a[32:35], v[64:67], v[32:35], 0
    ds_read_b128 v[40:43], v16 offset:6144
    v_mfma_f32_16x16x32_bf16 a[32:35], v[68:71], v[36:39], a[32:35]
    ds_read_b128 v[44:47], v17 offset:6144
    v_accvgpr_read_b32 v214, a146
    v_mfma_f32_16x16x32_bf16 a[36:39], v[72:75], v[32:35], 0
    ds_read_b64_tr_b16 v[108:109], v193 offset:24576
    v_accvgpr_read_b32 v215, a147
    v_mfma_f32_16x16x32_bf16 a[36:39], v[76:79], v[36:39], a[36:39]
    buffer_load_dwordx4 v4, s[8:11], s48 offen offset:2048 sc1 lds
    v_cvt_pk_bf16_f32 v216, v208, v209
    v_mfma_f32_16x16x32_bf16 a[40:43], v[80:83], v[32:35], 0
    v_cvt_pk_bf16_f32 v217, v210, v211
    v_mfma_f32_16x16x32_bf16 a[40:43], v[84:87], v[36:39], a[40:43]
    ds_read_b64_tr_b16 v[110:111], v193 offset:26624
    buffer_load_dwordx4 v5, s[8:11], s48 offen offset:3072 sc1 lds
    v_cvt_pk_bf16_f32 v218, v212, v213
    v_mfma_f32_16x16x32_bf16 a[44:47], v[88:91], v[32:35], 0
    v_cvt_pk_bf16_f32 v219, v214, v215
    v_mfma_f32_16x16x32_bf16 a[44:47], v[92:95], v[36:39], a[44:47]
    s_waitcnt lgkmcnt(2)
    v_mfma_f32_16x16x32_bf16 a[48:51], v[64:67], v[40:43], 0
    ds_read_b128 v[32:35], v16 offset:8192
    buffer_store_dwordx4 v[216:219], v14, s[8:11], s88 offen offset:0 sc0 sc1
    v_mfma_f32_16x16x32_bf16 a[48:51], v[68:71], v[44:47], a[48:51]
    ds_read_b128 v[36:39], v17 offset:8192
    v_accvgpr_read_b32 v220, a132
    v_mfma_f32_16x16x32_bf16 a[52:55], v[72:75], v[40:43], 0
    ds_read_b64_tr_b16 v[112:113], v194 offset:16384
    v_accvgpr_read_b32 v221, a133
    v_mfma_f32_16x16x32_bf16 a[52:55], v[76:79], v[44:47], a[52:55]
    s_add_u32 m0, s41, 98304
    s_add_u32 s48, s37, 2097152
    buffer_load_dwordx4 v6, s[60:63], s48 offen offset:0 lds
    v_accvgpr_read_b32 v222, a134
    v_mfma_f32_16x16x32_bf16 a[56:59], v[80:83], v[40:43], 0
    ds_read_b64_tr_b16 v[114:115], v194 offset:18432
    v_accvgpr_read_b32 v223, a135
    v_mfma_f32_16x16x32_bf16 a[56:59], v[84:87], v[44:47], a[56:59]
    v_accvgpr_read_b32 v224, a148
    v_mfma_f32_16x16x32_bf16 a[60:63], v[88:91], v[40:43], 0
    ds_read_b64_tr_b16 v[116:117], v194 offset:24576
    buffer_load_dwordx4 v7, s[60:63], s48 offen offset:1024 lds
    v_accvgpr_read_b32 v225, a149
    v_mfma_f32_16x16x32_bf16 a[60:63], v[92:95], v[44:47], a[60:63]
    s_waitcnt lgkmcnt(3)
    v_mfma_f32_16x16x32_bf16 a[64:67], v[64:67], v[32:35], 0
    ds_read_b128 v[40:43], v16 offset:10240
    v_mfma_f32_16x16x32_bf16 a[64:67], v[68:71], v[36:39], a[64:67]
    ds_read_b128 v[44:47], v17 offset:10240
    v_accvgpr_read_b32 v226, a150
    v_mfma_f32_16x16x32_bf16 a[68:71], v[72:75], v[32:35], 0
    ds_read_b64_tr_b16 v[118:119], v194 offset:26624
    v_accvgpr_read_b32 v227, a151
    v_mfma_f32_16x16x32_bf16 a[68:71], v[76:79], v[36:39], a[68:71]
    buffer_load_dwordx4 v8, s[60:63], s48 offen offset:2048 lds
    v_cvt_pk_bf16_f32 v228, v220, v221
    v_mfma_f32_16x16x32_bf16 a[72:75], v[80:83], v[32:35], 0
    ds_read_b64_tr_b16 v[120:121], v195 offset:16384
    v_cvt_pk_bf16_f32 v229, v222, v223
    v_mfma_f32_16x16x32_bf16 a[72:75], v[84:87], v[36:39], a[72:75]
    buffer_load_dwordx4 v9, s[60:63], s48 offen offset:3072 lds
    v_cvt_pk_bf16_f32 v230, v224, v225
    v_mfma_f32_16x16x32_bf16 a[76:79], v[88:91], v[32:35], 0
    ds_read_b64_tr_b16 v[122:123], v195 offset:18432
    v_cvt_pk_bf16_f32 v231, v226, v227
    v_mfma_f32_16x16x32_bf16 a[76:79], v[92:95], v[36:39], a[76:79]
    s_waitcnt lgkmcnt(3)
    v_mfma_f32_16x16x32_bf16 a[80:83], v[64:67], v[40:43], 0
    ds_read_b128 v[32:35], v16 offset:12288
    buffer_store_dwordx4 v[228:231], v14, s[8:11], s88 offen offset:256 sc0 sc1
    v_mfma_f32_16x16x32_bf16 a[80:83], v[68:71], v[44:47], a[80:83]
    ds_read_b128 v[36:39], v17 offset:12288
    v_accvgpr_read_b32 v208, a136
    v_mfma_f32_16x16x32_bf16 a[84:87], v[72:75], v[40:43], 0
    ds_read_b64_tr_b16 v[124:125], v195 offset:24576
    v_accvgpr_read_b32 v209, a137
    v_mfma_f32_16x16x32_bf16 a[84:87], v[76:79], v[44:47], a[84:87]
    v_accvgpr_read_b32 v210, a138
    v_mfma_f32_16x16x32_bf16 a[88:91], v[80:83], v[40:43], 0
    v_accvgpr_read_b32 v211, a139
    v_mfma_f32_16x16x32_bf16 a[88:91], v[84:87], v[44:47], a[88:91]
    ds_read_b64_tr_b16 v[126:127], v195 offset:26624
    v_accvgpr_read_b32 v212, a152
    v_mfma_f32_16x16x32_bf16 a[92:95], v[88:91], v[40:43], 0
    v_accvgpr_read_b32 v213, a153
    v_mfma_f32_16x16x32_bf16 a[92:95], v[92:95], v[44:47], a[92:95]
    s_waitcnt lgkmcnt(2)
    v_mfma_f32_16x16x32_bf16 a[96:99], v[64:67], v[32:35], 0
    ds_read_b128 v[40:43], v16 offset:14336
    v_mfma_f32_16x16x32_bf16 a[96:99], v[68:71], v[36:39], a[96:99]
    ds_read_b128 v[44:47], v17 offset:14336
    v_accvgpr_read_b32 v214, a154
    v_mfma_f32_16x16x32_bf16 a[100:103], v[72:75], v[32:35], 0
    v_accvgpr_read_b32 v215, a155
    v_mfma_f32_16x16x32_bf16 a[100:103], v[76:79], v[36:39], a[100:103]
    v_cvt_pk_bf16_f32 v216, v208, v209
    v_mfma_f32_16x16x32_bf16 a[104:107], v[80:83], v[32:35], 0
    v_cvt_pk_bf16_f32 v217, v210, v211
    v_mfma_f32_16x16x32_bf16 a[104:107], v[84:87], v[36:39], a[104:107]
    v_cvt_pk_bf16_f32 v218, v212, v213
    v_mfma_f32_16x16x32_bf16 a[108:111], v[88:91], v[32:35], 0
    v_cvt_pk_bf16_f32 v219, v214, v215
    v_mfma_f32_16x16x32_bf16 a[108:111], v[92:95], v[36:39], a[108:111]
    s_waitcnt lgkmcnt(0)
    v_mfma_f32_16x16x32_bf16 a[112:115], v[64:67], v[40:43], 0
    s_waitcnt vmcnt(18)
    s_barrier
    buffer_store_dwordx4 v[216:219], v14, s[8:11], s88 offen offset:2048 sc0 sc1
    v_mfma_f32_16x16x32_bf16 a[112:115], v[68:71], v[44:47], a[112:115]
    ds_read_b128 v[32:35], v16 offset:32768
    v_accvgpr_read_b32 v220, a140
    v_mfma_f32_16x16x32_bf16 a[116:119], v[72:75], v[40:43], 0
    ds_read_b128 v[36:39], v17 offset:32768
    v_accvgpr_read_b32 v221, a141
    v_mfma_f32_16x16x32_bf16 a[116:119], v[76:79], v[44:47], a[116:119]
    s_add_u32 m0, s40, 0
    s_add_u32 s48, s36, 384
    buffer_load_dwordx4 v2, s[8:11], s48 offen offset:0 sc1 lds
    v_accvgpr_read_b32 v222, a142
    v_mfma_f32_16x16x32_bf16 a[120:123], v[80:83], v[40:43], 0
    v_accvgpr_read_b32 v223, a143
    v_mfma_f32_16x16x32_bf16 a[120:123], v[84:87], v[44:47], a[120:123]
    v_accvgpr_read_b32 v224, a156
    v_mfma_f32_16x16x32_bf16 a[124:127], v[88:91], v[40:43], 0
    buffer_load_dwordx4 v3, s[8:11], s48 offen offset:1024 sc1 lds
    v_accvgpr_read_b32 v225, a157
    v_mfma_f32_16x16x32_bf16 a[124:127], v[92:95], v[44:47], a[124:127]
    s_waitcnt lgkmcnt(0)
    v_mfma_f32_16x16x32_bf16 a[0:3], v[96:99], v[32:35], a[0:3]
    ds_read_b128 v[40:43], v16 offset:34816
    v_mfma_f32_16x16x32_bf16 a[0:3], v[100:103], v[36:39], a[0:3]
    ds_read_b128 v[44:47], v17 offset:34816
    v_accvgpr_read_b32 v226, a158
    v_mfma_f32_16x16x32_bf16 a[4:7], v[104:107], v[32:35], a[4:7]
    ds_read_b64_tr_b16 v[64:65], v192 offset:32768
    v_accvgpr_read_b32 v227, a159
    v_mfma_f32_16x16x32_bf16 a[4:7], v[108:111], v[36:39], a[4:7]
    buffer_load_dwordx4 v4, s[8:11], s48 offen offset:2048 sc1 lds
    v_cvt_pk_bf16_f32 v228, v220, v221
    v_mfma_f32_16x16x32_bf16 a[8:11], v[112:115], v[32:35], a[8:11]
    ds_read_b64_tr_b16 v[66:67], v192 offset:34816
    v_cvt_pk_bf16_f32 v229, v222, v223
    v_mfma_f32_16x16x32_bf16 a[8:11], v[116:119], v[36:39], a[8:11]
    buffer_load_dwordx4 v5, s[8:11], s48 offen offset:3072 sc1 lds
    v_cvt_pk_bf16_f32 v230, v224, v225
    v_mfma_f32_16x16x32_bf16 a[12:15], v[120:123], v[32:35], a[12:15]
    ds_read_b64_tr_b16 v[68:69], v192 offset:40960
    v_cvt_pk_bf16_f32 v231, v226, v227
    v_mfma_f32_16x16x32_bf16 a[12:15], v[124:127], v[36:39], a[12:15]
    s_waitcnt lgkmcnt(3)
    v_mfma_f32_16x16x32_bf16 a[16:19], v[96:99], v[40:43], a[16:19]
    ds_read_b128 v[32:35], v16 offset:36864
    buffer_store_dwordx4 v[228:231], v14, s[8:11], s88 offen offset:2304 sc0 sc1
    v_mfma_f32_16x16x32_bf16 a[16:19], v[100:103], v[44:47], a[16:19]
    ds_read_b128 v[36:39], v17 offset:36864
    v_accvgpr_read_b32 v208, a160
    v_mfma_f32_16x16x32_bf16 a[20:23], v[104:107], v[40:43], a[20:23]
    ds_read_b64_tr_b16 v[70:71], v192 offset:43008
    v_accvgpr_read_b32 v209, a161
    v_mfma_f32_16x16x32_bf16 a[20:23], v[108:111], v[44:47], a[20:23]
    s_add_u32 m0, s40, 4096
    s_add_u32 s48, s36, 33152
    buffer_load_dwordx4 v2, s[8:11], s48 offen offset:0 sc1 lds
    v_accvgpr_read_b32 v210, a162
    v_mfma_f32_16x16x32_bf16 a[24:27], v[112:115], v[40:43], a[24:27]
    ds_read_b64_tr_b16 v[72:73], v193 offset:32768
    v_accvgpr_read_b32 v211, a163
    v_mfma_f32_16x16x32_bf16 a[24:27], v[116:119], v[44:47], a[24:27]
    v_accvgpr_read_b32 v212, a176
    v_mfma_f32_16x16x32_bf16 a[28:31], v[120:123], v[40:43], a[28:31]
    ds_read_b64_tr_b16 v[74:75], v193 offset:34816
    buffer_load_dwordx4 v3, s[8:11], s48 offen offset:1024 sc1 lds
    v_accvgpr_read_b32 v213, a177
    v_mfma_f32_16x16x32_bf16 a[28:31], v[124:127], v[44:47], a[28:31]
    s_waitcnt lgkmcnt(3)
    v_mfma_f32_16x16x32_bf16 a[32:35], v[96:99], v[32:35], a[32:35]
    ds_read_b128 v[40:43], v16 offset:38912
    v_mfma_f32_16x16x32_bf16 a[32:35], v[100:103], v[36:39], a[32:35]
    ds_read_b128 v[44:47], v17 offset:38912
    v_accvgpr_read_b32 v214, a178
    v_mfma_f32_16x16x32_bf16 a[36:39], v[104:107], v[32:35], a[36:39]
    ds_read_b64_tr_b16 v[76:77], v193 offset:40960
    v_accvgpr_read_b32 v215, a179
    v_mfma_f32_16x16x32_bf16 a[36:39], v[108:111], v[36:39], a[36:39]
    buffer_load_dwordx4 v4, s[8:11], s48 offen offset:2048 sc1 lds
    v_cvt_pk_bf16_f32 v216, v208, v209
    v_mfma_f32_16x16x32_bf16 a[40:43], v[112:115], v[32:35], a[40:43]
    v_cvt_pk_bf16_f32 v217, v210, v211
    v_mfma_f32_16x16x32_bf16 a[40:43], v[116:119], v[36:39], a[40:43]
    ds_read_b64_tr_b16 v[78:79], v193 offset:43008
    buffer_load_dwordx4 v5, s[8:11], s48 offen offset:3072 sc1 lds
    v_cvt_pk_bf16_f32 v218, v212, v213
    v_mfma_f32_16x16x32_bf16 a[44:47], v[120:123], v[32:35], a[44:47]
    v_cvt_pk_bf16_f32 v219, v214, v215
    v_mfma_f32_16x16x32_bf16 a[44:47], v[124:127], v[36:39], a[44:47]
    s_waitcnt lgkmcnt(2)
    v_mfma_f32_16x16x32_bf16 a[48:51], v[96:99], v[40:43], a[48:51]
    ds_read_b128 v[32:35], v16 offset:40960
    buffer_store_dwordx4 v[216:219], v14, s[8:11], s89 offen offset:0 sc0 sc1
    v_mfma_f32_16x16x32_bf16 a[48:51], v[100:103], v[44:47], a[48:51]
    ds_read_b128 v[36:39], v17 offset:40960
    v_accvgpr_read_b32 v220, a164
    v_mfma_f32_16x16x32_bf16 a[52:55], v[104:107], v[40:43], a[52:55]
    ds_read_b64_tr_b16 v[80:81], v194 offset:32768
    v_accvgpr_read_b32 v221, a165
    v_mfma_f32_16x16x32_bf16 a[52:55], v[108:111], v[44:47], a[52:55]
    s_add_u32 m0, s41, 114688
    s_add_u32 s48, s37, 2621440
    buffer_load_dwordx4 v6, s[60:63], s48 offen offset:0 lds
    v_accvgpr_read_b32 v222, a166
    v_mfma_f32_16x16x32_bf16 a[56:59], v[112:115], v[40:43], a[56:59]
    ds_read_b64_tr_b16 v[82:83], v194 offset:34816
    v_accvgpr_read_b32 v223, a167
    v_mfma_f32_16x16x32_bf16 a[56:59], v[116:119], v[44:47], a[56:59]
    v_accvgpr_read_b32 v224, a180
    v_mfma_f32_16x16x32_bf16 a[60:63], v[120:123], v[40:43], a[60:63]
    ds_read_b64_tr_b16 v[84:85], v194 offset:40960
    buffer_load_dwordx4 v7, s[60:63], s48 offen offset:1024 lds
    v_accvgpr_read_b32 v225, a181
    v_mfma_f32_16x16x32_bf16 a[60:63], v[124:127], v[44:47], a[60:63]
    s_waitcnt lgkmcnt(3)
    v_mfma_f32_16x16x32_bf16 a[64:67], v[96:99], v[32:35], a[64:67]
    ds_read_b128 v[40:43], v16 offset:43008
    v_mfma_f32_16x16x32_bf16 a[64:67], v[100:103], v[36:39], a[64:67]
    ds_read_b128 v[44:47], v17 offset:43008
    v_accvgpr_read_b32 v226, a182
    v_mfma_f32_16x16x32_bf16 a[68:71], v[104:107], v[32:35], a[68:71]
    ds_read_b64_tr_b16 v[86:87], v194 offset:43008
    v_accvgpr_read_b32 v227, a183
    v_mfma_f32_16x16x32_bf16 a[68:71], v[108:111], v[36:39], a[68:71]
    buffer_load_dwordx4 v8, s[60:63], s48 offen offset:2048 lds
    v_cvt_pk_bf16_f32 v228, v220, v221
    v_mfma_f32_16x16x32_bf16 a[72:75], v[112:115], v[32:35], a[72:75]
    ds_read_b64_tr_b16 v[88:89], v195 offset:32768
    v_cvt_pk_bf16_f32 v229, v222, v223
    v_mfma_f32_16x16x32_bf16 a[72:75], v[116:119], v[36:39], a[72:75]
    buffer_load_dwordx4 v9, s[60:63], s48 offen offset:3072 lds
    v_cvt_pk_bf16_f32 v230, v224, v225
    v_mfma_f32_16x16x32_bf16 a[76:79], v[120:123], v[32:35], a[76:79]
    ds_read_b64_tr_b16 v[90:91], v195 offset:34816
    v_cvt_pk_bf16_f32 v231, v226, v227
    v_mfma_f32_16x16x32_bf16 a[76:79], v[124:127], v[36:39], a[76:79]
    s_waitcnt lgkmcnt(3)
    v_mfma_f32_16x16x32_bf16 a[80:83], v[96:99], v[40:43], a[80:83]
    ds_read_b128 v[32:35], v16 offset:45056
    buffer_store_dwordx4 v[228:231], v14, s[8:11], s89 offen offset:256 sc0 sc1
    v_mfma_f32_16x16x32_bf16 a[80:83], v[100:103], v[44:47], a[80:83]
    ds_read_b128 v[36:39], v17 offset:45056
    v_accvgpr_read_b32 v208, a168
    v_mfma_f32_16x16x32_bf16 a[84:87], v[104:107], v[40:43], a[84:87]
    ds_read_b64_tr_b16 v[92:93], v195 offset:40960
    v_accvgpr_read_b32 v209, a169
    v_mfma_f32_16x16x32_bf16 a[84:87], v[108:111], v[44:47], a[84:87]
    v_accvgpr_read_b32 v210, a170
    v_mfma_f32_16x16x32_bf16 a[88:91], v[112:115], v[40:43], a[88:91]
    v_accvgpr_read_b32 v211, a171
    v_mfma_f32_16x16x32_bf16 a[88:91], v[116:119], v[44:47], a[88:91]
    ds_read_b64_tr_b16 v[94:95], v195 offset:43008
    v_accvgpr_read_b32 v212, a184
    v_mfma_f32_16x16x32_bf16 a[92:95], v[120:123], v[40:43], a[92:95]
    v_accvgpr_read_b32 v213, a185
    v_mfma_f32_16x16x32_bf16 a[92:95], v[124:127], v[44:47], a[92:95]
    s_waitcnt lgkmcnt(2)
    v_mfma_f32_16x16x32_bf16 a[96:99], v[96:99], v[32:35], a[96:99]
    ds_read_b128 v[40:43], v16 offset:47104
    v_mfma_f32_16x16x32_bf16 a[96:99], v[100:103], v[36:39], a[96:99]
    ds_read_b128 v[44:47], v17 offset:47104
    v_accvgpr_read_b32 v214, a186
    v_mfma_f32_16x16x32_bf16 a[100:103], v[104:107], v[32:35], a[100:103]
    v_accvgpr_read_b32 v215, a187
    v_mfma_f32_16x16x32_bf16 a[100:103], v[108:111], v[36:39], a[100:103]
    v_cvt_pk_bf16_f32 v216, v208, v209
    v_mfma_f32_16x16x32_bf16 a[104:107], v[112:115], v[32:35], a[104:107]
    v_cvt_pk_bf16_f32 v217, v210, v211
    v_mfma_f32_16x16x32_bf16 a[104:107], v[116:119], v[36:39], a[104:107]
    v_cvt_pk_bf16_f32 v218, v212, v213
    v_mfma_f32_16x16x32_bf16 a[108:111], v[120:123], v[32:35], a[108:111]
    v_cvt_pk_bf16_f32 v219, v214, v215
    v_mfma_f32_16x16x32_bf16 a[108:111], v[124:127], v[36:39], a[108:111]
    s_waitcnt lgkmcnt(0)
    v_mfma_f32_16x16x32_bf16 a[112:115], v[96:99], v[40:43], a[112:115]
    s_waitcnt vmcnt(22)
    s_barrier
    buffer_store_dwordx4 v[216:219], v14, s[8:11], s89 offen offset:2048 sc0 sc1
    v_mfma_f32_16x16x32_bf16 a[112:115], v[100:103], v[44:47], a[112:115]
    ds_read_b128 v[32:35], v18 offset:0
    v_accvgpr_read_b32 v220, a172
    v_mfma_f32_16x16x32_bf16 a[116:119], v[104:107], v[40:43], a[116:119]
    ds_read_b128 v[36:39], v19 offset:0
    v_accvgpr_read_b32 v221, a173
    v_mfma_f32_16x16x32_bf16 a[116:119], v[108:111], v[44:47], a[116:119]
    s_add_u32 m0, s40, 32768
    s_add_u32 s48, s36, 512
    buffer_load_dwordx4 v2, s[8:11], s48 offen offset:0 sc1 lds
    v_accvgpr_read_b32 v222, a174
    v_mfma_f32_16x16x32_bf16 a[120:123], v[112:115], v[40:43], a[120:123]
    v_accvgpr_read_b32 v223, a175
    v_mfma_f32_16x16x32_bf16 a[120:123], v[116:119], v[44:47], a[120:123]
    v_accvgpr_read_b32 v224, a188
    v_mfma_f32_16x16x32_bf16 a[124:127], v[120:123], v[40:43], a[124:127]
    buffer_load_dwordx4 v3, s[8:11], s48 offen offset:1024 sc1 lds
    v_accvgpr_read_b32 v225, a189
    v_mfma_f32_16x16x32_bf16 a[124:127], v[124:127], v[44:47], a[124:127]
    s_waitcnt lgkmcnt(0)
    v_mfma_f32_16x16x32_bf16 a[0:3], v[64:67], v[32:35], a[0:3]
    ds_read_b128 v[40:43], v18 offset:2048
    v_mfma_f32_16x16x32_bf16 a[0:3], v[68:71], v[36:39], a[0:3]
    ds_read_b128 v[44:47], v19 offset:2048
    v_accvgpr_read_b32 v226, a190
    v_mfma_f32_16x16x32_bf16 a[4:7], v[72:75], v[32:35], a[4:7]
    ds_read_b64_tr_b16 v[96:97], v192 offset:49152
    v_accvgpr_read_b32 v227, a191
    v_mfma_f32_16x16x32_bf16 a[4:7], v[76:79], v[36:39], a[4:7]
    buffer_load_dwordx4 v4, s[8:11], s48 offen offset:2048 sc1 lds
    v_cvt_pk_bf16_f32 v228, v220, v221
    v_mfma_f32_16x16x32_bf16 a[8:11], v[80:83], v[32:35], a[8:11]
    ds_read_b64_tr_b16 v[98:99], v192 offset:51200
    v_cvt_pk_bf16_f32 v229, v222, v223
    v_mfma_f32_16x16x32_bf16 a[8:11], v[84:87], v[36:39], a[8:11]
    buffer_load_dwordx4 v5, s[8:11], s48 offen offset:3072 sc1 lds
    v_cvt_pk_bf16_f32 v230, v224, v225
    v_mfma_f32_16x16x32_bf16 a[12:15], v[88:91], v[32:35], a[12:15]
    ds_read_b64_tr_b16 v[100:101], v192 offset:57344
    v_cvt_pk_bf16_f32 v231, v226, v227
    v_mfma_f32_16x16x32_bf16 a[12:15], v[92:95], v[36:39], a[12:15]
    s_waitcnt lgkmcnt(3)
    v_mfma_f32_16x16x32_bf16 a[16:19], v[64:67], v[40:43], a[16:19]
    ds_read_b128 v[32:35], v18 offset:4096
    buffer_store_dwordx4 v[228:231], v14, s[8:11], s89 offen offset:2304 sc0 sc1
    v_mfma_f32_16x16x32_bf16 a[16:19], v[68:71], v[44:47], a[16:19]
    ds_read_b128 v[36:39], v19 offset:4096
    v_accvgpr_read_b32 v208, a192
    v_mfma_f32_16x16x32_bf16 a[20:23], v[72:75], v[40:43], a[20:23]
    ds_read_b64_tr_b16 v[102:103], v192 offset:59392
    v_accvgpr_read_b32 v209, a193
    v_mfma_f32_16x16x32_bf16 a[20:23], v[76:79], v[44:47], a[20:23]
    s_add_u32 m0, s40, 36864
    s_add_u32 s48, s36, 33280
    buffer_load_dwordx4 v2, s[8:11], s48 offen offset:0 sc1 lds
    v_accvgpr_read_b32 v210, a194
    v_mfma_f32_16x16x32_bf16 a[24:27], v[80:83], v[40:43], a[24:27]
    ds_read_b64_tr_b16 v[104:105], v193 offset:49152
    v_accvgpr_read_b32 v211, a195
    v_mfma_f32_16x16x32_bf16 a[24:27], v[84:87], v[44:47], a[24:27]
    v_accvgpr_read_b32 v212, a208
    v_mfma_f32_16x16x32_bf16 a[28:31], v[88:91], v[40:43], a[28:31]
    ds_read_b64_tr_b16 v[106:107], v193 offset:51200
    buffer_load_dwordx4 v3, s[8:11], s48 offen offset:1024 sc1 lds
    v_accvgpr_read_b32 v213, a209
    v_mfma_f32_16x16x32_bf16 a[28:31], v[92:95], v[44:47], a[28:31]
    s_waitcnt lgkmcnt(3)
    v_mfma_f32_16x16x32_bf16 a[32:35], v[64:67], v[32:35], a[32:35]
    ds_read_b128 v[40:43], v18 offset:6144
    v_mfma_f32_16x16x32_bf16 a[32:35], v[68:71], v[36:39], a[32:35]
    ds_read_b128 v[44:47], v19 offset:6144
    v_accvgpr_read_b32 v214, a210
    v_mfma_f32_16x16x32_bf16 a[36:39], v[72:75], v[32:35], a[36:39]
    ds_read_b64_tr_b16 v[108:109], v193 offset:57344
    v_accvgpr_read_b32 v215, a211
    v_mfma_f32_16x16x32_bf16 a[36:39], v[76:79], v[36:39], a[36:39]
    buffer_load_dwordx4 v4, s[8:11], s48 offen offset:2048 sc1 lds
    v_cvt_pk_bf16_f32 v216, v208, v209
    v_mfma_f32_16x16x32_bf16 a[40:43], v[80:83], v[32:35], a[40:43]
    v_cvt_pk_bf16_f32 v217, v210, v211
    v_mfma_f32_16x16x32_bf16 a[40:43], v[84:87], v[36:39], a[40:43]
    ds_read_b64_tr_b16 v[110:111], v193 offset:59392
    buffer_load_dwordx4 v5, s[8:11], s48 offen offset:3072 sc1 lds
    v_cvt_pk_bf16_f32 v218, v212, v213
    v_mfma_f32_16x16x32_bf16 a[44:47], v[88:91], v[32:35], a[44:47]
    v_cvt_pk_bf16_f32 v219, v214, v215
    v_mfma_f32_16x16x32_bf16 a[44:47], v[92:95], v[36:39], a[44:47]
    s_waitcnt lgkmcnt(2)
    v_mfma_f32_16x16x32_bf16 a[48:51], v[64:67], v[40:43], a[48:51]
    ds_read_b128 v[32:35], v18 offset:8192
    buffer_store_dwordx4 v[216:219], v14, s[8:11], s90 offen offset:0 sc0 sc1
    v_mfma_f32_16x16x32_bf16 a[48:51], v[68:71], v[44:47], a[48:51]
    ds_read_b128 v[36:39], v19 offset:8192
    v_accvgpr_read_b32 v220, a196
    v_mfma_f32_16x16x32_bf16 a[52:55], v[72:75], v[40:43], a[52:55]
    ds_read_b64_tr_b16 v[112:113], v194 offset:49152
    v_accvgpr_read_b32 v221, a197
    v_mfma_f32_16x16x32_bf16 a[52:55], v[76:79], v[44:47], a[52:55]
    s_add_u32 m0, s41, 131072
    s_add_u32 s48, s37, 3145728
    buffer_load_dwordx4 v6, s[60:63], s48 offen offset:0 lds
    v_accvgpr_read_b32 v222, a198
    v_mfma_f32_16x16x32_bf16 a[56:59], v[80:83], v[40:43], a[56:59]
    ds_read_b64_tr_b16 v[114:115], v194 offset:51200
    v_accvgpr_read_b32 v223, a199
    v_mfma_f32_16x16x32_bf16 a[56:59], v[84:87], v[44:47], a[56:59]
    v_accvgpr_read_b32 v224, a212
    v_mfma_f32_16x16x32_bf16 a[60:63], v[88:91], v[40:43], a[60:63]
    ds_read_b64_tr_b16 v[116:117], v194 offset:57344
    buffer_load_dwordx4 v7, s[60:63], s48 offen offset:1024 lds
    v_accvgpr_read_b32 v225, a213
    v_mfma_f32_16x16x32_bf16 a[60:63], v[92:95], v[44:47], a[60:63]
    s_waitcnt lgkmcnt(3)
    v_mfma_f32_16x16x32_bf16 a[64:67], v[64:67], v[32:35], a[64:67]
    ds_read_b128 v[40:43], v18 offset:10240
    v_mfma_f32_16x16x32_bf16 a[64:67], v[68:71], v[36:39], a[64:67]
    ds_read_b128 v[44:47], v19 offset:10240
    v_accvgpr_read_b32 v226, a214
    v_mfma_f32_16x16x32_bf16 a[68:71], v[72:75], v[32:35], a[68:71]
    ds_read_b64_tr_b16 v[118:119], v194 offset:59392
    v_accvgpr_read_b32 v227, a215
    v_mfma_f32_16x16x32_bf16 a[68:71], v[76:79], v[36:39], a[68:71]
    buffer_load_dwordx4 v8, s[60:63], s48 offen offset:2048 lds
    v_cvt_pk_bf16_f32 v228, v220, v221
    v_mfma_f32_16x16x32_bf16 a[72:75], v[80:83], v[32:35], a[72:75]
    ds_read_b64_tr_b16 v[120:121], v195 offset:49152
    v_cvt_pk_bf16_f32 v229, v222, v223
    v_mfma_f32_16x16x32_bf16 a[72:75], v[84:87], v[36:39], a[72:75]
    buffer_load_dwordx4 v9, s[60:63], s48 offen offset:3072 lds
    v_cvt_pk_bf16_f32 v230, v224, v225
    v_mfma_f32_16x16x32_bf16 a[76:79], v[88:91], v[32:35], a[76:79]
    ds_read_b64_tr_b16 v[122:123], v195 offset:51200
    v_cvt_pk_bf16_f32 v231, v226, v227
    v_mfma_f32_16x16x32_bf16 a[76:79], v[92:95], v[36:39], a[76:79]
    s_waitcnt lgkmcnt(3)
    v_mfma_f32_16x16x32_bf16 a[80:83], v[64:67], v[40:43], a[80:83]
    ds_read_b128 v[32:35], v18 offset:12288
    buffer_store_dwordx4 v[228:231], v14, s[8:11], s90 offen offset:256 sc0 sc1
    v_mfma_f32_16x16x32_bf16 a[80:83], v[68:71], v[44:47], a[80:83]
    ds_read_b128 v[36:39], v19 offset:12288
    v_accvgpr_read_b32 v208, a200
    v_mfma_f32_16x16x32_bf16 a[84:87], v[72:75], v[40:43], a[84:87]
    ds_read_b64_tr_b16 v[124:125], v195 offset:57344
    v_accvgpr_read_b32 v209, a201
    v_mfma_f32_16x16x32_bf16 a[84:87], v[76:79], v[44:47], a[84:87]
    v_accvgpr_read_b32 v210, a202
    v_mfma_f32_16x16x32_bf16 a[88:91], v[80:83], v[40:43], a[88:91]
    v_accvgpr_read_b32 v211, a203
    v_mfma_f32_16x16x32_bf16 a[88:91], v[84:87], v[44:47], a[88:91]
    ds_read_b64_tr_b16 v[126:127], v195 offset:59392
    v_accvgpr_read_b32 v212, a216
    v_mfma_f32_16x16x32_bf16 a[92:95], v[88:91], v[40:43], a[92:95]
    v_accvgpr_read_b32 v213, a217
    v_mfma_f32_16x16x32_bf16 a[92:95], v[92:95], v[44:47], a[92:95]
    s_waitcnt lgkmcnt(2)
    v_mfma_f32_16x16x32_bf16 a[96:99], v[64:67], v[32:35], a[96:99]
    ds_read_b128 v[40:43], v18 offset:14336
    v_mfma_f32_16x16x32_bf16 a[96:99], v[68:71], v[36:39], a[96:99]
    ds_read_b128 v[44:47], v19 offset:14336
    v_accvgpr_read_b32 v214, a218
    v_mfma_f32_16x16x32_bf16 a[100:103], v[72:75], v[32:35], a[100:103]
    v_accvgpr_read_b32 v215, a219
    v_mfma_f32_16x16x32_bf16 a[100:103], v[76:79], v[36:39], a[100:103]
    v_cvt_pk_bf16_f32 v216, v208, v209
    v_mfma_f32_16x16x32_bf16 a[104:107], v[80:83], v[32:35], a[104:107]
    v_cvt_pk_bf16_f32 v217, v210, v211
    v_mfma_f32_16x16x32_bf16 a[104:107], v[84:87], v[36:39], a[104:107]
    v_cvt_pk_bf16_f32 v218, v212, v213
    v_mfma_f32_16x16x32_bf16 a[108:111], v[88:91], v[32:35], a[108:111]
    v_cvt_pk_bf16_f32 v219, v214, v215
    v_mfma_f32_16x16x32_bf16 a[108:111], v[92:95], v[36:39], a[108:111]
    s_waitcnt lgkmcnt(0)
    v_mfma_f32_16x16x32_bf16 a[112:115], v[64:67], v[40:43], a[112:115]
    s_waitcnt vmcnt(22)
    s_barrier
    buffer_store_dwordx4 v[216:219], v14, s[8:11], s90 offen offset:2048 sc0 sc1
    v_mfma_f32_16x16x32_bf16 a[112:115], v[68:71], v[44:47], a[112:115]
    ds_read_b128 v[32:35], v16 offset:0
    v_accvgpr_read_b32 v220, a204
    v_mfma_f32_16x16x32_bf16 a[116:119], v[72:75], v[40:43], a[116:119]
    ds_read_b128 v[36:39], v17 offset:0
    v_accvgpr_read_b32 v221, a205
    v_mfma_f32_16x16x32_bf16 a[116:119], v[76:79], v[44:47], a[116:119]
    s_add_u32 m0, s40, 65536
    s_add_u32 s48, s36, 640
    buffer_load_dwordx4 v2, s[8:11], s48 offen offset:0 sc1 lds
    v_accvgpr_read_b32 v222, a206
    v_mfma_f32_16x16x32_bf16 a[120:123], v[80:83], v[40:43], a[120:123]
    v_accvgpr_read_b32 v223, a207
    v_mfma_f32_16x16x32_bf16 a[120:123], v[84:87], v[44:47], a[120:123]
    v_accvgpr_read_b32 v224, a220
    v_mfma_f32_16x16x32_bf16 a[124:127], v[88:91], v[40:43], a[124:127]
    buffer_load_dwordx4 v3, s[8:11], s48 offen offset:1024 sc1 lds
    v_accvgpr_read_b32 v225, a221
    v_mfma_f32_16x16x32_bf16 a[124:127], v[92:95], v[44:47], a[124:127]
    s_waitcnt lgkmcnt(0)
    v_mfma_f32_16x16x32_bf16 a[0:3], v[96:99], v[32:35], a[0:3]
    ds_read_b128 v[40:43], v16 offset:2048
    v_mfma_f32_16x16x32_bf16 a[0:3], v[100:103], v[36:39], a[0:3]
    ds_read_b128 v[44:47], v17 offset:2048
    v_accvgpr_read_b32 v226, a222
    v_mfma_f32_16x16x32_bf16 a[4:7], v[104:107], v[32:35], a[4:7]
    ds_read_b64_tr_b16 v[64:65], v192 offset:0
    v_accvgpr_read_b32 v227, a223
    v_mfma_f32_16x16x32_bf16 a[4:7], v[108:111], v[36:39], a[4:7]
    buffer_load_dwordx4 v4, s[8:11], s48 offen offset:2048 sc1 lds
    v_cvt_pk_bf16_f32 v228, v220, v221
    v_mfma_f32_16x16x32_bf16 a[8:11], v[112:115], v[32:35], a[8:11]
    ds_read_b64_tr_b16 v[66:67], v192 offset:2048
    v_cvt_pk_bf16_f32 v229, v222, v223
    v_mfma_f32_16x16x32_bf16 a[8:11], v[116:119], v[36:39], a[8:11]
    buffer_load_dwordx4 v5, s[8:11], s48 offen offset:3072 sc1 lds
    v_cvt_pk_bf16_f32 v230, v224, v225
    v_mfma_f32_16x16x32_bf16 a[12:15], v[120:123], v[32:35], a[12:15]
    ds_read_b64_tr_b16 v[68:69], v192 offset:8192
    v_cvt_pk_bf16_f32 v231, v226, v227
    v_mfma_f32_16x16x32_bf16 a[12:15], v[124:127], v[36:39], a[12:15]
    s_waitcnt lgkmcnt(3)
    v_mfma_f32_16x16x32_bf16 a[16:19], v[96:99], v[40:43], a[16:19]
    ds_read_b128 v[32:35], v16 offset:4096
    buffer_store_dwordx4 v[228:231], v14, s[8:11], s90 offen offset:2304 sc0 sc1
    v_mfma_f32_16x16x32_bf16 a[16:19], v[100:103], v[44:47], a[16:19]
    ds_read_b128 v[36:39], v17 offset:4096
    v_accvgpr_read_b32 v208, a224
    v_mfma_f32_16x16x32_bf16 a[20:23], v[104:107], v[40:43], a[20:23]
    ds_read_b64_tr_b16 v[70:71], v192 offset:10240
    v_accvgpr_read_b32 v209, a225
    v_mfma_f32_16x16x32_bf16 a[20:23], v[108:111], v[44:47], a[20:23]
    s_add_u32 m0, s40, 69632
    s_add_u32 s48, s36, 33408
    buffer_load_dwordx4 v2, s[8:11], s48 offen offset:0 sc1 lds
    v_accvgpr_read_b32 v210, a226
    v_mfma_f32_16x16x32_bf16 a[24:27], v[112:115], v[40:43], a[24:27]
    ds_read_b64_tr_b16 v[72:73], v193 offset:0
    v_accvgpr_read_b32 v211, a227
    v_mfma_f32_16x16x32_bf16 a[24:27], v[116:119], v[44:47], a[24:27]
    v_accvgpr_read_b32 v212, a240
    v_mfma_f32_16x16x32_bf16 a[28:31], v[120:123], v[40:43], a[28:31]
    ds_read_b64_tr_b16 v[74:75], v193 offset:2048
    buffer_load_dwordx4 v3, s[8:11], s48 offen offset:1024 sc1 lds
    v_accvgpr_read_b32 v213, a241
    v_mfma_f32_16x16x32_bf16 a[28:31], v[124:127], v[44:47], a[28:31]
    s_waitcnt lgkmcnt(3)
    v_mfma_f32_16x16x32_bf16 a[32:35], v[96:99], v[32:35], a[32:35]
    ds_read_b128 v[40:43], v16 offset:6144
    v_mfma_f32_16x16x32_bf16 a[32:35], v[100:103], v[36:39], a[32:35]
    ds_read_b128 v[44:47], v17 offset:6144
    v_accvgpr_read_b32 v214, a242
    v_mfma_f32_16x16x32_bf16 a[36:39], v[104:107], v[32:35], a[36:39]
    ds_read_b64_tr_b16 v[76:77], v193 offset:8192
    v_accvgpr_read_b32 v215, a243
    v_mfma_f32_16x16x32_bf16 a[36:39], v[108:111], v[36:39], a[36:39]
    buffer_load_dwordx4 v4, s[8:11], s48 offen offset:2048 sc1 lds
    v_cvt_pk_bf16_f32 v216, v208, v209
    v_mfma_f32_16x16x32_bf16 a[40:43], v[112:115], v[32:35], a[40:43]
    v_cvt_pk_bf16_f32 v217, v210, v211
    v_mfma_f32_16x16x32_bf16 a[40:43], v[116:119], v[36:39], a[40:43]
    ds_read_b64_tr_b16 v[78:79], v193 offset:10240
    buffer_load_dwordx4 v5, s[8:11], s48 offen offset:3072 sc1 lds
    v_cvt_pk_bf16_f32 v218, v212, v213
    v_mfma_f32_16x16x32_bf16 a[44:47], v[120:123], v[32:35], a[44:47]
    v_cvt_pk_bf16_f32 v219, v214, v215
    v_mfma_f32_16x16x32_bf16 a[44:47], v[124:127], v[36:39], a[44:47]
    s_waitcnt lgkmcnt(2)
    v_mfma_f32_16x16x32_bf16 a[48:51], v[96:99], v[40:43], a[48:51]
    ds_read_b128 v[32:35], v16 offset:8192
    buffer_store_dwordx4 v[216:219], v14, s[8:11], s91 offen offset:0 sc0 sc1
    v_mfma_f32_16x16x32_bf16 a[48:51], v[100:103], v[44:47], a[48:51]
    ds_read_b128 v[36:39], v17 offset:8192
    v_accvgpr_read_b32 v220, a228
    v_mfma_f32_16x16x32_bf16 a[52:55], v[104:107], v[40:43], a[52:55]
    ds_read_b64_tr_b16 v[80:81], v194 offset:0
    v_accvgpr_read_b32 v221, a229
    v_mfma_f32_16x16x32_bf16 a[52:55], v[108:111], v[44:47], a[52:55]
    s_add_u32 m0, s41, 147456
    s_add_u32 s48, s37, 3670016
    buffer_load_dwordx4 v6, s[60:63], s48 offen offset:0 lds
    v_accvgpr_read_b32 v222, a230
    v_mfma_f32_16x16x32_bf16 a[56:59], v[112:115], v[40:43], a[56:59]
    ds_read_b64_tr_b16 v[82:83], v194 offset:2048
    v_accvgpr_read_b32 v223, a231
    v_mfma_f32_16x16x32_bf16 a[56:59], v[116:119], v[44:47], a[56:59]
    v_accvgpr_read_b32 v224, a244
    v_mfma_f32_16x16x32_bf16 a[60:63], v[120:123], v[40:43], a[60:63]
    ds_read_b64_tr_b16 v[84:85], v194 offset:8192
    buffer_load_dwordx4 v7, s[60:63], s48 offen offset:1024 lds
    v_accvgpr_read_b32 v225, a245
    v_mfma_f32_16x16x32_bf16 a[60:63], v[124:127], v[44:47], a[60:63]
    s_waitcnt lgkmcnt(3)
    v_mfma_f32_16x16x32_bf16 a[64:67], v[96:99], v[32:35], a[64:67]
    ds_read_b128 v[40:43], v16 offset:10240
    v_mfma_f32_16x16x32_bf16 a[64:67], v[100:103], v[36:39], a[64:67]
    ds_read_b128 v[44:47], v17 offset:10240
    v_accvgpr_read_b32 v226, a246
    v_mfma_f32_16x16x32_bf16 a[68:71], v[104:107], v[32:35], a[68:71]
    ds_read_b64_tr_b16 v[86:87], v194 offset:10240
    v_accvgpr_read_b32 v227, a247
    v_mfma_f32_16x16x32_bf16 a[68:71], v[108:111], v[36:39], a[68:71]
    buffer_load_dwordx4 v8, s[60:63], s48 offen offset:2048 lds
    v_cvt_pk_bf16_f32 v228, v220, v221
    v_mfma_f32_16x16x32_bf16 a[72:75], v[112:115], v[32:35], a[72:75]
    ds_read_b64_tr_b16 v[88:89], v195 offset:0
    v_cvt_pk_bf16_f32 v229, v222, v223
    v_mfma_f32_16x16x32_bf16 a[72:75], v[116:119], v[36:39], a[72:75]
    buffer_load_dwordx4 v9, s[60:63], s48 offen offset:3072 lds
    v_cvt_pk_bf16_f32 v230, v224, v225
    v_mfma_f32_16x16x32_bf16 a[76:79], v[120:123], v[32:35], a[76:79]
    ds_read_b64_tr_b16 v[90:91], v195 offset:2048
    v_cvt_pk_bf16_f32 v231, v226, v227
    v_mfma_f32_16x16x32_bf16 a[76:79], v[124:127], v[36:39], a[76:79]
    s_waitcnt lgkmcnt(3)
    v_mfma_f32_16x16x32_bf16 a[80:83], v[96:99], v[40:43], a[80:83]
    ds_read_b128 v[32:35], v16 offset:12288
    buffer_store_dwordx4 v[228:231], v14, s[8:11], s91 offen offset:256 sc0 sc1
    v_mfma_f32_16x16x32_bf16 a[80:83], v[100:103], v[44:47], a[80:83]
    ds_read_b128 v[36:39], v17 offset:12288
    v_accvgpr_read_b32 v208, a232
    v_mfma_f32_16x16x32_bf16 a[84:87], v[104:107], v[40:43], a[84:87]
    ds_read_b64_tr_b16 v[92:93], v195 offset:8192
    v_accvgpr_read_b32 v209, a233
    v_mfma_f32_16x16x32_bf16 a[84:87], v[108:111], v[44:47], a[84:87]
    v_accvgpr_read_b32 v210, a234
    v_mfma_f32_16x16x32_bf16 a[88:91], v[112:115], v[40:43], a[88:91]
    v_accvgpr_read_b32 v211, a235
    v_mfma_f32_16x16x32_bf16 a[88:91], v[116:119], v[44:47], a[88:91]
    ds_read_b64_tr_b16 v[94:95], v195 offset:10240
    v_accvgpr_read_b32 v212, a248
    v_mfma_f32_16x16x32_bf16 a[92:95], v[120:123], v[40:43], a[92:95]
    v_accvgpr_read_b32 v213, a249
    v_mfma_f32_16x16x32_bf16 a[92:95], v[124:127], v[44:47], a[92:95]
    s_waitcnt lgkmcnt(2)
    v_mfma_f32_16x16x32_bf16 a[96:99], v[96:99], v[32:35], a[96:99]
    ds_read_b128 v[40:43], v16 offset:14336
    v_mfma_f32_16x16x32_bf16 a[96:99], v[100:103], v[36:39], a[96:99]
    ds_read_b128 v[44:47], v17 offset:14336
    v_accvgpr_read_b32 v214, a250
    v_mfma_f32_16x16x32_bf16 a[100:103], v[104:107], v[32:35], a[100:103]
    v_accvgpr_read_b32 v215, a251
    v_mfma_f32_16x16x32_bf16 a[100:103], v[108:111], v[36:39], a[100:103]
    v_cvt_pk_bf16_f32 v216, v208, v209
    v_mfma_f32_16x16x32_bf16 a[104:107], v[112:115], v[32:35], a[104:107]
    v_cvt_pk_bf16_f32 v217, v210, v211
    v_mfma_f32_16x16x32_bf16 a[104:107], v[116:119], v[36:39], a[104:107]
    v_cvt_pk_bf16_f32 v218, v212, v213
    v_mfma_f32_16x16x32_bf16 a[108:111], v[120:123], v[32:35], a[108:111]
    v_cvt_pk_bf16_f32 v219, v214, v215
    v_mfma_f32_16x16x32_bf16 a[108:111], v[124:127], v[36:39], a[108:111]
    s_waitcnt lgkmcnt(0)
    v_mfma_f32_16x16x32_bf16 a[112:115], v[96:99], v[40:43], a[112:115]
    s_waitcnt vmcnt(22)
    s_barrier
    buffer_store_dwordx4 v[216:219], v14, s[8:11], s91 offen offset:2048 sc0 sc1
    v_mfma_f32_16x16x32_bf16 a[112:115], v[100:103], v[44:47], a[112:115]
    ds_read_b128 v[32:35], v16 offset:32768
    v_accvgpr_read_b32 v220, a236
    v_mfma_f32_16x16x32_bf16 a[116:119], v[104:107], v[40:43], a[116:119]
    ds_read_b128 v[36:39], v17 offset:32768
    v_accvgpr_read_b32 v221, a237
    v_mfma_f32_16x16x32_bf16 a[116:119], v[108:111], v[44:47], a[116:119]
    s_add_u32 m0, s40, 0
    s_add_u32 s48, s36, 768
    buffer_load_dwordx4 v2, s[8:11], s48 offen offset:0 sc1 lds
    v_accvgpr_read_b32 v222, a238
    v_mfma_f32_16x16x32_bf16 a[120:123], v[112:115], v[40:43], a[120:123]
    v_accvgpr_read_b32 v223, a239
    v_mfma_f32_16x16x32_bf16 a[120:123], v[116:119], v[44:47], a[120:123]
    v_accvgpr_read_b32 v224, a252
    v_mfma_f32_16x16x32_bf16 a[124:127], v[120:123], v[40:43], a[124:127]
    buffer_load_dwordx4 v3, s[8:11], s48 offen offset:1024 sc1 lds
    v_accvgpr_read_b32 v225, a253
    v_mfma_f32_16x16x32_bf16 a[124:127], v[124:127], v[44:47], a[124:127]
    s_waitcnt lgkmcnt(0)
    v_mfma_f32_16x16x32_bf16 a[0:3], v[64:67], v[32:35], a[0:3]
    ds_read_b128 v[40:43], v16 offset:34816
    v_mfma_f32_16x16x32_bf16 a[0:3], v[68:71], v[36:39], a[0:3]
    ds_read_b128 v[44:47], v17 offset:34816
    v_accvgpr_read_b32 v226, a254
    v_mfma_f32_16x16x32_bf16 a[4:7], v[72:75], v[32:35], a[4:7]
    ds_read_b64_tr_b16 v[96:97], v192 offset:16384
    v_accvgpr_read_b32 v227, a255
    v_mfma_f32_16x16x32_bf16 a[4:7], v[76:79], v[36:39], a[4:7]
    buffer_load_dwordx4 v4, s[8:11], s48 offen offset:2048 sc1 lds
    v_cvt_pk_bf16_f32 v228, v220, v221
    v_mfma_f32_16x16x32_bf16 a[8:11], v[80:83], v[32:35], a[8:11]
    ds_read_b64_tr_b16 v[98:99], v192 offset:18432
    v_cvt_pk_bf16_f32 v229, v222, v223
    v_mfma_f32_16x16x32_bf16 a[8:11], v[84:87], v[36:39], a[8:11]
    buffer_load_dwordx4 v5, s[8:11], s48 offen offset:3072 sc1 lds
    v_cvt_pk_bf16_f32 v230, v224, v225
    v_mfma_f32_16x16x32_bf16 a[12:15], v[88:91], v[32:35], a[12:15]
    ds_read_b64_tr_b16 v[100:101], v192 offset:24576
    v_cvt_pk_bf16_f32 v231, v226, v227
    v_mfma_f32_16x16x32_bf16 a[12:15], v[92:95], v[36:39], a[12:15]
    s_waitcnt lgkmcnt(3)
    v_mfma_f32_16x16x32_bf16 a[16:19], v[64:67], v[40:43], a[16:19]
    ds_read_b128 v[32:35], v16 offset:36864
    buffer_store_dwordx4 v[228:231], v14, s[8:11], s91 offen offset:2304 sc0 sc1
    v_mfma_f32_16x16x32_bf16 a[16:19], v[68:71], v[44:47], a[16:19]
    ds_read_b128 v[36:39], v17 offset:36864
    v_mfma_f32_16x16x32_bf16 a[20:23], v[72:75], v[40:43], a[20:23]
    ds_read_b64_tr_b16 v[102:103], v192 offset:26624
    v_mfma_f32_16x16x32_bf16 a[20:23], v[76:79], v[44:47], a[20:23]
    s_add_u32 m0, s40, 4096
    s_add_u32 s48, s36, 33536
    buffer_load_dwordx4 v2, s[8:11], s48 offen offset:0 sc1 lds
    v_mfma_f32_16x16x32_bf16 a[24:27], v[80:83], v[40:43], a[24:27]
    ds_read_b64_tr_b16 v[104:105], v193 offset:16384
    v_mfma_f32_16x16x32_bf16 a[24:27], v[84:87], v[44:47], a[24:27]
    v_mfma_f32_16x16x32_bf16 a[28:31], v[88:91], v[40:43], a[28:31]
    ds_read_b64_tr_b16 v[106:107], v193 offset:18432
    buffer_load_dwordx4 v3, s[8:11], s48 offen offset:1024 sc1 lds
    v_mfma_f32_16x16x32_bf16 a[28:31], v[92:95], v[44:47], a[28:31]
    s_waitcnt lgkmcnt(3)
    v_mfma_f32_16x16x32_bf16 a[32:35], v[64:67], v[32:35], a[32:35]
    ds_read_b128 v[40:43], v16 offset:38912
    v_mfma_f32_16x16x32_bf16 a[32:35], v[68:71], v[36:39], a[32:35]
    ds_read_b128 v[44:47], v17 offset:38912
    v_mfma_f32_16x16x32_bf16 a[36:39], v[72:75], v[32:35], a[36:39]
    ds_read_b64_tr_b16 v[108:109], v193 offset:24576
    v_mfma_f32_16x16x32_bf16 a[36:39], v[76:79], v[36:39], a[36:39]
    buffer_load_dwordx4 v4, s[8:11], s48 offen offset:2048 sc1 lds
    v_mfma_f32_16x16x32_bf16 a[40:43], v[80:83], v[32:35], a[40:43]
    v_mfma_f32_16x16x32_bf16 a[40:43], v[84:87], v[36:39], a[40:43]
    ds_read_b64_tr_b16 v[110:111], v193 offset:26624
    buffer_load_dwordx4 v5, s[8:11], s48 offen offset:3072 sc1 lds
    v_mfma_f32_16x16x32_bf16 a[44:47], v[88:91], v[32:35], a[44:47]
    v_mfma_f32_16x16x32_bf16 a[44:47], v[92:95], v[36:39], a[44:47]
    s_waitcnt lgkmcnt(2)
    v_mfma_f32_16x16x32_bf16 a[48:51], v[64:67], v[40:43], a[48:51]
    ds_read_b128 v[32:35], v16 offset:40960
    v_mfma_f32_16x16x32_bf16 a[48:51], v[68:71], v[44:47], a[48:51]
    ds_read_b128 v[36:39], v17 offset:40960
    v_mfma_f32_16x16x32_bf16 a[52:55], v[72:75], v[40:43], a[52:55]
    ds_read_b64_tr_b16 v[112:113], v194 offset:16384
    v_mfma_f32_16x16x32_bf16 a[52:55], v[76:79], v[44:47], a[52:55]
    v_mfma_f32_16x16x32_bf16 a[56:59], v[80:83], v[40:43], a[56:59]
    ds_read_b64_tr_b16 v[114:115], v194 offset:18432
    v_mfma_f32_16x16x32_bf16 a[56:59], v[84:87], v[44:47], a[56:59]
    v_mfma_f32_16x16x32_bf16 a[60:63], v[88:91], v[40:43], a[60:63]
    ds_read_b64_tr_b16 v[116:117], v194 offset:24576
    v_mfma_f32_16x16x32_bf16 a[60:63], v[92:95], v[44:47], a[60:63]
    s_waitcnt vmcnt(4)
    s_mov_b64 exec, 1
    buffer_store_dword v49, v48, s[8:11], s53 offen sc0 sc1
    s_mov_b64 exec, -1
    s_waitcnt lgkmcnt(3)
    v_mfma_f32_16x16x32_bf16 a[64:67], v[64:67], v[32:35], a[64:67]
    ds_read_b128 v[40:43], v16 offset:43008
    v_mfma_f32_16x16x32_bf16 a[64:67], v[68:71], v[36:39], a[64:67]
    ds_read_b128 v[44:47], v17 offset:43008
    v_mfma_f32_16x16x32_bf16 a[68:71], v[72:75], v[32:35], a[68:71]
    ds_read_b64_tr_b16 v[118:119], v194 offset:26624
    v_mfma_f32_16x16x32_bf16 a[68:71], v[76:79], v[36:39], a[68:71]
    v_mfma_f32_16x16x32_bf16 a[72:75], v[80:83], v[32:35], a[72:75]
    ds_read_b64_tr_b16 v[120:121], v195 offset:16384
    v_mfma_f32_16x16x32_bf16 a[72:75], v[84:87], v[36:39], a[72:75]
    v_mfma_f32_16x16x32_bf16 a[76:79], v[88:91], v[32:35], a[76:79]
    ds_read_b64_tr_b16 v[122:123], v195 offset:18432
    v_mfma_f32_16x16x32_bf16 a[76:79], v[92:95], v[36:39], a[76:79]
    s_waitcnt lgkmcnt(3)
    v_mfma_f32_16x16x32_bf16 a[80:83], v[64:67], v[40:43], a[80:83]
    ds_read_b128 v[32:35], v16 offset:45056
    v_mfma_f32_16x16x32_bf16 a[80:83], v[68:71], v[44:47], a[80:83]
    ds_read_b128 v[36:39], v17 offset:45056
    v_mfma_f32_16x16x32_bf16 a[84:87], v[72:75], v[40:43], a[84:87]
    ds_read_b64_tr_b16 v[124:125], v195 offset:24576
    v_mfma_f32_16x16x32_bf16 a[84:87], v[76:79], v[44:47], a[84:87]
    v_mfma_f32_16x16x32_bf16 a[88:91], v[80:83], v[40:43], a[88:91]
    v_mfma_f32_16x16x32_bf16 a[88:91], v[84:87], v[44:47], a[88:91]
    ds_read_b64_tr_b16 v[126:127], v195 offset:26624
    v_mfma_f32_16x16x32_bf16 a[92:95], v[88:91], v[40:43], a[92:95]
    v_mfma_f32_16x16x32_bf16 a[92:95], v[92:95], v[44:47], a[92:95]
    s_waitcnt lgkmcnt(2)
    v_mfma_f32_16x16x32_bf16 a[96:99], v[64:67], v[32:35], a[96:99]
    ds_read_b128 v[40:43], v16 offset:47104
    v_mfma_f32_16x16x32_bf16 a[96:99], v[68:71], v[36:39], a[96:99]
    ds_read_b128 v[44:47], v17 offset:47104
    v_mfma_f32_16x16x32_bf16 a[100:103], v[72:75], v[32:35], a[100:103]
    v_mfma_f32_16x16x32_bf16 a[100:103], v[76:79], v[36:39], a[100:103]
    v_mfma_f32_16x16x32_bf16 a[104:107], v[80:83], v[32:35], a[104:107]
    v_mfma_f32_16x16x32_bf16 a[104:107], v[84:87], v[36:39], a[104:107]
    v_mfma_f32_16x16x32_bf16 a[108:111], v[88:91], v[32:35], a[108:111]
    v_mfma_f32_16x16x32_bf16 a[108:111], v[92:95], v[36:39], a[108:111]
    s_waitcnt lgkmcnt(0)
    v_mfma_f32_16x16x32_bf16 a[112:115], v[64:67], v[40:43], a[112:115]
    s_waitcnt vmcnt(17)
    s_barrier
    v_mfma_f32_16x16x32_bf16 a[112:115], v[68:71], v[44:47], a[112:115]
    ds_read_b128 v[32:35], v18 offset:0
    v_mfma_f32_16x16x32_bf16 a[116:119], v[72:75], v[40:43], a[116:119]
    ds_read_b128 v[36:39], v19 offset:0
    v_mfma_f32_16x16x32_bf16 a[116:119], v[76:79], v[44:47], a[116:119]
    s_add_u32 m0, s40, 32768
    s_add_u32 s48, s36, 896
    buffer_load_dwordx4 v2, s[8:11], s48 offen offset:0 sc1 lds
    v_mfma_f32_16x16x32_bf16 a[120:123], v[80:83], v[40:43], a[120:123]
    v_mfma_f32_16x16x32_bf16 a[120:123], v[84:87], v[44:47], a[120:123]
    v_mfma_f32_16x16x32_bf16 a[124:127], v[88:91], v[40:43], a[124:127]
    buffer_load_dwordx4 v3, s[8:11], s48 offen offset:1024 sc1 lds
    v_mfma_f32_16x16x32_bf16 a[124:127], v[92:95], v[44:47], a[124:127]
    s_waitcnt lgkmcnt(0)
    v_mfma_f32_16x16x32_bf16 a[0:3], v[96:99], v[32:35], a[0:3]
    ds_read_b128 v[40:43], v18 offset:2048
    v_mfma_f32_16x16x32_bf16 a[0:3], v[100:103], v[36:39], a[0:3]
    ds_read_b128 v[44:47], v19 offset:2048
    v_mfma_f32_16x16x32_bf16 a[4:7], v[104:107], v[32:35], a[4:7]
    ds_read_b64_tr_b16 v[64:65], v192 offset:32768
    v_mfma_f32_16x16x32_bf16 a[4:7], v[108:111], v[36:39], a[4:7]
    buffer_load_dwordx4 v4, s[8:11], s48 offen offset:2048 sc1 lds
    v_mfma_f32_16x16x32_bf16 a[8:11], v[112:115], v[32:35], a[8:11]
    ds_read_b64_tr_b16 v[66:67], v192 offset:34816
    v_mfma_f32_16x16x32_bf16 a[8:11], v[116:119], v[36:39], a[8:11]
    buffer_load_dwordx4 v5, s[8:11], s48 offen offset:3072 sc1 lds
    buffer_load_dwordx4 v[204:207], v202, s[8:11], s52 offen sc0 sc1
    v_mfma_f32_16x16x32_bf16 a[12:15], v[120:123], v[32:35], a[12:15]
    ds_read_b64_tr_b16 v[68:69], v192 offset:40960
    v_mfma_f32_16x16x32_bf16 a[12:15], v[124:127], v[36:39], a[12:15]
    s_waitcnt lgkmcnt(3)
    v_mfma_f32_16x16x32_bf16 a[16:19], v[96:99], v[40:43], a[16:19]
    ds_read_b128 v[32:35], v18 offset:4096
    v_mfma_f32_16x16x32_bf16 a[16:19], v[100:103], v[44:47], a[16:19]
    ds_read_b128 v[36:39], v19 offset:4096
    v_mfma_f32_16x16x32_bf16 a[20:23], v[104:107], v[40:43], a[20:23]
    ds_read_b64_tr_b16 v[70:71], v192 offset:43008
    v_mfma_f32_16x16x32_bf16 a[20:23], v[108:111], v[44:47], a[20:23]
    s_add_u32 m0, s40, 36864
    s_add_u32 s48, s36, 33664
    buffer_load_dwordx4 v2, s[8:11], s48 offen offset:0 sc1 lds
    v_mfma_f32_16x16x32_bf16 a[24:27], v[112:115], v[40:43], a[24:27]
    ds_read_b64_tr_b16 v[72:73], v193 offset:32768
    v_mfma_f32_16x16x32_bf16 a[24:27], v[116:119], v[44:47], a[24:27]
    v_mfma_f32_16x16x32_bf16 a[28:31], v[120:123], v[40:43], a[28:31]
    ds_read_b64_tr_b16 v[74:75], v193 offset:34816
    buffer_load_dwordx4 v3, s[8:11], s48 offen offset:1024 sc1 lds
    v_mfma_f32_16x16x32_bf16 a[28:31], v[124:127], v[44:47], a[28:31]
    s_waitcnt lgkmcnt(3)
    v_mfma_f32_16x16x32_bf16 a[32:35], v[96:99], v[32:35], a[32:35]
    ds_read_b128 v[40:43], v18 offset:6144
    v_mfma_f32_16x16x32_bf16 a[32:35], v[100:103], v[36:39], a[32:35]
    ds_read_b128 v[44:47], v19 offset:6144
    v_mfma_f32_16x16x32_bf16 a[36:39], v[104:107], v[32:35], a[36:39]
    ds_read_b64_tr_b16 v[76:77], v193 offset:40960
    v_mfma_f32_16x16x32_bf16 a[36:39], v[108:111], v[36:39], a[36:39]
    buffer_load_dwordx4 v4, s[8:11], s48 offen offset:2048 sc1 lds
    v_mfma_f32_16x16x32_bf16 a[40:43], v[112:115], v[32:35], a[40:43]
    v_mfma_f32_16x16x32_bf16 a[40:43], v[116:119], v[36:39], a[40:43]
    ds_read_b64_tr_b16 v[78:79], v193 offset:43008
    buffer_load_dwordx4 v5, s[8:11], s48 offen offset:3072 sc1 lds
    v_mfma_f32_16x16x32_bf16 a[44:47], v[120:123], v[32:35], a[44:47]
    v_mfma_f32_16x16x32_bf16 a[44:47], v[124:127], v[36:39], a[44:47]
    s_waitcnt lgkmcnt(2)
    v_mfma_f32_16x16x32_bf16 a[48:51], v[96:99], v[40:43], a[48:51]
    ds_read_b128 v[32:35], v18 offset:8192
    v_mfma_f32_16x16x32_bf16 a[48:51], v[100:103], v[44:47], a[48:51]
    ds_read_b128 v[36:39], v19 offset:8192
    v_mfma_f32_16x16x32_bf16 a[52:55], v[104:107], v[40:43], a[52:55]
    ds_read_b64_tr_b16 v[80:81], v194 offset:32768
    v_mfma_f32_16x16x32_bf16 a[52:55], v[108:111], v[44:47], a[52:55]
    v_mfma_f32_16x16x32_bf16 a[56:59], v[112:115], v[40:43], a[56:59]
    ds_read_b64_tr_b16 v[82:83], v194 offset:34816
    v_mfma_f32_16x16x32_bf16 a[56:59], v[116:119], v[44:47], a[56:59]
    v_mfma_f32_16x16x32_bf16 a[60:63], v[120:123], v[40:43], a[60:63]
    ds_read_b64_tr_b16 v[84:85], v194 offset:40960
    v_mfma_f32_16x16x32_bf16 a[60:63], v[124:127], v[44:47], a[60:63]
    s_waitcnt lgkmcnt(3)
    v_mfma_f32_16x16x32_bf16 a[64:67], v[96:99], v[32:35], a[64:67]
    ds_read_b128 v[40:43], v18 offset:10240
    v_mfma_f32_16x16x32_bf16 a[64:67], v[100:103], v[36:39], a[64:67]
    ds_read_b128 v[44:47], v19 offset:10240
    v_mfma_f32_16x16x32_bf16 a[68:71], v[104:107], v[32:35], a[68:71]
    ds_read_b64_tr_b16 v[86:87], v194 offset:43008
    v_mfma_f32_16x16x32_bf16 a[68:71], v[108:111], v[36:39], a[68:71]
    v_mfma_f32_16x16x32_bf16 a[72:75], v[112:115], v[32:35], a[72:75]
    ds_read_b64_tr_b16 v[88:89], v195 offset:32768
    v_mfma_f32_16x16x32_bf16 a[72:75], v[116:119], v[36:39], a[72:75]
    v_mfma_f32_16x16x32_bf16 a[76:79], v[120:123], v[32:35], a[76:79]
    ds_read_b64_tr_b16 v[90:91], v195 offset:34816
    v_mfma_f32_16x16x32_bf16 a[76:79], v[124:127], v[36:39], a[76:79]
    s_waitcnt lgkmcnt(3)
    v_mfma_f32_16x16x32_bf16 a[80:83], v[96:99], v[40:43], a[80:83]
    ds_read_b128 v[32:35], v18 offset:12288
    v_mfma_f32_16x16x32_bf16 a[80:83], v[100:103], v[44:47], a[80:83]
    ds_read_b128 v[36:39], v19 offset:12288
    v_mfma_f32_16x16x32_bf16 a[84:87], v[104:107], v[40:43], a[84:87]
    ds_read_b64_tr_b16 v[92:93], v195 offset:40960
    v_mfma_f32_16x16x32_bf16 a[84:87], v[108:111], v[44:47], a[84:87]
    v_mfma_f32_16x16x32_bf16 a[88:91], v[112:115], v[40:43], a[88:91]
    v_mfma_f32_16x16x32_bf16 a[88:91], v[116:119], v[44:47], a[88:91]
    ds_read_b64_tr_b16 v[94:95], v195 offset:43008
    v_mfma_f32_16x16x32_bf16 a[92:95], v[120:123], v[40:43], a[92:95]
    v_mfma_f32_16x16x32_bf16 a[92:95], v[124:127], v[44:47], a[92:95]
    s_waitcnt lgkmcnt(2)
    v_mfma_f32_16x16x32_bf16 a[96:99], v[96:99], v[32:35], a[96:99]
    ds_read_b128 v[40:43], v18 offset:14336
    v_mfma_f32_16x16x32_bf16 a[96:99], v[100:103], v[36:39], a[96:99]
    ds_read_b128 v[44:47], v19 offset:14336
    v_mfma_f32_16x16x32_bf16 a[100:103], v[104:107], v[32:35], a[100:103]
    v_mfma_f32_16x16x32_bf16 a[100:103], v[108:111], v[36:39], a[100:103]
    v_mfma_f32_16x16x32_bf16 a[104:107], v[112:115], v[32:35], a[104:107]
    v_mfma_f32_16x16x32_bf16 a[104:107], v[116:119], v[36:39], a[104:107]
    v_mfma_f32_16x16x32_bf16 a[108:111], v[120:123], v[32:35], a[108:111]
    v_mfma_f32_16x16x32_bf16 a[108:111], v[124:127], v[36:39], a[108:111]
    s_waitcnt lgkmcnt(0)
    v_mfma_f32_16x16x32_bf16 a[112:115], v[96:99], v[40:43], a[112:115]
    s_waitcnt vmcnt(10)
    s_barrier
    v_mfma_f32_16x16x32_bf16 a[112:115], v[100:103], v[44:47], a[112:115]
    ds_read_b128 v[32:35], v16 offset:0
    v_mfma_f32_16x16x32_bf16 a[116:119], v[104:107], v[40:43], a[116:119]
    ds_read_b128 v[36:39], v17 offset:0
    v_mfma_f32_16x16x32_bf16 a[116:119], v[108:111], v[44:47], a[116:119]
    v_mfma_f32_16x16x32_bf16 a[120:123], v[112:115], v[40:43], a[120:123]
    v_mfma_f32_16x16x32_bf16 a[120:123], v[116:119], v[44:47], a[120:123]
    v_mfma_f32_16x16x32_bf16 a[124:127], v[120:123], v[40:43], a[124:127]
    v_mfma_f32_16x16x32_bf16 a[124:127], v[124:127], v[44:47], a[124:127]
    s_waitcnt lgkmcnt(0)
    v_mfma_f32_16x16x32_bf16 a[0:3], v[64:67], v[32:35], a[0:3]
    ds_read_b128 v[40:43], v16 offset:2048
    v_mfma_f32_16x16x32_bf16 a[0:3], v[68:71], v[36:39], a[0:3]
    ds_read_b128 v[44:47], v17 offset:2048
    v_mfma_f32_16x16x32_bf16 a[4:7], v[72:75], v[32:35], a[4:7]
    ds_read_b64_tr_b16 v[96:97], v192 offset:49152
    v_mfma_f32_16x16x32_bf16 a[4:7], v[76:79], v[36:39], a[4:7]
    v_mfma_f32_16x16x32_bf16 a[8:11], v[80:83], v[32:35], a[8:11]
    ds_read_b64_tr_b16 v[98:99], v192 offset:51200
    v_mfma_f32_16x16x32_bf16 a[8:11], v[84:87], v[36:39], a[8:11]
    v_mfma_f32_16x16x32_bf16 a[12:15], v[88:91], v[32:35], a[12:15]
    ds_read_b64_tr_b16 v[100:101], v192 offset:57344
    v_mfma_f32_16x16x32_bf16 a[12:15], v[92:95], v[36:39], a[12:15]
    s_waitcnt lgkmcnt(3)
    v_mfma_f32_16x16x32_bf16 a[16:19], v[64:67], v[40:43], a[16:19]
    ds_read_b128 v[32:35], v16 offset:4096
    v_mfma_f32_16x16x32_bf16 a[16:19], v[68:71], v[44:47], a[16:19]
    ds_read_b128 v[36:39], v17 offset:4096
    v_mfma_f32_16x16x32_bf16 a[20:23], v[72:75], v[40:43], a[20:23]
    ds_read_b64_tr_b16 v[102:103], v192 offset:59392
    v_mfma_f32_16x16x32_bf16 a[20:23], v[76:79], v[44:47], a[20:23]
    v_mfma_f32_16x16x32_bf16 a[24:27], v[80:83], v[40:43], a[24:27]
    ds_read_b64_tr_b16 v[104:105], v193 offset:49152
    v_mfma_f32_16x16x32_bf16 a[24:27], v[84:87], v[44:47], a[24:27]
    v_mfma_f32_16x16x32_bf16 a[28:31], v[88:91], v[40:43], a[28:31]
    ds_read_b64_tr_b16 v[106:107], v193 offset:51200
    v_mfma_f32_16x16x32_bf16 a[28:31], v[92:95], v[44:47], a[28:31]
    s_waitcnt lgkmcnt(3)
    v_mfma_f32_16x16x32_bf16 a[32:35], v[64:67], v[32:35], a[32:35]
    ds_read_b128 v[40:43], v16 offset:6144
    v_mfma_f32_16x16x32_bf16 a[32:35], v[68:71], v[36:39], a[32:35]
    ds_read_b128 v[44:47], v17 offset:6144
    v_mfma_f32_16x16x32_bf16 a[36:39], v[72:75], v[32:35], a[36:39]
    ds_read_b64_tr_b16 v[108:109], v193 offset:57344
    v_mfma_f32_16x16x32_bf16 a[36:39], v[76:79], v[36:39], a[36:39]
    v_mfma_f32_16x16x32_bf16 a[40:43], v[80:83], v[32:35], a[40:43]
    v_mfma_f32_16x16x32_bf16 a[40:43], v[84:87], v[36:39], a[40:43]
    ds_read_b64_tr_b16 v[110:111], v193 offset:59392
    v_mfma_f32_16x16x32_bf16 a[44:47], v[88:91], v[32:35], a[44:47]
    v_mfma_f32_16x16x32_bf16 a[44:47], v[92:95], v[36:39], a[44:47]
    s_waitcnt lgkmcnt(2)
    v_mfma_f32_16x16x32_bf16 a[48:51], v[64:67], v[40:43], a[48:51]
    ds_read_b128 v[32:35], v16 offset:8192
    v_mfma_f32_16x16x32_bf16 a[48:51], v[68:71], v[44:47], a[48:51]
    ds_read_b128 v[36:39], v17 offset:8192
    v_mfma_f32_16x16x32_bf16 a[52:55], v[72:75], v[40:43], a[52:55]
    ds_read_b64_tr_b16 v[112:113], v194 offset:49152
    v_mfma_f32_16x16x32_bf16 a[52:55], v[76:79], v[44:47], a[52:55]
    v_mfma_f32_16x16x32_bf16 a[56:59], v[80:83], v[40:43], a[56:59]
    ds_read_b64_tr_b16 v[114:115], v194 offset:51200
    v_mfma_f32_16x16x32_bf16 a[56:59], v[84:87], v[44:47], a[56:59]
    v_mfma_f32_16x16x32_bf16 a[60:63], v[88:91], v[40:43], a[60:63]
    ds_read_b64_tr_b16 v[116:117], v194 offset:57344
    v_mfma_f32_16x16x32_bf16 a[60:63], v[92:95], v[44:47], a[60:63]
    s_waitcnt lgkmcnt(3)
    v_mfma_f32_16x16x32_bf16 a[64:67], v[64:67], v[32:35], a[64:67]
    ds_read_b128 v[40:43], v16 offset:10240
    v_mfma_f32_16x16x32_bf16 a[64:67], v[68:71], v[36:39], a[64:67]
    ds_read_b128 v[44:47], v17 offset:10240
    v_mfma_f32_16x16x32_bf16 a[68:71], v[72:75], v[32:35], a[68:71]
    ds_read_b64_tr_b16 v[118:119], v194 offset:59392
    v_mfma_f32_16x16x32_bf16 a[68:71], v[76:79], v[36:39], a[68:71]
    v_mfma_f32_16x16x32_bf16 a[72:75], v[80:83], v[32:35], a[72:75]
    ds_read_b64_tr_b16 v[120:121], v195 offset:49152
    v_mfma_f32_16x16x32_bf16 a[72:75], v[84:87], v[36:39], a[72:75]
    v_mfma_f32_16x16x32_bf16 a[76:79], v[88:91], v[32:35], a[76:79]
    ds_read_b64_tr_b16 v[122:123], v195 offset:51200
    v_mfma_f32_16x16x32_bf16 a[76:79], v[92:95], v[36:39], a[76:79]
    s_waitcnt lgkmcnt(3)
    v_mfma_f32_16x16x32_bf16 a[80:83], v[64:67], v[40:43], a[80:83]
    ds_read_b128 v[32:35], v16 offset:12288
    v_mfma_f32_16x16x32_bf16 a[80:83], v[68:71], v[44:47], a[80:83]
    ds_read_b128 v[36:39], v17 offset:12288
    v_mfma_f32_16x16x32_bf16 a[84:87], v[72:75], v[40:43], a[84:87]
    ds_read_b64_tr_b16 v[124:125], v195 offset:57344
    v_mfma_f32_16x16x32_bf16 a[84:87], v[76:79], v[44:47], a[84:87]
    v_mfma_f32_16x16x32_bf16 a[88:91], v[80:83], v[40:43], a[88:91]
    v_mfma_f32_16x16x32_bf16 a[88:91], v[84:87], v[44:47], a[88:91]
    ds_read_b64_tr_b16 v[126:127], v195 offset:59392
    v_mfma_f32_16x16x32_bf16 a[92:95], v[88:91], v[40:43], a[92:95]
    v_mfma_f32_16x16x32_bf16 a[92:95], v[92:95], v[44:47], a[92:95]
    s_waitcnt lgkmcnt(2)
    v_mfma_f32_16x16x32_bf16 a[96:99], v[64:67], v[32:35], a[96:99]
    ds_read_b128 v[40:43], v16 offset:14336
    v_mfma_f32_16x16x32_bf16 a[96:99], v[68:71], v[36:39], a[96:99]
    ds_read_b128 v[44:47], v17 offset:14336
    v_mfma_f32_16x16x32_bf16 a[100:103], v[72:75], v[32:35], a[100:103]
    v_mfma_f32_16x16x32_bf16 a[100:103], v[76:79], v[36:39], a[100:103]
    v_mfma_f32_16x16x32_bf16 a[104:107], v[80:83], v[32:35], a[104:107]
    v_mfma_f32_16x16x32_bf16 a[104:107], v[84:87], v[36:39], a[104:107]
    v_mfma_f32_16x16x32_bf16 a[108:111], v[88:91], v[32:35], a[108:111]
    v_mfma_f32_16x16x32_bf16 a[108:111], v[92:95], v[36:39], a[108:111]
    s_waitcnt vmcnt(4)
    s_cmp_lg_u32 s32, 0
    s_cbranch_scc1 L_g1_kv6g
    s_mov_b32 s7, 0
L_g1_kv6:
    v_and_b32 v204, v204, v205
    v_and_b32 v206, v206, v207
    v_and_b32 v204, v204, v206
    v_cmp_ne_u32 vcc, 1, v204
    s_add_u32 s7, s7, 1
    s_cbranch_vccz L_g1_kv6g
    s_sleep 2
    buffer_load_dwordx4 v[204:207], v202, s[8:11], s52 offen sc0 sc1
    s_waitcnt vmcnt(0)
    s_cmp_lt_u32 s7, 0x40000
    s_cbranch_scc1 L_g1_kv6
L_g1_kv6g:
    s_waitcnt lgkmcnt(0)
    v_mfma_f32_16x16x32_bf16 a[112:115], v[64:67], v[40:43], a[112:115]
    s_waitcnt vmcnt(0)
    s_barrier
    v_mfma_f32_16x16x32_bf16 a[112:115], v[68:71], v[44:47], a[112:115]
    ds_read_b128 v[32:35], v16 offset:32768
    v_mfma_f32_16x16x32_bf16 a[116:119], v[72:75], v[40:43], a[116:119]
    ds_read_b128 v[36:39], v17 offset:32768
    v_mfma_f32_16x16x32_bf16 a[116:119], v[76:79], v[44:47], a[116:119]
    v_mfma_f32_16x16x32_bf16 a[120:123], v[80:83], v[40:43], a[120:123]
    v_mfma_f32_16x16x32_bf16 a[120:123], v[84:87], v[44:47], a[120:123]
    v_mfma_f32_16x16x32_bf16 a[124:127], v[88:91], v[40:43], a[124:127]
    v_mfma_f32_16x16x32_bf16 a[124:127], v[92:95], v[44:47], a[124:127]
    s_waitcnt lgkmcnt(0)
    v_mfma_f32_16x16x32_bf16 a[0:3], v[96:99], v[32:35], a[0:3]
    ds_read_b128 v[40:43], v16 offset:34816
    v_mfma_f32_16x16x32_bf16 a[0:3], v[100:103], v[36:39], a[0:3]
    ds_read_b128 v[44:47], v17 offset:34816
    v_mfma_f32_16x16x32_bf16 a[4:7], v[104:107], v[32:35], a[4:7]
    s_lshl_b32 s4, s33, 20
    s_add_u32 s4, s4, 23068672
    s_add_u32 s4, s4, s41
    s_cmp_lt_u32 s32, 2
    s_cselect_b32 s5, s4, 0x7ff00000
    s_cselect_b32 s6, 16384, 0
    s_add_u32 s6, s6, s4
    s_add_u32 s7, s6, 32768
    s_add_u32 m0, s41, 98304
    s_nop 0
    buffer_load_dwordx4 v1, s[8:11], s5 offen offset:0 sc1 lds
    v_mfma_f32_16x16x32_bf16 a[4:7], v[108:111], v[36:39], a[4:7]
    v_mfma_f32_16x16x32_bf16 a[8:11], v[112:115], v[32:35], a[8:11]
    v_mfma_f32_16x16x32_bf16 a[8:11], v[116:119], v[36:39], a[8:11]
    v_mfma_f32_16x16x32_bf16 a[12:15], v[120:123], v[32:35], a[12:15]
    buffer_load_dwordx4 v1, s[8:11], s5 offen offset:1024 sc1 lds
    v_mfma_f32_16x16x32_bf16 a[12:15], v[124:127], v[36:39], a[12:15]
    buffer_load_dwordx4 v1, s[8:11], s5 offen offset:2048 sc1 lds
    buffer_load_dwordx4 v1, s[8:11], s5 offen offset:3072 sc1 lds
    s_waitcnt lgkmcnt(0)
    v_mfma_f32_16x16x32_bf16 a[16:19], v[96:99], v[40:43], a[16:19]
    ds_read_b128 v[32:35], v16 offset:36864
    v_mfma_f32_16x16x32_bf16 a[16:19], v[100:103], v[44:47], a[16:19]
    ds_read_b128 v[36:39], v17 offset:36864
    v_mfma_f32_16x16x32_bf16 a[20:23], v[104:107], v[40:43], a[20:23]
    s_add_u32 m0, s41, 0
    s_nop 0
    buffer_load_dwordx4 v1, s[8:11], s6 offen offset:0 sc1 lds
    v_mfma_f32_16x16x32_bf16 a[20:23], v[108:111], v[44:47], a[20:23]
    v_accvgpr_read_b32 v208, a0
    v_accvgpr_read_b32 v209, a1
    v_accvgpr_read_b32 v210, a2
    v_accvgpr_read_b32 v211, a3
    v_accvgpr_read_b32 v212, a4
    v_accvgpr_read_b32 v213, a5
    v_accvgpr_read_b32 v214, a6
    v_accvgpr_read_b32 v215, a7
    v_mul_f32 v208, s54, v208
    v_mul_f32 v209, s54, v209
    v_mfma_f32_16x16x32_bf16 a[24:27], v[112:115], v[40:43], a[24:27]
    v_mul_f32 v210, s54, v210
    v_mul_f32 v211, s54, v211
    v_mul_f32 v212, s54, v212
    v_mul_f32 v213, s54, v213
    v_mul_f32 v214, s54, v214
    v_mul_f32 v215, s54, v215
    v_cvt_pk_bf16_f32 v216, v208, v209
    v_cvt_pk_bf16_f32 v217, v210, v211
    v_cvt_pk_bf16_f32 v218, v212, v213
    v_cvt_pk_bf16_f32 v219, v214, v215
    v_mfma_f32_16x16x32_bf16 a[24:27], v[116:119], v[44:47], a[24:27]
    buffer_load_dwordx4 v1, s[8:11], s6 offen offset:1024 sc1 lds
    v_accvgpr_read_b32 v220, a8
    v_accvgpr_read_b32 v221, a9
    v_accvgpr_read_b32 v222, a10
    v_accvgpr_read_b32 v223, a11
    v_accvgpr_read_b32 v224, a12
    v_accvgpr_read_b32 v225, a13
    v_accvgpr_read_b32 v226, a14
    v_mfma_f32_16x16x32_bf16 a[28:31], v[120:123], v[40:43], a[28:31]
    buffer_load_dwordx4 v1, s[8:11], s6 offen offset:2048 sc1 lds
    v_accvgpr_read_b32 v227, a15
    v_mul_f32 v220, s54, v220
    v_mul_f32 v221, s54, v221
    v_mul_f32 v222, s54, v222
    v_mul_f32 v223, s54, v223
    v_mul_f32 v224, s54, v224
    v_mul_f32 v225, s54, v225
    v_mfma_f32_16x16x32_bf16 a[28:31], v[124:127], v[44:47], a[28:31]
    buffer_load_dwordx4 v1, s[8:11], s6 offen offset:3072 sc1 lds
    v_mul_f32 v226, s54, v226
    v_mul_f32 v227, s54, v227
    v_cvt_pk_bf16_f32 v228, v220, v221
    v_cvt_pk_bf16_f32 v229, v222, v223
    v_cvt_pk_bf16_f32 v230, v224, v225
    v_cvt_pk_bf16_f32 v231, v226, v227
    s_waitcnt lgkmcnt(0)
    v_mfma_f32_16x16x32_bf16 a[32:35], v[96:99], v[32:35], a[32:35]
    ds_read_b128 v[40:43], v16 offset:38912
    ds_write_b128 v50, v[216:219] offset:0
    v_mfma_f32_16x16x32_bf16 a[32:35], v[100:103], v[36:39], a[32:35]
    ds_read_b128 v[44:47], v17 offset:38912
    ds_write_b128 v50, v[228:231] offset:2048
    v_mfma_f32_16x16x32_bf16 a[36:39], v[104:107], v[32:35], a[36:39]
    s_add_u32 m0, s41, 65536
    s_nop 0
    buffer_load_dwordx4 v1, s[8:11], s7 offen offset:0 sc1 lds
    v_mfma_f32_16x16x32_bf16 a[36:39], v[108:111], v[36:39], a[36:39]
    v_accvgpr_read_b32 v232, a16
    v_accvgpr_read_b32 v233, a17
    v_accvgpr_read_b32 v234, a18
    v_accvgpr_read_b32 v235, a19
    v_accvgpr_read_b32 v236, a20
    v_accvgpr_read_b32 v237, a21
    v_accvgpr_read_b32 v238, a22
    v_accvgpr_read_b32 v239, a23
    v_mul_f32 v232, s54, v232
    v_mul_f32 v233, s54, v233
    v_mfma_f32_16x16x32_bf16 a[40:43], v[112:115], v[32:35], a[40:43]
    v_mul_f32 v234, s54, v234
    v_mul_f32 v235, s54, v235
    v_mul_f32 v236, s54, v236
    v_mul_f32 v237, s54, v237
    v_mul_f32 v238, s54, v238
    v_mul_f32 v239, s54, v239
    v_cvt_pk_bf16_f32 v240, v232, v233
    v_cvt_pk_bf16_f32 v241, v234, v235
    v_cvt_pk_bf16_f32 v242, v236, v237
    v_cvt_pk_bf16_f32 v243, v238, v239
    v_mfma_f32_16x16x32_bf16 a[40:43], v[116:119], v[36:39], a[40:43]
    buffer_load_dwordx4 v1, s[8:11], s7 offen offset:1024 sc1 lds
    v_accvgpr_read_b32 v208, a24
    v_accvgpr_read_b32 v209, a25
    v_accvgpr_read_b32 v210, a26
    v_accvgpr_read_b32 v211, a27
    v_accvgpr_read_b32 v212, a28
    v_accvgpr_read_b32 v213, a29
    v_accvgpr_read_b32 v214, a30
    v_mfma_f32_16x16x32_bf16 a[44:47], v[120:123], v[32:35], a[44:47]
    buffer_load_dwordx4 v1, s[8:11], s7 offen offset:2048 sc1 lds
    v_accvgpr_read_b32 v215, a31
    v_mul_f32 v208, s54, v208
    v_mul_f32 v209, s54, v209
    v_mul_f32 v210, s54, v210
    v_mul_f32 v211, s54, v211
    v_mul_f32 v212, s54, v212
    v_mul_f32 v213, s54, v213
    v_mfma_f32_16x16x32_bf16 a[44:47], v[124:127], v[36:39], a[44:47]
    buffer_load_dwordx4 v1, s[8:11], s7 offen offset:3072 sc1 lds
    v_mul_f32 v214, s54, v214
    v_mul_f32 v215, s54, v215
    v_cvt_pk_bf16_f32 v216, v208, v209
    v_cvt_pk_bf16_f32 v217, v210, v211
    v_cvt_pk_bf16_f32 v218, v212, v213
    v_cvt_pk_bf16_f32 v219, v214, v215
    s_waitcnt lgkmcnt(1)
    v_mfma_f32_16x16x32_bf16 a[48:51], v[96:99], v[40:43], a[48:51]
    ds_read_b128 v[32:35], v16 offset:40960
    ds_write_b128 v50, v[240:243] offset:256
    v_mfma_f32_16x16x32_bf16 a[48:51], v[100:103], v[44:47], a[48:51]
    ds_read_b128 v[36:39], v17 offset:40960
    ds_write_b128 v50, v[216:219] offset:2304
    v_mfma_f32_16x16x32_bf16 a[52:55], v[104:107], v[40:43], a[52:55]
    v_mfma_f32_16x16x32_bf16 a[52:55], v[108:111], v[44:47], a[52:55]
    v_accvgpr_read_b32 v220, a32
    v_accvgpr_read_b32 v221, a33
    v_accvgpr_read_b32 v222, a34
    v_accvgpr_read_b32 v223, a35
    v_accvgpr_read_b32 v224, a36
    v_accvgpr_read_b32 v225, a37
    v_accvgpr_read_b32 v226, a38
    v_accvgpr_read_b32 v227, a39
    v_mul_f32 v220, s54, v220
    v_mul_f32 v221, s54, v221
    v_mfma_f32_16x16x32_bf16 a[56:59], v[112:115], v[40:43], a[56:59]
    v_mul_f32 v222, s54, v222
    v_mul_f32 v223, s54, v223
    v_mul_f32 v224, s54, v224
    v_mul_f32 v225, s54, v225
    v_mul_f32 v226, s54, v226
    v_mul_f32 v227, s54, v227
    v_cvt_pk_bf16_f32 v228, v220, v221
    v_cvt_pk_bf16_f32 v229, v222, v223
    v_cvt_pk_bf16_f32 v230, v224, v225
    v_cvt_pk_bf16_f32 v231, v226, v227
    v_mfma_f32_16x16x32_bf16 a[56:59], v[116:119], v[44:47], a[56:59]
    v_accvgpr_read_b32 v232, a40
    v_accvgpr_read_b32 v233, a41
    v_accvgpr_read_b32 v234, a42
    v_accvgpr_read_b32 v235, a43
    v_accvgpr_read_b32 v236, a44
    v_accvgpr_read_b32 v237, a45
    v_accvgpr_read_b32 v238, a46
    v_mfma_f32_16x16x32_bf16 a[60:63], v[120:123], v[40:43], a[60:63]
    v_accvgpr_read_b32 v239, a47
    v_mul_f32 v232, s54, v232
    v_mul_f32 v233, s54, v233
    v_mul_f32 v234, s54, v234
    v_mul_f32 v235, s54, v235
    v_mul_f32 v236, s54, v236
    v_mul_f32 v237, s54, v237
    v_mfma_f32_16x16x32_bf16 a[60:63], v[124:127], v[44:47], a[60:63]
    v_mul_f32 v238, s54, v238
    v_mul_f32 v239, s54, v239
    v_cvt_pk_bf16_f32 v240, v232, v233
    v_cvt_pk_bf16_f32 v241, v234, v235
    v_cvt_pk_bf16_f32 v242, v236, v237
    v_cvt_pk_bf16_f32 v243, v238, v239
    s_waitcnt lgkmcnt(1)
    v_mfma_f32_16x16x32_bf16 a[64:67], v[96:99], v[32:35], a[64:67]
    ds_read_b128 v[40:43], v16 offset:43008
    ds_write_b128 v50, v[228:231] offset:8192
    v_mfma_f32_16x16x32_bf16 a[64:67], v[100:103], v[36:39], a[64:67]
    ds_read_b128 v[44:47], v17 offset:43008
    ds_write_b128 v50, v[240:243] offset:10240
    v_mfma_f32_16x16x32_bf16 a[68:71], v[104:107], v[32:35], a[68:71]
    v_mfma_f32_16x16x32_bf16 a[68:71], v[108:111], v[36:39], a[68:71]
    v_accvgpr_read_b32 v208, a48
    v_accvgpr_read_b32 v209, a49
    v_accvgpr_read_b32 v210, a50
    v_accvgpr_read_b32 v211, a51
    v_accvgpr_read_b32 v212, a52
    v_accvgpr_read_b32 v213, a53
    v_accvgpr_read_b32 v214, a54
    v_accvgpr_read_b32 v215, a55
    v_mul_f32 v208, s54, v208
    v_mul_f32 v209, s54, v209
    v_mfma_f32_16x16x32_bf16 a[72:75], v[112:115], v[32:35], a[72:75]
    v_mul_f32 v210, s54, v210
    v_mul_f32 v211, s54, v211
    v_mul_f32 v212, s54, v212
    v_mul_f32 v213, s54, v213
    v_mul_f32 v214, s54, v214
    v_mul_f32 v215, s54, v215
    v_cvt_pk_bf16_f32 v216, v208, v209
    v_cvt_pk_bf16_f32 v217, v210, v211
    v_cvt_pk_bf16_f32 v218, v212, v213
    v_cvt_pk_bf16_f32 v219, v214, v215
    v_mfma_f32_16x16x32_bf16 a[72:75], v[116:119], v[36:39], a[72:75]
    v_accvgpr_read_b32 v220, a56
    v_accvgpr_read_b32 v221, a57
    v_accvgpr_read_b32 v222, a58
    v_accvgpr_read_b32 v223, a59
    v_accvgpr_read_b32 v224, a60
    v_accvgpr_read_b32 v225, a61
    v_accvgpr_read_b32 v226, a62
    v_mfma_f32_16x16x32_bf16 a[76:79], v[120:123], v[32:35], a[76:79]
    v_accvgpr_read_b32 v227, a63
    v_mul_f32 v220, s54, v220
    v_mul_f32 v221, s54, v221
    v_mul_f32 v222, s54, v222
    v_mul_f32 v223, s54, v223
    v_mul_f32 v224, s54, v224
    v_mul_f32 v225, s54, v225
    v_mfma_f32_16x16x32_bf16 a[76:79], v[124:127], v[36:39], a[76:79]
    v_mul_f32 v226, s54, v226
    v_mul_f32 v227, s54, v227
    v_cvt_pk_bf16_f32 v228, v220, v221
    v_cvt_pk_bf16_f32 v229, v222, v223
    v_cvt_pk_bf16_f32 v230, v224, v225
    v_cvt_pk_bf16_f32 v231, v226, v227
    s_waitcnt lgkmcnt(1)
    v_mfma_f32_16x16x32_bf16 a[80:83], v[96:99], v[40:43], a[80:83]
    ds_read_b128 v[32:35], v16 offset:45056
    ds_write_b128 v50, v[216:219] offset:8448
    v_mfma_f32_16x16x32_bf16 a[80:83], v[100:103], v[44:47], a[80:83]
    ds_read_b128 v[36:39], v17 offset:45056
    ds_write_b128 v50, v[228:231] offset:10496
    v_mfma_f32_16x16x32_bf16 a[84:87], v[104:107], v[40:43], a[84:87]
    v_mfma_f32_16x16x32_bf16 a[84:87], v[108:111], v[44:47], a[84:87]
    v_accvgpr_read_b32 v232, a64
    v_accvgpr_read_b32 v233, a65
    v_accvgpr_read_b32 v234, a66
    v_accvgpr_read_b32 v235, a67
    v_accvgpr_read_b32 v236, a68
    v_accvgpr_read_b32 v237, a69
    v_accvgpr_read_b32 v238, a70
    v_accvgpr_read_b32 v239, a71
    v_mul_f32 v232, s54, v232
    v_mul_f32 v233, s54, v233
    v_mfma_f32_16x16x32_bf16 a[88:91], v[112:115], v[40:43], a[88:91]
    v_mul_f32 v234, s54, v234
    v_mul_f32 v235, s54, v235
    v_mul_f32 v236, s54, v236
    v_mul_f32 v237, s54, v237
    v_mul_f32 v238, s54, v238
    v_mul_f32 v239, s54, v239
    v_cvt_pk_bf16_f32 v240, v232, v233
    v_cvt_pk_bf16_f32 v241, v234, v235
    v_cvt_pk_bf16_f32 v242, v236, v237
    v_cvt_pk_bf16_f32 v243, v238, v239
    v_mfma_f32_16x16x32_bf16 a[88:91], v[116:119], v[44:47], a[88:91]
    v_accvgpr_read_b32 v208, a72
    v_accvgpr_read_b32 v209, a73
    v_accvgpr_read_b32 v210, a74
    v_accvgpr_read_b32 v211, a75
    v_accvgpr_read_b32 v212, a76
    v_accvgpr_read_b32 v213, a77
    v_accvgpr_read_b32 v214, a78
    v_mfma_f32_16x16x32_bf16 a[92:95], v[120:123], v[40:43], a[92:95]
    v_accvgpr_read_b32 v215, a79
    v_mul_f32 v208, s54, v208
    v_mul_f32 v209, s54, v209
    v_mul_f32 v210, s54, v210
    v_mul_f32 v211, s54, v211
    v_mul_f32 v212, s54, v212
    v_mul_f32 v213, s54, v213
    v_mfma_f32_16x16x32_bf16 a[92:95], v[124:127], v[44:47], a[92:95]
    v_mul_f32 v214, s54, v214
    v_mul_f32 v215, s54, v215
    v_cvt_pk_bf16_f32 v216, v208, v209
    v_cvt_pk_bf16_f32 v217, v210, v211
    v_cvt_pk_bf16_f32 v218, v212, v213
    v_cvt_pk_bf16_f32 v219, v214, v215
    s_waitcnt lgkmcnt(1)
    v_mfma_f32_16x16x32_bf16 a[96:99], v[96:99], v[32:35], a[96:99]
    ds_read_b128 v[40:43], v16 offset:47104
    ds_write_b128 v51, v[240:243] offset:0
    v_mfma_f32_16x16x32_bf16 a[96:99], v[100:103], v[36:39], a[96:99]
    ds_read_b128 v[44:47], v17 offset:47104
    ds_write_b128 v51, v[216:219] offset:2048
    v_mfma_f32_16x16x32_bf16 a[100:103], v[104:107], v[32:35], a[100:103]
    v_mfma_f32_16x16x32_bf16 a[100:103], v[108:111], v[36:39], a[100:103]
    v_accvgpr_read_b32 v220, a80
    v_accvgpr_read_b32 v221, a81
    v_accvgpr_read_b32 v222, a82
    v_accvgpr_read_b32 v223, a83
    v_accvgpr_read_b32 v224, a84
    v_accvgpr_read_b32 v225, a85
    v_accvgpr_read_b32 v226, a86
    v_accvgpr_read_b32 v227, a87
    v_mul_f32 v220, s54, v220
    v_mul_f32 v221, s54, v221
    v_mfma_f32_16x16x32_bf16 a[104:107], v[112:115], v[32:35], a[104:107]
    v_mul_f32 v222, s54, v222
    v_mul_f32 v223, s54, v223
    v_mul_f32 v224, s54, v224
    v_mul_f32 v225, s54, v225
    v_mul_f32 v226, s54, v226
    v_mul_f32 v227, s54, v227
    v_cvt_pk_bf16_f32 v228, v220, v221
    v_cvt_pk_bf16_f32 v229, v222, v223
    v_cvt_pk_bf16_f32 v230, v224, v225
    v_cvt_pk_bf16_f32 v231, v226, v227
    v_mfma_f32_16x16x32_bf16 a[104:107], v[116:119], v[36:39], a[104:107]
    v_accvgpr_read_b32 v232, a88
    v_accvgpr_read_b32 v233, a89
    v_accvgpr_read_b32 v234, a90
    v_accvgpr_read_b32 v235, a91
    v_accvgpr_read_b32 v236, a92
    v_accvgpr_read_b32 v237, a93
    v_accvgpr_read_b32 v238, a94
    v_mfma_f32_16x16x32_bf16 a[108:111], v[120:123], v[32:35], a[108:111]
    v_accvgpr_read_b32 v239, a95
    v_mul_f32 v232, s54, v232
    v_mul_f32 v233, s54, v233
    v_mul_f32 v234, s54, v234
    v_mul_f32 v235, s54, v235
    v_mul_f32 v236, s54, v236
    v_mul_f32 v237, s54, v237
    v_mfma_f32_16x16x32_bf16 a[108:111], v[124:127], v[36:39], a[108:111]
    v_mul_f32 v238, s54, v238
    v_mul_f32 v239, s54, v239
    v_cvt_pk_bf16_f32 v240, v232, v233
    v_cvt_pk_bf16_f32 v241, v234, v235
    v_cvt_pk_bf16_f32 v242, v236, v237
    v_cvt_pk_bf16_f32 v243, v238, v239
    s_waitcnt lgkmcnt(1)
    v_mfma_f32_16x16x32_bf16 a[112:115], v[96:99], v[40:43], a[112:115]
    ds_write_b128 v51, v[228:231] offset:256
    v_mfma_f32_16x16x32_bf16 a[112:115], v[100:103], v[44:47], a[112:115]
    ds_write_b128 v51, v[240:243] offset:2304
    v_mfma_f32_16x16x32_bf16 a[116:119], v[104:107], v[40:43], a[116:119]
    v_mfma_f32_16x16x32_bf16 a[116:119], v[108:111], v[44:47], a[116:119]
    v_mfma_f32_16x16x32_bf16 a[120:123], v[112:115], v[40:43], a[120:123]
    v_mfma_f32_16x16x32_bf16 a[120:123], v[116:119], v[44:47], a[120:123]
    v_mfma_f32_16x16x32_bf16 a[124:127], v[120:123], v[40:43], a[124:127]
    v_mfma_f32_16x16x32_bf16 a[124:127], v[124:127], v[44:47], a[124:127]
    s_nop 1
    v_accvgpr_read_b32 v208, a96
    v_accvgpr_read_b32 v209, a97
    v_accvgpr_read_b32 v210, a98
    v_accvgpr_read_b32 v211, a99
    v_accvgpr_read_b32 v212, a100
    v_accvgpr_read_b32 v213, a101
    v_accvgpr_read_b32 v214, a102
    v_accvgpr_read_b32 v215, a103
    v_mul_f32 v208, s54, v208
    v_mul_f32 v209, s54, v209
    v_mul_f32 v210, s54, v210
    v_mul_f32 v211, s54, v211
    v_mul_f32 v212, s54, v212
    v_mul_f32 v213, s54, v213
    v_mul_f32 v214, s54, v214
    v_mul_f32 v215, s54, v215
    v_cvt_pk_bf16_f32 v216, v208, v209
    v_cvt_pk_bf16_f32 v217, v210, v211
    v_cvt_pk_bf16_f32 v218, v212, v213
    v_cvt_pk_bf16_f32 v219, v214, v215
    ds_write_b128 v51, v[216:219] offset:8192
    v_accvgpr_read_b32 v220, a104
    v_accvgpr_read_b32 v221, a105
    v_accvgpr_read_b32 v222, a106
    v_accvgpr_read_b32 v223, a107
    v_accvgpr_read_b32 v224, a108
    v_accvgpr_read_b32 v225, a109
    v_accvgpr_read_b32 v226, a110
    v_accvgpr_read_b32 v227, a111
    v_mul_f32 v220, s54, v220
    v_mul_f32 v221, s54, v221
    v_mul_f32 v222, s54, v222
    v_mul_f32 v223, s54, v223
    v_mul_f32 v224, s54, v224
    v_mul_f32 v225, s54, v225
    v_mul_f32 v226, s54, v226
    v_mul_f32 v227, s54, v227
    v_cvt_pk_bf16_f32 v228, v220, v221
    v_cvt_pk_bf16_f32 v229, v222, v223
    v_cvt_pk_bf16_f32 v230, v224, v225
    v_cvt_pk_bf16_f32 v231, v226, v227
    ds_write_b128 v51, v[228:231] offset:10240
    s_nop 3
    v_accvgpr_read_b32 v232, a112
    v_accvgpr_read_b32 v233, a113
    v_accvgpr_read_b32 v234, a114
    v_accvgpr_read_b32 v235, a115
    v_accvgpr_read_b32 v236, a116
    v_accvgpr_read_b32 v237, a117
    v_accvgpr_read_b32 v238, a118
    v_accvgpr_read_b32 v239, a119
    v_mul_f32 v232, s54, v232
    v_mul_f32 v233, s54, v233
    v_mul_f32 v234, s54, v234
    v_mul_f32 v235, s54, v235
    v_mul_f32 v236, s54, v236
    v_mul_f32 v237, s54, v237
    v_mul_f32 v238, s54, v238
    v_mul_f32 v239, s54, v239
    v_cvt_pk_bf16_f32 v240, v232, v233
    v_cvt_pk_bf16_f32 v241, v234, v235
    v_cvt_pk_bf16_f32 v242, v236, v237
    v_cvt_pk_bf16_f32 v243, v238, v239
    ds_write_b128 v51, v[240:243] offset:8448
    v_accvgpr_read_b32 v208, a120
    v_accvgpr_read_b32 v209, a121
    v_accvgpr_read_b32 v210, a122
    v_accvgpr_read_b32 v211, a123
    v_accvgpr_read_b32 v212, a124
    v_accvgpr_read_b32 v213, a125
    v_accvgpr_read_b32 v214, a126
    v_accvgpr_read_b32 v215, a127
    v_mul_f32 v208, s54, v208
    v_mul_f32 v209, s54, v209
    v_mul_f32 v210, s54, v210
    v_mul_f32 v211, s54, v211
    v_mul_f32 v212, s54, v212
    v_mul_f32 v213, s54, v213
    v_mul_f32 v214, s54, v214
    v_mul_f32 v215, s54, v215
    v_cvt_pk_bf16_f32 v216, v208, v209
    v_cvt_pk_bf16_f32 v217, v210, v211
    v_cvt_pk_bf16_f32 v218, v212, v213
    v_cvt_pk_bf16_f32 v219, v214, v215
    ds_write_b128 v51, v[216:219] offset:10496
L_g1_done:
    s_load_dwordx2 s[60:61], s[0:1], 40
    s_load_dwordx2 s[62:63], s[0:1], 72
    s_mov_b32 s12, s32
    v_lshlrev_b32 v1, 4, v0
    s_and_b32 s3, s2, 7
    s_lshr_b32 s6, s2, 3
    s_and_b32 s7, s6, 3
    s_lshl_b32 s3, s3, 2
    s_add_u32 s14, s3, s7
    s_lshr_b32 s13, s6, 2
    s_lshl_b32 s32, s14, 20
    s_add_u32 s32, s32, 23068672
    s_lshl_b32 s24, s12, 12
    s_add_u32 s25, s24, s32
    s_cmp_lt_u32 s12, 2
    s_cselect_b32 s37, 16384, 0
    s_cselect_b32 s57, s25, 0x7ff00000
    s_lshl_b32 s27, s13, 2
    s_sub_u32 s28, 60, s27
    s_add_u32 s27, s27, s12
    s_xor_b32 s29, s12, 1
    s_add_u32 s29, s29, s28
    s_add_u32 s28, s28, s12
    s_lshl_b32 s30, s14, 19
    s_add_u32 s30, s30, 6291456
    s_lshl_b32 s58, s27, 13
    s_add_u32 s58, s58, s30
    s_lshl_b32 s59, s28, 13
    s_add_u32 s59, s59, s30
    s_lshl_b32 s70, s29, 13
    s_add_u32 s70, s70, s30
    s_add_u32 s16, s25, s37
    s_mov_b32 s18, s24
    v_add_u32 v11, 4096, v1
    s_waitcnt lgkmcnt(0)
    s_cmp_lt_u32 s12, 2
    s_mov_b32 s5, 81920
    s_cselect_b32 s3, 16384, s5
    s_mov_b32 s5, 131072
    s_cselect_b32 s6, 114688, s5
    s_and_b32 s4, s12, 1
    s_lshl_b32 s4, s4, 13
    s_add_u32 s3, s3, s4
    s_add_u32 s6, s6, s4
    v_add_u32 v5, s3, v1
    v_add_u32 v6, s6, v1
    v_xor_b32 v7, 0x2000, v6
    s_barrier
    s_add_u32 s18, s18, 32768
    s_add_u32 s16, s16, 16384
    s_mov_b32 m0, s18
    s_add_u32 s18, s18, 32768
    buffer_load_dwordx4 v1, s[8:11], s16 offen offset:0 sc1 lds
    buffer_load_dwordx4 v1, s[8:11], s16 offen offset:1024 sc1 lds
    buffer_load_dwordx4 v1, s[8:11], s16 offen offset:2048 sc1 lds
    buffer_load_dwordx4 v1, s[8:11], s16 offen offset:3072 sc1 lds
    s_add_u32 s16, s16, 16384
    s_add_u32 s18, s18, 32768
    s_add_u32 s16, s16, 16384
    ds_read_b128 a[128:131], v5 offset:0
    ds_read_b128 a[132:135], v5 offset:1024
    ds_read_b128 a[136:139], v5 offset:2048
    ds_read_b128 a[140:143], v5 offset:3072
    ds_read_b128 a[144:147], v5 offset:4096
    ds_read_b128 a[148:151], v5 offset:5120
    ds_read_b128 a[152:155], v5 offset:6144
    ds_read_b128 a[156:159], v5 offset:7168
    ds_read_b128 a[160:163], v6 offset:0
    ds_read_b128 a[164:167], v6 offset:1024
    ds_read_b128 a[168:171], v6 offset:2048
    ds_read_b128 a[172:175], v6 offset:3072
    ds_read_b128 a[176:179], v6 offset:4096
    ds_read_b128 a[180:183], v6 offset:5120
    ds_read_b128 a[184:187], v6 offset:6144
    ds_read_b128 a[188:191], v6 offset:7168
    ds_read_b128 v[128:131], v7 offset:0
    ds_read_b128 v[132:135], v7 offset:1024
    ds_read_b128 v[136:139], v7 offset:2048
    ds_read_b128 v[140:143], v7 offset:3072
    ds_read_b128 v[144:147], v7 offset:4096
    ds_read_b128 v[148:151], v7 offset:5120
    ds_read_b128 v[152:155], v7 offset:6144
    ds_read_b128 v[156:159], v7 offset:7168
    s_waitcnt lgkmcnt(0)
    v_mov_b32 v240, 0
    v_mov_b32 v241, 0
    v_mov_b32 v242, 0
    v_mov_b32 v243, 0
    v_and_b32 v5, 31, v0
    v_lshrrev_b32 v6, 5, v0
    v_mfma_f32_32x32x16_bf16 a[0:15], v[240:243], v[240:243], 0
    v_mfma_f32_32x32x16_bf16 a[16:31], v[240:243], v[240:243], 0
    v_mfma_f32_32x32x16_bf16 a[32:47], v[240:243], v[240:243], 0
    v_mfma_f32_32x32x16_bf16 a[48:63], v[240:243], v[240:243], 0
    v_mfma_f32_32x32x16_bf16 a[64:79], v[240:243], v[240:243], 0
    v_mfma_f32_32x32x16_bf16 a[80:95], v[240:243], v[240:243], 0
    v_mfma_f32_32x32x16_bf16 a[96:111], v[240:243], v[240:243], 0
    v_mfma_f32_32x32x16_bf16 a[112:127], v[240:243], v[240:243], 0
    v_mfma_f32_32x32x16_bf16 a[224:239], v[240:243], v[240:243], 0
    v_mfma_f32_32x32x16_bf16 a[240:255], v[240:243], v[240:243], 0
    v_mfma_f32_32x32x16_bf16 v[80:95], v[240:243], v[240:243], 0
    v_mfma_f32_32x32x16_bf16 v[96:111], v[240:243], v[240:243], 0
    v_mfma_f32_32x32x16_bf16 v[112:127], v[240:243], v[240:243], 0
    v_mfma_f32_32x32x16_bf16 v[160:175], v[240:243], v[240:243], 0
    v_mfma_f32_32x32x16_bf16 v[176:191], v[240:243], v[240:243], 0
    v_mfma_f32_32x32x16_bf16 v[192:207], v[240:243], v[240:243], 0
    v_mfma_f32_32x32x16_bf16 v[208:223], v[240:243], v[240:243], 0
    v_mfma_f32_32x32x16_bf16 v[224:239], v[240:243], v[240:243], 0
    v_lshlrev_b32 v7, 2, v6
    v_sub_u32 v26, v5, v7
    v_lshrrev_b32 v7, 4, v5
    v_mul_u32_u24 v4, 176128, v7
    v_lshl_add_u32 v4, v6, 8, v4
    v_and_b32 v7, 15, v5
    v_lshl_add_u32 v4, v7, 4, v4
    v_mov_b32 v25, 0xff800000
    v_mov_b32 v16, 0
    v_mov_b32 v19, -1.0
    v_mov_b32 v17, 0
    v_mov_b32 v20, -1.0
    v_mov_b32 v18, 0
    v_mov_b32 v21, -1.0
    s_lshl_b32 s31, s14, 12
    s_add_u32 s31, s31, 56688640
    s_mul_i32 s50, s27, 352256
    s_add_u32 s50, s50, s31
    s_mul_i32 s51, s28, 352256
    s_add_u32 s51, s51, s31
    s_lshl_b32 s31, s13, 16
    s_add_u32 s31, s31, 49152
    s_add_u32 s31, s31, s25
    s_lshl_b32 s35, s37, 1
    s_add_u32 s35, s35, s31
    s_add_u32 s36, s24, 114688
    s_add_u32 s38, s37, 16384
    s_lshl_b32 s21, s12, 5
    s_and_b32 s24, s12, 1
    s_lshl_b32 s56, s24, 14
    s_add_u32 s39, s56, 98304
    s_lshr_b32 s25, s12, 1
    s_lshl_b32 s26, s13, 2
    s_lshl_b32 s27, s25, 13
    s_add_u32 s27, s27, 1032192
    s_add_u32 s34, s27, s32
    s_add_u32 s26, s26, s24
    s_add_u32 s26, s26, 10
    s_lshl_b32 s26, s26, 14
    s_add_u32 s26, s26, s32
    s_cmp_eq_u32 s25, 0
    s_movk_i32 s27, 0x2000
    s_cselect_b32 s27, 0x8000, s27
    s_add_u32 s52, s26, s27
    s_lshl_b32 s27, s25, 13
    s_add_u32 s53, s27, s39
    s_sub_u32 s53, s53, 28672
    s_xor_b32 s27, s12, 1
    s_sub_u32 s27, s27, s24
    s_lshl_b32 s54, s27, 5
    s_sub_u32 s27, s12, s24
    s_lshl_b32 s22, s27, 5
    s_lshr_b32 s68, s2, 3
    s_lshl_b32 s68, s68, 2
    s_add_u32 s68, s68, s12
    s_bfe_u32 s3, s2, 0x20001
    s_mul_i32 s69, s3, 393216
    s_lshl_b32 s4, s68, 13
    s_add_u32 s69, s69, s4
    s_cmp_lt_u32 s68, 48
    s_cselect_b32 s69, s69, 0x7ff00000
    s_lshl_b32 s3, s3, 20
    s_add_u32 s68, s3, s4
    v_lshlrev_b32 v27, 7, v0
    s_mov_b32 s64, s60
    s_and_b32 s65, s61, 0xffff
    s_mov_b32 s66, 0x400000
    s_mov_b32 s67, 0x00020000
    s_mov_b32 s89, s12
    v_lshlrev_b32 v8, 4, v0
    v_add_u32 v9, 176128, v8
    s_bfe_u32 s87, s2, 0x20001
    s_and_b32 s3, s2, 1
    s_lshl_b32 s3, s3, 3
    s_bfe_u32 s5, s2, 0x30003
    s_add_u32 s3, s3, s5
    s_lshr_b32 s4, s2, 6
    s_lshl_b32 s88, s3, 2
    s_add_u32 s88, s88, s4
    s_lshl_b32 s73, s89, 12
    s_lshl_b32 s6, s89, 1
    s_lshl_b32 s7, s87, 15
    s_lshr_b32 s5, s89, 1
    s_lshl_b32 s5, s5, 15
    s_and_b32 s80, s89, 1
    s_lshl_b32 s80, s80, 7
    s_add_u32 s5, s5, s80
    s_lshl_b32 s80, s4, 8
    s_add_u32 s5, s5, s80
    s_sub_u32 s5, s5, 65536
    s_lshl_b32 s80, s87, 20
    s_add_u32 s80, s80, s5
    s_mul_i32 s74, s87, 393216
    s_add_u32 s74, s74, s5
    v_lshrrev_b32 v13, 3, v0
    v_and_b32 v14, 7, v0
    v_and_b32 v15, 6, v13
    v_xor_b32 v14, v14, v15
    v_lshlrev_b32 v6, 10, v13
    v_lshl_add_u32 v6, v14, 4, v6
    v_add_u32 v12, 15360, v6
    v_add_u32 v15, 6144, v6
    v_add_u32 v31, 21504, v6
    v_add_u32 v5, 7168, v6
    v_add_u32 v13, 14336, v6
    s_mov_b32 s76, s62
    s_and_b32 s77, s63, 0xffff
    s_mov_b32 s78, 0x158000
    s_mov_b32 s79, 0x00020000
    s_lshl_b32 s5, s3, 3
    s_add_u32 s5, s5, s6
    s_mul_i32 s5, s5, 176128
    s_add_u32 s81, s5, s7
    s_add_u32 s81, s81, 56686592
    s_mul_i32 s75, s87, 12288
    s_add_u32 s75, s75, s5
    s_add_u32 s75, s75, 56817664
    s_lshl_b32 s5, s3, 17
    s_lshr_b32 s6, s87, 1
    s_lshl_b32 s6, s6, 16
    s_add_u32 s5, s5, s6
    s_lshl_b32 s6, s89, 14
    s_add_u32 s5, s5, s6
    s_lshl_b32 s6, s4, 8
    s_add_u32 s5, s5, s6
    s_and_b32 s6, s87, 1
    s_lshl_b32 s6, s6, 7
    s_add_u32 s82, s5, s6
    s_sub_u32 s7, 15, s3
    s_min_u32 s6, s3, s7
    s_lshl_b32 s6, s6, 12
    s_lshl_b32 s7, s87, 8
    s_add_u32 s6, s6, s7
    s_add_u32 s83, s6, 79233024
    s_lshr_b32 s5, s89, 1
    s_lshl_b32 s5, s5, 13
    v_add_u32 v10, s5, v8
    v_add_u32 v2, 98304, v1
    v_mov_b32 v22, 0
    s_mul_i32 s3, s87, 6
    v_min_u32 v38, 5, v0
    v_add_u32 v38, s3, v38
    v_min_u32 v38, 21, v38
    v_cmp_le_u32 vcc, 0, v38
    v_add_u32 v39, 10, v38
    s_nop 0
    v_cndmask_b32 v38, v38, v39, vcc
    s_lshr_b32 s4, s88, 2
    s_sub_u32 s5, 15, s4
    s_min_u32 s4, s4, s5
    s_lshl_b32 s4, s4, 12
    s_add_u32 s71, s4, 79331328
    v_and_b32 v39, 3, v38
    v_lshrrev_b32 v38, 2, v38
    v_lshl_add_u32 v38, v39, 3, v38
    v_lshlrev_b32 v248, 7, v38
    s_waitcnt vmcnt(4)
    s_barrier
    ds_read_b128 a[192:195], v2 offset:0
    ds_read_b128 a[196:199], v2 offset:1024
    ds_read_b128 a[200:203], v2 offset:2048
    ds_read_b128 a[204:207], v2 offset:3072
    ds_read_b128 a[208:211], v2 offset:4096
    ds_read_b128 a[212:215], v2 offset:5120
    ds_read_b128 a[216:219], v2 offset:6144
    ds_read_b128 a[220:223], v2 offset:7168
    v_add_u32 v2, s39, v1
    v_mov_b32 v3, v1
    s_lshl_b32 s20, s13, 2
    s_waitcnt lgkmcnt(7)
    v_mfma_f32_32x32x16_bf16 v[32:47], a[192:195], a[128:131], v[96:111]
    s_waitcnt lgkmcnt(6)
    v_mfma_f32_32x32x16_bf16 v[32:47], a[196:199], a[132:135], v[32:47]
    s_waitcnt lgkmcnt(5)
    v_mfma_f32_32x32x16_bf16 v[32:47], a[200:203], a[136:139], v[32:47]
    s_waitcnt lgkmcnt(4)
    v_mfma_f32_32x32x16_bf16 v[32:47], a[204:207], a[140:143], v[32:47]
    s_waitcnt lgkmcnt(3)
    v_mfma_f32_32x32x16_bf16 v[32:47], a[208:211], a[144:147], v[32:47]
    s_waitcnt lgkmcnt(2)
    v_mfma_f32_32x32x16_bf16 v[32:47], a[212:215], a[148:151], v[32:47]
    s_waitcnt lgkmcnt(1)
    v_mfma_f32_32x32x16_bf16 v[32:47], a[216:219], a[152:155], v[32:47]
    s_waitcnt lgkmcnt(0)
    v_mfma_f32_32x32x16_bf16 v[32:47], a[220:223], a[156:159], v[32:47]
    s_waitcnt vmcnt(0)
    s_nop 7
    s_cmp_eq_u32 s20, 0
    s_cbranch_scc1 L_attn_m1pre
L_attn_n1:
    v_mfma_f32_32x32x16_bf16 v[48:63], a[192:195], a[160:163], v[112:127]
    s_waitcnt vmcnt(8)
    s_barrier
    v_exp_f32 v64, v32
    v_exp_f32 v65, v33
    v_mfma_f32_32x32x16_bf16 v[48:63], a[196:199], a[164:167], v[48:63]
    ds_read_b128 a[192:195], v3 offset:0
    v_exp_f32 v66, v34
    v_exp_f32 v67, v35
    v_mfma_f32_32x32x16_bf16 v[48:63], a[200:203], a[168:171], v[48:63]
    ds_read_b128 a[196:199], v3 offset:1024
    v_exp_f32 v68, v36
    v_add_f32 v22, v64, v65
    v_cvt_pk_bf16_f32 v80, v64, v65
    v_mfma_f32_32x32x16_bf16 v[48:63], a[204:207], a[172:175], v[48:63]
    ds_read_b128 a[200:203], v3 offset:2048
    v_exp_f32 v69, v37
    v_add_f32 v23, v66, v67
    v_cvt_pk_bf16_f32 v81, v66, v67
    v_mfma_f32_32x32x16_bf16 v[48:63], a[208:211], a[176:179], v[48:63]
    ds_read_b128 a[204:207], v3 offset:3072
    v_exp_f32 v70, v38
    v_add_f32 v22, v22, v68
    v_add_f32 v23, v23, v69
    v_mfma_f32_32x32x16_bf16 v[48:63], a[212:215], a[180:183], v[48:63]
    ds_read_b128 a[208:211], v3 offset:4096
    v_exp_f32 v71, v39
    v_cvt_pk_bf16_f32 v82, v68, v69
    v_mfma_f32_32x32x16_bf16 v[48:63], a[216:219], a[184:187], v[48:63]
    ds_read_b128 a[212:215], v3 offset:5120
    v_exp_f32 v72, v40
    v_add_f32 v22, v22, v70
    v_add_f32 v23, v23, v71
    v_mfma_f32_32x32x16_bf16 v[48:63], a[220:223], a[188:191], v[48:63]
    ds_read_b128 a[216:219], v3 offset:6144
    v_exp_f32 v73, v41
    v_cvt_pk_bf16_f32 v83, v70, v71
    v_mfma_f32_32x32x16_bf16 a[64:79], a[224:227], v[88:91], a[64:79]
    ds_read_b128 a[220:223], v3 offset:7168
    v_exp_f32 v74, v42
    v_add_f32 v22, v22, v72
    v_add_f32 v23, v23, v73
    v_mfma_f32_32x32x16_bf16 a[64:79], a[228:231], v[92:95], a[64:79]
    ds_read_b128 a[224:227], v3 offset:8192
    v_exp_f32 v75, v43
    v_cvt_pk_bf16_f32 v84, v72, v73
    v_mfma_f32_32x32x16_bf16 a[80:95], a[232:235], v[88:91], a[80:95]
    ds_read_b128 a[228:231], v3 offset:9216
    v_exp_f32 v76, v44
    v_add_f32 v22, v22, v74
    v_add_f32 v23, v23, v75
    v_mfma_f32_32x32x16_bf16 a[80:95], a[236:239], v[92:95], a[80:95]
    ds_read_b128 a[232:235], v3 offset:10240
    v_exp_f32 v77, v45
    v_cvt_pk_bf16_f32 v85, v74, v75
    v_mfma_f32_32x32x16_bf16 a[96:111], a[240:243], v[88:91], a[96:111]
    ds_read_b128 a[236:239], v3 offset:11264
    v_exp_f32 v78, v46
    v_add_f32 v22, v22, v76
    v_add_f32 v23, v23, v77
    v_mfma_f32_32x32x16_bf16 a[96:111], a[244:247], v[92:95], a[96:111]
    ds_read_b128 a[240:243], v3 offset:12288
    v_exp_f32 v79, v47
    v_cvt_pk_bf16_f32 v86, v76, v77
    v_add_f32 v22, v22, v23
    v_mfma_f32_32x32x16_bf16 a[112:127], a[248:251], v[88:91], a[112:127]
    ds_read_b128 a[244:247], v3 offset:13312
    v_add_f32 v23, v78, v79
    v_cvt_pk_bf16_f32 v87, v78, v79
    v_add_f32 v22, v22, v23
    v_cmp_gt_f32 vcc, v22, v19
    v_mfma_f32_32x32x16_bf16 a[112:127], a[252:255], v[92:95], a[112:127]
    s_cbranch_vccnz L_attn_s1
L_attn_s1r:
    v_add_f32 v16, v16, v22
    s_waitcnt lgkmcnt(6)
    v_mfma_f32_32x32x16_bf16 v[32:47], a[192:195], a[128:131], v[96:111]
    ds_read_b128 a[248:251], v3 offset:14336
    v_exp_f32 v64, v48
    v_exp_f32 v65, v49
    v_mfma_f32_32x32x16_bf16 v[32:47], a[196:199], a[132:135], v[32:47]
    ds_read_b128 a[252:255], v3 offset:15360
    s_mov_b32 m0, s18
    v_exp_f32 v66, v50
    v_exp_f32 v67, v51
    v_mfma_f32_32x32x16_bf16 v[32:47], a[200:203], a[136:139], v[32:47]
    buffer_load_dwordx4 v1, s[8:11], s16 offen offset:0 sc1 lds
    v_exp_f32 v68, v52
    v_add_f32 v22, v64, v65
    v_cvt_pk_bf16_f32 v88, v64, v65
    v_mfma_f32_32x32x16_bf16 v[32:47], a[204:207], a[140:143], v[32:47]
    s_add_u32 s18, s18, 32768
    v_exp_f32 v69, v53
    v_add_f32 v23, v66, v67
    v_cvt_pk_bf16_f32 v89, v66, v67
    v_mfma_f32_32x32x16_bf16 v[32:47], a[208:211], a[144:147], v[32:47]
    buffer_load_dwordx4 v1, s[8:11], s16 offen offset:1024 sc1 lds
    v_exp_f32 v70, v54
    v_add_f32 v22, v22, v68
    v_add_f32 v23, v23, v69
    v_add_u32 v3, 0x8000, v3
    v_mfma_f32_32x32x16_bf16 v[32:47], a[212:215], a[148:151], v[32:47]
    s_and_b32 s18, s18, 0x1ffff
    v_exp_f32 v71, v55
    v_cvt_pk_bf16_f32 v90, v68, v69
    v_mfma_f32_32x32x16_bf16 v[32:47], a[216:219], a[152:155], v[32:47]
    buffer_load_dwordx4 v1, s[8:11], s16 offen offset:2048 sc1 lds
    v_exp_f32 v72, v56
    v_add_f32 v22, v22, v70
    v_add_f32 v23, v23, v71
    v_and_b32 v3, 0x1ffff, v3
    v_mfma_f32_32x32x16_bf16 v[32:47], a[220:223], a[156:159], v[32:47]
    v_exp_f32 v73, v57
    v_cvt_pk_bf16_f32 v91, v70, v71
    s_waitcnt lgkmcnt(0)
    v_mfma_f32_32x32x16_bf16 a[0:15], a[224:227], v[80:83], a[0:15]
    buffer_load_dwordx4 v1, s[8:11], s16 offen offset:3072 sc1 lds
    v_exp_f32 v74, v58
    v_add_f32 v22, v22, v72
    v_add_f32 v23, v23, v73
    v_mfma_f32_32x32x16_bf16 a[0:15], a[228:231], v[84:87], a[0:15]
    s_add_u32 s16, s16, 16384
    v_exp_f32 v75, v59
    v_cvt_pk_bf16_f32 v92, v72, v73
    v_mfma_f32_32x32x16_bf16 a[16:31], a[232:235], v[80:83], a[16:31]
    v_exp_f32 v76, v60
    v_add_f32 v22, v22, v74
    v_add_f32 v23, v23, v75
    v_mfma_f32_32x32x16_bf16 a[16:31], a[236:239], v[84:87], a[16:31]
    v_exp_f32 v77, v61
    v_cvt_pk_bf16_f32 v93, v74, v75
    v_mfma_f32_32x32x16_bf16 a[32:47], a[240:243], v[80:83], a[32:47]
    v_exp_f32 v78, v62
    v_add_f32 v22, v22, v76
    v_add_f32 v23, v23, v77
    v_mfma_f32_32x32x16_bf16 a[32:47], a[244:247], v[84:87], a[32:47]
    s_sub_u32 s20, s20, 1
    v_exp_f32 v79, v63
    v_cvt_pk_bf16_f32 v94, v76, v77
    v_add_f32 v22, v22, v23
    v_mfma_f32_32x32x16_bf16 a[48:63], a[248:251], v[80:83], a[48:63]
    v_add_f32 v23, v78, v79
    v_cvt_pk_bf16_f32 v95, v78, v79
    v_add_f32 v22, v22, v23
    v_cmp_gt_f32 vcc, v22, v20
    v_mfma_f32_32x32x16_bf16 a[48:63], a[252:255], v[84:87], a[48:63]
    s_cbranch_vccnz L_attn_s2
L_attn_s2r:
    v_add_f32 v17, v17, v22
    s_cmp_lg_u32 s20, 0
    s_cbranch_scc1 L_attn_n1
L_attn_m1pre:
    s_mov_b32 s20, 3
L_attn_m1:
    v_mfma_f32_32x32x16_bf16 v[48:63], a[192:195], a[160:163], v[112:127]
    s_waitcnt vmcnt(8)
    s_barrier
    v_add_u32 v24, s21, v26
    v_cmp_le_i32_e64 s[40:41], 0, v24
    v_cmp_le_i32_e64 s[42:43], 1, v24
    v_cmp_le_i32_e64 s[44:45], 2, v24
    v_cmp_le_i32_e64 s[46:47], 3, v24
    v_cndmask_b32_e64 v32, v25, v32, s[40:41]
    v_exp_f32 v64, v32
    v_cmp_le_i32_e64 s[40:41], 16, v24
    v_cndmask_b32_e64 v33, v25, v33, s[42:43]
    v_exp_f32 v65, v33
    v_mfma_f32_32x32x16_bf16 v[48:63], a[196:199], a[164:167], v[48:63]
    ds_read_b128 a[192:195], v3 offset:0
    v_cmp_le_i32_e64 s[42:43], 17, v24
    v_cndmask_b32_e64 v34, v25, v34, s[44:45]
    v_exp_f32 v66, v34
    v_cmp_le_i32_e64 s[44:45], 18, v24
    v_cndmask_b32_e64 v35, v25, v35, s[46:47]
    v_exp_f32 v67, v35
    v_mfma_f32_32x32x16_bf16 v[48:63], a[200:203], a[168:171], v[48:63]
    ds_read_b128 a[196:199], v3 offset:1024
    v_cmp_le_i32_e64 s[46:47], 19, v24
    v_cndmask_b32_e64 v36, v25, v36, s[40:41]
    v_exp_f32 v68, v36
    v_add_f32 v22, v64, v65
    v_cvt_pk_bf16_f32 v80, v64, v65
    v_mfma_f32_32x32x16_bf16 v[48:63], a[204:207], a[172:175], v[48:63]
    ds_read_b128 a[200:203], v3 offset:2048
    v_cmp_le_i32_e64 s[40:41], 8, v24
    v_cndmask_b32_e64 v37, v25, v37, s[42:43]
    v_exp_f32 v69, v37
    v_add_f32 v23, v66, v67
    v_cvt_pk_bf16_f32 v81, v66, v67
    v_mfma_f32_32x32x16_bf16 v[48:63], a[208:211], a[176:179], v[48:63]
    ds_read_b128 a[204:207], v3 offset:3072
    v_cmp_le_i32_e64 s[42:43], 9, v24
    v_cndmask_b32_e64 v38, v25, v38, s[44:45]
    v_exp_f32 v70, v38
    v_add_f32 v22, v22, v68
    v_add_f32 v23, v23, v69
    v_mfma_f32_32x32x16_bf16 v[48:63], a[212:215], a[180:183], v[48:63]
    ds_read_b128 a[208:211], v3 offset:4096
    v_cmp_le_i32_e64 s[44:45], 10, v24
    v_cndmask_b32_e64 v39, v25, v39, s[46:47]
    v_exp_f32 v71, v39
    v_cvt_pk_bf16_f32 v82, v68, v69
    v_mfma_f32_32x32x16_bf16 v[48:63], a[216:219], a[184:187], v[48:63]
    ds_read_b128 a[212:215], v3 offset:5120
    v_cmp_le_i32_e64 s[46:47], 11, v24
    v_cndmask_b32_e64 v40, v25, v40, s[40:41]
    v_exp_f32 v72, v40
    v_add_f32 v22, v22, v70
    v_add_f32 v23, v23, v71
    v_mfma_f32_32x32x16_bf16 v[48:63], a[220:223], a[188:191], v[48:63]
    ds_read_b128 a[216:219], v3 offset:6144
    v_cmp_le_i32_e64 s[40:41], 24, v24
    v_cndmask_b32_e64 v41, v25, v41, s[42:43]
    v_exp_f32 v73, v41
    v_cvt_pk_bf16_f32 v83, v70, v71
    v_mfma_f32_32x32x16_bf16 a[64:79], a[224:227], v[88:91], a[64:79]
    ds_read_b128 a[220:223], v3 offset:7168
    v_cmp_le_i32_e64 s[42:43], 25, v24
    v_cndmask_b32_e64 v42, v25, v42, s[44:45]
    v_exp_f32 v74, v42
    v_add_f32 v22, v22, v72
    v_add_f32 v23, v23, v73
    v_mfma_f32_32x32x16_bf16 a[64:79], a[228:231], v[92:95], a[64:79]
    ds_read_b128 a[224:227], v3 offset:8192
    v_cmp_le_i32_e64 s[44:45], 26, v24
    v_cndmask_b32_e64 v43, v25, v43, s[46:47]
    v_exp_f32 v75, v43
    v_cvt_pk_bf16_f32 v84, v72, v73
    v_mfma_f32_32x32x16_bf16 a[80:95], a[232:235], v[88:91], a[80:95]
    ds_read_b128 a[228:231], v3 offset:9216
    v_cmp_le_i32_e64 s[46:47], 27, v24
    v_cndmask_b32_e64 v44, v25, v44, s[40:41]
    v_exp_f32 v76, v44
    v_add_f32 v22, v22, v74
    v_add_f32 v23, v23, v75
    v_mfma_f32_32x32x16_bf16 a[80:95], a[236:239], v[92:95], a[80:95]
    ds_read_b128 a[232:235], v3 offset:10240
    v_cndmask_b32_e64 v45, v25, v45, s[42:43]
    v_exp_f32 v77, v45
    v_cvt_pk_bf16_f32 v85, v74, v75
    v_mfma_f32_32x32x16_bf16 a[96:111], a[240:243], v[88:91], a[96:111]
    ds_read_b128 a[236:239], v3 offset:11264
    v_cndmask_b32_e64 v46, v25, v46, s[44:45]
    v_exp_f32 v78, v46
    v_add_f32 v22, v22, v76
    v_add_f32 v23, v23, v77
    v_mfma_f32_32x32x16_bf16 a[96:111], a[244:247], v[92:95], a[96:111]
    ds_read_b128 a[240:243], v3 offset:12288
    v_cndmask_b32_e64 v47, v25, v47, s[46:47]
    v_exp_f32 v79, v47
    v_cvt_pk_bf16_f32 v86, v76, v77
    v_add_f32 v22, v22, v23
    v_mfma_f32_32x32x16_bf16 a[112:127], a[248:251], v[88:91], a[112:127]
    ds_read_b128 a[244:247], v3 offset:13312
    v_add_f32 v23, v78, v79
    v_cvt_pk_bf16_f32 v87, v78, v79
    v_add_f32 v22, v22, v23
    v_cmp_gt_f32 vcc, v22, v19
    v_mfma_f32_32x32x16_bf16 a[112:127], a[252:255], v[92:95], a[112:127]
    s_cbranch_vccnz L_attn_s3
L_attn_s3r:
    v_add_f32 v16, v16, v22
    s_waitcnt lgkmcnt(6)
    v_mfma_f32_32x32x16_bf16 v[32:47], a[192:195], a[128:131], v[96:111]
    ds_read_b128 a[248:251], v3 offset:14336
    v_exp_f32 v64, v48
    v_exp_f32 v65, v49
    v_mfma_f32_32x32x16_bf16 v[32:47], a[196:199], a[132:135], v[32:47]
    ds_read_b128 a[252:255], v3 offset:15360
    s_mov_b32 m0, s18
    v_exp_f32 v66, v50
    v_exp_f32 v67, v51
    v_mfma_f32_32x32x16_bf16 v[32:47], a[200:203], a[136:139], v[32:47]
    buffer_load_dwordx4 v1, s[8:11], s16 offen offset:0 sc1 lds
    v_exp_f32 v68, v52
    v_add_f32 v22, v64, v65
    v_cvt_pk_bf16_f32 v88, v64, v65
    v_mfma_f32_32x32x16_bf16 v[32:47], a[204:207], a[140:143], v[32:47]
    buffer_load_dwordx4 v1, s[8:11], s16 offen offset:1024 sc1 lds
    s_add_u32 s18, s18, 32768
    v_exp_f32 v69, v53
    v_add_f32 v23, v66, v67
    v_cvt_pk_bf16_f32 v89, v66, v67
    v_mfma_f32_32x32x16_bf16 v[32:47], a[208:211], a[144:147], v[32:47]
    buffer_load_dwordx4 v1, s[8:11], s16 offen offset:2048 sc1 lds
    v_exp_f32 v70, v54
    v_add_f32 v22, v22, v68
    v_add_f32 v23, v23, v69
    v_add_u32 v3, 0x8000, v3
    v_mfma_f32_32x32x16_bf16 v[32:47], a[212:215], a[148:151], v[32:47]
    buffer_load_dwordx4 v1, s[8:11], s16 offen offset:3072 sc1 lds
    s_and_b32 s18, s18, 0x1ffff
    v_exp_f32 v71, v55
    v_cvt_pk_bf16_f32 v90, v68, v69
    v_mfma_f32_32x32x16_bf16 v[32:47], a[216:219], a[152:155], v[32:47]
    s_mov_b32 m0, s36
    s_add_u32 s16, s16, s38
    v_exp_f32 v72, v56
    v_add_f32 v22, v22, v70
    v_add_f32 v23, v23, v71
    v_and_b32 v3, 0x1ffff, v3
    v_mfma_f32_32x32x16_bf16 v[32:47], a[220:223], a[156:159], v[32:47]
    buffer_load_dwordx4 v1, s[8:11], s35 offen offset:0 sc1 lds
    s_mov_b32 s38, 0x8000
    v_exp_f32 v73, v57
    v_cvt_pk_bf16_f32 v91, v70, v71
    s_waitcnt lgkmcnt(0)
    v_mfma_f32_32x32x16_bf16 a[0:15], a[224:227], v[80:83], a[0:15]
    buffer_load_dwordx4 v1, s[8:11], s35 offen offset:1024 sc1 lds
    s_add_u32 s36, s36, 32768
    v_exp_f32 v74, v58
    v_add_f32 v22, v22, v72
    v_add_f32 v23, v23, v73
    v_mfma_f32_32x32x16_bf16 a[0:15], a[228:231], v[84:87], a[0:15]
    buffer_load_dwordx4 v1, s[8:11], s35 offen offset:2048 sc1 lds
    s_and_b32 s36, s36, 0x1ffff
    v_exp_f32 v75, v59
    v_cvt_pk_bf16_f32 v92, v72, v73
    v_mfma_f32_32x32x16_bf16 a[16:31], a[232:235], v[80:83], a[16:31]
    buffer_load_dwordx4 v1, s[8:11], s35 offen offset:3072 sc1 lds
    v_exp_f32 v76, v60
    v_add_f32 v22, v22, v74
    v_add_f32 v23, v23, v75
    v_mfma_f32_32x32x16_bf16 a[16:31], a[236:239], v[84:87], a[16:31]
    s_add_u32 s35, s35, 0x8000
    s_sub_u32 s21, s21, 32
    v_exp_f32 v77, v61
    v_cvt_pk_bf16_f32 v93, v74, v75
    v_mfma_f32_32x32x16_bf16 a[32:47], a[240:243], v[80:83], a[32:47]
    v_exp_f32 v78, v62
    v_add_f32 v22, v22, v76
    v_add_f32 v23, v23, v77
    v_mfma_f32_32x32x16_bf16 a[32:47], a[244:247], v[84:87], a[32:47]
    s_sub_u32 s20, s20, 1
    v_exp_f32 v79, v63
    v_cvt_pk_bf16_f32 v94, v76, v77
    v_add_f32 v22, v22, v23
    v_mfma_f32_32x32x16_bf16 a[48:63], a[248:251], v[80:83], a[48:63]
    v_add_f32 v23, v78, v79
    v_cvt_pk_bf16_f32 v95, v78, v79
    v_add_f32 v22, v22, v23
    v_cmp_gt_f32 vcc, v22, v20
    v_mfma_f32_32x32x16_bf16 a[48:63], a[252:255], v[84:87], a[48:63]
    s_cbranch_vccnz L_attn_s4
L_attn_s4r:
    v_add_f32 v17, v17, v22
    s_cmp_lg_u32 s20, 0
    s_cbranch_scc1 L_attn_m1
    v_mfma_f32_32x32x16_bf16 v[48:63], a[192:195], a[160:163], v[112:127]
    s_waitcnt vmcnt(8)
    s_barrier
    v_add_u32 v24, s21, v26
    v_cmp_le_i32_e64 s[40:41], 0, v24
    v_cmp_le_i32_e64 s[42:43], 1, v24
    v_cmp_le_i32_e64 s[44:45], 2, v24
    v_cmp_le_i32_e64 s[46:47], 3, v24
    v_cndmask_b32_e64 v32, v25, v32, s[40:41]
    v_exp_f32 v64, v32
    v_cmp_le_i32_e64 s[40:41], 16, v24
    v_cndmask_b32_e64 v33, v25, v33, s[42:43]
    v_exp_f32 v65, v33
    v_mfma_f32_32x32x16_bf16 v[48:63], a[196:199], a[164:167], v[48:63]
    ds_read_b128 a[192:195], v2 offset:0
    v_cmp_le_i32_e64 s[42:43], 17, v24
    v_cndmask_b32_e64 v34, v25, v34, s[44:45]
    v_exp_f32 v66, v34
    v_cmp_le_i32_e64 s[44:45], 18, v24
    v_cndmask_b32_e64 v35, v25, v35, s[46:47]
    v_exp_f32 v67, v35
    v_mfma_f32_32x32x16_bf16 v[48:63], a[200:203], a[168:171], v[48:63]
    ds_read_b128 a[196:199], v2 offset:1024
    v_cmp_le_i32_e64 s[46:47], 19, v24
    v_cndmask_b32_e64 v36, v25, v36, s[40:41]
    v_exp_f32 v68, v36
    v_add_f32 v22, v64, v65
    v_cvt_pk_bf16_f32 v80, v64, v65
    v_mfma_f32_32x32x16_bf16 v[48:63], a[204:207], a[172:175], v[48:63]
    ds_read_b128 a[200:203], v2 offset:2048
    v_cmp_le_i32_e64 s[40:41], 8, v24
    v_cndmask_b32_e64 v37, v25, v37, s[42:43]
    v_exp_f32 v69, v37
    v_add_f32 v23, v66, v67
    v_cvt_pk_bf16_f32 v81, v66, v67
    v_mfma_f32_32x32x16_bf16 v[48:63], a[208:211], a[176:179], v[48:63]
    ds_read_b128 a[204:207], v2 offset:3072
    v_cmp_le_i32_e64 s[42:43], 9, v24
    v_cndmask_b32_e64 v38, v25, v38, s[44:45]
    v_exp_f32 v70, v38
    v_add_f32 v22, v22, v68
    v_add_f32 v23, v23, v69
    v_mfma_f32_32x32x16_bf16 v[48:63], a[212:215], a[180:183], v[48:63]
    ds_read_b128 a[208:211], v2 offset:4096
    v_cmp_le_i32_e64 s[44:45], 10, v24
    v_cndmask_b32_e64 v39, v25, v39, s[46:47]
    v_exp_f32 v71, v39
    v_cvt_pk_bf16_f32 v82, v68, v69
    v_mfma_f32_32x32x16_bf16 v[48:63], a[216:219], a[184:187], v[48:63]
    ds_read_b128 a[212:215], v2 offset:5120
    v_cmp_le_i32_e64 s[46:47], 11, v24
    v_cndmask_b32_e64 v40, v25, v40, s[40:41]
    v_exp_f32 v72, v40
    v_add_f32 v22, v22, v70
    v_add_f32 v23, v23, v71
    v_mfma_f32_32x32x16_bf16 v[48:63], a[220:223], a[188:191], v[48:63]
    ds_read_b128 a[216:219], v2 offset:6144
    v_cmp_le_i32_e64 s[40:41], 24, v24
    v_cndmask_b32_e64 v41, v25, v41, s[42:43]
    v_exp_f32 v73, v41
    v_cvt_pk_bf16_f32 v83, v70, v71
    v_mfma_f32_32x32x16_bf16 a[64:79], a[224:227], v[88:91], a[64:79]
    ds_read_b128 a[220:223], v2 offset:7168
    v_cmp_le_i32_e64 s[42:43], 25, v24
    v_cndmask_b32_e64 v42, v25, v42, s[44:45]
    v_exp_f32 v74, v42
    v_add_f32 v22, v22, v72
    v_add_f32 v23, v23, v73
    v_mfma_f32_32x32x16_bf16 a[64:79], a[228:231], v[92:95], a[64:79]
    ds_read_b128 a[224:227], v3 offset:8192
    v_cmp_le_i32_e64 s[44:45], 26, v24
    v_cndmask_b32_e64 v43, v25, v43, s[46:47]
    v_exp_f32 v75, v43
    v_cvt_pk_bf16_f32 v84, v72, v73
    v_mfma_f32_32x32x16_bf16 a[80:95], a[232:235], v[88:91], a[80:95]
    ds_read_b128 a[228:231], v3 offset:9216
    v_cmp_le_i32_e64 s[46:47], 27, v24
    v_cndmask_b32_e64 v44, v25, v44, s[40:41]
    v_exp_f32 v76, v44
    v_add_f32 v22, v22, v74
    v_add_f32 v23, v23, v75
    v_mfma_f32_32x32x16_bf16 a[80:95], a[236:239], v[92:95], a[80:95]
    ds_read_b128 a[232:235], v3 offset:10240
    v_cndmask_b32_e64 v45, v25, v45, s[42:43]
    v_exp_f32 v77, v45
    v_cvt_pk_bf16_f32 v85, v74, v75
    v_mfma_f32_32x32x16_bf16 a[96:111], a[240:243], v[88:91], a[96:111]
    ds_read_b128 a[236:239], v3 offset:11264
    v_cndmask_b32_e64 v46, v25, v46, s[44:45]
    v_exp_f32 v78, v46
    v_add_f32 v22, v22, v76
    v_add_f32 v23, v23, v77
    v_mfma_f32_32x32x16_bf16 a[96:111], a[244:247], v[92:95], a[96:111]
    ds_read_b128 a[240:243], v3 offset:12288
    v_cndmask_b32_e64 v47, v25, v47, s[46:47]
    v_exp_f32 v79, v47
    v_cvt_pk_bf16_f32 v86, v76, v77
    v_add_f32 v22, v22, v23
    v_mfma_f32_32x32x16_bf16 a[112:127], a[248:251], v[88:91], a[112:127]
    ds_read_b128 a[244:247], v3 offset:13312
    v_add_f32 v23, v78, v79
    v_cvt_pk_bf16_f32 v87, v78, v79
    v_add_f32 v22, v22, v23
    v_cmp_gt_f32 vcc, v22, v19
    v_mfma_f32_32x32x16_bf16 a[112:127], a[252:255], v[92:95], a[112:127]
    s_cbranch_vccnz L_attn_s5
L_attn_s5r:
    v_add_f32 v16, v16, v22
    s_waitcnt lgkmcnt(6)
    v_mfma_f32_32x32x16_bf16 v[32:47], a[192:195], v[128:131], v[224:239]
    ds_read_b128 a[248:251], v3 offset:14336
    v_exp_f32 v64, v48
    v_exp_f32 v65, v49
    v_mfma_f32_32x32x16_bf16 v[32:47], a[196:199], v[132:135], v[32:47]
    ds_read_b128 a[252:255], v3 offset:15360
    s_mov_b32 m0, s18
    v_exp_f32 v66, v50
    v_exp_f32 v67, v51
    v_mfma_f32_32x32x16_bf16 v[32:47], a[200:203], v[136:139], v[32:47]
    buffer_load_dwordx4 v1, s[8:11], s16 offen offset:0 sc1 lds
    v_exp_f32 v68, v52
    v_add_f32 v22, v64, v65
    v_cvt_pk_bf16_f32 v88, v64, v65
    v_mfma_f32_32x32x16_bf16 v[32:47], a[204:207], v[140:143], v[32:47]
    buffer_load_dwordx4 v1, s[8:11], s16 offen offset:1024 sc1 lds
    s_add_u32 s18, s18, 32768
    v_exp_f32 v69, v53
    v_add_f32 v23, v66, v67
    v_cvt_pk_bf16_f32 v89, v66, v67
    v_mfma_f32_32x32x16_bf16 v[32:47], a[208:211], v[144:147], v[32:47]
    buffer_load_dwordx4 v1, s[8:11], s16 offen offset:2048 sc1 lds
    v_exp_f32 v70, v54
    v_add_f32 v22, v22, v68
    v_add_f32 v23, v23, v69
    v_add_u32 v3, s56, v1
    v_mfma_f32_32x32x16_bf16 v[32:47], a[212:215], v[148:151], v[32:47]
    buffer_load_dwordx4 v1, s[8:11], s16 offen offset:3072 sc1 lds
    s_and_b32 s18, s18, 0x1ffff
    v_exp_f32 v71, v55
    v_cvt_pk_bf16_f32 v90, v68, v69
    v_mfma_f32_32x32x16_bf16 v[32:47], a[216:219], v[152:155], v[32:47]
    s_mov_b32 m0, s36
    s_add_u32 s16, s16, s38
    v_exp_f32 v72, v56
    v_add_f32 v22, v22, v70
    v_add_f32 v23, v23, v71
    v_mfma_f32_32x32x16_bf16 v[32:47], a[220:223], v[156:159], v[32:47]
    buffer_load_dwordx4 v1, s[8:11], s35 offen offset:0 sc1 lds
    s_mov_b32 s38, 0x8000
    v_exp_f32 v73, v57
    v_cvt_pk_bf16_f32 v91, v70, v71
    s_waitcnt lgkmcnt(0)
    v_mfma_f32_32x32x16_bf16 a[0:15], a[224:227], v[80:83], a[0:15]
    buffer_load_dwordx4 v1, s[8:11], s35 offen offset:1024 sc1 lds
    s_add_u32 s36, s36, 32768
    v_exp_f32 v74, v58
    v_add_f32 v22, v22, v72
    v_add_f32 v23, v23, v73
    v_mfma_f32_32x32x16_bf16 a[0:15], a[228:231], v[84:87], a[0:15]
    buffer_load_dwordx4 v1, s[8:11], s35 offen offset:2048 sc1 lds
    s_and_b32 s36, s36, 0x1ffff
    v_exp_f32 v75, v59
    v_cvt_pk_bf16_f32 v92, v72, v73
    v_mfma_f32_32x32x16_bf16 a[16:31], a[232:235], v[80:83], a[16:31]
    buffer_load_dwordx4 v1, s[8:11], s35 offen offset:3072 sc1 lds
    v_exp_f32 v76, v60
    v_add_f32 v22, v22, v74
    v_add_f32 v23, v23, v75
    v_mfma_f32_32x32x16_bf16 a[16:31], a[236:239], v[84:87], a[16:31]
    s_add_u32 s35, s35, 0x8000
    s_sub_u32 s21, s21, 32
    v_exp_f32 v77, v61
    v_cvt_pk_bf16_f32 v93, v74, v75
    v_mfma_f32_32x32x16_bf16 a[32:47], a[240:243], v[80:83], a[32:47]
    s_mov_b32 s21, s54
    s_mov_b32 s16, s52
    v_exp_f32 v78, v62
    v_add_f32 v22, v22, v76
    v_add_f32 v23, v23, v77
    v_mfma_f32_32x32x16_bf16 a[32:47], a[244:247], v[84:87], a[32:47]
    s_mov_b32 m0, s53
    v_exp_f32 v79, v63
    v_cvt_pk_bf16_f32 v94, v76, v77
    v_add_f32 v22, v22, v23
    v_mfma_f32_32x32x16_bf16 a[48:63], a[248:251], v[80:83], a[48:63]
    v_add_f32 v23, v78, v79
    v_cvt_pk_bf16_f32 v95, v78, v79
    v_add_f32 v22, v22, v23
    v_cmp_gt_f32 vcc, v22, v20
    v_mfma_f32_32x32x16_bf16 a[48:63], a[252:255], v[84:87], a[48:63]
    s_cbranch_vccnz L_attn_s6
L_attn_s6r:
    v_add_f32 v17, v17, v22
    buffer_load_dwordx4 v[244:247], v248, s[8:11], s71 offen sc0 sc1
    v_mov_b32 v241, v16
    s_nop 1
    v_permlane32_swap_b32 v16, v241
    s_nop 1
    v_add_f32 v16, v16, v241
    v_rcp_f32 v240, v16
    s_nop 0
    v_accvgpr_read_b32 v64, a0
    v_accvgpr_read_b32 v65, a1
    v_accvgpr_read_b32 v66, a2
    v_accvgpr_read_b32 v67, a3
    v_accvgpr_read_b32 v68, a4
    v_accvgpr_read_b32 v69, a5
    v_accvgpr_read_b32 v70, a6
    v_accvgpr_read_b32 v71, a7
    v_pk_mul_f32 v[64:65], v[64:65], v[240:241] op_sel_hi:[1,0]
    v_pk_mul_f32 v[66:67], v[66:67], v[240:241] op_sel_hi:[1,0]
    v_pk_mul_f32 v[68:69], v[68:69], v[240:241] op_sel_hi:[1,0]
    v_pk_mul_f32 v[70:71], v[70:71], v[240:241] op_sel_hi:[1,0]
    v_cvt_pk_bf16_f32 v72, v64, v65
    v_cvt_pk_bf16_f32 v73, v66, v67
    v_cvt_pk_bf16_f32 v74, v68, v69
    v_cvt_pk_bf16_f32 v75, v70, v71
    buffer_store_dwordx4 v[72:75], v4, s[8:11], s50 offen offset:0 sc0 sc1
    s_nop 0
    v_accvgpr_read_b32 v64, a8
    v_accvgpr_read_b32 v65, a9
    v_accvgpr_read_b32 v66, a10
    v_accvgpr_read_b32 v67, a11
    v_accvgpr_read_b32 v68, a12
    v_accvgpr_read_b32 v69, a13
    v_accvgpr_read_b32 v70, a14
    v_accvgpr_read_b32 v71, a15
    v_pk_mul_f32 v[64:65], v[64:65], v[240:241] op_sel_hi:[1,0]
    v_pk_mul_f32 v[66:67], v[66:67], v[240:241] op_sel_hi:[1,0]
    v_pk_mul_f32 v[68:69], v[68:69], v[240:241] op_sel_hi:[1,0]
    v_pk_mul_f32 v[70:71], v[70:71], v[240:241] op_sel_hi:[1,0]
    v_cvt_pk_bf16_f32 v72, v64, v65
    v_cvt_pk_bf16_f32 v73, v66, v67
    v_cvt_pk_bf16_f32 v74, v68, v69
    v_cvt_pk_bf16_f32 v75, v70, v71
    buffer_store_dwordx4 v[72:75], v4, s[8:11], s50 offen offset:512 sc0 sc1
    s_nop 0
    v_accvgpr_read_b32 v64, a16
    v_accvgpr_read_b32 v65, a17
    v_accvgpr_read_b32 v66, a18
    v_accvgpr_read_b32 v67, a19
    v_accvgpr_read_b32 v68, a20
    v_accvgpr_read_b32 v69, a21
    v_accvgpr_read_b32 v70, a22
    v_accvgpr_read_b32 v71, a23
    v_pk_mul_f32 v[64:65], v[64:65], v[240:241] op_sel_hi:[1,0]
    v_pk_mul_f32 v[66:67], v[66:67], v[240:241] op_sel_hi:[1,0]
    v_pk_mul_f32 v[68:69], v[68:69], v[240:241] op_sel_hi:[1,0]
    v_pk_mul_f32 v[70:71], v[70:71], v[240:241] op_sel_hi:[1,0]
    v_cvt_pk_bf16_f32 v72, v64, v65
    v_cvt_pk_bf16_f32 v73, v66, v67
    v_cvt_pk_bf16_f32 v74, v68, v69
    v_cvt_pk_bf16_f32 v75, v70, v71
    buffer_store_dwordx4 v[72:75], v4, s[8:11], s50 offen offset:1024 sc0 sc1
    s_nop 0
    v_accvgpr_read_b32 v64, a24
    v_accvgpr_read_b32 v65, a25
    v_accvgpr_read_b32 v66, a26
    v_accvgpr_read_b32 v67, a27
    v_accvgpr_read_b32 v68, a28
    v_accvgpr_read_b32 v69, a29
    v_accvgpr_read_b32 v70, a30
    v_accvgpr_read_b32 v71, a31
    v_pk_mul_f32 v[64:65], v[64:65], v[240:241] op_sel_hi:[1,0]
    v_pk_mul_f32 v[66:67], v[66:67], v[240:241] op_sel_hi:[1,0]
    v_pk_mul_f32 v[68:69], v[68:69], v[240:241] op_sel_hi:[1,0]
    v_pk_mul_f32 v[70:71], v[70:71], v[240:241] op_sel_hi:[1,0]
    v_cvt_pk_bf16_f32 v72, v64, v65
    v_cvt_pk_bf16_f32 v73, v66, v67
    v_cvt_pk_bf16_f32 v74, v68, v69
    v_cvt_pk_bf16_f32 v75, v70, v71
    buffer_store_dwordx4 v[72:75], v4, s[8:11], s50 offen offset:1536 sc0 sc1
    s_nop 0
    v_accvgpr_read_b32 v64, a32
    v_accvgpr_read_b32 v65, a33
    v_accvgpr_read_b32 v66, a34
    v_accvgpr_read_b32 v67, a35
    v_accvgpr_read_b32 v68, a36
    v_accvgpr_read_b32 v69, a37
    v_accvgpr_read_b32 v70, a38
    v_accvgpr_read_b32 v71, a39
    v_pk_mul_f32 v[64:65], v[64:65], v[240:241] op_sel_hi:[1,0]
    v_pk_mul_f32 v[66:67], v[66:67], v[240:241] op_sel_hi:[1,0]
    v_pk_mul_f32 v[68:69], v[68:69], v[240:241] op_sel_hi:[1,0]
    v_pk_mul_f32 v[70:71], v[70:71], v[240:241] op_sel_hi:[1,0]
    v_cvt_pk_bf16_f32 v72, v64, v65
    v_cvt_pk_bf16_f32 v73, v66, v67
    v_cvt_pk_bf16_f32 v74, v68, v69
    v_cvt_pk_bf16_f32 v75, v70, v71
    buffer_store_dwordx4 v[72:75], v4, s[8:11], s50 offen offset:2048 sc0 sc1
    s_nop 0
    v_accvgpr_read_b32 v64, a40
    v_accvgpr_read_b32 v65, a41
    v_accvgpr_read_b32 v66, a42
    v_accvgpr_read_b32 v67, a43
    v_accvgpr_read_b32 v68, a44
    v_accvgpr_read_b32 v69, a45
    v_accvgpr_read_b32 v70, a46
    v_accvgpr_read_b32 v71, a47
    v_pk_mul_f32 v[64:65], v[64:65], v[240:241] op_sel_hi:[1,0]
    v_pk_mul_f32 v[66:67], v[66:67], v[240:241] op_sel_hi:[1,0]
    v_pk_mul_f32 v[68:69], v[68:69], v[240:241] op_sel_hi:[1,0]
    v_pk_mul_f32 v[70:71], v[70:71], v[240:241] op_sel_hi:[1,0]
    v_cvt_pk_bf16_f32 v72, v64, v65
    v_cvt_pk_bf16_f32 v73, v66, v67
    v_cvt_pk_bf16_f32 v74, v68, v69
    v_cvt_pk_bf16_f32 v75, v70, v71
    buffer_store_dwordx4 v[72:75], v4, s[8:11], s50 offen offset:2560 sc0 sc1
    s_nop 0
    v_accvgpr_read_b32 v64, a48
    v_accvgpr_read_b32 v65, a49
    v_accvgpr_read_b32 v66, a50
    v_accvgpr_read_b32 v67, a51
    v_accvgpr_read_b32 v68, a52
    v_accvgpr_read_b32 v69, a53
    v_accvgpr_read_b32 v70, a54
    v_accvgpr_read_b32 v71, a55
    v_pk_mul_f32 v[64:65], v[64:65], v[240:241] op_sel_hi:[1,0]
    v_pk_mul_f32 v[66:67], v[66:67], v[240:241] op_sel_hi:[1,0]
    v_pk_mul_f32 v[68:69], v[68:69], v[240:241] op_sel_hi:[1,0]
    v_pk_mul_f32 v[70:71], v[70:71], v[240:241] op_sel_hi:[1,0]
    v_cvt_pk_bf16_f32 v72, v64, v65
    v_cvt_pk_bf16_f32 v73, v66, v67
    v_cvt_pk_bf16_f32 v74, v68, v69
    v_cvt_pk_bf16_f32 v75, v70, v71
    buffer_store_dwordx4 v[72:75], v4, s[8:11], s50 offen offset:3072 sc0 sc1
    s_nop 0
    v_accvgpr_read_b32 v64, a56
    v_accvgpr_read_b32 v65, a57
    v_accvgpr_read_b32 v66, a58
    v_accvgpr_read_b32 v67, a59
    v_accvgpr_read_b32 v68, a60
    v_accvgpr_read_b32 v69, a61
    v_accvgpr_read_b32 v70, a62
    v_accvgpr_read_b32 v71, a63
    v_pk_mul_f32 v[64:65], v[64:65], v[240:241] op_sel_hi:[1,0]
    v_pk_mul_f32 v[66:67], v[66:67], v[240:241] op_sel_hi:[1,0]
    v_pk_mul_f32 v[68:69], v[68:69], v[240:241] op_sel_hi:[1,0]
    v_pk_mul_f32 v[70:71], v[70:71], v[240:241] op_sel_hi:[1,0]
    v_cvt_pk_bf16_f32 v72, v64, v65
    v_cvt_pk_bf16_f32 v73, v66, v67
    v_cvt_pk_bf16_f32 v74, v68, v69
    v_cvt_pk_bf16_f32 v75, v70, v71
    buffer_store_dwordx4 v[72:75], v4, s[8:11], s50 offen offset:3584 sc0 sc1
    s_nop 0
    s_waitcnt vmcnt(8)
    s_mov_b32 s7, 0
L_attn_hf:
    v_and_b32 v244, v244, v245
    v_and_b32 v246, v246, v247
    v_and_b32 v244, v244, v246
    v_cmp_ne_u32 vcc, 1, v244
    s_add_u32 s7, s7, 1
    s_cbranch_vccz L_attn_hfg
    s_sleep 2
    buffer_load_dwordx4 v[244:247], v248, s[8:11], s71 offen sc0 sc1
    s_waitcnt vmcnt(0)
    s_cmp_lt_u32 s7, 0x40000
    s_cbranch_scc1 L_attn_hf
L_attn_hfg:
    buffer_load_dword v28, v27, s[76:79], s69 offen
    buffer_load_dword v29, v27, s[64:67], s68 offen
    s_lshl_b32 s24, s13, 2
    s_sub_u32 s20, 28, s24
    s_cmp_eq_u32 s20, 0
    s_cbranch_scc1 L_attn_m2
L_attn_n2:
    v_mfma_f32_32x32x16_bf16 v[48:63], a[192:195], a[160:163], v[112:127]
    s_waitcnt vmcnt(16)
    s_barrier
    v_exp_f32 v64, v32
    v_exp_f32 v65, v33
    v_mfma_f32_32x32x16_bf16 v[48:63], a[196:199], a[164:167], v[48:63]
    ds_read_b128 a[192:195], v3 offset:0
    v_exp_f32 v66, v34
    v_exp_f32 v67, v35
    v_mfma_f32_32x32x16_bf16 v[48:63], a[200:203], a[168:171], v[48:63]
    ds_read_b128 a[196:199], v3 offset:1024
    v_exp_f32 v68, v36
    v_add_f32 v22, v64, v65
    v_cvt_pk_bf16_f32 v80, v64, v65
    v_mfma_f32_32x32x16_bf16 v[48:63], a[204:207], a[172:175], v[48:63]
    ds_read_b128 a[200:203], v3 offset:2048
    v_exp_f32 v69, v37
    v_add_f32 v23, v66, v67
    v_cvt_pk_bf16_f32 v81, v66, v67
    v_mfma_f32_32x32x16_bf16 v[48:63], a[208:211], a[176:179], v[48:63]
    ds_read_b128 a[204:207], v3 offset:3072
    v_exp_f32 v70, v38
    v_add_f32 v22, v22, v68
    v_add_f32 v23, v23, v69
    v_mfma_f32_32x32x16_bf16 v[48:63], a[212:215], a[180:183], v[48:63]
    ds_read_b128 a[208:211], v3 offset:4096
    v_exp_f32 v71, v39
    v_cvt_pk_bf16_f32 v82, v68, v69
    v_mfma_f32_32x32x16_bf16 v[48:63], a[216:219], a[184:187], v[48:63]
    ds_read_b128 a[212:215], v3 offset:5120
    v_exp_f32 v72, v40
    v_add_f32 v22, v22, v70
    v_add_f32 v23, v23, v71
    v_mfma_f32_32x32x16_bf16 v[48:63], a[220:223], a[188:191], v[48:63]
    ds_read_b128 a[216:219], v3 offset:6144
    v_exp_f32 v73, v41
    v_cvt_pk_bf16_f32 v83, v70, v71
    v_mfma_f32_32x32x16_bf16 a[64:79], a[224:227], v[88:91], a[64:79]
    ds_read_b128 a[220:223], v3 offset:7168
    v_exp_f32 v74, v42
    v_add_f32 v22, v22, v72
    v_add_f32 v23, v23, v73
    v_mfma_f32_32x32x16_bf16 a[64:79], a[228:231], v[92:95], a[64:79]
    ds_read_b128 a[224:227], v3 offset:8192
    v_exp_f32 v75, v43
    v_cvt_pk_bf16_f32 v84, v72, v73
    v_mfma_f32_32x32x16_bf16 a[80:95], a[232:235], v[88:91], a[80:95]
    ds_read_b128 a[228:231], v3 offset:9216
    v_exp_f32 v76, v44
    v_add_f32 v22, v22, v74
    v_add_f32 v23, v23, v75
    v_mfma_f32_32x32x16_bf16 a[80:95], a[236:239], v[92:95], a[80:95]
    ds_read_b128 a[232:235], v3 offset:10240
    v_exp_f32 v77, v45
    v_cvt_pk_bf16_f32 v85, v74, v75
    v_mfma_f32_32x32x16_bf16 a[96:111], a[240:243], v[88:91], a[96:111]
    ds_read_b128 a[236:239], v3 offset:11264
    v_exp_f32 v78, v46
    v_add_f32 v22, v22, v76
    v_add_f32 v23, v23, v77
    v_mfma_f32_32x32x16_bf16 a[96:111], a[244:247], v[92:95], a[96:111]
    ds_read_b128 a[240:243], v3 offset:12288
    v_exp_f32 v79, v47
    v_cvt_pk_bf16_f32 v86, v76, v77
    v_add_f32 v22, v22, v23
    v_mfma_f32_32x32x16_bf16 a[112:127], a[248:251], v[88:91], a[112:127]
    ds_read_b128 a[244:247], v3 offset:13312
    v_add_f32 v23, v78, v79
    v_cvt_pk_bf16_f32 v87, v78, v79
    v_add_f32 v22, v22, v23
    v_cmp_gt_f32 vcc, v22, v21
    v_mfma_f32_32x32x16_bf16 a[112:127], a[252:255], v[92:95], a[112:127]
    s_cbranch_vccnz L_attn_s7
L_attn_s7r:
    v_add_f32 v18, v18, v22
    s_waitcnt lgkmcnt(6)
    v_mfma_f32_32x32x16_bf16 v[32:47], a[192:195], v[128:131], v[224:239]
    ds_read_b128 a[248:251], v3 offset:14336
    s_add_u32 m0, m0, 28672
    v_exp_f32 v64, v48
    v_exp_f32 v65, v49
    v_mfma_f32_32x32x16_bf16 v[32:47], a[196:199], v[132:135], v[32:47]
    ds_read_b128 a[252:255], v3 offset:15360
    s_and_b32 m0, m0, 0x1ffff
    v_exp_f32 v66, v50
    v_exp_f32 v67, v51
    v_mfma_f32_32x32x16_bf16 v[32:47], a[200:203], v[136:139], v[32:47]
    buffer_load_dwordx4 v1, s[8:11], s16 offen offset:0 sc1 lds
    v_exp_f32 v68, v52
    v_add_f32 v22, v64, v65
    v_cvt_pk_bf16_f32 v88, v64, v65
    v_mfma_f32_32x32x16_bf16 v[32:47], a[204:207], v[140:143], v[32:47]
    buffer_load_dwordx4 v1, s[8:11], s16 offen offset:1024 sc1 lds
    v_exp_f32 v69, v53
    v_add_f32 v23, v66, v67
    v_cvt_pk_bf16_f32 v89, v66, v67
    v_mfma_f32_32x32x16_bf16 v[32:47], a[208:211], v[144:147], v[32:47]
    buffer_load_dwordx4 v1, s[8:11], s16 offen offset:2048 sc1 lds
    v_exp_f32 v70, v54
    v_add_f32 v22, v22, v68
    v_add_f32 v23, v23, v69
    v_add_u32 v3, 0x8000, v3
    v_mfma_f32_32x32x16_bf16 v[32:47], a[212:215], v[148:151], v[32:47]
    buffer_load_dwordx4 v1, s[8:11], s16 offen offset:3072 sc1 lds
    v_exp_f32 v71, v55
    v_cvt_pk_bf16_f32 v90, v68, v69
    v_mfma_f32_32x32x16_bf16 v[32:47], a[216:219], v[152:155], v[32:47]
    s_add_u32 m0, m0, 4096
    v_exp_f32 v72, v56
    v_add_f32 v22, v22, v70
    v_add_f32 v23, v23, v71
    v_and_b32 v3, 0x1ffff, v3
    v_mfma_f32_32x32x16_bf16 v[32:47], a[220:223], v[156:159], v[32:47]
    v_exp_f32 v73, v57
    v_cvt_pk_bf16_f32 v91, v70, v71
    s_waitcnt lgkmcnt(0)
    v_mfma_f32_32x32x16_bf16 v[160:175], a[224:227], v[80:83], v[160:175]
    buffer_load_dwordx4 v11, s[8:11], s16 offen offset:0 sc1 lds
    v_exp_f32 v74, v58
    v_add_f32 v22, v22, v72
    v_add_f32 v23, v23, v73
    v_mfma_f32_32x32x16_bf16 v[160:175], a[228:231], v[84:87], v[160:175]
    buffer_load_dwordx4 v11, s[8:11], s16 offen offset:1024 sc1 lds
    v_exp_f32 v75, v59
    v_cvt_pk_bf16_f32 v92, v72, v73
    v_mfma_f32_32x32x16_bf16 v[176:191], a[232:235], v[80:83], v[176:191]
    buffer_load_dwordx4 v11, s[8:11], s16 offen offset:2048 sc1 lds
    v_exp_f32 v76, v60
    v_add_f32 v22, v22, v74
    v_add_f32 v23, v23, v75
    v_mfma_f32_32x32x16_bf16 v[176:191], a[236:239], v[84:87], v[176:191]
    buffer_load_dwordx4 v11, s[8:11], s16 offen offset:3072 sc1 lds
    v_exp_f32 v77, v61
    v_cvt_pk_bf16_f32 v93, v74, v75
    v_mfma_f32_32x32x16_bf16 v[192:207], a[240:243], v[80:83], v[192:207]
    s_add_u32 s16, s16, 0x8000
    v_exp_f32 v78, v62
    v_add_f32 v22, v22, v76
    v_add_f32 v23, v23, v77
    v_mfma_f32_32x32x16_bf16 v[192:207], a[244:247], v[84:87], v[192:207]
    s_sub_u32 s20, s20, 1
    v_exp_f32 v79, v63
    v_cvt_pk_bf16_f32 v94, v76, v77
    v_add_f32 v22, v22, v23
    v_mfma_f32_32x32x16_bf16 v[208:223], a[248:251], v[80:83], v[208:223]
    s_min_u32 s16, s16, s34
    v_add_f32 v23, v78, v79
    v_cvt_pk_bf16_f32 v95, v78, v79
    v_add_f32 v22, v22, v23
    v_cmp_gt_f32 vcc, v22, v20
    v_mfma_f32_32x32x16_bf16 v[208:223], a[252:255], v[84:87], v[208:223]
    s_cbranch_vccnz L_attn_s8
L_attn_s8r:
    v_add_f32 v17, v17, v22
    s_cmp_lg_u32 s20, 0
    s_cbranch_scc1 L_attn_n2
L_attn_m2:
    v_mfma_f32_32x32x16_bf16 v[48:63], a[192:195], a[160:163], v[112:127]
    s_waitcnt vmcnt(16)
    s_barrier
    v_add_u32 v24, s21, v26
    v_cmp_le_i32_e64 s[40:41], 0, v24
    v_cmp_le_i32_e64 s[42:43], 1, v24
    v_cmp_le_i32_e64 s[44:45], 2, v24
    v_cmp_le_i32_e64 s[46:47], 3, v24
    v_cndmask_b32_e64 v32, v25, v32, s[40:41]
    v_exp_f32 v64, v32
    v_cmp_le_i32_e64 s[40:41], 16, v24
    v_cndmask_b32_e64 v33, v25, v33, s[42:43]
    v_exp_f32 v65, v33
    v_mfma_f32_32x32x16_bf16 v[48:63], a[196:199], a[164:167], v[48:63]
    ds_read_b128 a[192:195], v3 offset:0
    v_cmp_le_i32_e64 s[42:43], 17, v24
    v_cndmask_b32_e64 v34, v25, v34, s[44:45]
    v_exp_f32 v66, v34
    v_cmp_le_i32_e64 s[44:45], 18, v24
    v_cndmask_b32_e64 v35, v25, v35, s[46:47]
    v_exp_f32 v67, v35
    v_mfma_f32_32x32x16_bf16 v[48:63], a[200:203], a[168:171], v[48:63]
    ds_read_b128 a[196:199], v3 offset:1024
    v_cmp_le_i32_e64 s[46:47], 19, v24
    v_cndmask_b32_e64 v36, v25, v36, s[40:41]
    v_exp_f32 v68, v36
    v_add_f32 v22, v64, v65
    v_cvt_pk_bf16_f32 v80, v64, v65
    v_mfma_f32_32x32x16_bf16 v[48:63], a[204:207], a[172:175], v[48:63]
    ds_read_b128 a[200:203], v3 offset:2048
    v_cmp_le_i32_e64 s[40:41], 8, v24
    v_cndmask_b32_e64 v37, v25, v37, s[42:43]
    v_exp_f32 v69, v37
    v_add_f32 v23, v66, v67
    v_cvt_pk_bf16_f32 v81, v66, v67
    v_mfma_f32_32x32x16_bf16 v[48:63], a[208:211], a[176:179], v[48:63]
    ds_read_b128 a[204:207], v3 offset:3072
    v_cmp_le_i32_e64 s[42:43], 9, v24
    v_cndmask_b32_e64 v38, v25, v38, s[44:45]
    v_exp_f32 v70, v38
    v_add_f32 v22, v22, v68
    v_add_f32 v23, v23, v69
    v_mfma_f32_32x32x16_bf16 v[48:63], a[212:215], a[180:183], v[48:63]
    ds_read_b128 a[208:211], v3 offset:4096
    v_cmp_le_i32_e64 s[44:45], 10, v24
    v_cndmask_b32_e64 v39, v25, v39, s[46:47]
    v_exp_f32 v71, v39
    v_cvt_pk_bf16_f32 v82, v68, v69
    v_mfma_f32_32x32x16_bf16 v[48:63], a[216:219], a[184:187], v[48:63]
    ds_read_b128 a[212:215], v3 offset:5120
    v_cmp_le_i32_e64 s[46:47], 11, v24
    v_cndmask_b32_e64 v40, v25, v40, s[40:41]
    v_exp_f32 v72, v40
    v_add_f32 v22, v22, v70
    v_add_f32 v23, v23, v71
    v_mfma_f32_32x32x16_bf16 v[48:63], a[220:223], a[188:191], v[48:63]
    ds_read_b128 a[216:219], v3 offset:6144
    v_cmp_le_i32_e64 s[40:41], 24, v24
    v_cndmask_b32_e64 v41, v25, v41, s[42:43]
    v_exp_f32 v73, v41
    v_cvt_pk_bf16_f32 v83, v70, v71
    v_mfma_f32_32x32x16_bf16 a[64:79], a[224:227], v[88:91], a[64:79]
    ds_read_b128 a[220:223], v3 offset:7168
    v_cmp_le_i32_e64 s[42:43], 25, v24
    v_cndmask_b32_e64 v42, v25, v42, s[44:45]
    v_exp_f32 v74, v42
    v_add_f32 v22, v22, v72
    v_add_f32 v23, v23, v73
    v_mfma_f32_32x32x16_bf16 a[64:79], a[228:231], v[92:95], a[64:79]
    ds_read_b128 a[224:227], v3 offset:8192
    v_cmp_le_i32_e64 s[44:45], 26, v24
    v_cndmask_b32_e64 v43, v25, v43, s[46:47]
    v_exp_f32 v75, v43
    v_cvt_pk_bf16_f32 v84, v72, v73
    v_mfma_f32_32x32x16_bf16 a[80:95], a[232:235], v[88:91], a[80:95]
    ds_read_b128 a[228:231], v3 offset:9216
    v_cmp_le_i32_e64 s[46:47], 27, v24
    v_cndmask_b32_e64 v44, v25, v44, s[40:41]
    v_exp_f32 v76, v44
    v_add_f32 v22, v22, v74
    v_add_f32 v23, v23, v75
    v_mfma_f32_32x32x16_bf16 a[80:95], a[236:239], v[92:95], a[80:95]
    ds_read_b128 a[232:235], v3 offset:10240
    v_cndmask_b32_e64 v45, v25, v45, s[42:43]
    v_exp_f32 v77, v45
    v_cvt_pk_bf16_f32 v85, v74, v75
    v_mfma_f32_32x32x16_bf16 a[96:111], a[240:243], v[88:91], a[96:111]
    ds_read_b128 a[236:239], v3 offset:11264
    v_cndmask_b32_e64 v46, v25, v46, s[44:45]
    v_exp_f32 v78, v46
    v_add_f32 v22, v22, v76
    v_add_f32 v23, v23, v77
    v_mfma_f32_32x32x16_bf16 a[96:111], a[244:247], v[92:95], a[96:111]
    ds_read_b128 a[240:243], v3 offset:12288
    v_cndmask_b32_e64 v47, v25, v47, s[46:47]
    v_exp_f32 v79, v47
    v_cvt_pk_bf16_f32 v86, v76, v77
    v_add_f32 v22, v22, v23
    v_mfma_f32_32x32x16_bf16 a[112:127], a[248:251], v[88:91], a[112:127]
    ds_read_b128 a[244:247], v3 offset:13312
    v_add_f32 v23, v78, v79
    v_cvt_pk_bf16_f32 v87, v78, v79
    v_add_f32 v22, v22, v23
    v_cmp_gt_f32 vcc, v22, v21
    v_mfma_f32_32x32x16_bf16 a[112:127], a[252:255], v[92:95], a[112:127]
    s_cbranch_vccnz L_attn_s9
L_attn_s9r:
    v_add_f32 v18, v18, v22
    s_waitcnt lgkmcnt(6)
    v_mfma_f32_32x32x16_bf16 v[32:47], a[192:195], v[128:131], v[224:239]
    ds_read_b128 a[248:251], v3 offset:14336
    v_add_u32 v24, s22, v26
    v_cmp_le_i32_e64 s[40:41], 0, v24
    v_cmp_le_i32_e64 s[42:43], 1, v24
    v_cmp_le_i32_e64 s[44:45], 2, v24
    v_cmp_le_i32_e64 s[46:47], 3, v24
    v_cndmask_b32_e64 v48, v25, v48, s[40:41]
    v_exp_f32 v64, v48
    v_cmp_le_i32_e64 s[40:41], 16, v24
    v_cndmask_b32_e64 v49, v25, v49, s[42:43]
    v_exp_f32 v65, v49
    v_mfma_f32_32x32x16_bf16 v[32:47], a[196:199], v[132:135], v[32:47]
    ds_read_b128 a[252:255], v3 offset:15360
    v_cmp_le_i32_e64 s[42:43], 17, v24
    v_cndmask_b32_e64 v50, v25, v50, s[44:45]
    v_exp_f32 v66, v50
    v_cmp_le_i32_e64 s[44:45], 18, v24
    v_cndmask_b32_e64 v51, v25, v51, s[46:47]
    v_exp_f32 v67, v51
    v_mfma_f32_32x32x16_bf16 v[32:47], a[200:203], v[136:139], v[32:47]
    s_sub_u32 s21, s21, 64
    v_cmp_le_i32_e64 s[46:47], 19, v24
    v_cndmask_b32_e64 v52, v25, v52, s[40:41]
    v_exp_f32 v68, v52
    v_add_f32 v22, v64, v65
    v_cvt_pk_bf16_f32 v88, v64, v65
    v_mfma_f32_32x32x16_bf16 v[32:47], a[204:207], v[140:143], v[32:47]
    s_sub_u32 s22, s22, 64
    v_cmp_le_i32_e64 s[40:41], 8, v24
    v_cndmask_b32_e64 v53, v25, v53, s[42:43]
    v_exp_f32 v69, v53
    v_add_f32 v23, v66, v67
    v_cvt_pk_bf16_f32 v89, v66, v67
    v_mfma_f32_32x32x16_bf16 v[32:47], a[208:211], v[144:147], v[32:47]
    s_add_u32 m0, s73, 147456
    s_add_u32 s74, s74, 65536
    buffer_load_dwordx4 v6, s[76:79], s74 offen lds
    v_cmp_le_i32_e64 s[42:43], 9, v24
    v_cndmask_b32_e64 v54, v25, v54, s[44:45]
    v_exp_f32 v70, v54
    v_add_f32 v22, v22, v68
    v_add_f32 v23, v23, v69
    v_add_u32 v3, 0x8000, v3
    v_mfma_f32_32x32x16_bf16 v[32:47], a[212:215], v[148:151], v[32:47]
    buffer_load_dwordx4 v5, s[76:79], s74 offen offset:1024 lds
    v_cmp_le_i32_e64 s[44:45], 10, v24
    v_cndmask_b32_e64 v55, v25, v55, s[46:47]
    v_exp_f32 v71, v55
    v_cvt_pk_bf16_f32 v90, v68, v69
    v_mfma_f32_32x32x16_bf16 v[32:47], a[216:219], v[152:155], v[32:47]
    buffer_load_dwordx4 v13, s[76:79], s74 offen offset:2048 lds
    v_cmp_le_i32_e64 s[46:47], 11, v24
    v_cndmask_b32_e64 v56, v25, v56, s[40:41]
    v_exp_f32 v72, v56
    v_add_f32 v22, v22, v70
    v_add_f32 v23, v23, v71
    v_and_b32 v3, 0x1ffff, v3
    v_mfma_f32_32x32x16_bf16 v[32:47], a[220:223], v[156:159], v[32:47]
    buffer_load_dwordx4 v31, s[76:79], s74 offen offset:3072 lds
    v_cmp_le_i32_e64 s[40:41], 24, v24
    v_cndmask_b32_e64 v57, v25, v57, s[42:43]
    v_exp_f32 v73, v57
    v_cvt_pk_bf16_f32 v91, v70, v71
    s_waitcnt lgkmcnt(0)
    v_mfma_f32_32x32x16_bf16 v[160:175], a[224:227], v[80:83], v[160:175]
    s_add_u32 m0, s73, 131072
    s_add_u32 s75, s75, 2048
    buffer_load_dwordx4 v8, s[8:11], s75 offen sc1 lds
    v_cmp_le_i32_e64 s[42:43], 25, v24
    v_cndmask_b32_e64 v58, v25, v58, s[44:45]
    v_exp_f32 v74, v58
    v_add_f32 v22, v22, v72
    v_add_f32 v23, v23, v73
    v_mfma_f32_32x32x16_bf16 v[160:175], a[228:231], v[84:87], v[160:175]
    buffer_load_dwordx4 v8, s[8:11], s75 offen offset:1024 sc1 lds
    v_cmp_le_i32_e64 s[44:45], 26, v24
    v_cndmask_b32_e64 v59, v25, v59, s[46:47]
    v_exp_f32 v75, v59
    v_cvt_pk_bf16_f32 v92, v72, v73
    v_mfma_f32_32x32x16_bf16 v[176:191], a[232:235], v[80:83], v[176:191]
    s_add_u32 m0, s73, 133120
    s_nop 0
    buffer_load_dwordx4 v9, s[8:11], s75 offen sc1 lds
    v_cmp_le_i32_e64 s[46:47], 27, v24
    v_cndmask_b32_e64 v60, v25, v60, s[40:41]
    v_exp_f32 v76, v60
    v_add_f32 v22, v22, v74
    v_add_f32 v23, v23, v75
    v_mfma_f32_32x32x16_bf16 v[176:191], a[236:239], v[84:87], v[176:191]
    buffer_load_dwordx4 v9, s[8:11], s75 offen offset:1024 sc1 lds
    v_cndmask_b32_e64 v61, v25, v61, s[42:43]
    v_exp_f32 v77, v61
    v_cvt_pk_bf16_f32 v93, v74, v75
    v_mfma_f32_32x32x16_bf16 v[192:207], a[240:243], v[80:83], v[192:207]
    v_cndmask_b32_e64 v62, v25, v62, s[44:45]
    v_exp_f32 v78, v62
    v_add_f32 v22, v22, v76
    v_add_f32 v23, v23, v77
    v_mfma_f32_32x32x16_bf16 v[192:207], a[244:247], v[84:87], v[192:207]
    v_cndmask_b32_e64 v63, v25, v63, s[46:47]
    v_exp_f32 v79, v63
    v_cvt_pk_bf16_f32 v94, v76, v77
    v_add_f32 v22, v22, v23
    v_mfma_f32_32x32x16_bf16 v[208:223], a[248:251], v[80:83], v[208:223]
    v_add_f32 v23, v78, v79
    v_cvt_pk_bf16_f32 v95, v78, v79
    v_add_f32 v22, v22, v23
    v_cmp_gt_f32 vcc, v22, v20
    v_mfma_f32_32x32x16_bf16 v[208:223], a[252:255], v[84:87], v[208:223]
    s_cbranch_vccnz L_attn_s10
L_attn_s10r:
    v_add_f32 v17, v17, v22
    v_mfma_f32_32x32x16_bf16 v[48:63], a[192:195], a[160:163], v[112:127]
    s_waitcnt vmcnt(8)
    s_barrier
    v_add_u32 v24, s21, v26
    v_cmp_le_i32_e64 s[40:41], 0, v24
    v_cmp_le_i32_e64 s[42:43], 1, v24
    v_cmp_le_i32_e64 s[44:45], 2, v24
    v_cmp_le_i32_e64 s[46:47], 3, v24
    v_cndmask_b32_e64 v32, v25, v32, s[40:41]
    v_exp_f32 v64, v32
    v_cmp_le_i32_e64 s[40:41], 16, v24
    v_cndmask_b32_e64 v33, v25, v33, s[42:43]
    v_exp_f32 v65, v33
    v_mfma_f32_32x32x16_bf16 v[48:63], a[196:199], a[164:167], v[48:63]
    s_add_u32 m0, s73, 16384
    s_add_u32 s74, s74, 65536
    buffer_load_dwordx4 v6, s[76:79], s74 offen lds
    v_cmp_le_i32_e64 s[42:43], 17, v24
    v_cndmask_b32_e64 v34, v25, v34, s[44:45]
    v_exp_f32 v66, v34
    v_cmp_le_i32_e64 s[44:45], 18, v24
    v_cndmask_b32_e64 v35, v25, v35, s[46:47]
    v_exp_f32 v67, v35
    v_mfma_f32_32x32x16_bf16 v[48:63], a[200:203], a[168:171], v[48:63]
    buffer_load_dwordx4 v5, s[76:79], s74 offen offset:1024 lds
    v_cmp_le_i32_e64 s[46:47], 19, v24
    v_cndmask_b32_e64 v36, v25, v36, s[40:41]
    v_exp_f32 v68, v36
    v_add_f32 v22, v64, v65
    v_cvt_pk_bf16_f32 v80, v64, v65
    v_mfma_f32_32x32x16_bf16 v[48:63], a[204:207], a[172:175], v[48:63]
    buffer_load_dwordx4 v13, s[76:79], s74 offen offset:2048 lds
    v_cmp_le_i32_e64 s[40:41], 8, v24
    v_cndmask_b32_e64 v37, v25, v37, s[42:43]
    v_exp_f32 v69, v37
    v_add_f32 v23, v66, v67
    v_cvt_pk_bf16_f32 v81, v66, v67
    v_mfma_f32_32x32x16_bf16 v[48:63], a[208:211], a[176:179], v[48:63]
    buffer_load_dwordx4 v31, s[76:79], s74 offen offset:3072 lds
    v_cmp_le_i32_e64 s[42:43], 9, v24
    v_cndmask_b32_e64 v38, v25, v38, s[44:45]
    v_exp_f32 v70, v38
    v_add_f32 v22, v22, v68
    v_add_f32 v23, v23, v69
    v_mfma_f32_32x32x16_bf16 v[48:63], a[212:215], a[180:183], v[48:63]
    s_add_u32 m0, s73, 0
    s_add_u32 s75, s75, 2048
    buffer_load_dwordx4 v8, s[8:11], s75 offen sc1 lds
    v_cmp_le_i32_e64 s[44:45], 10, v24
    v_cndmask_b32_e64 v39, v25, v39, s[46:47]
    v_exp_f32 v71, v39
    v_cvt_pk_bf16_f32 v82, v68, v69
    v_mfma_f32_32x32x16_bf16 v[48:63], a[216:219], a[184:187], v[48:63]
    buffer_load_dwordx4 v8, s[8:11], s75 offen offset:1024 sc1 lds
    v_cmp_le_i32_e64 s[46:47], 11, v24
    v_cndmask_b32_e64 v40, v25, v40, s[40:41]
    v_exp_f32 v72, v40
    v_add_f32 v22, v22, v70
    v_add_f32 v23, v23, v71
    v_mfma_f32_32x32x16_bf16 v[48:63], a[220:223], a[188:191], v[48:63]
    s_add_u32 m0, s73, 2048
    s_nop 0
    buffer_load_dwordx4 v9, s[8:11], s75 offen sc1 lds
    v_cmp_le_i32_e64 s[40:41], 24, v24
    v_cndmask_b32_e64 v41, v25, v41, s[42:43]
    v_exp_f32 v73, v41
    v_cvt_pk_bf16_f32 v83, v70, v71
    v_mfma_f32_32x32x16_bf16 a[64:79], a[224:227], v[88:91], a[64:79]
    buffer_load_dwordx4 v9, s[8:11], s75 offen offset:1024 sc1 lds
    v_cmp_le_i32_e64 s[42:43], 25, v24
    v_cndmask_b32_e64 v42, v25, v42, s[44:45]
    v_exp_f32 v74, v42
    v_add_f32 v22, v22, v72
    v_add_f32 v23, v23, v73
    v_mfma_f32_32x32x16_bf16 a[64:79], a[228:231], v[92:95], a[64:79]
    ds_read_b128 a[224:227], v3 offset:8192
    v_cmp_le_i32_e64 s[44:45], 26, v24
    v_cndmask_b32_e64 v43, v25, v43, s[46:47]
    v_exp_f32 v75, v43
    v_cvt_pk_bf16_f32 v84, v72, v73
    v_mfma_f32_32x32x16_bf16 a[80:95], a[232:235], v[88:91], a[80:95]
    ds_read_b128 a[228:231], v3 offset:9216
    v_cmp_le_i32_e64 s[46:47], 27, v24
    v_cndmask_b32_e64 v44, v25, v44, s[40:41]
    v_exp_f32 v76, v44
    v_add_f32 v22, v22, v74
    v_add_f32 v23, v23, v75
    v_mfma_f32_32x32x16_bf16 a[80:95], a[236:239], v[92:95], a[80:95]
    ds_read_b128 a[232:235], v3 offset:10240
    v_cndmask_b32_e64 v45, v25, v45, s[42:43]
    v_exp_f32 v77, v45
    v_cvt_pk_bf16_f32 v85, v74, v75
    v_mfma_f32_32x32x16_bf16 a[96:111], a[240:243], v[88:91], a[96:111]
    ds_read_b128 a[236:239], v3 offset:11264
    v_cndmask_b32_e64 v46, v25, v46, s[44:45]
    v_exp_f32 v78, v46
    v_add_f32 v22, v22, v76
    v_add_f32 v23, v23, v77
    v_mfma_f32_32x32x16_bf16 a[96:111], a[244:247], v[92:95], a[96:111]
    ds_read_b128 a[240:243], v3 offset:12288
    v_cndmask_b32_e64 v47, v25, v47, s[46:47]
    v_exp_f32 v79, v47
    v_cvt_pk_bf16_f32 v86, v76, v77
    v_add_f32 v22, v22, v23
    v_mfma_f32_32x32x16_bf16 a[112:127], a[248:251], v[88:91], a[112:127]
    ds_read_b128 a[244:247], v3 offset:13312
    v_add_f32 v23, v78, v79
    v_cvt_pk_bf16_f32 v87, v78, v79
    v_add_f32 v22, v22, v23
    v_cmp_gt_f32 vcc, v22, v21
    v_mfma_f32_32x32x16_bf16 a[112:127], a[252:255], v[92:95], a[112:127]
    s_cbranch_vccnz L_attn_s11
L_attn_s11r:
    v_add_f32 v18, v18, v22
    ds_read_b128 a[248:251], v3 offset:14336
    ds_read_b128 a[252:255], v3 offset:15360
    s_waitcnt lgkmcnt(7)
    v_mfma_f32_32x32x16_bf16 v[160:175], a[224:227], v[80:83], v[160:175]
    v_add_u32 v24, s22, v26
    v_cmp_le_i32_e64 s[40:41], 0, v24
    v_cmp_le_i32_e64 s[42:43], 1, v24
    v_cmp_le_i32_e64 s[44:45], 2, v24
    v_cmp_le_i32_e64 s[46:47], 3, v24
    v_cndmask_b32_e64 v48, v25, v48, s[40:41]
    v_exp_f32 v64, v48
    v_cmp_le_i32_e64 s[40:41], 16, v24
    v_cndmask_b32_e64 v49, v25, v49, s[42:43]
    v_exp_f32 v65, v49
    v_cmp_le_i32_e64 s[42:43], 17, v24
    v_cndmask_b32_e64 v50, v25, v50, s[44:45]
    v_exp_f32 v66, v50
    v_cmp_le_i32_e64 s[44:45], 18, v24
    v_cndmask_b32_e64 v51, v25, v51, s[46:47]
    v_exp_f32 v67, v51
    s_waitcnt lgkmcnt(6)
    v_mfma_f32_32x32x16_bf16 v[160:175], a[228:231], v[84:87], v[160:175]
    v_cmp_le_i32_e64 s[46:47], 19, v24
    v_cndmask_b32_e64 v52, v25, v52, s[40:41]
    v_exp_f32 v68, v52
    v_add_f32 v22, v64, v65
    v_cvt_pk_bf16_f32 v88, v64, v65
    v_cmp_le_i32_e64 s[40:41], 8, v24
    v_cndmask_b32_e64 v53, v25, v53, s[42:43]
    v_exp_f32 v69, v53
    v_add_f32 v23, v66, v67
    v_cvt_pk_bf16_f32 v89, v66, v67
    s_waitcnt lgkmcnt(5)
    v_mfma_f32_32x32x16_bf16 v[176:191], a[232:235], v[80:83], v[176:191]
    v_cmp_le_i32_e64 s[42:43], 9, v24
    v_cndmask_b32_e64 v54, v25, v54, s[44:45]
    v_exp_f32 v70, v54
    v_add_f32 v22, v22, v68
    v_add_f32 v23, v23, v69
    v_cmp_le_i32_e64 s[44:45], 10, v24
    v_cndmask_b32_e64 v55, v25, v55, s[46:47]
    v_exp_f32 v71, v55
    v_cvt_pk_bf16_f32 v90, v68, v69
    s_waitcnt lgkmcnt(4)
    v_mfma_f32_32x32x16_bf16 v[176:191], a[236:239], v[84:87], v[176:191]
    v_cmp_le_i32_e64 s[46:47], 11, v24
    v_cndmask_b32_e64 v56, v25, v56, s[40:41]
    v_exp_f32 v72, v56
    v_add_f32 v22, v22, v70
    v_add_f32 v23, v23, v71
    v_cmp_le_i32_e64 s[40:41], 24, v24
    v_cndmask_b32_e64 v57, v25, v57, s[42:43]
    v_exp_f32 v73, v57
    v_cvt_pk_bf16_f32 v91, v70, v71
    s_waitcnt lgkmcnt(3)
    v_mfma_f32_32x32x16_bf16 v[192:207], a[240:243], v[80:83], v[192:207]
    v_cmp_le_i32_e64 s[42:43], 25, v24
    v_cndmask_b32_e64 v58, v25, v58, s[44:45]
    v_exp_f32 v74, v58
    v_add_f32 v22, v22, v72
    v_add_f32 v23, v23, v73
    v_cmp_le_i32_e64 s[44:45], 26, v24
    v_cndmask_b32_e64 v59, v25, v59, s[46:47]
    v_exp_f32 v75, v59
    v_cvt_pk_bf16_f32 v92, v72, v73
    s_waitcnt lgkmcnt(2)
    v_mfma_f32_32x32x16_bf16 v[192:207], a[244:247], v[84:87], v[192:207]
    v_cmp_le_i32_e64 s[46:47], 27, v24
    v_cndmask_b32_e64 v60, v25, v60, s[40:41]
    v_exp_f32 v76, v60
    v_add_f32 v22, v22, v74
    v_add_f32 v23, v23, v75
    v_cndmask_b32_e64 v61, v25, v61, s[42:43]
    v_exp_f32 v77, v61
    v_cvt_pk_bf16_f32 v93, v74, v75
    s_waitcnt lgkmcnt(1)
    v_mfma_f32_32x32x16_bf16 v[208:223], a[248:251], v[80:83], v[208:223]
    v_cndmask_b32_e64 v62, v25, v62, s[44:45]
    v_exp_f32 v78, v62
    v_add_f32 v22, v22, v76
    v_add_f32 v23, v23, v77
    v_cndmask_b32_e64 v63, v25, v63, s[46:47]
    v_exp_f32 v79, v63
    v_cvt_pk_bf16_f32 v94, v76, v77
    v_add_f32 v22, v22, v23
    s_waitcnt lgkmcnt(0)
    v_mfma_f32_32x32x16_bf16 v[208:223], a[252:255], v[84:87], v[208:223]
    v_add_f32 v23, v78, v79
    v_cvt_pk_bf16_f32 v95, v78, v79
    v_add_f32 v22, v22, v23
    v_cmp_gt_f32 vcc, v22, v20
    s_cbranch_vccnz L_attn_s12
L_attn_s12r:
    v_add_f32 v17, v17, v22
    s_lshr_b32 s24, s12, 1
    s_add_u32 s24, s24, 1
    s_lshl_b32 s24, s24, 15
    v_add_u32 v2, s24, v3
    v_and_b32 v2, 0x1ffff, v2
    v_xor_b32 v3, 0x4000, v2
    s_lshl_b32 s27, s12, 9
    s_add_u32 s27, s27, 0x8000
    s_xor_b32 s28, s27, 512
    v_lshrrev_b32 v243, 1, v1
    v_add_u32 v244, s28, v243
    v_add_u32 v243, s27, v243
    v_cmp_gt_f32 vcc, 0, v21
    v_sub_f32 v240, 0, v224
    v_mov_b32 v242, 0xff7fffff
    v_cndmask_b32 v240, v240, v242, vcc
    v_mov_b32 v241, v18
    v_mfma_f32_32x32x16_bf16 a[64:79], a[224:227], v[88:91], a[64:79]
    ds_write_b128 v2, v[160:163] offset:0
    ds_write_b128 v2, v[164:167] offset:1024
    ds_write_b128 v2, v[168:171] offset:2048
    v_mfma_f32_32x32x16_bf16 a[64:79], a[228:231], v[92:95], a[64:79]
    ds_write_b128 v2, v[172:175] offset:3072
    ds_write_b128 v2, v[176:179] offset:4096
    v_mfma_f32_32x32x16_bf16 a[80:95], a[232:235], v[88:91], a[80:95]
    ds_write_b128 v2, v[180:183] offset:5120
    ds_write_b128 v2, v[184:187] offset:6144
    v_mfma_f32_32x32x16_bf16 a[80:95], a[236:239], v[92:95], a[80:95]
    ds_write_b128 v2, v[188:191] offset:7168
    ds_write_b128 v2, v[192:195] offset:8192
    v_mfma_f32_32x32x16_bf16 a[96:111], a[240:243], v[88:91], a[96:111]
    ds_write_b128 v2, v[196:199] offset:9216
    ds_write_b128 v2, v[200:203] offset:10240
    v_mfma_f32_32x32x16_bf16 a[96:111], a[244:247], v[92:95], a[96:111]
    ds_write_b128 v2, v[204:207] offset:11264
    ds_write_b128 v2, v[208:211] offset:12288
    v_mfma_f32_32x32x16_bf16 a[112:127], a[248:251], v[88:91], a[112:127]
    ds_write_b128 v2, v[212:215] offset:13312
    ds_write_b128 v2, v[216:219] offset:14336
    v_mfma_f32_32x32x16_bf16 a[112:127], a[252:255], v[92:95], a[112:127]
    ds_write_b128 v2, v[220:223] offset:15360
    ds_write_b64 v243, v[240:241]
    s_waitcnt lgkmcnt(0)
    s_barrier
    ds_read_b64 v[240:241], v244
    ds_read_b128 v[160:163], v3 offset:0
    ds_read_b128 v[164:167], v3 offset:1024
    ds_read_b128 v[168:171], v3 offset:2048
    ds_read_b128 v[172:175], v3 offset:3072
    ds_read_b128 v[176:179], v3 offset:4096
    ds_read_b128 v[180:183], v3 offset:5120
    ds_read_b128 v[184:187], v3 offset:6144
    ds_read_b128 v[188:191], v3 offset:7168
    ds_read_b128 v[192:195], v3 offset:8192
    ds_read_b128 v[196:199], v3 offset:9216
    ds_read_b128 v[200:203], v3 offset:10240
    ds_read_b128 v[204:207], v3 offset:11264
    ds_read_b128 v[208:211], v3 offset:12288
    ds_read_b128 v[212:215], v3 offset:13312
    ds_read_b128 v[216:219], v3 offset:14336
    ds_read_b128 v[220:223], v3 offset:15360
    s_waitcnt vmcnt(0) lgkmcnt(0)
    v_sub_f32 v242, 0, v112
    v_max_f32 v243, v242, v240
    v_sub_f32 v242, v242, v243
    v_sub_f32 v240, v240, v243
    v_exp_f32 v242, v242
    v_exp_f32 v240, v240
    s_nop 0
    v_mul_f32 v244, v17, v242
    v_fmac_f32 v244, v241, v240
    v_mov_b32 v245, v244
    s_nop 1
    v_permlane32_swap_b32 v244, v245
    s_nop 1
    v_add_f32 v244, v244, v245
    v_rcp_f32 v244, v244
    s_nop 0
    v_mul_f32 v22, v242, v244
    v_mul_f32 v23, v240, v244
    v_accvgpr_read_b32 v32, a64
    v_accvgpr_read_b32 v33, a65
    v_accvgpr_read_b32 v34, a66
    v_accvgpr_read_b32 v35, a67
    v_accvgpr_read_b32 v36, a68
    v_accvgpr_read_b32 v37, a69
    v_accvgpr_read_b32 v38, a70
    v_accvgpr_read_b32 v39, a71
    v_pk_mul_f32 v[32:33], v[32:33], v[22:23] op_sel_hi:[1,0]
    v_pk_mul_f32 v[34:35], v[34:35], v[22:23] op_sel_hi:[1,0]
    v_pk_mul_f32 v[36:37], v[36:37], v[22:23] op_sel_hi:[1,0]
    v_pk_mul_f32 v[38:39], v[38:39], v[22:23] op_sel_hi:[1,0]
    v_pk_fma_f32 v[32:33], v[160:161], v[22:23], v[32:33] op_sel:[0,1,0] op_sel_hi:[1,1,1]
    v_pk_fma_f32 v[34:35], v[162:163], v[22:23], v[34:35] op_sel:[0,1,0] op_sel_hi:[1,1,1]
    v_pk_fma_f32 v[36:37], v[164:165], v[22:23], v[36:37] op_sel:[0,1,0] op_sel_hi:[1,1,1]
    v_pk_fma_f32 v[38:39], v[166:167], v[22:23], v[38:39] op_sel:[0,1,0] op_sel_hi:[1,1,1]
    v_cvt_pk_bf16_f32 v40, v32, v33
    v_cvt_pk_bf16_f32 v41, v34, v35
    v_cvt_pk_bf16_f32 v42, v36, v37
    v_cvt_pk_bf16_f32 v43, v38, v39
    buffer_store_dwordx4 v[40:43], v4, s[8:11], s51 offen offset:0 sc0 sc1
    v_accvgpr_read_b32 v44, a72
    v_accvgpr_read_b32 v45, a73
    v_accvgpr_read_b32 v46, a74
    v_accvgpr_read_b32 v47, a75
    v_accvgpr_read_b32 v48, a76
    v_accvgpr_read_b32 v49, a77
    v_accvgpr_read_b32 v50, a78
    v_accvgpr_read_b32 v51, a79
    v_pk_mul_f32 v[44:45], v[44:45], v[22:23] op_sel_hi:[1,0]
    v_pk_mul_f32 v[46:47], v[46:47], v[22:23] op_sel_hi:[1,0]
    v_pk_mul_f32 v[48:49], v[48:49], v[22:23] op_sel_hi:[1,0]
    v_pk_mul_f32 v[50:51], v[50:51], v[22:23] op_sel_hi:[1,0]
    v_pk_fma_f32 v[44:45], v[168:169], v[22:23], v[44:45] op_sel:[0,1,0] op_sel_hi:[1,1,1]
    v_pk_fma_f32 v[46:47], v[170:171], v[22:23], v[46:47] op_sel:[0,1,0] op_sel_hi:[1,1,1]
    v_pk_fma_f32 v[48:49], v[172:173], v[22:23], v[48:49] op_sel:[0,1,0] op_sel_hi:[1,1,1]
    v_pk_fma_f32 v[50:51], v[174:175], v[22:23], v[50:51] op_sel:[0,1,0] op_sel_hi:[1,1,1]
    v_cvt_pk_bf16_f32 v52, v44, v45
    v_cvt_pk_bf16_f32 v53, v46, v47
    v_cvt_pk_bf16_f32 v54, v48, v49
    v_cvt_pk_bf16_f32 v55, v50, v51
    buffer_store_dwordx4 v[52:55], v4, s[8:11], s51 offen offset:512 sc0 sc1
    v_accvgpr_read_b32 v56, a80
    v_accvgpr_read_b32 v57, a81
    v_accvgpr_read_b32 v58, a82
    v_accvgpr_read_b32 v59, a83
    v_accvgpr_read_b32 v60, a84
    v_accvgpr_read_b32 v61, a85
    v_accvgpr_read_b32 v62, a86
    v_accvgpr_read_b32 v63, a87
    v_pk_mul_f32 v[56:57], v[56:57], v[22:23] op_sel_hi:[1,0]
    v_pk_mul_f32 v[58:59], v[58:59], v[22:23] op_sel_hi:[1,0]
    v_pk_mul_f32 v[60:61], v[60:61], v[22:23] op_sel_hi:[1,0]
    v_pk_mul_f32 v[62:63], v[62:63], v[22:23] op_sel_hi:[1,0]
    v_pk_fma_f32 v[56:57], v[176:177], v[22:23], v[56:57] op_sel:[0,1,0] op_sel_hi:[1,1,1]
    v_pk_fma_f32 v[58:59], v[178:179], v[22:23], v[58:59] op_sel:[0,1,0] op_sel_hi:[1,1,1]
    v_pk_fma_f32 v[60:61], v[180:181], v[22:23], v[60:61] op_sel:[0,1,0] op_sel_hi:[1,1,1]
    v_pk_fma_f32 v[62:63], v[182:183], v[22:23], v[62:63] op_sel:[0,1,0] op_sel_hi:[1,1,1]
    v_cvt_pk_bf16_f32 v64, v56, v57
    v_cvt_pk_bf16_f32 v65, v58, v59
    v_cvt_pk_bf16_f32 v66, v60, v61
    v_cvt_pk_bf16_f32 v67, v62, v63
    buffer_store_dwordx4 v[64:67], v4, s[8:11], s51 offen offset:1024 sc0 sc1
    v_accvgpr_read_b32 v68, a88
    v_accvgpr_read_b32 v69, a89
    v_accvgpr_read_b32 v70, a90
    v_accvgpr_read_b32 v71, a91
    v_accvgpr_read_b32 v72, a92
    v_accvgpr_read_b32 v73, a93
    v_accvgpr_read_b32 v74, a94
    v_accvgpr_read_b32 v75, a95
    v_pk_mul_f32 v[68:69], v[68:69], v[22:23] op_sel_hi:[1,0]
    v_pk_mul_f32 v[70:71], v[70:71], v[22:23] op_sel_hi:[1,0]
    v_pk_mul_f32 v[72:73], v[72:73], v[22:23] op_sel_hi:[1,0]
    v_pk_mul_f32 v[74:75], v[74:75], v[22:23] op_sel_hi:[1,0]
    v_pk_fma_f32 v[68:69], v[184:185], v[22:23], v[68:69] op_sel:[0,1,0] op_sel_hi:[1,1,1]
    v_pk_fma_f32 v[70:71], v[186:187], v[22:23], v[70:71] op_sel:[0,1,0] op_sel_hi:[1,1,1]
    v_pk_fma_f32 v[72:73], v[188:189], v[22:23], v[72:73] op_sel:[0,1,0] op_sel_hi:[1,1,1]
    v_pk_fma_f32 v[74:75], v[190:191], v[22:23], v[74:75] op_sel:[0,1,0] op_sel_hi:[1,1,1]
    v_cvt_pk_bf16_f32 v76, v68, v69
    v_cvt_pk_bf16_f32 v77, v70, v71
    v_cvt_pk_bf16_f32 v78, v72, v73
    v_cvt_pk_bf16_f32 v79, v74, v75
    buffer_store_dwordx4 v[76:79], v4, s[8:11], s51 offen offset:1536 sc0 sc1
    v_accvgpr_read_b32 v32, a96
    v_accvgpr_read_b32 v33, a97
    v_accvgpr_read_b32 v34, a98
    v_accvgpr_read_b32 v35, a99
    v_accvgpr_read_b32 v36, a100
    v_accvgpr_read_b32 v37, a101
    v_accvgpr_read_b32 v38, a102
    v_accvgpr_read_b32 v39, a103
    v_pk_mul_f32 v[32:33], v[32:33], v[22:23] op_sel_hi:[1,0]
    v_pk_mul_f32 v[34:35], v[34:35], v[22:23] op_sel_hi:[1,0]
    v_pk_mul_f32 v[36:37], v[36:37], v[22:23] op_sel_hi:[1,0]
    v_pk_mul_f32 v[38:39], v[38:39], v[22:23] op_sel_hi:[1,0]
    v_pk_fma_f32 v[32:33], v[192:193], v[22:23], v[32:33] op_sel:[0,1,0] op_sel_hi:[1,1,1]
    v_pk_fma_f32 v[34:35], v[194:195], v[22:23], v[34:35] op_sel:[0,1,0] op_sel_hi:[1,1,1]
    v_pk_fma_f32 v[36:37], v[196:197], v[22:23], v[36:37] op_sel:[0,1,0] op_sel_hi:[1,1,1]
    v_pk_fma_f32 v[38:39], v[198:199], v[22:23], v[38:39] op_sel:[0,1,0] op_sel_hi:[1,1,1]
    v_cvt_pk_bf16_f32 v40, v32, v33
    v_cvt_pk_bf16_f32 v41, v34, v35
    v_cvt_pk_bf16_f32 v42, v36, v37
    v_cvt_pk_bf16_f32 v43, v38, v39
    buffer_store_dwordx4 v[40:43], v4, s[8:11], s51 offen offset:2048 sc0 sc1
    v_accvgpr_read_b32 v44, a104
    v_accvgpr_read_b32 v45, a105
    v_accvgpr_read_b32 v46, a106
    v_accvgpr_read_b32 v47, a107
    v_accvgpr_read_b32 v48, a108
    v_accvgpr_read_b32 v49, a109
    v_accvgpr_read_b32 v50, a110
    v_accvgpr_read_b32 v51, a111
    v_pk_mul_f32 v[44:45], v[44:45], v[22:23] op_sel_hi:[1,0]
    v_pk_mul_f32 v[46:47], v[46:47], v[22:23] op_sel_hi:[1,0]
    v_pk_mul_f32 v[48:49], v[48:49], v[22:23] op_sel_hi:[1,0]
    v_pk_mul_f32 v[50:51], v[50:51], v[22:23] op_sel_hi:[1,0]
    v_pk_fma_f32 v[44:45], v[200:201], v[22:23], v[44:45] op_sel:[0,1,0] op_sel_hi:[1,1,1]
    v_pk_fma_f32 v[46:47], v[202:203], v[22:23], v[46:47] op_sel:[0,1,0] op_sel_hi:[1,1,1]
    v_pk_fma_f32 v[48:49], v[204:205], v[22:23], v[48:49] op_sel:[0,1,0] op_sel_hi:[1,1,1]
    v_pk_fma_f32 v[50:51], v[206:207], v[22:23], v[50:51] op_sel:[0,1,0] op_sel_hi:[1,1,1]
    v_cvt_pk_bf16_f32 v52, v44, v45
    v_cvt_pk_bf16_f32 v53, v46, v47
    v_cvt_pk_bf16_f32 v54, v48, v49
    v_cvt_pk_bf16_f32 v55, v50, v51
    buffer_store_dwordx4 v[52:55], v4, s[8:11], s51 offen offset:2560 sc0 sc1
    v_accvgpr_read_b32 v56, a112
    v_accvgpr_read_b32 v57, a113
    v_accvgpr_read_b32 v58, a114
    v_accvgpr_read_b32 v59, a115
    v_accvgpr_read_b32 v60, a116
    v_accvgpr_read_b32 v61, a117
    v_accvgpr_read_b32 v62, a118
    v_accvgpr_read_b32 v63, a119
    v_pk_mul_f32 v[56:57], v[56:57], v[22:23] op_sel_hi:[1,0]
    v_pk_mul_f32 v[58:59], v[58:59], v[22:23] op_sel_hi:[1,0]
    v_pk_mul_f32 v[60:61], v[60:61], v[22:23] op_sel_hi:[1,0]
    v_pk_mul_f32 v[62:63], v[62:63], v[22:23] op_sel_hi:[1,0]
    v_pk_fma_f32 v[56:57], v[208:209], v[22:23], v[56:57] op_sel:[0,1,0] op_sel_hi:[1,1,1]
    v_pk_fma_f32 v[58:59], v[210:211], v[22:23], v[58:59] op_sel:[0,1,0] op_sel_hi:[1,1,1]
    v_pk_fma_f32 v[60:61], v[212:213], v[22:23], v[60:61] op_sel:[0,1,0] op_sel_hi:[1,1,1]
    v_pk_fma_f32 v[62:63], v[214:215], v[22:23], v[62:63] op_sel:[0,1,0] op_sel_hi:[1,1,1]
    v_cvt_pk_bf16_f32 v64, v56, v57
    v_cvt_pk_bf16_f32 v65, v58, v59
    v_cvt_pk_bf16_f32 v66, v60, v61
    v_cvt_pk_bf16_f32 v67, v62, v63
    buffer_store_dwordx4 v[64:67], v4, s[8:11], s51 offen offset:3072 sc0 sc1
    v_accvgpr_read_b32 v68, a120
    v_accvgpr_read_b32 v69, a121
    v_accvgpr_read_b32 v70, a122
    v_accvgpr_read_b32 v71, a123
    v_accvgpr_read_b32 v72, a124
    v_accvgpr_read_b32 v73, a125
    v_accvgpr_read_b32 v74, a126
    v_accvgpr_read_b32 v75, a127
    v_pk_mul_f32 v[68:69], v[68:69], v[22:23] op_sel_hi:[1,0]
    v_pk_mul_f32 v[70:71], v[70:71], v[22:23] op_sel_hi:[1,0]
    v_pk_mul_f32 v[72:73], v[72:73], v[22:23] op_sel_hi:[1,0]
    v_pk_mul_f32 v[74:75], v[74:75], v[22:23] op_sel_hi:[1,0]
    v_pk_fma_f32 v[68:69], v[216:217], v[22:23], v[68:69] op_sel:[0,1,0] op_sel_hi:[1,1,1]
    v_pk_fma_f32 v[70:71], v[218:219], v[22:23], v[70:71] op_sel:[0,1,0] op_sel_hi:[1,1,1]
    v_pk_fma_f32 v[72:73], v[220:221], v[22:23], v[72:73] op_sel:[0,1,0] op_sel_hi:[1,1,1]
    v_pk_fma_f32 v[74:75], v[222:223], v[22:23], v[74:75] op_sel:[0,1,0] op_sel_hi:[1,1,1]
    v_cvt_pk_bf16_f32 v76, v68, v69
    v_cvt_pk_bf16_f32 v77, v70, v71
    v_cvt_pk_bf16_f32 v78, v72, v73
    v_cvt_pk_bf16_f32 v79, v74, v75
    buffer_store_dwordx4 v[76:79], v4, s[8:11], s51 offen offset:3584 sc0 sc1
    s_load_dwordx2 s[56:57], s[0:1], 0
    s_load_dwordx2 s[58:59], s[0:1], 80
    s_barrier
    s_add_u32 m0, s73, 49152
    s_add_u32 s74, s74, 65536
    buffer_load_dwordx4 v6, s[76:79], s74 offen lds
    buffer_load_dwordx4 v5, s[76:79], s74 offen offset:1024 lds
    buffer_load_dwordx4 v13, s[76:79], s74 offen offset:2048 lds
    buffer_load_dwordx4 v31, s[76:79], s74 offen offset:3072 lds
    s_add_u32 m0, s73, 32768
    s_add_u32 s75, s75, 2048
    buffer_load_dwordx4 v8, s[8:11], s75 offen sc1 lds
    buffer_load_dwordx4 v8, s[8:11], s75 offen offset:1024 sc1 lds
    s_add_u32 m0, s73, 34816
    s_nop 0
    buffer_load_dwordx4 v9, s[8:11], s75 offen sc1 lds
    buffer_load_dwordx4 v9, s[8:11], s75 offen offset:1024 sc1 lds
    s_add_u32 m0, s73, 81920
    s_add_u32 s74, s74, 65536
    buffer_load_dwordx4 v6, s[76:79], s74 offen lds
    buffer_load_dwordx4 v5, s[76:79], s74 offen offset:1024 lds
    buffer_load_dwordx4 v13, s[76:79], s74 offen offset:2048 lds
    buffer_load_dwordx4 v31, s[76:79], s74 offen offset:3072 lds
    s_add_u32 m0, s73, 65536
    s_add_u32 s75, s75, 2048
    buffer_load_dwordx4 v8, s[8:11], s75 offen sc1 lds
    buffer_load_dwordx4 v8, s[8:11], s75 offen offset:1024 sc1 lds
    s_add_u32 m0, s73, 67584
    s_nop 0
    buffer_load_dwordx4 v9, s[8:11], s75 offen sc1 lds
    buffer_load_dwordx4 v9, s[8:11], s75 offen offset:1024 sc1 lds
    v_and_b32 v16, 15, v0
    v_lshrrev_b32 v17, 4, v0
    v_lshlrev_b32 v228, 10, v16
    v_lshl_add_u32 v228, v17, 3, v228
    v_and_b32 v16, 7, v0
    v_lshrrev_b32 v17, 2, v16
    v_and_b32 v16, 3, v16
    v_lshl_add_u32 v16, v16, 3, v17
    v_lshlrev_b32 v229, 7, v16
    v_mov_b32 v20, 1
    v_mov_b32 v21, 0
    s_lshl_b32 s3, s2, 7
    s_lshl_b32 s4, s89, 2
    s_add_u32 s3, s3, s4
    s_add_u32 s3, s3, 79233024
    s_waitcnt lgkmcnt(0)
    s_mov_b32 s44, s56
    s_and_b32 s45, s57, 0xffff
    s_mov_b32 s46, 0x200000
    s_mov_b32 s47, 0x00020000
    s_mov_b32 s40, s58
    s_and_b32 s41, s59, 0xffff
    s_mov_b32 s42, 0x200000
    s_mov_b32 s43, 0x00020000
    s_mov_b32 s92, s60
    s_and_b32 s93, s61, 0xffff
    s_mov_b32 s94, 0x400000
    s_mov_b32 s95, 0x00020000
    v_lshrrev_b32 v16, 5, v0
    v_bfe_u32 v17, v0, 2, 3
    v_and_b32 v18, 3, v0
    v_lshlrev_b32 v19, 10, v16
    v_lshl_add_u32 v19, v17, 7, v19
    v_lshl_add_u32 v19, v18, 3, v19
    v_lshrrev_b32 v18, 1, v17
    v_lshl_add_u32 v19, v18, 5, v19
    s_and_b32 s5, s89, 1
    s_lshl_b32 s5, s5, 12
    s_add_u32 s5, s5, 16384
    v_add_u32 v19, s5, v19
    v_xor_b32 v96, 0, v19
    v_xor_b32 v97, 32, v19
    v_xor_b32 v98, 64, v19
    v_xor_b32 v99, 96, v19
    v_add_u32 v100, 65536, v96
    v_add_u32 v101, 65536, v97
    v_add_u32 v102, 65536, v98
    v_add_u32 v103, 65536, v99
    v_add_u32 v104, 131072, v96
    v_add_u32 v105, 131072, v97
    v_add_u32 v106, 131072, v98
    v_add_u32 v107, 131072, v99
    v_add_u32 v108, 65536, v10
    v_add_u32 v109, 131072, v10
    ds_read_b64_tr_b16 v[48:49], v104 offset:0
    ds_read_b64_tr_b16 v[50:51], v104 offset:2048
    ds_read_b128 v[32:35], v109 offset:0
    ds_read_b64_tr_b16 v[52:53], v105 offset:0
    ds_read_b64_tr_b16 v[54:55], v105 offset:2048
    ds_read_b128 v[36:39], v109 offset:2048
    ds_read_b64_tr_b16 v[56:57], v106 offset:0
    ds_read_b64_tr_b16 v[58:59], v106 offset:2048
    ds_read_b128 v[40:43], v109 offset:4096
    ds_read_b64_tr_b16 v[60:61], v107 offset:0
    ds_read_b64_tr_b16 v[62:63], v107 offset:2048
    ds_read_b128 v[44:47], v109 offset:6144
    s_waitcnt vmcnt(16)
    s_mov_b64 exec, 1
    buffer_store_dword v20, v21, s[8:11], s3 offen sc0 sc1
    s_mov_b64 exec, -1
    s_waitcnt lgkmcnt(0)
    s_barrier
    v_mfma_f32_16x16x32_bf16 v[144:147], v[48:51], v[32:35], 0
    ds_read_b64_tr_b16 v[80:81], v104 offset:8192
    ds_read_b64_tr_b16 v[82:83], v104 offset:10240
    v_mfma_f32_16x16x32_bf16 v[148:151], v[48:51], v[36:39], 0
    ds_read_b128 v[64:67], v109 offset:1024
    s_cmp_eq_u32 s87, 3
    s_cselect_b32 s75, 0x7ff00000, s75
    s_cselect_b32 s74, 0x7ff00000, s74
    v_mfma_f32_16x16x32_bf16 v[152:155], v[48:51], v[40:43], 0
    ds_read_b64_tr_b16 v[84:85], v105 offset:8192
    v_mfma_f32_16x16x32_bf16 v[156:159], v[48:51], v[44:47], 0
    ds_read_b64_tr_b16 v[86:87], v105 offset:10240
    v_mfma_f32_16x16x32_bf16 v[160:163], v[52:55], v[32:35], 0
    ds_read_b128 v[68:71], v109 offset:3072
    v_mfma_f32_16x16x32_bf16 v[164:167], v[52:55], v[36:39], 0
    ds_read_b64_tr_b16 v[88:89], v106 offset:8192
    ds_read_b64_tr_b16 v[90:91], v106 offset:10240
    v_mfma_f32_16x16x32_bf16 v[168:171], v[52:55], v[40:43], 0
    ds_read_b128 v[72:75], v109 offset:5120
    s_add_u32 m0, s73, 114688
    s_add_u32 s74, s74, 65536
    buffer_load_dwordx4 v6, s[76:79], s74 offen lds
    v_mfma_f32_16x16x32_bf16 v[172:175], v[52:55], v[44:47], 0
    ds_read_b64_tr_b16 v[92:93], v107 offset:8192
    v_mfma_f32_16x16x32_bf16 v[176:179], v[56:59], v[32:35], 0
    ds_read_b64_tr_b16 v[94:95], v107 offset:10240
    v_mfma_f32_16x16x32_bf16 v[180:183], v[56:59], v[36:39], 0
    ds_read_b128 v[76:79], v109 offset:7168
    v_mfma_f32_16x16x32_bf16 v[184:187], v[56:59], v[40:43], 0
    v_mfma_f32_16x16x32_bf16 v[188:191], v[56:59], v[44:47], 0
    v_mfma_f32_16x16x32_bf16 v[192:195], v[60:63], v[32:35], 0
    buffer_load_dwordx4 v5, s[76:79], s74 offen offset:1024 lds
    v_mfma_f32_16x16x32_bf16 v[196:199], v[60:63], v[36:39], 0
    v_mfma_f32_16x16x32_bf16 v[200:203], v[60:63], v[40:43], 0
    buffer_load_dwordx4 v13, s[76:79], s74 offen offset:2048 lds
    v_mfma_f32_16x16x32_bf16 v[204:207], v[60:63], v[44:47], 0
    s_waitcnt lgkmcnt(0)
    v_mfma_f32_16x16x32_bf16 v[144:147], v[80:83], v[64:67], v[144:147]
    ds_read_b64_tr_b16 v[48:49], v96 offset:0
    ds_read_b64_tr_b16 v[50:51], v96 offset:2048
    v_mfma_f32_16x16x32_bf16 v[148:151], v[80:83], v[68:71], v[148:151]
    ds_read_b128 v[32:35], v10 offset:0
    buffer_load_dwordx4 v31, s[76:79], s74 offen offset:3072 lds
    v_mfma_f32_16x16x32_bf16 v[152:155], v[80:83], v[72:75], v[152:155]
    ds_read_b64_tr_b16 v[52:53], v97 offset:0
    s_add_u32 m0, s73, 98304
    s_add_u32 s75, s75, 2048
    buffer_load_dwordx4 v8, s[8:11], s75 offen sc1 lds
    v_mfma_f32_16x16x32_bf16 v[156:159], v[80:83], v[76:79], v[156:159]
    ds_read_b64_tr_b16 v[54:55], v97 offset:2048
    v_mfma_f32_16x16x32_bf16 v[160:163], v[84:87], v[64:67], v[160:163]
    ds_read_b128 v[36:39], v10 offset:2048
    v_mfma_f32_16x16x32_bf16 v[164:167], v[84:87], v[68:71], v[164:167]
    ds_read_b64_tr_b16 v[56:57], v98 offset:0
    ds_read_b64_tr_b16 v[58:59], v98 offset:2048
    v_mfma_f32_16x16x32_bf16 v[168:171], v[84:87], v[72:75], v[168:171]
    ds_read_b128 v[40:43], v10 offset:4096
    v_mfma_f32_16x16x32_bf16 v[172:175], v[84:87], v[76:79], v[172:175]
    ds_read_b64_tr_b16 v[60:61], v99 offset:0
    buffer_load_dwordx4 v8, s[8:11], s75 offen offset:1024 sc1 lds
    v_mfma_f32_16x16x32_bf16 v[176:179], v[88:91], v[64:67], v[176:179]
    ds_read_b64_tr_b16 v[62:63], v99 offset:2048
    v_mfma_f32_16x16x32_bf16 v[180:183], v[88:91], v[68:71], v[180:183]
    ds_read_b128 v[44:47], v10 offset:6144
    s_add_u32 m0, s73, 100352
    s_nop 0
    buffer_load_dwordx4 v9, s[8:11], s75 offen sc1 lds
    v_mfma_f32_16x16x32_bf16 v[184:187], v[88:91], v[72:75], v[184:187]
    v_mfma_f32_16x16x32_bf16 v[188:191], v[88:91], v[76:79], v[188:191]
    v_mfma_f32_16x16x32_bf16 v[192:195], v[92:95], v[64:67], v[192:195]
    v_mfma_f32_16x16x32_bf16 v[196:199], v[92:95], v[68:71], v[196:199]
    v_mfma_f32_16x16x32_bf16 v[200:203], v[92:95], v[72:75], v[200:203]
    buffer_load_dwordx4 v9, s[8:11], s75 offen offset:1024 sc1 lds
    v_mfma_f32_16x16x32_bf16 v[204:207], v[92:95], v[76:79], v[204:207]
    s_waitcnt vmcnt(17)
    s_waitcnt lgkmcnt(0)
    s_barrier
    v_mfma_f32_16x16x32_bf16 v[144:147], v[48:51], v[32:35], v[144:147]
    ds_read_b64_tr_b16 v[80:81], v96 offset:8192
    ds_read_b64_tr_b16 v[82:83], v96 offset:10240
    v_mfma_f32_16x16x32_bf16 v[148:151], v[48:51], v[36:39], v[148:151]
    ds_read_b128 v[64:67], v10 offset:1024
    s_add_u32 m0, s73, 147456
    s_add_u32 s74, s74, 65536
    buffer_load_dwordx4 v6, s[76:79], s74 offen lds
    v_mfma_f32_16x16x32_bf16 v[152:155], v[48:51], v[40:43], v[152:155]
    ds_read_b64_tr_b16 v[84:85], v97 offset:8192
    v_mfma_f32_16x16x32_bf16 v[156:159], v[48:51], v[44:47], v[156:159]
    ds_read_b64_tr_b16 v[86:87], v97 offset:10240
    v_mfma_f32_16x16x32_bf16 v[160:163], v[52:55], v[32:35], v[160:163]
    ds_read_b128 v[68:71], v10 offset:3072
    v_mfma_f32_16x16x32_bf16 v[164:167], v[52:55], v[36:39], v[164:167]
    ds_read_b64_tr_b16 v[88:89], v98 offset:8192
    ds_read_b64_tr_b16 v[90:91], v98 offset:10240
    buffer_load_dwordx4 v5, s[76:79], s74 offen offset:1024 lds
    v_mfma_f32_16x16x32_bf16 v[168:171], v[52:55], v[40:43], v[168:171]
    ds_read_b128 v[72:75], v10 offset:5120
    v_mfma_f32_16x16x32_bf16 v[172:175], v[52:55], v[44:47], v[172:175]
    ds_read_b64_tr_b16 v[92:93], v99 offset:8192
    buffer_load_dwordx4 v13, s[76:79], s74 offen offset:2048 lds
    v_mfma_f32_16x16x32_bf16 v[176:179], v[56:59], v[32:35], v[176:179]
    ds_read_b64_tr_b16 v[94:95], v99 offset:10240
    buffer_load_dwordx4 v31, s[76:79], s74 offen offset:3072 lds
    v_mfma_f32_16x16x32_bf16 v[180:183], v[56:59], v[36:39], v[180:183]
    ds_read_b128 v[76:79], v10 offset:7168
    v_mfma_f32_16x16x32_bf16 v[184:187], v[56:59], v[40:43], v[184:187]
    s_add_u32 m0, s73, 131072
    s_add_u32 s75, s75, 2048
    buffer_load_dwordx4 v8, s[8:11], s75 offen sc1 lds
    v_mfma_f32_16x16x32_bf16 v[188:191], v[56:59], v[44:47], v[188:191]
    v_mfma_f32_16x16x32_bf16 v[192:195], v[60:63], v[32:35], v[192:195]
    v_mfma_f32_16x16x32_bf16 v[196:199], v[60:63], v[36:39], v[196:199]
    v_mfma_f32_16x16x32_bf16 v[200:203], v[60:63], v[40:43], v[200:203]
    buffer_load_dwordx4 v8, s[8:11], s75 offen offset:1024 sc1 lds
    v_mfma_f32_16x16x32_bf16 v[204:207], v[60:63], v[44:47], v[204:207]
    s_waitcnt lgkmcnt(0)
    v_mfma_f32_16x16x32_bf16 v[144:147], v[80:83], v[64:67], v[144:147]
    ds_read_b64_tr_b16 v[48:49], v96 offset:32768
    ds_read_b64_tr_b16 v[50:51], v96 offset:34816
    v_mfma_f32_16x16x32_bf16 v[148:151], v[80:83], v[68:71], v[148:151]
    ds_read_b128 v[32:35], v10 offset:32768
    s_add_u32 m0, s73, 133120
    s_nop 0
    buffer_load_dwordx4 v9, s[8:11], s75 offen sc1 lds
    v_mfma_f32_16x16x32_bf16 v[152:155], v[80:83], v[72:75], v[152:155]
    ds_read_b64_tr_b16 v[52:53], v97 offset:32768
    v_mfma_f32_16x16x32_bf16 v[156:159], v[80:83], v[76:79], v[156:159]
    ds_read_b64_tr_b16 v[54:55], v97 offset:34816
    v_mfma_f32_16x16x32_bf16 v[160:163], v[84:87], v[64:67], v[160:163]
    ds_read_b128 v[36:39], v10 offset:34816
    v_mfma_f32_16x16x32_bf16 v[164:167], v[84:87], v[68:71], v[164:167]
    ds_read_b64_tr_b16 v[56:57], v98 offset:32768
    ds_read_b64_tr_b16 v[58:59], v98 offset:34816
    v_mfma_f32_16x16x32_bf16 v[168:171], v[84:87], v[72:75], v[168:171]
    ds_read_b128 v[40:43], v10 offset:36864
    buffer_load_dwordx4 v9, s[8:11], s75 offen offset:1024 sc1 lds
    v_mfma_f32_16x16x32_bf16 v[172:175], v[84:87], v[76:79], v[172:175]
    ds_read_b64_tr_b16 v[60:61], v99 offset:32768
    v_mfma_f32_16x16x32_bf16 v[176:179], v[88:91], v[64:67], v[176:179]
    ds_read_b64_tr_b16 v[62:63], v99 offset:34816
    buffer_load_dwordx2 v[232:233], v228, s[44:47], s82 offen offset:0
    v_mfma_f32_16x16x32_bf16 v[180:183], v[88:91], v[68:71], v[180:183]
    ds_read_b128 v[44:47], v10 offset:38912
    v_mfma_f32_16x16x32_bf16 v[184:187], v[88:91], v[72:75], v[184:187]
    buffer_load_dwordx2 v[234:235], v228, s[44:47], s82 offen offset:32
    v_mfma_f32_16x16x32_bf16 v[188:191], v[88:91], v[76:79], v[188:191]
    v_mfma_f32_16x16x32_bf16 v[192:195], v[92:95], v[64:67], v[192:195]
    buffer_load_dwordx2 v[236:237], v228, s[44:47], s82 offen offset:64
    v_mfma_f32_16x16x32_bf16 v[196:199], v[92:95], v[68:71], v[196:199]
    v_mfma_f32_16x16x32_bf16 v[200:203], v[92:95], v[72:75], v[200:203]
    buffer_load_dwordx2 v[238:239], v228, s[44:47], s82 offen offset:96
    v_mfma_f32_16x16x32_bf16 v[204:207], v[92:95], v[76:79], v[204:207]
    s_waitcnt vmcnt(21)
    s_waitcnt lgkmcnt(0)
    s_barrier
    v_mfma_f32_16x16x32_bf16 v[144:147], v[48:51], v[32:35], v[144:147]
    ds_read_b64_tr_b16 v[80:81], v96 offset:40960
    ds_read_b64_tr_b16 v[82:83], v96 offset:43008
    v_mfma_f32_16x16x32_bf16 v[148:151], v[48:51], v[36:39], v[148:151]
    ds_read_b128 v[64:67], v10 offset:33792
    s_mov_b32 s74, s80
    s_mov_b32 s75, s81
    v_mfma_f32_16x16x32_bf16 v[152:155], v[48:51], v[40:43], v[152:155]
    ds_read_b64_tr_b16 v[84:85], v97 offset:40960
    v_mfma_f32_16x16x32_bf16 v[156:159], v[48:51], v[44:47], v[156:159]
    ds_read_b64_tr_b16 v[86:87], v97 offset:43008
    v_mfma_f32_16x16x32_bf16 v[160:163], v[52:55], v[32:35], v[160:163]
    ds_read_b128 v[68:71], v10 offset:35840
    v_mfma_f32_16x16x32_bf16 v[164:167], v[52:55], v[36:39], v[164:167]
    ds_read_b64_tr_b16 v[88:89], v98 offset:40960
    ds_read_b64_tr_b16 v[90:91], v98 offset:43008
    v_mfma_f32_16x16x32_bf16 v[168:171], v[52:55], v[40:43], v[168:171]
    ds_read_b128 v[72:75], v10 offset:37888
    v_mfma_f32_16x16x32_bf16 v[172:175], v[52:55], v[44:47], v[172:175]
    ds_read_b64_tr_b16 v[92:93], v99 offset:40960
    s_add_u32 m0, s73, 16384
    s_add_u32 s74, s74, 65536
    buffer_load_dwordx4 v6, s[92:95], s74 offen lds
    v_mfma_f32_16x16x32_bf16 v[176:179], v[56:59], v[32:35], v[176:179]
    ds_read_b64_tr_b16 v[94:95], v99 offset:43008
    v_mfma_f32_16x16x32_bf16 v[180:183], v[56:59], v[36:39], v[180:183]
    ds_read_b128 v[76:79], v10 offset:39936
    v_mfma_f32_16x16x32_bf16 v[184:187], v[56:59], v[40:43], v[184:187]
    v_mfma_f32_16x16x32_bf16 v[188:191], v[56:59], v[44:47], v[188:191]
    v_mfma_f32_16x16x32_bf16 v[192:195], v[60:63], v[32:35], v[192:195]
    v_mfma_f32_16x16x32_bf16 v[196:199], v[60:63], v[36:39], v[196:199]
    v_mfma_f32_16x16x32_bf16 v[200:203], v[60:63], v[40:43], v[200:203]
    v_mfma_f32_16x16x32_bf16 v[204:207], v[60:63], v[44:47], v[204:207]
    s_waitcnt lgkmcnt(0)
    v_mfma_f32_16x16x32_bf16 v[144:147], v[80:83], v[64:67], v[144:147]
    ds_read_b64_tr_b16 v[48:49], v100 offset:0
    ds_read_b64_tr_b16 v[50:51], v100 offset:2048
    v_mfma_f32_16x16x32_bf16 v[148:151], v[80:83], v[68:71], v[148:151]
    ds_read_b128 v[32:35], v108 offset:0
    buffer_load_dwordx4 v12, s[92:95], s74 offen offset:1024 lds
    v_mfma_f32_16x16x32_bf16 v[152:155], v[80:83], v[72:75], v[152:155]
    ds_read_b64_tr_b16 v[52:53], v101 offset:0
    v_mfma_f32_16x16x32_bf16 v[156:159], v[80:83], v[76:79], v[156:159]
    ds_read_b64_tr_b16 v[54:55], v101 offset:2048
    v_mfma_f32_16x16x32_bf16 v[160:163], v[84:87], v[64:67], v[160:163]
    ds_read_b128 v[36:39], v108 offset:2048
    v_mfma_f32_16x16x32_bf16 v[164:167], v[84:87], v[68:71], v[164:167]
    ds_read_b64_tr_b16 v[56:57], v102 offset:0
    ds_read_b64_tr_b16 v[58:59], v102 offset:2048
    v_mfma_f32_16x16x32_bf16 v[168:171], v[84:87], v[72:75], v[168:171]
    ds_read_b128 v[40:43], v108 offset:4096
    buffer_load_dwordx4 v15, s[92:95], s74 offen offset:2048 lds
    v_mfma_f32_16x16x32_bf16 v[172:175], v[84:87], v[76:79], v[172:175]
    ds_read_b64_tr_b16 v[60:61], v103 offset:0
    v_mfma_f32_16x16x32_bf16 v[176:179], v[88:91], v[64:67], v[176:179]
    ds_read_b64_tr_b16 v[62:63], v103 offset:2048
    v_mfma_f32_16x16x32_bf16 v[180:183], v[88:91], v[68:71], v[180:183]
    ds_read_b128 v[44:47], v108 offset:6144
    v_mfma_f32_16x16x32_bf16 v[184:187], v[88:91], v[72:75], v[184:187]
    v_mfma_f32_16x16x32_bf16 v[188:191], v[88:91], v[76:79], v[188:191]
    buffer_load_dwordx4 v31, s[92:95], s74 offen offset:3072 lds
    v_mfma_f32_16x16x32_bf16 v[192:195], v[92:95], v[64:67], v[192:195]
    v_mfma_f32_16x16x32_bf16 v[196:199], v[92:95], v[68:71], v[196:199]
    v_mfma_f32_16x16x32_bf16 v[200:203], v[92:95], v[72:75], v[200:203]
    v_mfma_f32_16x16x32_bf16 v[204:207], v[92:95], v[76:79], v[204:207]
    s_waitcnt vmcnt(16)
    s_waitcnt lgkmcnt(0)
    s_barrier
    v_mfma_f32_16x16x32_bf16 v[144:147], v[48:51], v[32:35], v[144:147]
    ds_read_b64_tr_b16 v[80:81], v100 offset:8192
    ds_read_b64_tr_b16 v[82:83], v100 offset:10240
    v_mfma_f32_16x16x32_bf16 v[148:151], v[48:51], v[36:39], v[148:151]
    ds_read_b128 v[64:67], v108 offset:1024
    s_add_u32 m0, s73, 49152
    s_add_u32 s74, s74, 65536
    buffer_load_dwordx4 v6, s[92:95], s74 offen lds
    v_mfma_f32_16x16x32_bf16 v[152:155], v[48:51], v[40:43], v[152:155]
    ds_read_b64_tr_b16 v[84:85], v101 offset:8192
    v_mfma_f32_16x16x32_bf16 v[156:159], v[48:51], v[44:47], v[156:159]
    ds_read_b64_tr_b16 v[86:87], v101 offset:10240
    v_mfma_f32_16x16x32_bf16 v[160:163], v[52:55], v[32:35], v[160:163]
    ds_read_b128 v[68:71], v108 offset:3072
    v_mfma_f32_16x16x32_bf16 v[164:167], v[52:55], v[36:39], v[164:167]
    ds_read_b64_tr_b16 v[88:89], v102 offset:8192
    ds_read_b64_tr_b16 v[90:91], v102 offset:10240
    v_mfma_f32_16x16x32_bf16 v[168:171], v[52:55], v[40:43], v[168:171]
    ds_read_b128 v[72:75], v108 offset:5120
    v_mfma_f32_16x16x32_bf16 v[172:175], v[52:55], v[44:47], v[172:175]
    ds_read_b64_tr_b16 v[92:93], v103 offset:8192
    v_mfma_f32_16x16x32_bf16 v[176:179], v[56:59], v[32:35], v[176:179]
    ds_read_b64_tr_b16 v[94:95], v103 offset:10240
    v_mfma_f32_16x16x32_bf16 v[180:183], v[56:59], v[36:39], v[180:183]
    ds_read_b128 v[76:79], v108 offset:7168
    v_mfma_f32_16x16x32_bf16 v[184:187], v[56:59], v[40:43], v[184:187]
    v_mfma_f32_16x16x32_bf16 v[188:191], v[56:59], v[44:47], v[188:191]
    v_mfma_f32_16x16x32_bf16 v[192:195], v[60:63], v[32:35], v[192:195]
    buffer_load_dwordx4 v12, s[92:95], s74 offen offset:1024 lds
    v_mfma_f32_16x16x32_bf16 v[196:199], v[60:63], v[36:39], v[196:199]
    v_mfma_f32_16x16x32_bf16 v[200:203], v[60:63], v[40:43], v[200:203]
    v_mfma_f32_16x16x32_bf16 v[204:207], v[60:63], v[44:47], v[204:207]
    s_waitcnt lgkmcnt(0)
    v_mfma_f32_16x16x32_bf16 v[144:147], v[80:83], v[64:67], v[144:147]
    ds_read_b64_tr_b16 v[48:49], v100 offset:32768
    ds_read_b64_tr_b16 v[50:51], v100 offset:34816
    v_mfma_f32_16x16x32_bf16 v[148:151], v[80:83], v[68:71], v[148:151]
    ds_read_b128 v[32:35], v108 offset:32768
    buffer_load_dwordx4 v15, s[92:95], s74 offen offset:2048 lds
    v_mfma_f32_16x16x32_bf16 v[152:155], v[80:83], v[72:75], v[152:155]
    ds_read_b64_tr_b16 v[52:53], v101 offset:32768
    v_mfma_f32_16x16x32_bf16 v[156:159], v[80:83], v[76:79], v[156:159]
    ds_read_b64_tr_b16 v[54:55], v101 offset:34816
    v_mfma_f32_16x16x32_bf16 v[160:163], v[84:87], v[64:67], v[160:163]
    ds_read_b128 v[36:39], v108 offset:34816
    v_mfma_f32_16x16x32_bf16 v[164:167], v[84:87], v[68:71], v[164:167]
    ds_read_b64_tr_b16 v[56:57], v102 offset:32768
    ds_read_b64_tr_b16 v[58:59], v102 offset:34816
    v_mfma_f32_16x16x32_bf16 v[168:171], v[84:87], v[72:75], v[168:171]
    ds_read_b128 v[40:43], v108 offset:36864
    buffer_load_dwordx4 v31, s[92:95], s74 offen offset:3072 lds
    v_mfma_f32_16x16x32_bf16 v[172:175], v[84:87], v[76:79], v[172:175]
    ds_read_b64_tr_b16 v[60:61], v103 offset:32768
    v_mfma_f32_16x16x32_bf16 v[176:179], v[88:91], v[64:67], v[176:179]
    ds_read_b64_tr_b16 v[62:63], v103 offset:34816
    v_mfma_f32_16x16x32_bf16 v[180:183], v[88:91], v[68:71], v[180:183]
    ds_read_b128 v[44:47], v108 offset:38912
    v_mfma_f32_16x16x32_bf16 v[184:187], v[88:91], v[72:75], v[184:187]
    v_mfma_f32_16x16x32_bf16 v[188:191], v[88:91], v[76:79], v[188:191]
    buffer_load_dwordx4 v[208:211], v229, s[8:11], s83 offen sc0 sc1
    v_mfma_f32_16x16x32_bf16 v[192:195], v[92:95], v[64:67], v[192:195]
    v_mfma_f32_16x16x32_bf16 v[196:199], v[92:95], v[68:71], v[196:199]
    v_mfma_f32_16x16x32_bf16 v[200:203], v[92:95], v[72:75], v[200:203]
    v_mfma_f32_16x16x32_bf16 v[204:207], v[92:95], v[76:79], v[204:207]
    s_waitcnt vmcnt(13)
    s_waitcnt lgkmcnt(0)
    s_barrier
    s_waitcnt vmcnt(0)
    s_mov_b32 s7, 0
L_attn3a_poll:
    v_and_b32 v208, v208, v209
    v_and_b32 v210, v210, v211
    v_and_b32 v208, v208, v210
    v_cmp_ne_u32 vcc, 1, v208
    s_add_u32 s7, s7, 1
    s_cbranch_vccz L_attn3a_go
    s_sleep 1
    buffer_load_dwordx4 v[208:211], v229, s[8:11], s83 offen sc0 sc1
    s_waitcnt vmcnt(0)
    s_cmp_lt_u32 s7, 0x40000
    s_cbranch_scc1 L_attn3a_poll
L_attn3a_go:
    v_mfma_f32_16x16x32_bf16 v[144:147], v[48:51], v[32:35], v[144:147]
    ds_read_b64_tr_b16 v[80:81], v100 offset:40960
    ds_read_b64_tr_b16 v[82:83], v100 offset:43008
    v_mfma_f32_16x16x32_bf16 v[148:151], v[48:51], v[36:39], v[148:151]
    ds_read_b128 v[64:67], v108 offset:33792
    s_add_u32 m0, s73, 0
    s_add_u32 s75, s75, 2048
    buffer_load_dwordx4 v8, s[8:11], s75 offen sc1 lds
    v_mfma_f32_16x16x32_bf16 v[152:155], v[48:51], v[40:43], v[152:155]
    ds_read_b64_tr_b16 v[84:85], v101 offset:40960
    v_mfma_f32_16x16x32_bf16 v[156:159], v[48:51], v[44:47], v[156:159]
    ds_read_b64_tr_b16 v[86:87], v101 offset:43008
    buffer_load_dwordx4 v8, s[8:11], s75 offen offset:1024 sc1 lds
    v_mfma_f32_16x16x32_bf16 v[160:163], v[52:55], v[32:35], v[160:163]
    ds_read_b128 v[68:71], v108 offset:35840
    s_add_u32 m0, s73, 2048
    s_nop 0
    buffer_load_dwordx4 v9, s[8:11], s75 offen sc1 lds
    v_mfma_f32_16x16x32_bf16 v[164:167], v[52:55], v[36:39], v[164:167]
    ds_read_b64_tr_b16 v[88:89], v102 offset:40960
    ds_read_b64_tr_b16 v[90:91], v102 offset:43008
    v_mfma_f32_16x16x32_bf16 v[168:171], v[52:55], v[40:43], v[168:171]
    ds_read_b128 v[72:75], v108 offset:37888
    v_mfma_f32_16x16x32_bf16 v[172:175], v[52:55], v[44:47], v[172:175]
    ds_read_b64_tr_b16 v[92:93], v103 offset:40960
    buffer_load_dwordx4 v9, s[8:11], s75 offen offset:1024 sc1 lds
    v_mfma_f32_16x16x32_bf16 v[176:179], v[56:59], v[32:35], v[176:179]
    ds_read_b64_tr_b16 v[94:95], v103 offset:43008
    s_add_u32 m0, s73, 32768
    s_add_u32 s75, s75, 2048
    buffer_load_dwordx4 v8, s[8:11], s75 offen sc1 lds
    v_mfma_f32_16x16x32_bf16 v[180:183], v[56:59], v[36:39], v[180:183]
    ds_read_b128 v[76:79], v108 offset:39936
    v_mfma_f32_16x16x32_bf16 v[184:187], v[56:59], v[40:43], v[184:187]
    v_mfma_f32_16x16x32_bf16 v[188:191], v[56:59], v[44:47], v[188:191]
    buffer_load_dwordx4 v8, s[8:11], s75 offen offset:1024 sc1 lds
    v_mfma_f32_16x16x32_bf16 v[192:195], v[60:63], v[32:35], v[192:195]
    s_add_u32 m0, s73, 34816
    s_nop 0
    buffer_load_dwordx4 v9, s[8:11], s75 offen sc1 lds
    v_mfma_f32_16x16x32_bf16 v[196:199], v[60:63], v[36:39], v[196:199]
    v_mfma_f32_16x16x32_bf16 v[200:203], v[60:63], v[40:43], v[200:203]
    v_mfma_f32_16x16x32_bf16 v[204:207], v[60:63], v[44:47], v[204:207]
    buffer_load_dwordx4 v9, s[8:11], s75 offen offset:1024 sc1 lds
    s_waitcnt lgkmcnt(0)
    v_mfma_f32_16x16x32_bf16 v[144:147], v[80:83], v[64:67], v[144:147]
    ds_read_b64_tr_b16 v[48:49], v104 offset:0
    ds_read_b64_tr_b16 v[50:51], v104 offset:2048
    v_mfma_f32_16x16x32_bf16 v[148:151], v[80:83], v[68:71], v[148:151]
    ds_read_b128 v[32:35], v109 offset:0
    s_add_u32 m0, s73, 65536
    s_add_u32 s75, s75, 2048
    buffer_load_dwordx4 v8, s[8:11], s75 offen sc1 lds
    v_mfma_f32_16x16x32_bf16 v[152:155], v[80:83], v[72:75], v[152:155]
    ds_read_b64_tr_b16 v[52:53], v105 offset:0
    v_mfma_f32_16x16x32_bf16 v[156:159], v[80:83], v[76:79], v[156:159]
    ds_read_b64_tr_b16 v[54:55], v105 offset:2048
    v_mfma_f32_16x16x32_bf16 v[160:163], v[84:87], v[64:67], v[160:163]
    ds_read_b128 v[36:39], v109 offset:2048
    buffer_load_dwordx4 v8, s[8:11], s75 offen offset:1024 sc1 lds
    v_mfma_f32_16x16x32_bf16 v[164:167], v[84:87], v[68:71], v[164:167]
    ds_read_b64_tr_b16 v[56:57], v106 offset:0
    ds_read_b64_tr_b16 v[58:59], v106 offset:2048
    s_add_u32 m0, s73, 67584
    s_nop 0
    buffer_load_dwordx4 v9, s[8:11], s75 offen sc1 lds
    v_mfma_f32_16x16x32_bf16 v[168:171], v[84:87], v[72:75], v[168:171]
    ds_read_b128 v[40:43], v109 offset:4096
    v_mfma_f32_16x16x32_bf16 v[172:175], v[84:87], v[76:79], v[172:175]
    ds_read_b64_tr_b16 v[60:61], v107 offset:0
    v_mfma_f32_16x16x32_bf16 v[176:179], v[88:91], v[64:67], v[176:179]
    ds_read_b64_tr_b16 v[62:63], v107 offset:2048
    buffer_load_dwordx4 v9, s[8:11], s75 offen offset:1024 sc1 lds
    v_mfma_f32_16x16x32_bf16 v[180:183], v[88:91], v[68:71], v[180:183]
    ds_read_b128 v[44:47], v109 offset:6144
    s_add_u32 m0, s73, 81920
    s_add_u32 s74, s74, 65536
    buffer_load_dwordx4 v6, s[92:95], s74 offen lds
    v_mfma_f32_16x16x32_bf16 v[184:187], v[88:91], v[72:75], v[184:187]
    v_mfma_f32_16x16x32_bf16 v[188:191], v[88:91], v[76:79], v[188:191]
    v_mfma_f32_16x16x32_bf16 v[192:195], v[92:95], v[64:67], v[192:195]
    buffer_load_dwordx4 v12, s[92:95], s74 offen offset:1024 lds
    v_mfma_f32_16x16x32_bf16 v[196:199], v[92:95], v[68:71], v[196:199]
    buffer_load_dwordx4 v15, s[92:95], s74 offen offset:2048 lds
    v_mfma_f32_16x16x32_bf16 v[200:203], v[92:95], v[72:75], v[200:203]
    buffer_load_dwordx4 v31, s[92:95], s74 offen offset:3072 lds
    v_mfma_f32_16x16x32_bf16 v[204:207], v[92:95], v[76:79], v[204:207]
    s_waitcnt vmcnt(12)
    s_waitcnt lgkmcnt(0)
    s_barrier
    v_mfma_f32_16x16x32_bf16 v[144:147], v[48:51], v[32:35], v[144:147]
    ds_read_b64_tr_b16 v[80:81], v104 offset:8192
    ds_read_b64_tr_b16 v[82:83], v104 offset:10240
    v_mfma_f32_16x16x32_bf16 v[148:151], v[48:51], v[36:39], v[148:151]
    ds_read_b128 v[64:67], v109 offset:1024
    s_add_u32 m0, s73, 114688
    s_add_u32 s74, s74, 65536
    buffer_load_dwordx4 v6, s[92:95], s74 offen lds
    v_mfma_f32_16x16x32_bf16 v[152:155], v[48:51], v[40:43], v[152:155]
    ds_read_b64_tr_b16 v[84:85], v105 offset:8192
    v_mfma_f32_16x16x32_bf16 v[156:159], v[48:51], v[44:47], v[156:159]
    ds_read_b64_tr_b16 v[86:87], v105 offset:10240
    v_mfma_f32_16x16x32_bf16 v[160:163], v[52:55], v[32:35], v[160:163]
    ds_read_b128 v[68:71], v109 offset:3072
    v_mfma_f32_16x16x32_bf16 v[164:167], v[52:55], v[36:39], v[164:167]
    ds_read_b64_tr_b16 v[88:89], v106 offset:8192
    ds_read_b64_tr_b16 v[90:91], v106 offset:10240
    v_mfma_f32_16x16x32_bf16 v[168:171], v[52:55], v[40:43], v[168:171]
    ds_read_b128 v[72:75], v109 offset:5120
    v_mfma_f32_16x16x32_bf16 v[172:175], v[52:55], v[44:47], v[172:175]
    ds_read_b64_tr_b16 v[92:93], v107 offset:8192
    v_mfma_f32_16x16x32_bf16 v[176:179], v[56:59], v[32:35], v[176:179]
    ds_read_b64_tr_b16 v[94:95], v107 offset:10240
    buffer_load_dwordx4 v12, s[92:95], s74 offen offset:1024 lds
    v_mfma_f32_16x16x32_bf16 v[180:183], v[56:59], v[36:39], v[180:183]
    ds_read_b128 v[76:79], v109 offset:7168
    v_mfma_f32_16x16x32_bf16 v[184:187], v[56:59], v[40:43], v[184:187]
    v_mfma_f32_16x16x32_bf16 v[188:191], v[56:59], v[44:47], v[188:191]
    buffer_load_dwordx4 v15, s[92:95], s74 offen offset:2048 lds
    v_mfma_f32_16x16x32_bf16 v[192:195], v[60:63], v[32:35], v[192:195]
    v_mfma_f32_16x16x32_bf16 v[196:199], v[60:63], v[36:39], v[196:199]
    buffer_load_dwordx4 v31, s[92:95], s74 offen offset:3072 lds
    v_mfma_f32_16x16x32_bf16 v[200:203], v[60:63], v[40:43], v[200:203]
    v_mfma_f32_16x16x32_bf16 v[204:207], v[60:63], v[44:47], v[204:207]
    s_waitcnt lgkmcnt(0)
    v_mfma_f32_16x16x32_bf16 v[144:147], v[80:83], v[64:67], v[144:147]
    ds_read_b64_tr_b16 v[48:49], v96 offset:0
    ds_read_b64_tr_b16 v[50:51], v96 offset:2048
    v_mfma_f32_16x16x32_bf16 v[148:151], v[80:83], v[68:71], v[148:151]
    ds_read_b128 v[32:35], v10 offset:0
    s_add_u32 m0, s73, 98304
    s_add_u32 s75, s75, 2048
    buffer_load_dwordx4 v8, s[8:11], s75 offen sc1 lds
    v_mfma_f32_16x16x32_bf16 v[152:155], v[80:83], v[72:75], v[152:155]
    ds_read_b64_tr_b16 v[52:53], v97 offset:0
    v_mfma_f32_16x16x32_bf16 v[156:159], v[80:83], v[76:79], v[156:159]
    ds_read_b64_tr_b16 v[54:55], v97 offset:2048
    v_mfma_f32_16x16x32_bf16 v[160:163], v[84:87], v[64:67], v[160:163]
    ds_read_b128 v[36:39], v10 offset:2048
    v_mfma_f32_16x16x32_bf16 v[164:167], v[84:87], v[68:71], v[164:167]
    ds_read_b64_tr_b16 v[56:57], v98 offset:0
    ds_read_b64_tr_b16 v[58:59], v98 offset:2048
    v_mfma_f32_16x16x32_bf16 v[168:171], v[84:87], v[72:75], v[168:171]
    ds_read_b128 v[40:43], v10 offset:4096
    buffer_load_dwordx4 v8, s[8:11], s75 offen offset:1024 sc1 lds
    v_mfma_f32_16x16x32_bf16 v[172:175], v[84:87], v[76:79], v[172:175]
    ds_read_b64_tr_b16 v[60:61], v99 offset:0
    v_mfma_f32_16x16x32_bf16 v[176:179], v[88:91], v[64:67], v[176:179]
    ds_read_b64_tr_b16 v[62:63], v99 offset:2048
    s_add_u32 m0, s73, 100352
    s_nop 0
    buffer_load_dwordx4 v9, s[8:11], s75 offen sc1 lds
    v_mfma_f32_16x16x32_bf16 v[180:183], v[88:91], v[68:71], v[180:183]
    ds_read_b128 v[44:47], v10 offset:6144
    v_mfma_f32_16x16x32_bf16 v[184:187], v[88:91], v[72:75], v[184:187]
    v_mfma_f32_16x16x32_bf16 v[188:191], v[88:91], v[76:79], v[188:191]
    v_mfma_f32_16x16x32_bf16 v[192:195], v[92:95], v[64:67], v[192:195]
    v_mfma_f32_16x16x32_bf16 v[196:199], v[92:95], v[68:71], v[196:199]
    v_mfma_f32_16x16x32_bf16 v[200:203], v[92:95], v[72:75], v[200:203]
    buffer_load_dwordx4 v9, s[8:11], s75 offen offset:1024 sc1 lds
    v_mfma_f32_16x16x32_bf16 v[204:207], v[92:95], v[76:79], v[204:207]
    s_waitcnt vmcnt(16)
    s_waitcnt lgkmcnt(0)
    s_barrier
    v_mfma_f32_16x16x32_bf16 v[144:147], v[48:51], v[32:35], v[144:147]
    ds_read_b64_tr_b16 v[80:81], v96 offset:8192
    ds_read_b64_tr_b16 v[82:83], v96 offset:10240
    v_mfma_f32_16x16x32_bf16 v[148:151], v[48:51], v[36:39], v[148:151]
    ds_read_b128 v[64:67], v10 offset:1024
    s_add_u32 m0, s73, 147456
    s_add_u32 s74, s74, 65536
    buffer_load_dwordx4 v6, s[92:95], s74 offen lds
    v_mfma_f32_16x16x32_bf16 v[152:155], v[48:51], v[40:43], v[152:155]
    ds_read_b64_tr_b16 v[84:85], v97 offset:8192
    v_mfma_f32_16x16x32_bf16 v[156:159], v[48:51], v[44:47], v[156:159]
    ds_read_b64_tr_b16 v[86:87], v97 offset:10240
    v_mfma_f32_16x16x32_bf16 v[160:163], v[52:55], v[32:35], v[160:163]
    ds_read_b128 v[68:71], v10 offset:3072
    v_mfma_f32_16x16x32_bf16 v[164:167], v[52:55], v[36:39], v[164:167]
    ds_read_b64_tr_b16 v[88:89], v98 offset:8192
    ds_read_b64_tr_b16 v[90:91], v98 offset:10240
    v_mfma_f32_16x16x32_bf16 v[168:171], v[52:55], v[40:43], v[168:171]
    ds_read_b128 v[72:75], v10 offset:5120
    v_mfma_f32_16x16x32_bf16 v[172:175], v[52:55], v[44:47], v[172:175]
    ds_read_b64_tr_b16 v[92:93], v99 offset:8192
    v_mfma_f32_16x16x32_bf16 v[176:179], v[56:59], v[32:35], v[176:179]
    ds_read_b64_tr_b16 v[94:95], v99 offset:10240
    buffer_load_dwordx4 v12, s[92:95], s74 offen offset:1024 lds
    v_mfma_f32_16x16x32_bf16 v[180:183], v[56:59], v[36:39], v[180:183]
    ds_read_b128 v[76:79], v10 offset:7168
    v_mfma_f32_16x16x32_bf16 v[184:187], v[56:59], v[40:43], v[184:187]
    v_mfma_f32_16x16x32_bf16 v[188:191], v[56:59], v[44:47], v[188:191]
    buffer_load_dwordx4 v15, s[92:95], s74 offen offset:2048 lds
    v_mfma_f32_16x16x32_bf16 v[192:195], v[60:63], v[32:35], v[192:195]
    v_mfma_f32_16x16x32_bf16 v[196:199], v[60:63], v[36:39], v[196:199]
    buffer_load_dwordx4 v31, s[92:95], s74 offen offset:3072 lds
    v_mfma_f32_16x16x32_bf16 v[200:203], v[60:63], v[40:43], v[200:203]
    v_mfma_f32_16x16x32_bf16 v[204:207], v[60:63], v[44:47], v[204:207]
    s_waitcnt lgkmcnt(0)
    v_mfma_f32_16x16x32_bf16 v[144:147], v[80:83], v[64:67], v[144:147]
    ds_read_b64_tr_b16 v[48:49], v96 offset:32768
    ds_read_b64_tr_b16 v[50:51], v96 offset:34816
    v_mfma_f32_16x16x32_bf16 v[148:151], v[80:83], v[68:71], v[148:151]
    ds_read_b128 v[32:35], v10 offset:32768
    s_add_u32 m0, s73, 131072
    s_add_u32 s75, s75, 2048
    buffer_load_dwordx4 v8, s[8:11], s75 offen sc1 lds
    v_mfma_f32_16x16x32_bf16 v[152:155], v[80:83], v[72:75], v[152:155]
    ds_read_b64_tr_b16 v[52:53], v97 offset:32768
    v_mfma_f32_16x16x32_bf16 v[156:159], v[80:83], v[76:79], v[156:159]
    ds_read_b64_tr_b16 v[54:55], v97 offset:34816
    v_mfma_f32_16x16x32_bf16 v[160:163], v[84:87], v[64:67], v[160:163]
    ds_read_b128 v[36:39], v10 offset:34816
    v_mfma_f32_16x16x32_bf16 v[164:167], v[84:87], v[68:71], v[164:167]
    ds_read_b64_tr_b16 v[56:57], v98 offset:32768
    ds_read_b64_tr_b16 v[58:59], v98 offset:34816
    v_mfma_f32_16x16x32_bf16 v[168:171], v[84:87], v[72:75], v[168:171]
    ds_read_b128 v[40:43], v10 offset:36864
    buffer_load_dwordx4 v8, s[8:11], s75 offen offset:1024 sc1 lds
    v_mfma_f32_16x16x32_bf16 v[172:175], v[84:87], v[76:79], v[172:175]
    ds_read_b64_tr_b16 v[60:61], v99 offset:32768
    v_mfma_f32_16x16x32_bf16 v[176:179], v[88:91], v[64:67], v[176:179]
    ds_read_b64_tr_b16 v[62:63], v99 offset:34816
    s_add_u32 m0, s73, 133120
    s_nop 0
    buffer_load_dwordx4 v9, s[8:11], s75 offen sc1 lds
    v_mfma_f32_16x16x32_bf16 v[180:183], v[88:91], v[68:71], v[180:183]
    ds_read_b128 v[44:47], v10 offset:38912
    v_mfma_f32_16x16x32_bf16 v[184:187], v[88:91], v[72:75], v[184:187]
    v_mfma_f32_16x16x32_bf16 v[188:191], v[88:91], v[76:79], v[188:191]
    v_mfma_f32_16x16x32_bf16 v[192:195], v[92:95], v[64:67], v[192:195]
    v_mfma_f32_16x16x32_bf16 v[196:199], v[92:95], v[68:71], v[196:199]
    v_mfma_f32_16x16x32_bf16 v[200:203], v[92:95], v[72:75], v[200:203]
    buffer_load_dwordx4 v9, s[8:11], s75 offen offset:1024 sc1 lds
    v_mfma_f32_16x16x32_bf16 v[204:207], v[92:95], v[76:79], v[204:207]
    s_waitcnt vmcnt(16)
    s_waitcnt lgkmcnt(0)
    s_barrier
    v_mfma_f32_16x16x32_bf16 v[144:147], v[48:51], v[32:35], v[144:147]
    ds_read_b64_tr_b16 v[80:81], v96 offset:40960
    ds_read_b64_tr_b16 v[82:83], v96 offset:43008
    v_mfma_f32_16x16x32_bf16 v[148:151], v[48:51], v[36:39], v[148:151]
    ds_read_b128 v[64:67], v10 offset:33792
    s_add_u32 m0, s73, 16384
    s_add_u32 s74, s74, 65536
    buffer_load_dwordx4 v6, s[92:95], s74 offen lds
    v_mfma_f32_16x16x32_bf16 v[152:155], v[48:51], v[40:43], v[152:155]
    ds_read_b64_tr_b16 v[84:85], v97 offset:40960
    v_mfma_f32_16x16x32_bf16 v[156:159], v[48:51], v[44:47], v[156:159]
    ds_read_b64_tr_b16 v[86:87], v97 offset:43008
    v_mfma_f32_16x16x32_bf16 v[160:163], v[52:55], v[32:35], v[160:163]
    ds_read_b128 v[68:71], v10 offset:35840
    v_mfma_f32_16x16x32_bf16 v[164:167], v[52:55], v[36:39], v[164:167]
    ds_read_b64_tr_b16 v[88:89], v98 offset:40960
    ds_read_b64_tr_b16 v[90:91], v98 offset:43008
    v_mfma_f32_16x16x32_bf16 v[168:171], v[52:55], v[40:43], v[168:171]
    ds_read_b128 v[72:75], v10 offset:37888
    v_mfma_f32_16x16x32_bf16 v[172:175], v[52:55], v[44:47], v[172:175]
    ds_read_b64_tr_b16 v[92:93], v99 offset:40960
    v_mfma_f32_16x16x32_bf16 v[176:179], v[56:59], v[32:35], v[176:179]
    ds_read_b64_tr_b16 v[94:95], v99 offset:43008
    buffer_load_dwordx4 v12, s[92:95], s74 offen offset:1024 lds
    v_mfma_f32_16x16x32_bf16 v[180:183], v[56:59], v[36:39], v[180:183]
    ds_read_b128 v[76:79], v10 offset:39936
    v_mfma_f32_16x16x32_bf16 v[184:187], v[56:59], v[40:43], v[184:187]
    v_mfma_f32_16x16x32_bf16 v[188:191], v[56:59], v[44:47], v[188:191]
    buffer_load_dwordx4 v15, s[92:95], s74 offen offset:2048 lds
    v_mfma_f32_16x16x32_bf16 v[192:195], v[60:63], v[32:35], v[192:195]
    v_mfma_f32_16x16x32_bf16 v[196:199], v[60:63], v[36:39], v[196:199]
    buffer_load_dwordx4 v31, s[92:95], s74 offen offset:3072 lds
    v_mfma_f32_16x16x32_bf16 v[200:203], v[60:63], v[40:43], v[200:203]
    v_mfma_f32_16x16x32_bf16 v[204:207], v[60:63], v[44:47], v[204:207]
    s_waitcnt lgkmcnt(0)
    v_mfma_f32_16x16x32_bf16 v[144:147], v[80:83], v[64:67], v[144:147]
    ds_read_b64_tr_b16 v[48:49], v100 offset:0
    ds_read_b64_tr_b16 v[50:51], v100 offset:2048
    v_mfma_f32_16x16x32_bf16 v[148:151], v[80:83], v[68:71], v[148:151]
    ds_read_b128 v[32:35], v108 offset:0
    s_add_u32 m0, s73, 0
    s_add_u32 s75, s75, 2048
    buffer_load_dwordx4 v8, s[8:11], s75 offen sc1 lds
    v_mfma_f32_16x16x32_bf16 v[152:155], v[80:83], v[72:75], v[152:155]
    ds_read_b64_tr_b16 v[52:53], v101 offset:0
    v_mfma_f32_16x16x32_bf16 v[156:159], v[80:83], v[76:79], v[156:159]
    ds_read_b64_tr_b16 v[54:55], v101 offset:2048
    v_mfma_f32_16x16x32_bf16 v[160:163], v[84:87], v[64:67], v[160:163]
    ds_read_b128 v[36:39], v108 offset:2048
    v_mfma_f32_16x16x32_bf16 v[164:167], v[84:87], v[68:71], v[164:167]
    ds_read_b64_tr_b16 v[56:57], v102 offset:0
    ds_read_b64_tr_b16 v[58:59], v102 offset:2048
    v_mfma_f32_16x16x32_bf16 v[168:171], v[84:87], v[72:75], v[168:171]
    ds_read_b128 v[40:43], v108 offset:4096
    buffer_load_dwordx4 v8, s[8:11], s75 offen offset:1024 sc1 lds
    v_mfma_f32_16x16x32_bf16 v[172:175], v[84:87], v[76:79], v[172:175]
    ds_read_b64_tr_b16 v[60:61], v103 offset:0
    v_mfma_f32_16x16x32_bf16 v[176:179], v[88:91], v[64:67], v[176:179]
    ds_read_b64_tr_b16 v[62:63], v103 offset:2048
    s_add_u32 m0, s73, 2048
    s_nop 0
    buffer_load_dwordx4 v9, s[8:11], s75 offen sc1 lds
    v_mfma_f32_16x16x32_bf16 v[180:183], v[88:91], v[68:71], v[180:183]
    ds_read_b128 v[44:47], v108 offset:6144
    v_mfma_f32_16x16x32_bf16 v[184:187], v[88:91], v[72:75], v[184:187]
    v_mfma_f32_16x16x32_bf16 v[188:191], v[88:91], v[76:79], v[188:191]
    v_mfma_f32_16x16x32_bf16 v[192:195], v[92:95], v[64:67], v[192:195]
    v_mfma_f32_16x16x32_bf16 v[196:199], v[92:95], v[68:71], v[196:199]
    v_mfma_f32_16x16x32_bf16 v[200:203], v[92:95], v[72:75], v[200:203]
    buffer_load_dwordx4 v9, s[8:11], s75 offen offset:1024 sc1 lds
    v_mfma_f32_16x16x32_bf16 v[204:207], v[92:95], v[76:79], v[204:207]
    s_waitcnt vmcnt(16)
    s_waitcnt lgkmcnt(0)
    s_barrier
    v_mfma_f32_16x16x32_bf16 v[144:147], v[48:51], v[32:35], v[144:147]
    ds_read_b64_tr_b16 v[80:81], v100 offset:8192
    ds_read_b64_tr_b16 v[82:83], v100 offset:10240
    v_mfma_f32_16x16x32_bf16 v[148:151], v[48:51], v[36:39], v[148:151]
    ds_read_b128 v[64:67], v108 offset:1024
    s_add_u32 m0, s73, 49152
    s_add_u32 s74, s74, 65536
    buffer_load_dwordx4 v6, s[92:95], s74 offen lds
    v_mfma_f32_16x16x32_bf16 v[152:155], v[48:51], v[40:43], v[152:155]
    ds_read_b64_tr_b16 v[84:85], v101 offset:8192
    v_mfma_f32_16x16x32_bf16 v[156:159], v[48:51], v[44:47], v[156:159]
    ds_read_b64_tr_b16 v[86:87], v101 offset:10240
    v_mfma_f32_16x16x32_bf16 v[160:163], v[52:55], v[32:35], v[160:163]
    ds_read_b128 v[68:71], v108 offset:3072
    v_mfma_f32_16x16x32_bf16 v[164:167], v[52:55], v[36:39], v[164:167]
    ds_read_b64_tr_b16 v[88:89], v102 offset:8192
    ds_read_b64_tr_b16 v[90:91], v102 offset:10240
    v_mfma_f32_16x16x32_bf16 v[168:171], v[52:55], v[40:43], v[168:171]
    ds_read_b128 v[72:75], v108 offset:5120
    v_mfma_f32_16x16x32_bf16 v[172:175], v[52:55], v[44:47], v[172:175]
    ds_read_b64_tr_b16 v[92:93], v103 offset:8192
    v_mfma_f32_16x16x32_bf16 v[176:179], v[56:59], v[32:35], v[176:179]
    ds_read_b64_tr_b16 v[94:95], v103 offset:10240
    buffer_load_dwordx4 v12, s[92:95], s74 offen offset:1024 lds
    v_mfma_f32_16x16x32_bf16 v[180:183], v[56:59], v[36:39], v[180:183]
    ds_read_b128 v[76:79], v108 offset:7168
    v_mfma_f32_16x16x32_bf16 v[184:187], v[56:59], v[40:43], v[184:187]
    v_mfma_f32_16x16x32_bf16 v[188:191], v[56:59], v[44:47], v[188:191]
    buffer_load_dwordx4 v15, s[92:95], s74 offen offset:2048 lds
    v_mfma_f32_16x16x32_bf16 v[192:195], v[60:63], v[32:35], v[192:195]
    v_mfma_f32_16x16x32_bf16 v[196:199], v[60:63], v[36:39], v[196:199]
    buffer_load_dwordx4 v31, s[92:95], s74 offen offset:3072 lds
    v_mfma_f32_16x16x32_bf16 v[200:203], v[60:63], v[40:43], v[200:203]
    v_mfma_f32_16x16x32_bf16 v[204:207], v[60:63], v[44:47], v[204:207]
    s_waitcnt lgkmcnt(0)
    v_mfma_f32_16x16x32_bf16 v[144:147], v[80:83], v[64:67], v[144:147]
    ds_read_b64_tr_b16 v[48:49], v100 offset:32768
    ds_read_b64_tr_b16 v[50:51], v100 offset:34816
    v_mfma_f32_16x16x32_bf16 v[148:151], v[80:83], v[68:71], v[148:151]
    ds_read_b128 v[32:35], v108 offset:32768
    s_add_u32 m0, s73, 32768
    s_add_u32 s75, s75, 2048
    buffer_load_dwordx4 v8, s[8:11], s75 offen sc1 lds
    v_mfma_f32_16x16x32_bf16 v[152:155], v[80:83], v[72:75], v[152:155]
    ds_read_b64_tr_b16 v[52:53], v101 offset:32768
    v_mfma_f32_16x16x32_bf16 v[156:159], v[80:83], v[76:79], v[156:159]
    ds_read_b64_tr_b16 v[54:55], v101 offset:34816
    v_mfma_f32_16x16x32_bf16 v[160:163], v[84:87], v[64:67], v[160:163]
    ds_read_b128 v[36:39], v108 offset:34816
    v_mfma_f32_16x16x32_bf16 v[164:167], v[84:87], v[68:71], v[164:167]
    ds_read_b64_tr_b16 v[56:57], v102 offset:32768
    ds_read_b64_tr_b16 v[58:59], v102 offset:34816
    v_mfma_f32_16x16x32_bf16 v[168:171], v[84:87], v[72:75], v[168:171]
    ds_read_b128 v[40:43], v108 offset:36864
    buffer_load_dwordx4 v8, s[8:11], s75 offen offset:1024 sc1 lds
    v_mfma_f32_16x16x32_bf16 v[172:175], v[84:87], v[76:79], v[172:175]
    ds_read_b64_tr_b16 v[60:61], v103 offset:32768
    v_mfma_f32_16x16x32_bf16 v[176:179], v[88:91], v[64:67], v[176:179]
    ds_read_b64_tr_b16 v[62:63], v103 offset:34816
    s_add_u32 m0, s73, 34816
    s_nop 0
    buffer_load_dwordx4 v9, s[8:11], s75 offen sc1 lds
    v_mfma_f32_16x16x32_bf16 v[180:183], v[88:91], v[68:71], v[180:183]
    ds_read_b128 v[44:47], v108 offset:38912
    v_mfma_f32_16x16x32_bf16 v[184:187], v[88:91], v[72:75], v[184:187]
    v_mfma_f32_16x16x32_bf16 v[188:191], v[88:91], v[76:79], v[188:191]
    v_mfma_f32_16x16x32_bf16 v[192:195], v[92:95], v[64:67], v[192:195]
    v_mfma_f32_16x16x32_bf16 v[196:199], v[92:95], v[68:71], v[196:199]
    v_mfma_f32_16x16x32_bf16 v[200:203], v[92:95], v[72:75], v[200:203]
    buffer_load_dwordx4 v9, s[8:11], s75 offen offset:1024 sc1 lds
    v_mfma_f32_16x16x32_bf16 v[204:207], v[92:95], v[76:79], v[204:207]
    s_waitcnt vmcnt(16)
    s_waitcnt lgkmcnt(0)
    s_barrier
    v_mfma_f32_16x16x32_bf16 v[144:147], v[48:51], v[32:35], v[144:147]
    ds_read_b64_tr_b16 v[80:81], v100 offset:40960
    ds_read_b64_tr_b16 v[82:83], v100 offset:43008
    v_mfma_f32_16x16x32_bf16 v[148:151], v[48:51], v[36:39], v[148:151]
    ds_read_b128 v[64:67], v108 offset:33792
    s_add_u32 m0, s73, 81920
    s_add_u32 s74, s74, 65536
    buffer_load_dwordx4 v6, s[92:95], s74 offen lds
    v_mfma_f32_16x16x32_bf16 v[152:155], v[48:51], v[40:43], v[152:155]
    ds_read_b64_tr_b16 v[84:85], v101 offset:40960
    v_mfma_f32_16x16x32_bf16 v[156:159], v[48:51], v[44:47], v[156:159]
    ds_read_b64_tr_b16 v[86:87], v101 offset:43008
    v_mfma_f32_16x16x32_bf16 v[160:163], v[52:55], v[32:35], v[160:163]
    ds_read_b128 v[68:71], v108 offset:35840
    v_mfma_f32_16x16x32_bf16 v[164:167], v[52:55], v[36:39], v[164:167]
    ds_read_b64_tr_b16 v[88:89], v102 offset:40960
    ds_read_b64_tr_b16 v[90:91], v102 offset:43008
    v_mfma_f32_16x16x32_bf16 v[168:171], v[52:55], v[40:43], v[168:171]
    ds_read_b128 v[72:75], v108 offset:37888
    v_mfma_f32_16x16x32_bf16 v[172:175], v[52:55], v[44:47], v[172:175]
    ds_read_b64_tr_b16 v[92:93], v103 offset:40960
    v_mfma_f32_16x16x32_bf16 v[176:179], v[56:59], v[32:35], v[176:179]
    ds_read_b64_tr_b16 v[94:95], v103 offset:43008
    buffer_load_dwordx4 v12, s[92:95], s74 offen offset:1024 lds
    v_mfma_f32_16x16x32_bf16 v[180:183], v[56:59], v[36:39], v[180:183]
    ds_read_b128 v[76:79], v108 offset:39936
    v_mfma_f32_16x16x32_bf16 v[184:187], v[56:59], v[40:43], v[184:187]
    v_mfma_f32_16x16x32_bf16 v[188:191], v[56:59], v[44:47], v[188:191]
    buffer_load_dwordx4 v15, s[92:95], s74 offen offset:2048 lds
    v_mfma_f32_16x16x32_bf16 v[192:195], v[60:63], v[32:35], v[192:195]
    v_mfma_f32_16x16x32_bf16 v[196:199], v[60:63], v[36:39], v[196:199]
    buffer_load_dwordx4 v31, s[92:95], s74 offen offset:3072 lds
    v_mfma_f32_16x16x32_bf16 v[200:203], v[60:63], v[40:43], v[200:203]
    v_mfma_f32_16x16x32_bf16 v[204:207], v[60:63], v[44:47], v[204:207]
    s_waitcnt lgkmcnt(0)
    v_mfma_f32_16x16x32_bf16 v[144:147], v[80:83], v[64:67], v[144:147]
    ds_read_b64_tr_b16 v[48:49], v104 offset:0
    ds_read_b64_tr_b16 v[50:51], v104 offset:2048
    v_mfma_f32_16x16x32_bf16 v[148:151], v[80:83], v[68:71], v[148:151]
    ds_read_b128 v[32:35], v109 offset:0
    s_add_u32 m0, s73, 65536
    s_add_u32 s75, s75, 2048
    buffer_load_dwordx4 v8, s[8:11], s75 offen sc1 lds
    v_mfma_f32_16x16x32_bf16 v[152:155], v[80:83], v[72:75], v[152:155]
    ds_read_b64_tr_b16 v[52:53], v105 offset:0
    v_mfma_f32_16x16x32_bf16 v[156:159], v[80:83], v[76:79], v[156:159]
    ds_read_b64_tr_b16 v[54:55], v105 offset:2048
    v_mfma_f32_16x16x32_bf16 v[160:163], v[84:87], v[64:67], v[160:163]
    ds_read_b128 v[36:39], v109 offset:2048
    v_mfma_f32_16x16x32_bf16 v[164:167], v[84:87], v[68:71], v[164:167]
    ds_read_b64_tr_b16 v[56:57], v106 offset:0
    ds_read_b64_tr_b16 v[58:59], v106 offset:2048
    v_mfma_f32_16x16x32_bf16 v[168:171], v[84:87], v[72:75], v[168:171]
    ds_read_b128 v[40:43], v109 offset:4096
    buffer_load_dwordx4 v8, s[8:11], s75 offen offset:1024 sc1 lds
    v_mfma_f32_16x16x32_bf16 v[172:175], v[84:87], v[76:79], v[172:175]
    ds_read_b64_tr_b16 v[60:61], v107 offset:0
    v_mfma_f32_16x16x32_bf16 v[176:179], v[88:91], v[64:67], v[176:179]
    ds_read_b64_tr_b16 v[62:63], v107 offset:2048
    s_add_u32 m0, s73, 67584
    s_nop 0
    buffer_load_dwordx4 v9, s[8:11], s75 offen sc1 lds
    v_mfma_f32_16x16x32_bf16 v[180:183], v[88:91], v[68:71], v[180:183]
    ds_read_b128 v[44:47], v109 offset:6144
    v_mfma_f32_16x16x32_bf16 v[184:187], v[88:91], v[72:75], v[184:187]
    v_mfma_f32_16x16x32_bf16 v[188:191], v[88:91], v[76:79], v[188:191]
    v_mfma_f32_16x16x32_bf16 v[192:195], v[92:95], v[64:67], v[192:195]
    v_mfma_f32_16x16x32_bf16 v[196:199], v[92:95], v[68:71], v[196:199]
    v_mfma_f32_16x16x32_bf16 v[200:203], v[92:95], v[72:75], v[200:203]
    buffer_load_dwordx4 v9, s[8:11], s75 offen offset:1024 sc1 lds
    v_mfma_f32_16x16x32_bf16 v[204:207], v[92:95], v[76:79], v[204:207]
    s_waitcnt vmcnt(16)
    s_waitcnt lgkmcnt(0)
    s_barrier
    v_mfma_f32_16x16x32_bf16 v[144:147], v[48:51], v[32:35], v[144:147]
    ds_read_b64_tr_b16 v[80:81], v104 offset:8192
    ds_read_b64_tr_b16 v[82:83], v104 offset:10240
    v_mfma_f32_16x16x32_bf16 v[148:151], v[48:51], v[36:39], v[148:151]
    ds_read_b128 v[64:67], v109 offset:1024
    s_add_u32 m0, s73, 114688
    s_add_u32 s74, s74, 65536
    buffer_load_dwordx4 v6, s[92:95], s74 offen lds
    v_mfma_f32_16x16x32_bf16 v[152:155], v[48:51], v[40:43], v[152:155]
    ds_read_b64_tr_b16 v[84:85], v105 offset:8192
    v_mfma_f32_16x16x32_bf16 v[156:159], v[48:51], v[44:47], v[156:159]
    ds_read_b64_tr_b16 v[86:87], v105 offset:10240
    v_mfma_f32_16x16x32_bf16 v[160:163], v[52:55], v[32:35], v[160:163]
    ds_read_b128 v[68:71], v109 offset:3072
    v_mfma_f32_16x16x32_bf16 v[164:167], v[52:55], v[36:39], v[164:167]
    ds_read_b64_tr_b16 v[88:89], v106 offset:8192
    ds_read_b64_tr_b16 v[90:91], v106 offset:10240
    v_mfma_f32_16x16x32_bf16 v[168:171], v[52:55], v[40:43], v[168:171]
    ds_read_b128 v[72:75], v109 offset:5120
    v_mfma_f32_16x16x32_bf16 v[172:175], v[52:55], v[44:47], v[172:175]
    ds_read_b64_tr_b16 v[92:93], v107 offset:8192
    v_mfma_f32_16x16x32_bf16 v[176:179], v[56:59], v[32:35], v[176:179]
    ds_read_b64_tr_b16 v[94:95], v107 offset:10240
    buffer_load_dwordx4 v12, s[92:95], s74 offen offset:1024 lds
    v_mfma_f32_16x16x32_bf16 v[180:183], v[56:59], v[36:39], v[180:183]
    ds_read_b128 v[76:79], v109 offset:7168
    v_mfma_f32_16x16x32_bf16 v[184:187], v[56:59], v[40:43], v[184:187]
    v_mfma_f32_16x16x32_bf16 v[188:191], v[56:59], v[44:47], v[188:191]
    buffer_load_dwordx4 v15, s[92:95], s74 offen offset:2048 lds
    v_mfma_f32_16x16x32_bf16 v[192:195], v[60:63], v[32:35], v[192:195]
    v_mfma_f32_16x16x32_bf16 v[196:199], v[60:63], v[36:39], v[196:199]
    buffer_load_dwordx4 v31, s[92:95], s74 offen offset:3072 lds
    v_mfma_f32_16x16x32_bf16 v[200:203], v[60:63], v[40:43], v[200:203]
    v_mfma_f32_16x16x32_bf16 v[204:207], v[60:63], v[44:47], v[204:207]
    s_waitcnt lgkmcnt(0)
    v_mfma_f32_16x16x32_bf16 v[144:147], v[80:83], v[64:67], v[144:147]
    ds_read_b64_tr_b16 v[48:49], v96 offset:0
    ds_read_b64_tr_b16 v[50:51], v96 offset:2048
    v_mfma_f32_16x16x32_bf16 v[148:151], v[80:83], v[68:71], v[148:151]
    ds_read_b128 v[32:35], v10 offset:0
    s_add_u32 m0, s73, 98304
    s_add_u32 s75, s75, 2048
    buffer_load_dwordx4 v8, s[8:11], s75 offen sc1 lds
    v_mfma_f32_16x16x32_bf16 v[152:155], v[80:83], v[72:75], v[152:155]
    ds_read_b64_tr_b16 v[52:53], v97 offset:0
    v_mfma_f32_16x16x32_bf16 v[156:159], v[80:83], v[76:79], v[156:159]
    ds_read_b64_tr_b16 v[54:55], v97 offset:2048
    v_mfma_f32_16x16x32_bf16 v[160:163], v[84:87], v[64:67], v[160:163]
    ds_read_b128 v[36:39], v10 offset:2048
    v_mfma_f32_16x16x32_bf16 v[164:167], v[84:87], v[68:71], v[164:167]
    ds_read_b64_tr_b16 v[56:57], v98 offset:0
    ds_read_b64_tr_b16 v[58:59], v98 offset:2048
    v_mfma_f32_16x16x32_bf16 v[168:171], v[84:87], v[72:75], v[168:171]
    ds_read_b128 v[40:43], v10 offset:4096
    buffer_load_dwordx4 v8, s[8:11], s75 offen offset:1024 sc1 lds
    v_mfma_f32_16x16x32_bf16 v[172:175], v[84:87], v[76:79], v[172:175]
    ds_read_b64_tr_b16 v[60:61], v99 offset:0
    v_mfma_f32_16x16x32_bf16 v[176:179], v[88:91], v[64:67], v[176:179]
    ds_read_b64_tr_b16 v[62:63], v99 offset:2048
    s_add_u32 m0, s73, 100352
    s_nop 0
    buffer_load_dwordx4 v9, s[8:11], s75 offen sc1 lds
    v_mfma_f32_16x16x32_bf16 v[180:183], v[88:91], v[68:71], v[180:183]
    ds_read_b128 v[44:47], v10 offset:6144
    v_mfma_f32_16x16x32_bf16 v[184:187], v[88:91], v[72:75], v[184:187]
    v_mfma_f32_16x16x32_bf16 v[188:191], v[88:91], v[76:79], v[188:191]
    v_mfma_f32_16x16x32_bf16 v[192:195], v[92:95], v[64:67], v[192:195]
    v_mfma_f32_16x16x32_bf16 v[196:199], v[92:95], v[68:71], v[196:199]
    v_mfma_f32_16x16x32_bf16 v[200:203], v[92:95], v[72:75], v[200:203]
    buffer_load_dwordx4 v9, s[8:11], s75 offen offset:1024 sc1 lds
    v_mfma_f32_16x16x32_bf16 v[204:207], v[92:95], v[76:79], v[204:207]
    s_waitcnt vmcnt(16)
    s_waitcnt lgkmcnt(0)
    s_barrier
    v_mfma_f32_16x16x32_bf16 v[144:147], v[48:51], v[32:35], v[144:147]
    ds_read_b64_tr_b16 v[80:81], v96 offset:8192
    ds_read_b64_tr_b16 v[82:83], v96 offset:10240
    v_mfma_f32_16x16x32_bf16 v[148:151], v[48:51], v[36:39], v[148:151]
    ds_read_b128 v[64:67], v10 offset:1024
    s_add_u32 m0, s73, 147456
    s_add_u32 s74, s74, 65536
    buffer_load_dwordx4 v6, s[92:95], s74 offen lds
    v_mfma_f32_16x16x32_bf16 v[152:155], v[48:51], v[40:43], v[152:155]
    ds_read_b64_tr_b16 v[84:85], v97 offset:8192
    v_mfma_f32_16x16x32_bf16 v[156:159], v[48:51], v[44:47], v[156:159]
    ds_read_b64_tr_b16 v[86:87], v97 offset:10240
    v_mfma_f32_16x16x32_bf16 v[160:163], v[52:55], v[32:35], v[160:163]
    ds_read_b128 v[68:71], v10 offset:3072
    v_mfma_f32_16x16x32_bf16 v[164:167], v[52:55], v[36:39], v[164:167]
    ds_read_b64_tr_b16 v[88:89], v98 offset:8192
    ds_read_b64_tr_b16 v[90:91], v98 offset:10240
    v_mfma_f32_16x16x32_bf16 v[168:171], v[52:55], v[40:43], v[168:171]
    ds_read_b128 v[72:75], v10 offset:5120
    v_mfma_f32_16x16x32_bf16 v[172:175], v[52:55], v[44:47], v[172:175]
    ds_read_b64_tr_b16 v[92:93], v99 offset:8192
    v_mfma_f32_16x16x32_bf16 v[176:179], v[56:59], v[32:35], v[176:179]
    ds_read_b64_tr_b16 v[94:95], v99 offset:10240
    buffer_load_dwordx4 v12, s[92:95], s74 offen offset:1024 lds
    v_mfma_f32_16x16x32_bf16 v[180:183], v[56:59], v[36:39], v[180:183]
    ds_read_b128 v[76:79], v10 offset:7168
    v_mfma_f32_16x16x32_bf16 v[184:187], v[56:59], v[40:43], v[184:187]
    v_mfma_f32_16x16x32_bf16 v[188:191], v[56:59], v[44:47], v[188:191]
    buffer_load_dwordx4 v15, s[92:95], s74 offen offset:2048 lds
    v_mfma_f32_16x16x32_bf16 v[192:195], v[60:63], v[32:35], v[192:195]
    v_mfma_f32_16x16x32_bf16 v[196:199], v[60:63], v[36:39], v[196:199]
    buffer_load_dwordx4 v31, s[92:95], s74 offen offset:3072 lds
    v_mfma_f32_16x16x32_bf16 v[200:203], v[60:63], v[40:43], v[200:203]
    v_mfma_f32_16x16x32_bf16 v[204:207], v[60:63], v[44:47], v[204:207]
    s_waitcnt lgkmcnt(0)
    v_mfma_f32_16x16x32_bf16 v[144:147], v[80:83], v[64:67], v[144:147]
    ds_read_b64_tr_b16 v[48:49], v96 offset:32768
    ds_read_b64_tr_b16 v[50:51], v96 offset:34816
    v_mfma_f32_16x16x32_bf16 v[148:151], v[80:83], v[68:71], v[148:151]
    ds_read_b128 v[32:35], v10 offset:32768
    s_add_u32 m0, s73, 131072
    s_add_u32 s75, s75, 2048
    buffer_load_dwordx4 v8, s[8:11], s75 offen sc1 lds
    v_mfma_f32_16x16x32_bf16 v[152:155], v[80:83], v[72:75], v[152:155]
    ds_read_b64_tr_b16 v[52:53], v97 offset:32768
    v_mfma_f32_16x16x32_bf16 v[156:159], v[80:83], v[76:79], v[156:159]
    ds_read_b64_tr_b16 v[54:55], v97 offset:34816
    v_mfma_f32_16x16x32_bf16 v[160:163], v[84:87], v[64:67], v[160:163]
    ds_read_b128 v[36:39], v10 offset:34816
    v_mfma_f32_16x16x32_bf16 v[164:167], v[84:87], v[68:71], v[164:167]
    ds_read_b64_tr_b16 v[56:57], v98 offset:32768
    ds_read_b64_tr_b16 v[58:59], v98 offset:34816
    v_mfma_f32_16x16x32_bf16 v[168:171], v[84:87], v[72:75], v[168:171]
    ds_read_b128 v[40:43], v10 offset:36864
    buffer_load_dwordx4 v8, s[8:11], s75 offen offset:1024 sc1 lds
    v_mfma_f32_16x16x32_bf16 v[172:175], v[84:87], v[76:79], v[172:175]
    ds_read_b64_tr_b16 v[60:61], v99 offset:32768
    v_mfma_f32_16x16x32_bf16 v[176:179], v[88:91], v[64:67], v[176:179]
    ds_read_b64_tr_b16 v[62:63], v99 offset:34816
    s_add_u32 m0, s73, 133120
    s_nop 0
    buffer_load_dwordx4 v9, s[8:11], s75 offen sc1 lds
    v_mfma_f32_16x16x32_bf16 v[180:183], v[88:91], v[68:71], v[180:183]
    ds_read_b128 v[44:47], v10 offset:38912
    v_mfma_f32_16x16x32_bf16 v[184:187], v[88:91], v[72:75], v[184:187]
    v_mfma_f32_16x16x32_bf16 v[188:191], v[88:91], v[76:79], v[188:191]
    v_mfma_f32_16x16x32_bf16 v[192:195], v[92:95], v[64:67], v[192:195]
    v_mfma_f32_16x16x32_bf16 v[196:199], v[92:95], v[68:71], v[196:199]
    v_mfma_f32_16x16x32_bf16 v[200:203], v[92:95], v[72:75], v[200:203]
    buffer_load_dwordx4 v9, s[8:11], s75 offen offset:1024 sc1 lds
    v_mfma_f32_16x16x32_bf16 v[204:207], v[92:95], v[76:79], v[204:207]
    s_waitcnt vmcnt(16)
    s_waitcnt lgkmcnt(0)
    s_barrier
    v_mfma_f32_16x16x32_bf16 v[144:147], v[48:51], v[32:35], v[144:147]
    ds_read_b64_tr_b16 v[80:81], v96 offset:40960
    ds_read_b64_tr_b16 v[82:83], v96 offset:43008
    v_mfma_f32_16x16x32_bf16 v[148:151], v[48:51], v[36:39], v[148:151]
    ds_read_b128 v[64:67], v10 offset:33792
    s_add_u32 m0, s73, 16384
    s_add_u32 s74, s74, 65536
    buffer_load_dwordx4 v6, s[92:95], s74 offen lds
    v_mfma_f32_16x16x32_bf16 v[152:155], v[48:51], v[40:43], v[152:155]
    ds_read_b64_tr_b16 v[84:85], v97 offset:40960
    v_mfma_f32_16x16x32_bf16 v[156:159], v[48:51], v[44:47], v[156:159]
    ds_read_b64_tr_b16 v[86:87], v97 offset:43008
    v_mfma_f32_16x16x32_bf16 v[160:163], v[52:55], v[32:35], v[160:163]
    ds_read_b128 v[68:71], v10 offset:35840
    v_mfma_f32_16x16x32_bf16 v[164:167], v[52:55], v[36:39], v[164:167]
    ds_read_b64_tr_b16 v[88:89], v98 offset:40960
    ds_read_b64_tr_b16 v[90:91], v98 offset:43008
    v_mfma_f32_16x16x32_bf16 v[168:171], v[52:55], v[40:43], v[168:171]
    ds_read_b128 v[72:75], v10 offset:37888
    v_mfma_f32_16x16x32_bf16 v[172:175], v[52:55], v[44:47], v[172:175]
    ds_read_b64_tr_b16 v[92:93], v99 offset:40960
    v_mfma_f32_16x16x32_bf16 v[176:179], v[56:59], v[32:35], v[176:179]
    ds_read_b64_tr_b16 v[94:95], v99 offset:43008
    buffer_load_dwordx4 v12, s[92:95], s74 offen offset:1024 lds
    v_mfma_f32_16x16x32_bf16 v[180:183], v[56:59], v[36:39], v[180:183]
    ds_read_b128 v[76:79], v10 offset:39936
    v_mfma_f32_16x16x32_bf16 v[184:187], v[56:59], v[40:43], v[184:187]
    v_mfma_f32_16x16x32_bf16 v[188:191], v[56:59], v[44:47], v[188:191]
    buffer_load_dwordx4 v15, s[92:95], s74 offen offset:2048 lds
    v_mfma_f32_16x16x32_bf16 v[192:195], v[60:63], v[32:35], v[192:195]
    v_mfma_f32_16x16x32_bf16 v[196:199], v[60:63], v[36:39], v[196:199]
    buffer_load_dwordx4 v31, s[92:95], s74 offen offset:3072 lds
    v_mfma_f32_16x16x32_bf16 v[200:203], v[60:63], v[40:43], v[200:203]
    v_mfma_f32_16x16x32_bf16 v[204:207], v[60:63], v[44:47], v[204:207]
    s_waitcnt lgkmcnt(0)
    v_mfma_f32_16x16x32_bf16 v[144:147], v[80:83], v[64:67], v[144:147]
    ds_read_b64_tr_b16 v[48:49], v100 offset:0
    ds_read_b64_tr_b16 v[50:51], v100 offset:2048
    v_mfma_f32_16x16x32_bf16 v[148:151], v[80:83], v[68:71], v[148:151]
    ds_read_b128 v[32:35], v108 offset:0
    s_add_u32 m0, s73, 0
    s_add_u32 s75, s75, 2048
    buffer_load_dwordx4 v8, s[8:11], s75 offen sc1 lds
    v_mfma_f32_16x16x32_bf16 v[152:155], v[80:83], v[72:75], v[152:155]
    ds_read_b64_tr_b16 v[52:53], v101 offset:0
    v_mfma_f32_16x16x32_bf16 v[156:159], v[80:83], v[76:79], v[156:159]
    ds_read_b64_tr_b16 v[54:55], v101 offset:2048
    v_mfma_f32_16x16x32_bf16 v[160:163], v[84:87], v[64:67], v[160:163]
    ds_read_b128 v[36:39], v108 offset:2048
    v_mfma_f32_16x16x32_bf16 v[164:167], v[84:87], v[68:71], v[164:167]
    ds_read_b64_tr_b16 v[56:57], v102 offset:0
    ds_read_b64_tr_b16 v[58:59], v102 offset:2048
    v_mfma_f32_16x16x32_bf16 v[168:171], v[84:87], v[72:75], v[168:171]
    ds_read_b128 v[40:43], v108 offset:4096
    buffer_load_dwordx4 v8, s[8:11], s75 offen offset:1024 sc1 lds
    v_mfma_f32_16x16x32_bf16 v[172:175], v[84:87], v[76:79], v[172:175]
    ds_read_b64_tr_b16 v[60:61], v103 offset:0
    v_mfma_f32_16x16x32_bf16 v[176:179], v[88:91], v[64:67], v[176:179]
    ds_read_b64_tr_b16 v[62:63], v103 offset:2048
    s_add_u32 m0, s73, 2048
    s_nop 0
    buffer_load_dwordx4 v9, s[8:11], s75 offen sc1 lds
    v_mfma_f32_16x16x32_bf16 v[180:183], v[88:91], v[68:71], v[180:183]
    ds_read_b128 v[44:47], v108 offset:6144
    v_mfma_f32_16x16x32_bf16 v[184:187], v[88:91], v[72:75], v[184:187]
    v_mfma_f32_16x16x32_bf16 v[188:191], v[88:91], v[76:79], v[188:191]
    v_mfma_f32_16x16x32_bf16 v[192:195], v[92:95], v[64:67], v[192:195]
    v_mfma_f32_16x16x32_bf16 v[196:199], v[92:95], v[68:71], v[196:199]
    v_mfma_f32_16x16x32_bf16 v[200:203], v[92:95], v[72:75], v[200:203]
    buffer_load_dwordx4 v9, s[8:11], s75 offen offset:1024 sc1 lds
    v_mfma_f32_16x16x32_bf16 v[204:207], v[92:95], v[76:79], v[204:207]
    s_waitcnt vmcnt(16)
    s_waitcnt lgkmcnt(0)
    s_barrier
    v_mfma_f32_16x16x32_bf16 v[144:147], v[48:51], v[32:35], v[144:147]
    ds_read_b64_tr_b16 v[80:81], v100 offset:8192
    ds_read_b64_tr_b16 v[82:83], v100 offset:10240
    v_mfma_f32_16x16x32_bf16 v[148:151], v[48:51], v[36:39], v[148:151]
    ds_read_b128 v[64:67], v108 offset:1024
    s_add_u32 m0, s73, 49152
    s_add_u32 s74, s74, 65536
    buffer_load_dwordx4 v6, s[92:95], s74 offen lds
    v_mfma_f32_16x16x32_bf16 v[152:155], v[48:51], v[40:43], v[152:155]
    ds_read_b64_tr_b16 v[84:85], v101 offset:8192
    v_mfma_f32_16x16x32_bf16 v[156:159], v[48:51], v[44:47], v[156:159]
    ds_read_b64_tr_b16 v[86:87], v101 offset:10240
    v_mfma_f32_16x16x32_bf16 v[160:163], v[52:55], v[32:35], v[160:163]
    ds_read_b128 v[68:71], v108 offset:3072
    v_mfma_f32_16x16x32_bf16 v[164:167], v[52:55], v[36:39], v[164:167]
    ds_read_b64_tr_b16 v[88:89], v102 offset:8192
    ds_read_b64_tr_b16 v[90:91], v102 offset:10240
    v_mfma_f32_16x16x32_bf16 v[168:171], v[52:55], v[40:43], v[168:171]
    ds_read_b128 v[72:75], v108 offset:5120
    v_mfma_f32_16x16x32_bf16 v[172:175], v[52:55], v[44:47], v[172:175]
    ds_read_b64_tr_b16 v[92:93], v103 offset:8192
    v_mfma_f32_16x16x32_bf16 v[176:179], v[56:59], v[32:35], v[176:179]
    ds_read_b64_tr_b16 v[94:95], v103 offset:10240
    buffer_load_dwordx4 v12, s[92:95], s74 offen offset:1024 lds
    v_mfma_f32_16x16x32_bf16 v[180:183], v[56:59], v[36:39], v[180:183]
    ds_read_b128 v[76:79], v108 offset:7168
    v_mfma_f32_16x16x32_bf16 v[184:187], v[56:59], v[40:43], v[184:187]
    v_mfma_f32_16x16x32_bf16 v[188:191], v[56:59], v[44:47], v[188:191]
    buffer_load_dwordx4 v15, s[92:95], s74 offen offset:2048 lds
    v_mfma_f32_16x16x32_bf16 v[192:195], v[60:63], v[32:35], v[192:195]
    v_mfma_f32_16x16x32_bf16 v[196:199], v[60:63], v[36:39], v[196:199]
    buffer_load_dwordx4 v31, s[92:95], s74 offen offset:3072 lds
    v_mfma_f32_16x16x32_bf16 v[200:203], v[60:63], v[40:43], v[200:203]
    v_mfma_f32_16x16x32_bf16 v[204:207], v[60:63], v[44:47], v[204:207]
    s_waitcnt lgkmcnt(0)
    v_mfma_f32_16x16x32_bf16 v[144:147], v[80:83], v[64:67], v[144:147]
    ds_read_b64_tr_b16 v[48:49], v100 offset:32768
    ds_read_b64_tr_b16 v[50:51], v100 offset:34816
    v_mfma_f32_16x16x32_bf16 v[148:151], v[80:83], v[68:71], v[148:151]
    ds_read_b128 v[32:35], v108 offset:32768
    s_add_u32 m0, s73, 32768
    s_add_u32 s75, s75, 2048
    buffer_load_dwordx4 v8, s[8:11], s75 offen sc1 lds
    v_mfma_f32_16x16x32_bf16 v[152:155], v[80:83], v[72:75], v[152:155]
    ds_read_b64_tr_b16 v[52:53], v101 offset:32768
    v_mfma_f32_16x16x32_bf16 v[156:159], v[80:83], v[76:79], v[156:159]
    ds_read_b64_tr_b16 v[54:55], v101 offset:34816
    v_mfma_f32_16x16x32_bf16 v[160:163], v[84:87], v[64:67], v[160:163]
    ds_read_b128 v[36:39], v108 offset:34816
    v_mfma_f32_16x16x32_bf16 v[164:167], v[84:87], v[68:71], v[164:167]
    ds_read_b64_tr_b16 v[56:57], v102 offset:32768
    ds_read_b64_tr_b16 v[58:59], v102 offset:34816
    v_mfma_f32_16x16x32_bf16 v[168:171], v[84:87], v[72:75], v[168:171]
    ds_read_b128 v[40:43], v108 offset:36864
    buffer_load_dwordx4 v8, s[8:11], s75 offen offset:1024 sc1 lds
    v_mfma_f32_16x16x32_bf16 v[172:175], v[84:87], v[76:79], v[172:175]
    ds_read_b64_tr_b16 v[60:61], v103 offset:32768
    v_mfma_f32_16x16x32_bf16 v[176:179], v[88:91], v[64:67], v[176:179]
    ds_read_b64_tr_b16 v[62:63], v103 offset:34816
    s_add_u32 m0, s73, 34816
    s_nop 0
    buffer_load_dwordx4 v9, s[8:11], s75 offen sc1 lds
    v_mfma_f32_16x16x32_bf16 v[180:183], v[88:91], v[68:71], v[180:183]
    ds_read_b128 v[44:47], v108 offset:38912
    v_mfma_f32_16x16x32_bf16 v[184:187], v[88:91], v[72:75], v[184:187]
    v_mfma_f32_16x16x32_bf16 v[188:191], v[88:91], v[76:79], v[188:191]
    v_mfma_f32_16x16x32_bf16 v[192:195], v[92:95], v[64:67], v[192:195]
    v_mfma_f32_16x16x32_bf16 v[196:199], v[92:95], v[68:71], v[196:199]
    v_mfma_f32_16x16x32_bf16 v[200:203], v[92:95], v[72:75], v[200:203]
    buffer_load_dwordx4 v9, s[8:11], s75 offen offset:1024 sc1 lds
    v_mfma_f32_16x16x32_bf16 v[204:207], v[92:95], v[76:79], v[204:207]
    s_waitcnt vmcnt(16)
    s_waitcnt lgkmcnt(0)
    s_barrier
    v_mfma_f32_16x16x32_bf16 v[144:147], v[48:51], v[32:35], v[144:147]
    ds_read_b64_tr_b16 v[80:81], v100 offset:40960
    ds_read_b64_tr_b16 v[82:83], v100 offset:43008
    v_mfma_f32_16x16x32_bf16 v[148:151], v[48:51], v[36:39], v[148:151]
    ds_read_b128 v[64:67], v108 offset:33792
    s_add_u32 m0, s73, 81920
    s_add_u32 s74, s74, 65536
    buffer_load_dwordx4 v6, s[92:95], s74 offen lds
    v_mfma_f32_16x16x32_bf16 v[152:155], v[48:51], v[40:43], v[152:155]
    ds_read_b64_tr_b16 v[84:85], v101 offset:40960
    v_mfma_f32_16x16x32_bf16 v[156:159], v[48:51], v[44:47], v[156:159]
    ds_read_b64_tr_b16 v[86:87], v101 offset:43008
    v_mfma_f32_16x16x32_bf16 v[160:163], v[52:55], v[32:35], v[160:163]
    ds_read_b128 v[68:71], v108 offset:35840
    v_mfma_f32_16x16x32_bf16 v[164:167], v[52:55], v[36:39], v[164:167]
    ds_read_b64_tr_b16 v[88:89], v102 offset:40960
    ds_read_b64_tr_b16 v[90:91], v102 offset:43008
    v_mfma_f32_16x16x32_bf16 v[168:171], v[52:55], v[40:43], v[168:171]
    ds_read_b128 v[72:75], v108 offset:37888
    v_mfma_f32_16x16x32_bf16 v[172:175], v[52:55], v[44:47], v[172:175]
    ds_read_b64_tr_b16 v[92:93], v103 offset:40960
    v_mfma_f32_16x16x32_bf16 v[176:179], v[56:59], v[32:35], v[176:179]
    ds_read_b64_tr_b16 v[94:95], v103 offset:43008
    buffer_load_dwordx4 v12, s[92:95], s74 offen offset:1024 lds
    v_mfma_f32_16x16x32_bf16 v[180:183], v[56:59], v[36:39], v[180:183]
    ds_read_b128 v[76:79], v108 offset:39936
    v_mfma_f32_16x16x32_bf16 v[184:187], v[56:59], v[40:43], v[184:187]
    v_mfma_f32_16x16x32_bf16 v[188:191], v[56:59], v[44:47], v[188:191]
    buffer_load_dwordx4 v15, s[92:95], s74 offen offset:2048 lds
    v_mfma_f32_16x16x32_bf16 v[192:195], v[60:63], v[32:35], v[192:195]
    v_mfma_f32_16x16x32_bf16 v[196:199], v[60:63], v[36:39], v[196:199]
    buffer_load_dwordx4 v31, s[92:95], s74 offen offset:3072 lds
    v_mfma_f32_16x16x32_bf16 v[200:203], v[60:63], v[40:43], v[200:203]
    v_mfma_f32_16x16x32_bf16 v[204:207], v[60:63], v[44:47], v[204:207]
    s_waitcnt lgkmcnt(0)
    v_mfma_f32_16x16x32_bf16 v[144:147], v[80:83], v[64:67], v[144:147]
    ds_read_b64_tr_b16 v[48:49], v104 offset:0
    ds_read_b64_tr_b16 v[50:51], v104 offset:2048
    v_mfma_f32_16x16x32_bf16 v[148:151], v[80:83], v[68:71], v[148:151]
    ds_read_b128 v[32:35], v109 offset:0
    s_add_u32 m0, s73, 65536
    s_add_u32 s75, s75, 2048
    buffer_load_dwordx4 v8, s[8:11], s75 offen sc1 lds
    v_mfma_f32_16x16x32_bf16 v[152:155], v[80:83], v[72:75], v[152:155]
    ds_read_b64_tr_b16 v[52:53], v105 offset:0
    v_mfma_f32_16x16x32_bf16 v[156:159], v[80:83], v[76:79], v[156:159]
    ds_read_b64_tr_b16 v[54:55], v105 offset:2048
    v_mfma_f32_16x16x32_bf16 v[160:163], v[84:87], v[64:67], v[160:163]
    ds_read_b128 v[36:39], v109 offset:2048
    v_mfma_f32_16x16x32_bf16 v[164:167], v[84:87], v[68:71], v[164:167]
    ds_read_b64_tr_b16 v[56:57], v106 offset:0
    ds_read_b64_tr_b16 v[58:59], v106 offset:2048
    v_mfma_f32_16x16x32_bf16 v[168:171], v[84:87], v[72:75], v[168:171]
    ds_read_b128 v[40:43], v109 offset:4096
    buffer_load_dwordx4 v8, s[8:11], s75 offen offset:1024 sc1 lds
    v_mfma_f32_16x16x32_bf16 v[172:175], v[84:87], v[76:79], v[172:175]
    ds_read_b64_tr_b16 v[60:61], v107 offset:0
    v_mfma_f32_16x16x32_bf16 v[176:179], v[88:91], v[64:67], v[176:179]
    ds_read_b64_tr_b16 v[62:63], v107 offset:2048
    s_add_u32 m0, s73, 67584
    s_nop 0
    buffer_load_dwordx4 v9, s[8:11], s75 offen sc1 lds
    v_mfma_f32_16x16x32_bf16 v[180:183], v[88:91], v[68:71], v[180:183]
    ds_read_b128 v[44:47], v109 offset:6144
    v_mfma_f32_16x16x32_bf16 v[184:187], v[88:91], v[72:75], v[184:187]
    v_mfma_f32_16x16x32_bf16 v[188:191], v[88:91], v[76:79], v[188:191]
    v_mfma_f32_16x16x32_bf16 v[192:195], v[92:95], v[64:67], v[192:195]
    v_mfma_f32_16x16x32_bf16 v[196:199], v[92:95], v[68:71], v[196:199]
    v_mfma_f32_16x16x32_bf16 v[200:203], v[92:95], v[72:75], v[200:203]
    buffer_load_dwordx4 v9, s[8:11], s75 offen offset:1024 sc1 lds
    v_mfma_f32_16x16x32_bf16 v[204:207], v[92:95], v[76:79], v[204:207]
    s_waitcnt vmcnt(16)
    s_waitcnt lgkmcnt(0)
    s_barrier
    v_mfma_f32_16x16x32_bf16 v[144:147], v[48:51], v[32:35], v[144:147]
    ds_read_b64_tr_b16 v[80:81], v104 offset:8192
    ds_read_b64_tr_b16 v[82:83], v104 offset:10240
    v_mfma_f32_16x16x32_bf16 v[148:151], v[48:51], v[36:39], v[148:151]
    ds_read_b128 v[64:67], v109 offset:1024
    s_add_u32 m0, s73, 114688
    s_add_u32 s74, s74, 65536
    buffer_load_dwordx4 v6, s[92:95], s74 offen lds
    v_mfma_f32_16x16x32_bf16 v[152:155], v[48:51], v[40:43], v[152:155]
    ds_read_b64_tr_b16 v[84:85], v105 offset:8192
    v_mfma_f32_16x16x32_bf16 v[156:159], v[48:51], v[44:47], v[156:159]
    ds_read_b64_tr_b16 v[86:87], v105 offset:10240
    v_mfma_f32_16x16x32_bf16 v[160:163], v[52:55], v[32:35], v[160:163]
    ds_read_b128 v[68:71], v109 offset:3072
    v_mfma_f32_16x16x32_bf16 v[164:167], v[52:55], v[36:39], v[164:167]
    ds_read_b64_tr_b16 v[88:89], v106 offset:8192
    ds_read_b64_tr_b16 v[90:91], v106 offset:10240
    v_mfma_f32_16x16x32_bf16 v[168:171], v[52:55], v[40:43], v[168:171]
    ds_read_b128 v[72:75], v109 offset:5120
    v_mfma_f32_16x16x32_bf16 v[172:175], v[52:55], v[44:47], v[172:175]
    ds_read_b64_tr_b16 v[92:93], v107 offset:8192
    v_mfma_f32_16x16x32_bf16 v[176:179], v[56:59], v[32:35], v[176:179]
    ds_read_b64_tr_b16 v[94:95], v107 offset:10240
    buffer_load_dwordx4 v12, s[92:95], s74 offen offset:1024 lds
    v_mfma_f32_16x16x32_bf16 v[180:183], v[56:59], v[36:39], v[180:183]
    ds_read_b128 v[76:79], v109 offset:7168
    v_mfma_f32_16x16x32_bf16 v[184:187], v[56:59], v[40:43], v[184:187]
    v_mfma_f32_16x16x32_bf16 v[188:191], v[56:59], v[44:47], v[188:191]
    buffer_load_dwordx4 v15, s[92:95], s74 offen offset:2048 lds
    v_mfma_f32_16x16x32_bf16 v[192:195], v[60:63], v[32:35], v[192:195]
    v_mfma_f32_16x16x32_bf16 v[196:199], v[60:63], v[36:39], v[196:199]
    buffer_load_dwordx4 v31, s[92:95], s74 offen offset:3072 lds
    v_mfma_f32_16x16x32_bf16 v[200:203], v[60:63], v[40:43], v[200:203]
    v_mfma_f32_16x16x32_bf16 v[204:207], v[60:63], v[44:47], v[204:207]
    s_waitcnt lgkmcnt(0)
    v_mfma_f32_16x16x32_bf16 v[144:147], v[80:83], v[64:67], v[144:147]
    ds_read_b64_tr_b16 v[48:49], v96 offset:0
    ds_read_b64_tr_b16 v[50:51], v96 offset:2048
    v_mfma_f32_16x16x32_bf16 v[148:151], v[80:83], v[68:71], v[148:151]
    ds_read_b128 v[32:35], v10 offset:0
    s_add_u32 m0, s73, 98304
    s_add_u32 s75, s75, 2048
    buffer_load_dwordx4 v8, s[8:11], s75 offen sc1 lds
    v_mfma_f32_16x16x32_bf16 v[152:155], v[80:83], v[72:75], v[152:155]
    ds_read_b64_tr_b16 v[52:53], v97 offset:0
    v_mfma_f32_16x16x32_bf16 v[156:159], v[80:83], v[76:79], v[156:159]
    ds_read_b64_tr_b16 v[54:55], v97 offset:2048
    v_mfma_f32_16x16x32_bf16 v[160:163], v[84:87], v[64:67], v[160:163]
    ds_read_b128 v[36:39], v10 offset:2048
    v_mfma_f32_16x16x32_bf16 v[164:167], v[84:87], v[68:71], v[164:167]
    ds_read_b64_tr_b16 v[56:57], v98 offset:0
    ds_read_b64_tr_b16 v[58:59], v98 offset:2048
    v_mfma_f32_16x16x32_bf16 v[168:171], v[84:87], v[72:75], v[168:171]
    ds_read_b128 v[40:43], v10 offset:4096
    buffer_load_dwordx4 v8, s[8:11], s75 offen offset:1024 sc1 lds
    v_mfma_f32_16x16x32_bf16 v[172:175], v[84:87], v[76:79], v[172:175]
    ds_read_b64_tr_b16 v[60:61], v99 offset:0
    v_mfma_f32_16x16x32_bf16 v[176:179], v[88:91], v[64:67], v[176:179]
    ds_read_b64_tr_b16 v[62:63], v99 offset:2048
    s_add_u32 m0, s73, 100352
    s_nop 0
    buffer_load_dwordx4 v9, s[8:11], s75 offen sc1 lds
    v_mfma_f32_16x16x32_bf16 v[180:183], v[88:91], v[68:71], v[180:183]
    ds_read_b128 v[44:47], v10 offset:6144
    v_mfma_f32_16x16x32_bf16 v[184:187], v[88:91], v[72:75], v[184:187]
    v_mfma_f32_16x16x32_bf16 v[188:191], v[88:91], v[76:79], v[188:191]
    v_mfma_f32_16x16x32_bf16 v[192:195], v[92:95], v[64:67], v[192:195]
    v_mfma_f32_16x16x32_bf16 v[196:199], v[92:95], v[68:71], v[196:199]
    v_mfma_f32_16x16x32_bf16 v[200:203], v[92:95], v[72:75], v[200:203]
    buffer_load_dwordx4 v9, s[8:11], s75 offen offset:1024 sc1 lds
    v_mfma_f32_16x16x32_bf16 v[204:207], v[92:95], v[76:79], v[204:207]
    s_waitcnt vmcnt(16)
    s_waitcnt lgkmcnt(0)
    s_barrier
    v_mfma_f32_16x16x32_bf16 v[144:147], v[48:51], v[32:35], v[144:147]
    ds_read_b64_tr_b16 v[80:81], v96 offset:8192
    ds_read_b64_tr_b16 v[82:83], v96 offset:10240
    v_mfma_f32_16x16x32_bf16 v[148:151], v[48:51], v[36:39], v[148:151]
    ds_read_b128 v[64:67], v10 offset:1024
    s_add_u32 m0, s73, 147456
    s_add_u32 s74, s74, 65536
    buffer_load_dwordx4 v6, s[92:95], s74 offen lds
    v_mfma_f32_16x16x32_bf16 v[152:155], v[48:51], v[40:43], v[152:155]
    ds_read_b64_tr_b16 v[84:85], v97 offset:8192
    v_mfma_f32_16x16x32_bf16 v[156:159], v[48:51], v[44:47], v[156:159]
    ds_read_b64_tr_b16 v[86:87], v97 offset:10240
    v_mfma_f32_16x16x32_bf16 v[160:163], v[52:55], v[32:35], v[160:163]
    ds_read_b128 v[68:71], v10 offset:3072
    v_mfma_f32_16x16x32_bf16 v[164:167], v[52:55], v[36:39], v[164:167]
    ds_read_b64_tr_b16 v[88:89], v98 offset:8192
    ds_read_b64_tr_b16 v[90:91], v98 offset:10240
    v_mfma_f32_16x16x32_bf16 v[168:171], v[52:55], v[40:43], v[168:171]
    ds_read_b128 v[72:75], v10 offset:5120
    v_mfma_f32_16x16x32_bf16 v[172:175], v[52:55], v[44:47], v[172:175]
    ds_read_b64_tr_b16 v[92:93], v99 offset:8192
    v_mfma_f32_16x16x32_bf16 v[176:179], v[56:59], v[32:35], v[176:179]
    ds_read_b64_tr_b16 v[94:95], v99 offset:10240
    buffer_load_dwordx4 v12, s[92:95], s74 offen offset:1024 lds
    v_mfma_f32_16x16x32_bf16 v[180:183], v[56:59], v[36:39], v[180:183]
    ds_read_b128 v[76:79], v10 offset:7168
    v_mfma_f32_16x16x32_bf16 v[184:187], v[56:59], v[40:43], v[184:187]
    v_mfma_f32_16x16x32_bf16 v[188:191], v[56:59], v[44:47], v[188:191]
    buffer_load_dwordx4 v15, s[92:95], s74 offen offset:2048 lds
    v_mfma_f32_16x16x32_bf16 v[192:195], v[60:63], v[32:35], v[192:195]
    v_mfma_f32_16x16x32_bf16 v[196:199], v[60:63], v[36:39], v[196:199]
    buffer_load_dwordx4 v31, s[92:95], s74 offen offset:3072 lds
    v_mfma_f32_16x16x32_bf16 v[200:203], v[60:63], v[40:43], v[200:203]
    v_mfma_f32_16x16x32_bf16 v[204:207], v[60:63], v[44:47], v[204:207]
    s_waitcnt lgkmcnt(0)
    v_mfma_f32_16x16x32_bf16 v[144:147], v[80:83], v[64:67], v[144:147]
    ds_read_b64_tr_b16 v[48:49], v96 offset:32768
    ds_read_b64_tr_b16 v[50:51], v96 offset:34816
    v_mfma_f32_16x16x32_bf16 v[148:151], v[80:83], v[68:71], v[148:151]
    ds_read_b128 v[32:35], v10 offset:32768
    s_add_u32 m0, s73, 131072
    s_add_u32 s75, s75, 2048
    buffer_load_dwordx4 v8, s[8:11], s75 offen sc1 lds
    v_mfma_f32_16x16x32_bf16 v[152:155], v[80:83], v[72:75], v[152:155]
    ds_read_b64_tr_b16 v[52:53], v97 offset:32768
    v_mfma_f32_16x16x32_bf16 v[156:159], v[80:83], v[76:79], v[156:159]
    ds_read_b64_tr_b16 v[54:55], v97 offset:34816
    v_mfma_f32_16x16x32_bf16 v[160:163], v[84:87], v[64:67], v[160:163]
    ds_read_b128 v[36:39], v10 offset:34816
    v_mfma_f32_16x16x32_bf16 v[164:167], v[84:87], v[68:71], v[164:167]
    ds_read_b64_tr_b16 v[56:57], v98 offset:32768
    ds_read_b64_tr_b16 v[58:59], v98 offset:34816
    v_mfma_f32_16x16x32_bf16 v[168:171], v[84:87], v[72:75], v[168:171]
    ds_read_b128 v[40:43], v10 offset:36864
    buffer_load_dwordx4 v8, s[8:11], s75 offen offset:1024 sc1 lds
    v_mfma_f32_16x16x32_bf16 v[172:175], v[84:87], v[76:79], v[172:175]
    ds_read_b64_tr_b16 v[60:61], v99 offset:32768
    v_mfma_f32_16x16x32_bf16 v[176:179], v[88:91], v[64:67], v[176:179]
    ds_read_b64_tr_b16 v[62:63], v99 offset:34816
    s_add_u32 m0, s73, 133120
    s_nop 0
    buffer_load_dwordx4 v9, s[8:11], s75 offen sc1 lds
    v_mfma_f32_16x16x32_bf16 v[180:183], v[88:91], v[68:71], v[180:183]
    ds_read_b128 v[44:47], v10 offset:38912
    v_mfma_f32_16x16x32_bf16 v[184:187], v[88:91], v[72:75], v[184:187]
    v_mfma_f32_16x16x32_bf16 v[188:191], v[88:91], v[76:79], v[188:191]
    v_mfma_f32_16x16x32_bf16 v[192:195], v[92:95], v[64:67], v[192:195]
    v_mfma_f32_16x16x32_bf16 v[196:199], v[92:95], v[68:71], v[196:199]
    v_mfma_f32_16x16x32_bf16 v[200:203], v[92:95], v[72:75], v[200:203]
    buffer_load_dwordx4 v9, s[8:11], s75 offen offset:1024 sc1 lds
    v_mfma_f32_16x16x32_bf16 v[204:207], v[92:95], v[76:79], v[204:207]
    s_waitcnt vmcnt(16)
    s_waitcnt lgkmcnt(0)
    s_barrier
    v_mfma_f32_16x16x32_bf16 v[144:147], v[48:51], v[32:35], v[144:147]
    ds_read_b64_tr_b16 v[80:81], v96 offset:40960
    ds_read_b64_tr_b16 v[82:83], v96 offset:43008
    v_mfma_f32_16x16x32_bf16 v[148:151], v[48:51], v[36:39], v[148:151]
    ds_read_b128 v[64:67], v10 offset:33792
    s_add_u32 m0, s73, 16384
    s_add_u32 s74, s74, 65536
    buffer_load_dwordx4 v6, s[92:95], s74 offen lds
    v_mfma_f32_16x16x32_bf16 v[152:155], v[48:51], v[40:43], v[152:155]
    ds_read_b64_tr_b16 v[84:85], v97 offset:40960
    v_mfma_f32_16x16x32_bf16 v[156:159], v[48:51], v[44:47], v[156:159]
    ds_read_b64_tr_b16 v[86:87], v97 offset:43008
    v_mfma_f32_16x16x32_bf16 v[160:163], v[52:55], v[32:35], v[160:163]
    ds_read_b128 v[68:71], v10 offset:35840
    v_mfma_f32_16x16x32_bf16 v[164:167], v[52:55], v[36:39], v[164:167]
    ds_read_b64_tr_b16 v[88:89], v98 offset:40960
    ds_read_b64_tr_b16 v[90:91], v98 offset:43008
    v_mfma_f32_16x16x32_bf16 v[168:171], v[52:55], v[40:43], v[168:171]
    ds_read_b128 v[72:75], v10 offset:37888
    v_mfma_f32_16x16x32_bf16 v[172:175], v[52:55], v[44:47], v[172:175]
    ds_read_b64_tr_b16 v[92:93], v99 offset:40960
    v_mfma_f32_16x16x32_bf16 v[176:179], v[56:59], v[32:35], v[176:179]
    ds_read_b64_tr_b16 v[94:95], v99 offset:43008
    buffer_load_dwordx4 v12, s[92:95], s74 offen offset:1024 lds
    v_mfma_f32_16x16x32_bf16 v[180:183], v[56:59], v[36:39], v[180:183]
    ds_read_b128 v[76:79], v10 offset:39936
    v_mfma_f32_16x16x32_bf16 v[184:187], v[56:59], v[40:43], v[184:187]
    v_mfma_f32_16x16x32_bf16 v[188:191], v[56:59], v[44:47], v[188:191]
    buffer_load_dwordx4 v15, s[92:95], s74 offen offset:2048 lds
    v_mfma_f32_16x16x32_bf16 v[192:195], v[60:63], v[32:35], v[192:195]
    v_mfma_f32_16x16x32_bf16 v[196:199], v[60:63], v[36:39], v[196:199]
    buffer_load_dwordx4 v31, s[92:95], s74 offen offset:3072 lds
    v_mfma_f32_16x16x32_bf16 v[200:203], v[60:63], v[40:43], v[200:203]
    v_mfma_f32_16x16x32_bf16 v[204:207], v[60:63], v[44:47], v[204:207]
    s_waitcnt lgkmcnt(0)
    v_mfma_f32_16x16x32_bf16 v[144:147], v[80:83], v[64:67], v[144:147]
    ds_read_b64_tr_b16 v[48:49], v100 offset:0
    ds_read_b64_tr_b16 v[50:51], v100 offset:2048
    v_mfma_f32_16x16x32_bf16 v[148:151], v[80:83], v[68:71], v[148:151]
    ds_read_b128 v[32:35], v108 offset:0
    s_add_u32 m0, s73, 0
    s_add_u32 s75, s75, 2048
    buffer_load_dwordx4 v8, s[8:11], s75 offen sc1 lds
    v_mfma_f32_16x16x32_bf16 v[152:155], v[80:83], v[72:75], v[152:155]
    ds_read_b64_tr_b16 v[52:53], v101 offset:0
    v_mfma_f32_16x16x32_bf16 v[156:159], v[80:83], v[76:79], v[156:159]
    ds_read_b64_tr_b16 v[54:55], v101 offset:2048
    v_mfma_f32_16x16x32_bf16 v[160:163], v[84:87], v[64:67], v[160:163]
    ds_read_b128 v[36:39], v108 offset:2048
    v_mfma_f32_16x16x32_bf16 v[164:167], v[84:87], v[68:71], v[164:167]
    ds_read_b64_tr_b16 v[56:57], v102 offset:0
    ds_read_b64_tr_b16 v[58:59], v102 offset:2048
    v_mfma_f32_16x16x32_bf16 v[168:171], v[84:87], v[72:75], v[168:171]
    ds_read_b128 v[40:43], v108 offset:4096
    buffer_load_dwordx4 v8, s[8:11], s75 offen offset:1024 sc1 lds
    v_mfma_f32_16x16x32_bf16 v[172:175], v[84:87], v[76:79], v[172:175]
    ds_read_b64_tr_b16 v[60:61], v103 offset:0
    v_mfma_f32_16x16x32_bf16 v[176:179], v[88:91], v[64:67], v[176:179]
    ds_read_b64_tr_b16 v[62:63], v103 offset:2048
    s_add_u32 m0, s73, 2048
    s_nop 0
    buffer_load_dwordx4 v9, s[8:11], s75 offen sc1 lds
    v_mfma_f32_16x16x32_bf16 v[180:183], v[88:91], v[68:71], v[180:183]
    ds_read_b128 v[44:47], v108 offset:6144
    v_mfma_f32_16x16x32_bf16 v[184:187], v[88:91], v[72:75], v[184:187]
    v_mfma_f32_16x16x32_bf16 v[188:191], v[88:91], v[76:79], v[188:191]
    v_mfma_f32_16x16x32_bf16 v[192:195], v[92:95], v[64:67], v[192:195]
    v_mfma_f32_16x16x32_bf16 v[196:199], v[92:95], v[68:71], v[196:199]
    v_mfma_f32_16x16x32_bf16 v[200:203], v[92:95], v[72:75], v[200:203]
    buffer_load_dwordx4 v9, s[8:11], s75 offen offset:1024 sc1 lds
    v_mfma_f32_16x16x32_bf16 v[204:207], v[92:95], v[76:79], v[204:207]
    s_waitcnt vmcnt(16)
    s_waitcnt lgkmcnt(0)
    s_barrier
    v_mfma_f32_16x16x32_bf16 v[144:147], v[48:51], v[32:35], v[144:147]
    ds_read_b64_tr_b16 v[80:81], v100 offset:8192
    ds_read_b64_tr_b16 v[82:83], v100 offset:10240
    v_mfma_f32_16x16x32_bf16 v[148:151], v[48:51], v[36:39], v[148:151]
    ds_read_b128 v[64:67], v108 offset:1024
    v_mfma_f32_16x16x32_bf16 v[152:155], v[48:51], v[40:43], v[152:155]
    ds_read_b64_tr_b16 v[84:85], v101 offset:8192
    v_mfma_f32_16x16x32_bf16 v[156:159], v[48:51], v[44:47], v[156:159]
    ds_read_b64_tr_b16 v[86:87], v101 offset:10240
    v_mfma_f32_16x16x32_bf16 v[160:163], v[52:55], v[32:35], v[160:163]
    ds_read_b128 v[68:71], v108 offset:3072
    v_mfma_f32_16x16x32_bf16 v[164:167], v[52:55], v[36:39], v[164:167]
    ds_read_b64_tr_b16 v[88:89], v102 offset:8192
    ds_read_b64_tr_b16 v[90:91], v102 offset:10240
    v_mfma_f32_16x16x32_bf16 v[168:171], v[52:55], v[40:43], v[168:171]
    ds_read_b128 v[72:75], v108 offset:5120
    v_mfma_f32_16x16x32_bf16 v[172:175], v[52:55], v[44:47], v[172:175]
    ds_read_b64_tr_b16 v[92:93], v103 offset:8192
    v_mfma_f32_16x16x32_bf16 v[176:179], v[56:59], v[32:35], v[176:179]
    ds_read_b64_tr_b16 v[94:95], v103 offset:10240
    v_mfma_f32_16x16x32_bf16 v[180:183], v[56:59], v[36:39], v[180:183]
    ds_read_b128 v[76:79], v108 offset:7168
    v_mfma_f32_16x16x32_bf16 v[184:187], v[56:59], v[40:43], v[184:187]
    v_mfma_f32_16x16x32_bf16 v[188:191], v[56:59], v[44:47], v[188:191]
    v_mfma_f32_16x16x32_bf16 v[192:195], v[60:63], v[32:35], v[192:195]
    v_mfma_f32_16x16x32_bf16 v[196:199], v[60:63], v[36:39], v[196:199]
    v_mfma_f32_16x16x32_bf16 v[200:203], v[60:63], v[40:43], v[200:203]
    v_mfma_f32_16x16x32_bf16 v[204:207], v[60:63], v[44:47], v[204:207]
    s_waitcnt lgkmcnt(0)
    v_mfma_f32_16x16x32_bf16 v[144:147], v[80:83], v[64:67], v[144:147]
    ds_read_b64_tr_b16 v[48:49], v100 offset:32768
    ds_read_b64_tr_b16 v[50:51], v100 offset:34816
    v_mfma_f32_16x16x32_bf16 v[148:151], v[80:83], v[68:71], v[148:151]
    ds_read_b128 v[32:35], v108 offset:32768
    v_mfma_f32_16x16x32_bf16 v[152:155], v[80:83], v[72:75], v[152:155]
    ds_read_b64_tr_b16 v[52:53], v101 offset:32768
    v_mfma_f32_16x16x32_bf16 v[156:159], v[80:83], v[76:79], v[156:159]
    ds_read_b64_tr_b16 v[54:55], v101 offset:34816
    v_mfma_f32_16x16x32_bf16 v[160:163], v[84:87], v[64:67], v[160:163]
    ds_read_b128 v[36:39], v108 offset:34816
    v_mfma_f32_16x16x32_bf16 v[164:167], v[84:87], v[68:71], v[164:167]
    ds_read_b64_tr_b16 v[56:57], v102 offset:32768
    ds_read_b64_tr_b16 v[58:59], v102 offset:34816
    v_mfma_f32_16x16x32_bf16 v[168:171], v[84:87], v[72:75], v[168:171]
    ds_read_b128 v[40:43], v108 offset:36864
    v_mfma_f32_16x16x32_bf16 v[172:175], v[84:87], v[76:79], v[172:175]
    ds_read_b64_tr_b16 v[60:61], v103 offset:32768
    v_mfma_f32_16x16x32_bf16 v[176:179], v[88:91], v[64:67], v[176:179]
    ds_read_b64_tr_b16 v[62:63], v103 offset:34816
    v_mfma_f32_16x16x32_bf16 v[180:183], v[88:91], v[68:71], v[180:183]
    ds_read_b128 v[44:47], v108 offset:38912
    v_mfma_f32_16x16x32_bf16 v[184:187], v[88:91], v[72:75], v[184:187]
    v_mfma_f32_16x16x32_bf16 v[188:191], v[88:91], v[76:79], v[188:191]
    v_mfma_f32_16x16x32_bf16 v[192:195], v[92:95], v[64:67], v[192:195]
    v_mfma_f32_16x16x32_bf16 v[196:199], v[92:95], v[68:71], v[196:199]
    v_mfma_f32_16x16x32_bf16 v[200:203], v[92:95], v[72:75], v[200:203]
    v_mfma_f32_16x16x32_bf16 v[204:207], v[92:95], v[76:79], v[204:207]
    s_waitcnt vmcnt(8)
    s_waitcnt lgkmcnt(0)
    s_barrier
    v_mfma_f32_16x16x32_bf16 v[144:147], v[48:51], v[32:35], v[144:147]
    ds_read_b64_tr_b16 v[80:81], v100 offset:40960
    ds_read_b64_tr_b16 v[82:83], v100 offset:43008
    v_mfma_f32_16x16x32_bf16 v[148:151], v[48:51], v[36:39], v[148:151]
    ds_read_b128 v[64:67], v108 offset:33792
    v_mfma_f32_16x16x32_bf16 v[152:155], v[48:51], v[40:43], v[152:155]
    ds_read_b64_tr_b16 v[84:85], v101 offset:40960
    v_mfma_f32_16x16x32_bf16 v[156:159], v[48:51], v[44:47], v[156:159]
    ds_read_b64_tr_b16 v[86:87], v101 offset:43008
    v_mfma_f32_16x16x32_bf16 v[160:163], v[52:55], v[32:35], v[160:163]
    ds_read_b128 v[68:71], v108 offset:35840
    v_mfma_f32_16x16x32_bf16 v[164:167], v[52:55], v[36:39], v[164:167]
    ds_read_b64_tr_b16 v[88:89], v102 offset:40960
    ds_read_b64_tr_b16 v[90:91], v102 offset:43008
    v_mfma_f32_16x16x32_bf16 v[168:171], v[52:55], v[40:43], v[168:171]
    ds_read_b128 v[72:75], v108 offset:37888
    v_mfma_f32_16x16x32_bf16 v[172:175], v[52:55], v[44:47], v[172:175]
    ds_read_b64_tr_b16 v[92:93], v103 offset:40960
    v_mfma_f32_16x16x32_bf16 v[176:179], v[56:59], v[32:35], v[176:179]
    ds_read_b64_tr_b16 v[94:95], v103 offset:43008
    v_mfma_f32_16x16x32_bf16 v[180:183], v[56:59], v[36:39], v[180:183]
    ds_read_b128 v[76:79], v108 offset:39936
    v_mfma_f32_16x16x32_bf16 v[184:187], v[56:59], v[40:43], v[184:187]
    v_mfma_f32_16x16x32_bf16 v[188:191], v[56:59], v[44:47], v[188:191]
    v_mfma_f32_16x16x32_bf16 v[192:195], v[60:63], v[32:35], v[192:195]
    v_mfma_f32_16x16x32_bf16 v[196:199], v[60:63], v[36:39], v[196:199]
    v_mfma_f32_16x16x32_bf16 v[200:203], v[60:63], v[40:43], v[200:203]
    v_mfma_f32_16x16x32_bf16 v[204:207], v[60:63], v[44:47], v[204:207]
    s_waitcnt lgkmcnt(0)
    v_mfma_f32_16x16x32_bf16 v[144:147], v[80:83], v[64:67], v[144:147]
    ds_read_b64_tr_b16 v[48:49], v104 offset:0
    ds_read_b64_tr_b16 v[50:51], v104 offset:2048
    v_mfma_f32_16x16x32_bf16 v[148:151], v[80:83], v[68:71], v[148:151]
    ds_read_b128 v[32:35], v109 offset:0
    v_mfma_f32_16x16x32_bf16 v[152:155], v[80:83], v[72:75], v[152:155]
    ds_read_b64_tr_b16 v[52:53], v105 offset:0
    v_mfma_f32_16x16x32_bf16 v[156:159], v[80:83], v[76:79], v[156:159]
    ds_read_b64_tr_b16 v[54:55], v105 offset:2048
    v_mfma_f32_16x16x32_bf16 v[160:163], v[84:87], v[64:67], v[160:163]
    ds_read_b128 v[36:39], v109 offset:2048
    v_mfma_f32_16x16x32_bf16 v[164:167], v[84:87], v[68:71], v[164:167]
    ds_read_b64_tr_b16 v[56:57], v106 offset:0
    ds_read_b64_tr_b16 v[58:59], v106 offset:2048
    v_mfma_f32_16x16x32_bf16 v[168:171], v[84:87], v[72:75], v[168:171]
    ds_read_b128 v[40:43], v109 offset:4096
    v_mfma_f32_16x16x32_bf16 v[172:175], v[84:87], v[76:79], v[172:175]
    ds_read_b64_tr_b16 v[60:61], v107 offset:0
    v_mfma_f32_16x16x32_bf16 v[176:179], v[88:91], v[64:67], v[176:179]
    ds_read_b64_tr_b16 v[62:63], v107 offset:2048
    v_mfma_f32_16x16x32_bf16 v[180:183], v[88:91], v[68:71], v[180:183]
    ds_read_b128 v[44:47], v109 offset:6144
    v_mfma_f32_16x16x32_bf16 v[184:187], v[88:91], v[72:75], v[184:187]
    v_mfma_f32_16x16x32_bf16 v[188:191], v[88:91], v[76:79], v[188:191]
    v_mfma_f32_16x16x32_bf16 v[192:195], v[92:95], v[64:67], v[192:195]
    v_mfma_f32_16x16x32_bf16 v[196:199], v[92:95], v[68:71], v[196:199]
    v_mfma_f32_16x16x32_bf16 v[200:203], v[92:95], v[72:75], v[200:203]
    v_mfma_f32_16x16x32_bf16 v[204:207], v[92:95], v[76:79], v[204:207]
    s_waitcnt vmcnt(0)
    s_waitcnt lgkmcnt(0)
    s_barrier
    v_mfma_f32_16x16x32_bf16 v[144:147], v[48:51], v[32:35], v[144:147]
    ds_read_b64_tr_b16 v[80:81], v104 offset:8192
    ds_read_b64_tr_b16 v[82:83], v104 offset:10240
    v_mfma_f32_16x16x32_bf16 v[148:151], v[48:51], v[36:39], v[148:151]
    ds_read_b128 v[64:67], v109 offset:1024
    v_mfma_f32_16x16x32_bf16 v[152:155], v[48:51], v[40:43], v[152:155]
    ds_read_b64_tr_b16 v[84:85], v105 offset:8192
    v_mfma_f32_16x16x32_bf16 v[156:159], v[48:51], v[44:47], v[156:159]
    ds_read_b64_tr_b16 v[86:87], v105 offset:10240
    v_mfma_f32_16x16x32_bf16 v[160:163], v[52:55], v[32:35], v[160:163]
    ds_read_b128 v[68:71], v109 offset:3072
    v_mfma_f32_16x16x32_bf16 v[164:167], v[52:55], v[36:39], v[164:167]
    ds_read_b64_tr_b16 v[88:89], v106 offset:8192
    ds_read_b64_tr_b16 v[90:91], v106 offset:10240
    v_mfma_f32_16x16x32_bf16 v[168:171], v[52:55], v[40:43], v[168:171]
    ds_read_b128 v[72:75], v109 offset:5120
    v_mfma_f32_16x16x32_bf16 v[172:175], v[52:55], v[44:47], v[172:175]
    ds_read_b64_tr_b16 v[92:93], v107 offset:8192
    v_mfma_f32_16x16x32_bf16 v[176:179], v[56:59], v[32:35], v[176:179]
    ds_read_b64_tr_b16 v[94:95], v107 offset:10240
    v_mfma_f32_16x16x32_bf16 v[180:183], v[56:59], v[36:39], v[180:183]
    ds_read_b128 v[76:79], v109 offset:7168
    v_mfma_f32_16x16x32_bf16 v[184:187], v[56:59], v[40:43], v[184:187]
    v_mfma_f32_16x16x32_bf16 v[188:191], v[56:59], v[44:47], v[188:191]
    v_mfma_f32_16x16x32_bf16 v[192:195], v[60:63], v[32:35], v[192:195]
    v_mfma_f32_16x16x32_bf16 v[196:199], v[60:63], v[36:39], v[196:199]
    v_mfma_f32_16x16x32_bf16 v[200:203], v[60:63], v[40:43], v[200:203]
    v_mfma_f32_16x16x32_bf16 v[204:207], v[60:63], v[44:47], v[204:207]
    s_waitcnt lgkmcnt(0)
    v_mfma_f32_16x16x32_bf16 v[144:147], v[80:83], v[64:67], v[144:147]
    ds_read_b64_tr_b16 v[48:49], v96 offset:0
    ds_read_b64_tr_b16 v[50:51], v96 offset:2048
    v_mfma_f32_16x16x32_bf16 v[148:151], v[80:83], v[68:71], v[148:151]
    ds_read_b128 v[32:35], v10 offset:0
    v_mfma_f32_16x16x32_bf16 v[152:155], v[80:83], v[72:75], v[152:155]
    ds_read_b64_tr_b16 v[52:53], v97 offset:0
    v_mfma_f32_16x16x32_bf16 v[156:159], v[80:83], v[76:79], v[156:159]
    ds_read_b64_tr_b16 v[54:55], v97 offset:2048
    v_mfma_f32_16x16x32_bf16 v[160:163], v[84:87], v[64:67], v[160:163]
    ds_read_b128 v[36:39], v10 offset:2048
    v_mfma_f32_16x16x32_bf16 v[164:167], v[84:87], v[68:71], v[164:167]
    ds_read_b64_tr_b16 v[56:57], v98 offset:0
    ds_read_b64_tr_b16 v[58:59], v98 offset:2048
    v_mfma_f32_16x16x32_bf16 v[168:171], v[84:87], v[72:75], v[168:171]
    ds_read_b128 v[40:43], v10 offset:4096
    v_mfma_f32_16x16x32_bf16 v[172:175], v[84:87], v[76:79], v[172:175]
    ds_read_b64_tr_b16 v[60:61], v99 offset:0
    v_mfma_f32_16x16x32_bf16 v[176:179], v[88:91], v[64:67], v[176:179]
    ds_read_b64_tr_b16 v[62:63], v99 offset:2048
    v_mfma_f32_16x16x32_bf16 v[180:183], v[88:91], v[68:71], v[180:183]
    ds_read_b128 v[44:47], v10 offset:6144
    v_mfma_f32_16x16x32_bf16 v[184:187], v[88:91], v[72:75], v[184:187]
    v_mfma_f32_16x16x32_bf16 v[188:191], v[88:91], v[76:79], v[188:191]
    v_mfma_f32_16x16x32_bf16 v[192:195], v[92:95], v[64:67], v[192:195]
    v_mfma_f32_16x16x32_bf16 v[196:199], v[92:95], v[68:71], v[196:199]
    v_mfma_f32_16x16x32_bf16 v[200:203], v[92:95], v[72:75], v[200:203]
    v_mfma_f32_16x16x32_bf16 v[204:207], v[92:95], v[76:79], v[204:207]
    s_waitcnt lgkmcnt(0)
    s_barrier
    v_mfma_f32_16x16x32_bf16 v[144:147], v[48:51], v[32:35], v[144:147]
    ds_read_b64_tr_b16 v[80:81], v96 offset:8192
    ds_read_b64_tr_b16 v[82:83], v96 offset:10240
    v_mfma_f32_16x16x32_bf16 v[148:151], v[48:51], v[36:39], v[148:151]
    ds_read_b128 v[64:67], v10 offset:1024
    v_mfma_f32_16x16x32_bf16 v[152:155], v[48:51], v[40:43], v[152:155]
    ds_read_b64_tr_b16 v[84:85], v97 offset:8192
    v_mfma_f32_16x16x32_bf16 v[156:159], v[48:51], v[44:47], v[156:159]
    ds_read_b64_tr_b16 v[86:87], v97 offset:10240
    v_mfma_f32_16x16x32_bf16 v[160:163], v[52:55], v[32:35], v[160:163]
    ds_read_b128 v[68:71], v10 offset:3072
    v_mfma_f32_16x16x32_bf16 v[164:167], v[52:55], v[36:39], v[164:167]
    ds_read_b64_tr_b16 v[88:89], v98 offset:8192
    ds_read_b64_tr_b16 v[90:91], v98 offset:10240
    v_mfma_f32_16x16x32_bf16 v[168:171], v[52:55], v[40:43], v[168:171]
    ds_read_b128 v[72:75], v10 offset:5120
    v_mfma_f32_16x16x32_bf16 v[172:175], v[52:55], v[44:47], v[172:175]
    ds_read_b64_tr_b16 v[92:93], v99 offset:8192
    v_mfma_f32_16x16x32_bf16 v[176:179], v[56:59], v[32:35], v[176:179]
    ds_read_b64_tr_b16 v[94:95], v99 offset:10240
    v_mfma_f32_16x16x32_bf16 v[180:183], v[56:59], v[36:39], v[180:183]
    ds_read_b128 v[76:79], v10 offset:7168
    v_mfma_f32_16x16x32_bf16 v[184:187], v[56:59], v[40:43], v[184:187]
    v_mfma_f32_16x16x32_bf16 v[188:191], v[56:59], v[44:47], v[188:191]
    v_mfma_f32_16x16x32_bf16 v[192:195], v[60:63], v[32:35], v[192:195]
    v_mfma_f32_16x16x32_bf16 v[196:199], v[60:63], v[36:39], v[196:199]
    v_mfma_f32_16x16x32_bf16 v[200:203], v[60:63], v[40:43], v[200:203]
    v_mfma_f32_16x16x32_bf16 v[204:207], v[60:63], v[44:47], v[204:207]
    s_waitcnt lgkmcnt(0)
    v_mfma_f32_16x16x32_bf16 v[144:147], v[80:83], v[64:67], v[144:147]
    v_mfma_f32_16x16x32_bf16 v[148:151], v[80:83], v[68:71], v[148:151]
    v_mfma_f32_16x16x32_bf16 v[152:155], v[80:83], v[72:75], v[152:155]
    v_mfma_f32_16x16x32_bf16 v[156:159], v[80:83], v[76:79], v[156:159]
    v_mfma_f32_16x16x32_bf16 v[160:163], v[84:87], v[64:67], v[160:163]
    v_mfma_f32_16x16x32_bf16 v[164:167], v[84:87], v[68:71], v[164:167]
    v_mfma_f32_16x16x32_bf16 v[168:171], v[84:87], v[72:75], v[168:171]
    v_mfma_f32_16x16x32_bf16 v[172:175], v[84:87], v[76:79], v[172:175]
    v_mfma_f32_16x16x32_bf16 v[176:179], v[88:91], v[64:67], v[176:179]
    v_mfma_f32_16x16x32_bf16 v[180:183], v[88:91], v[68:71], v[180:183]
    v_mfma_f32_16x16x32_bf16 v[184:187], v[88:91], v[72:75], v[184:187]
    v_mfma_f32_16x16x32_bf16 v[188:191], v[88:91], v[76:79], v[188:191]
    v_mfma_f32_16x16x32_bf16 v[192:195], v[92:95], v[64:67], v[192:195]
    v_mfma_f32_16x16x32_bf16 v[196:199], v[92:95], v[68:71], v[196:199]
    v_mfma_f32_16x16x32_bf16 v[200:203], v[92:95], v[72:75], v[200:203]
    v_mfma_f32_16x16x32_bf16 v[204:207], v[92:95], v[76:79], v[204:207]
    s_lshl_b32 s3, s88, 2
    s_add_u32 s4, s3, s89
    s_lshl_b32 s5, s4, 2
    s_add_u32 s5, s5, s87
    s_lshl_b32 s5, s5, 13
    s_add_u32 s5, s5, 83886080
    s_lshl_b32 s4, s4, 7
    s_lshl_b32 s6, s87, 2
    s_add_u32 s4, s4, s6
    s_add_u32 s4, s4, 79265792
    s_barrier
    s_cmp_eq_u32 s89, s87
    s_cbranch_scc1 L_attn3_own
    v_cvt_pk_bf16_f32 v32, v144, v145
    v_cvt_pk_bf16_f32 v33, v146, v147
    v_cvt_pk_bf16_f32 v34, v160, v161
    v_cvt_pk_bf16_f32 v35, v162, v163
    buffer_store_dwordx4 v[32:35], v8, s[8:11], s5 offen offset:0 sc0 sc1
    v_cvt_pk_bf16_f32 v36, v176, v177
    v_cvt_pk_bf16_f32 v37, v178, v179
    v_cvt_pk_bf16_f32 v38, v192, v193
    v_cvt_pk_bf16_f32 v39, v194, v195
    buffer_store_dwordx4 v[36:39], v8, s[8:11], s5 offen offset:1024 sc0 sc1
    v_cvt_pk_bf16_f32 v40, v148, v149
    v_cvt_pk_bf16_f32 v41, v150, v151
    v_cvt_pk_bf16_f32 v42, v164, v165
    v_cvt_pk_bf16_f32 v43, v166, v167
    buffer_store_dwordx4 v[40:43], v8, s[8:11], s5 offen offset:2048 sc0 sc1
    v_cvt_pk_bf16_f32 v44, v180, v181
    v_cvt_pk_bf16_f32 v45, v182, v183
    v_cvt_pk_bf16_f32 v46, v196, v197
    v_cvt_pk_bf16_f32 v47, v198, v199
    buffer_store_dwordx4 v[44:47], v8, s[8:11], s5 offen offset:3072 sc0 sc1
    v_cvt_pk_bf16_f32 v48, v152, v153
    v_cvt_pk_bf16_f32 v49, v154, v155
    v_cvt_pk_bf16_f32 v50, v168, v169
    v_cvt_pk_bf16_f32 v51, v170, v171
    s_add_u32 s5, s5, 4096
    buffer_store_dwordx4 v[48:51], v8, s[8:11], s5 offen offset:0 sc0 sc1
    v_cvt_pk_bf16_f32 v52, v184, v185
    v_cvt_pk_bf16_f32 v53, v186, v187
    v_cvt_pk_bf16_f32 v54, v200, v201
    v_cvt_pk_bf16_f32 v55, v202, v203
    buffer_store_dwordx4 v[52:55], v8, s[8:11], s5 offen offset:1024 sc0 sc1
    v_cvt_pk_bf16_f32 v56, v156, v157
    v_cvt_pk_bf16_f32 v57, v158, v159
    v_cvt_pk_bf16_f32 v58, v172, v173
    v_cvt_pk_bf16_f32 v59, v174, v175
    buffer_store_dwordx4 v[56:59], v8, s[8:11], s5 offen offset:2048 sc0 sc1
    v_cvt_pk_bf16_f32 v60, v188, v189
    v_cvt_pk_bf16_f32 v61, v190, v191
    v_cvt_pk_bf16_f32 v62, v204, v205
    v_cvt_pk_bf16_f32 v63, v206, v207
    buffer_store_dwordx4 v[60:63], v8, s[8:11], s5 offen offset:3072 sc0 sc1
    s_waitcnt vmcnt(0)
    s_branch L_attn3_sent
L_attn3_own:
    ds_write_b128 v8, v[144:147] offset:0
    ds_write_b128 v8, v[160:163] offset:1024
    ds_write_b128 v8, v[176:179] offset:2048
    ds_write_b128 v8, v[192:195] offset:3072
    ds_write_b128 v8, v[148:151] offset:4096
    ds_write_b128 v8, v[164:167] offset:5120
    ds_write_b128 v8, v[180:183] offset:6144
    ds_write_b128 v8, v[196:199] offset:7168
    ds_write_b128 v8, v[152:155] offset:8192
    ds_write_b128 v8, v[168:171] offset:9216
    ds_write_b128 v8, v[184:187] offset:10240
    ds_write_b128 v8, v[200:203] offset:11264
    ds_write_b128 v8, v[156:159] offset:12288
    ds_write_b128 v8, v[172:175] offset:13312
    ds_write_b128 v8, v[188:191] offset:14336
    ds_write_b128 v8, v[204:207] offset:15360
    s_waitcnt lgkmcnt(0)
L_attn3_sent:
    s_mov_b64 exec, 1
    buffer_store_dword v20, v21, s[8:11], s4 offen sc0 sc1
    s_mov_b64 exec, -1
    s_add_u32 s3, s3, s87
    s_lshl_b32 s83, s3, 7
    s_add_u32 s83, s83, 79265792
    v_mov_b32 v229, 0
    buffer_load_dwordx4 v[208:211], v229, s[8:11], s83 offen sc0 sc1
    s_lshl_b32 s3, s3, 15
    s_add_u32 s3, s3, 83886080
    s_lshl_b32 s6, s89, 11
    s_add_u32 s3, s3, s6
    s_lshl_b32 s6, s89, 12
    v_add_u32 v12, s6, v8
    s_barrier
    ds_read_b128 v[96:99], v12 offset:0
    ds_read_b128 v[100:103], v12 offset:1024
    ds_read_b128 v[104:107], v12 offset:2048
    ds_read_b128 v[108:111], v12 offset:3072
    v_lshlrev_b32 v112, 16, v232
    v_and_b32 v113, 0xffff0000, v232
    v_lshlrev_b32 v114, 16, v233
    v_and_b32 v115, 0xffff0000, v233
    v_lshlrev_b32 v116, 16, v234
    v_and_b32 v117, 0xffff0000, v234
    v_lshlrev_b32 v118, 16, v235
    v_and_b32 v119, 0xffff0000, v235
    v_lshlrev_b32 v120, 16, v236
    v_and_b32 v121, 0xffff0000, v236
    v_lshlrev_b32 v122, 16, v237
    v_and_b32 v123, 0xffff0000, v237
    v_lshlrev_b32 v124, 16, v238
    v_and_b32 v125, 0xffff0000, v238
    v_lshlrev_b32 v126, 16, v239
    v_and_b32 v127, 0xffff0000, v239
    s_waitcnt vmcnt(0) lgkmcnt(0)
    v_pk_add_f32 v[96:97], v[96:97], v[112:113]
    v_pk_add_f32 v[98:99], v[98:99], v[114:115]
    v_pk_add_f32 v[100:101], v[100:101], v[116:117]
    v_pk_add_f32 v[102:103], v[102:103], v[118:119]
    v_pk_add_f32 v[104:105], v[104:105], v[120:121]
    v_pk_add_f32 v[106:107], v[106:107], v[122:123]
    v_pk_add_f32 v[108:109], v[108:109], v[124:125]
    v_pk_add_f32 v[110:111], v[110:111], v[126:127]
    s_mov_b32 s7, 0
L_attn3b_poll:
    v_and_b32 v208, v208, v209
    v_and_b32 v210, v210, v211
    v_and_b32 v208, v208, v210
    v_cmp_ne_u32 vcc, 1, v208
    s_add_u32 s7, s7, 1
    s_cbranch_vccz L_attn3b_go
    s_sleep 1
    buffer_load_dwordx4 v[208:211], v229, s[8:11], s83 offen sc0 sc1
    s_waitcnt vmcnt(0)
    s_cmp_lt_u32 s7, 0x40000
    s_cbranch_scc1 L_attn3b_poll
L_attn3b_go:
    s_add_u32 s6, s87, 1
    s_and_b32 s6, s6, 3
    s_lshl_b32 s6, s6, 13
    s_add_u32 s6, s6, s3
    buffer_load_dwordx4 v[32:35], v8, s[8:11], s6 offen offset:0 sc0 sc1
    buffer_load_dwordx4 v[36:39], v8, s[8:11], s6 offen offset:1024 sc0 sc1
    s_add_u32 s6, s87, 2
    s_and_b32 s6, s6, 3
    s_lshl_b32 s6, s6, 13
    s_add_u32 s6, s6, s3
    buffer_load_dwordx4 v[40:43], v8, s[8:11], s6 offen offset:0 sc0 sc1
    buffer_load_dwordx4 v[44:47], v8, s[8:11], s6 offen offset:1024 sc0 sc1
    s_add_u32 s6, s87, 3
    s_and_b32 s6, s6, 3
    s_lshl_b32 s6, s6, 13
    s_add_u32 s6, s6, s3
    buffer_load_dwordx4 v[48:51], v8, s[8:11], s6 offen offset:0 sc0 sc1
    buffer_load_dwordx4 v[52:55], v8, s[8:11], s6 offen offset:1024 sc0 sc1
    s_waitcnt vmcnt(4)
    v_lshlrev_b32 v112, 16, v32
    v_and_b32 v113, 0xffff0000, v32
    v_lshlrev_b32 v114, 16, v33
    v_and_b32 v115, 0xffff0000, v33
    v_lshlrev_b32 v116, 16, v34
    v_and_b32 v117, 0xffff0000, v34
    v_lshlrev_b32 v118, 16, v35
    v_and_b32 v119, 0xffff0000, v35
    v_lshlrev_b32 v120, 16, v36
    v_and_b32 v121, 0xffff0000, v36
    v_lshlrev_b32 v122, 16, v37
    v_and_b32 v123, 0xffff0000, v37
    v_lshlrev_b32 v124, 16, v38
    v_and_b32 v125, 0xffff0000, v38
    v_lshlrev_b32 v126, 16, v39
    v_and_b32 v127, 0xffff0000, v39
    v_pk_add_f32 v[96:97], v[96:97], v[112:113]
    v_pk_add_f32 v[98:99], v[98:99], v[114:115]
    v_pk_add_f32 v[100:101], v[100:101], v[116:117]
    v_pk_add_f32 v[102:103], v[102:103], v[118:119]
    v_pk_add_f32 v[104:105], v[104:105], v[120:121]
    v_pk_add_f32 v[106:107], v[106:107], v[122:123]
    v_pk_add_f32 v[108:109], v[108:109], v[124:125]
    v_pk_add_f32 v[110:111], v[110:111], v[126:127]
    s_waitcnt vmcnt(2)
    v_lshlrev_b32 v112, 16, v40
    v_and_b32 v113, 0xffff0000, v40
    v_lshlrev_b32 v114, 16, v41
    v_and_b32 v115, 0xffff0000, v41
    v_lshlrev_b32 v116, 16, v42
    v_and_b32 v117, 0xffff0000, v42
    v_lshlrev_b32 v118, 16, v43
    v_and_b32 v119, 0xffff0000, v43
    v_lshlrev_b32 v120, 16, v44
    v_and_b32 v121, 0xffff0000, v44
    v_lshlrev_b32 v122, 16, v45
    v_and_b32 v123, 0xffff0000, v45
    v_lshlrev_b32 v124, 16, v46
    v_and_b32 v125, 0xffff0000, v46
    v_lshlrev_b32 v126, 16, v47
    v_and_b32 v127, 0xffff0000, v47
    v_pk_add_f32 v[96:97], v[96:97], v[112:113]
    v_pk_add_f32 v[98:99], v[98:99], v[114:115]
    v_pk_add_f32 v[100:101], v[100:101], v[116:117]
    v_pk_add_f32 v[102:103], v[102:103], v[118:119]
    v_pk_add_f32 v[104:105], v[104:105], v[120:121]
    v_pk_add_f32 v[106:107], v[106:107], v[122:123]
    v_pk_add_f32 v[108:109], v[108:109], v[124:125]
    v_pk_add_f32 v[110:111], v[110:111], v[126:127]
    s_waitcnt vmcnt(0)
    v_lshlrev_b32 v112, 16, v48
    v_and_b32 v113, 0xffff0000, v48
    v_lshlrev_b32 v114, 16, v49
    v_and_b32 v115, 0xffff0000, v49
    v_lshlrev_b32 v116, 16, v50
    v_and_b32 v117, 0xffff0000, v50
    v_lshlrev_b32 v118, 16, v51
    v_and_b32 v119, 0xffff0000, v51
    v_lshlrev_b32 v120, 16, v52
    v_and_b32 v121, 0xffff0000, v52
    v_lshlrev_b32 v122, 16, v53
    v_and_b32 v123, 0xffff0000, v53
    v_lshlrev_b32 v124, 16, v54
    v_and_b32 v125, 0xffff0000, v54
    v_lshlrev_b32 v126, 16, v55
    v_and_b32 v127, 0xffff0000, v55
    v_pk_add_f32 v[96:97], v[96:97], v[112:113]
    v_pk_add_f32 v[98:99], v[98:99], v[114:115]
    v_pk_add_f32 v[100:101], v[100:101], v[116:117]
    v_pk_add_f32 v[102:103], v[102:103], v[118:119]
    v_pk_add_f32 v[104:105], v[104:105], v[120:121]
    v_pk_add_f32 v[106:107], v[106:107], v[122:123]
    v_pk_add_f32 v[108:109], v[108:109], v[124:125]
    v_pk_add_f32 v[110:111], v[110:111], v[126:127]
    v_cvt_pk_bf16_f32 v64, v96, v97
    v_cvt_pk_bf16_f32 v65, v98, v99
    v_cvt_pk_bf16_f32 v66, v100, v101
    v_cvt_pk_bf16_f32 v67, v102, v103
    v_cvt_pk_bf16_f32 v68, v104, v105
    v_cvt_pk_bf16_f32 v69, v106, v107
    v_cvt_pk_bf16_f32 v70, v108, v109
    v_cvt_pk_bf16_f32 v71, v110, v111
    buffer_store_dwordx2 v[64:65], v228, s[40:43], s82 offen offset:0
    buffer_store_dwordx2 v[66:67], v228, s[40:43], s82 offen offset:32
    buffer_store_dwordx2 v[68:69], v228, s[40:43], s82 offen offset:64
    buffer_store_dwordx2 v[70:71], v228, s[40:43], s82 offen offset:96
L_attn_end:
    s_endpgm
L_attn_s1:
    s_call_b64 s[48:49], L_attn_slow_a
    s_branch L_attn_s1r
L_attn_s2:
    s_call_b64 s[48:49], L_attn_slow_b
    s_branch L_attn_s2r
L_attn_s3:
    s_call_b64 s[48:49], L_attn_slow_a
    s_branch L_attn_s3r
L_attn_s4:
    s_call_b64 s[48:49], L_attn_slow_b
    s_branch L_attn_s4r
L_attn_s5:
    s_call_b64 s[48:49], L_attn_slow_a
    s_branch L_attn_s5r
L_attn_s6:
    s_call_b64 s[48:49], L_attn_slow_b
    s_branch L_attn_s6r
L_attn_s7:
    s_call_b64 s[48:49], L_attn_slow_c
    s_branch L_attn_s7r
L_attn_s8:
    s_call_b64 s[48:49], L_attn_slow_b
    s_branch L_attn_s8r
L_attn_s9:
    s_call_b64 s[48:49], L_attn_slow_c
    s_branch L_attn_s9r
L_attn_s10:
    s_call_b64 s[48:49], L_attn_slow_b
    s_branch L_attn_s10r
L_attn_s11:
    s_call_b64 s[48:49], L_attn_slow_c
    s_branch L_attn_s11r
L_attn_s12:
    s_call_b64 s[48:49], L_attn_slow_b
    s_branch L_attn_s12r
L_attn_slow_a:
    v_max3_f32 v240, v32, v33, v34
    v_max3_f32 v240, v240, v35, v36
    v_max3_f32 v240, v240, v37, v38
    v_max3_f32 v240, v240, v39, v40
    v_max3_f32 v240, v240, v41, v42
    v_max3_f32 v240, v240, v43, v44
    v_max3_f32 v240, v240, v45, v46
    v_max_f32 v240, v240, v47
    v_mov_b32 v241, v240
    v_cmp_gt_f32_e64 s[40:41], 0, v19
    s_nop 0
    v_permlane32_swap_b32 v240, v241
    v_mov_b32 v243, 0
    v_mov_b32 v242, 0x43800000
    v_max_f32 v240, v240, v241
    v_cndmask_b32_e64 v241, v243, v25, s[40:41]
    v_max_f32 v240, v240, v241
    v_cmp_eq_f32 vcc, v240, v25
    s_nop 1
    v_cndmask_b32 v240, v240, v243, vcc
    v_cndmask_b32 v19, v242, v19, vcc
    v_sub_f32 v242, v96, v240
    v_mov_b32 v96, v242
    v_sub_f32 v32, v32, v240
    v_mov_b32 v97, v242
    v_sub_f32 v33, v33, v240
    v_mov_b32 v98, v242
    v_sub_f32 v34, v34, v240
    v_mov_b32 v99, v242
    v_sub_f32 v35, v35, v240
    v_mov_b32 v100, v242
    v_sub_f32 v36, v36, v240
    v_mov_b32 v101, v242
    v_sub_f32 v37, v37, v240
    v_mov_b32 v102, v242
    v_sub_f32 v38, v38, v240
    v_mov_b32 v103, v242
    v_sub_f32 v39, v39, v240
    v_mov_b32 v104, v242
    v_sub_f32 v40, v40, v240
    v_mov_b32 v105, v242
    v_sub_f32 v41, v41, v240
    v_mov_b32 v106, v242
    v_sub_f32 v42, v42, v240
    v_mov_b32 v107, v242
    v_sub_f32 v43, v43, v240
    v_mov_b32 v108, v242
    v_sub_f32 v44, v44, v240
    v_mov_b32 v109, v242
    v_sub_f32 v45, v45, v240
    v_mov_b32 v110, v242
    v_sub_f32 v46, v46, v240
    v_mov_b32 v111, v242
    v_sub_f32 v47, v47, v240
    s_cmp_eq_u64 s[40:41], exec
    s_cbranch_scc1 L_attn_slow_a_n
    v_max_f32 v241, 0, v240
    v_exp_f32 v241, -v241
    s_nop 7
    v_mul_f32 v16, v16, v241
    v_accvgpr_read_b32 v244, a0
    v_accvgpr_read_b32 v245, a1
    v_accvgpr_read_b32 v246, a2
    v_accvgpr_read_b32 v247, a3
    v_mul_f32 v244, v244, v241
    v_mul_f32 v245, v245, v241
    v_mul_f32 v246, v246, v241
    v_mul_f32 v247, v247, v241
    v_accvgpr_write_b32 a0, v244
    v_accvgpr_write_b32 a1, v245
    v_accvgpr_write_b32 a2, v246
    v_accvgpr_write_b32 a3, v247
    v_accvgpr_read_b32 v244, a4
    v_accvgpr_read_b32 v245, a5
    v_accvgpr_read_b32 v246, a6
    v_accvgpr_read_b32 v247, a7
    v_mul_f32 v244, v244, v241
    v_mul_f32 v245, v245, v241
    v_mul_f32 v246, v246, v241
    v_mul_f32 v247, v247, v241
    v_accvgpr_write_b32 a4, v244
    v_accvgpr_write_b32 a5, v245
    v_accvgpr_write_b32 a6, v246
    v_accvgpr_write_b32 a7, v247
    v_accvgpr_read_b32 v244, a8
    v_accvgpr_read_b32 v245, a9
    v_accvgpr_read_b32 v246, a10
    v_accvgpr_read_b32 v247, a11
    v_mul_f32 v244, v244, v241
    v_mul_f32 v245, v245, v241
    v_mul_f32 v246, v246, v241
    v_mul_f32 v247, v247, v241
    v_accvgpr_write_b32 a8, v244
    v_accvgpr_write_b32 a9, v245
    v_accvgpr_write_b32 a10, v246
    v_accvgpr_write_b32 a11, v247
    v_accvgpr_read_b32 v244, a12
    v_accvgpr_read_b32 v245, a13
    v_accvgpr_read_b32 v246, a14
    v_accvgpr_read_b32 v247, a15
    v_mul_f32 v244, v244, v241
    v_mul_f32 v245, v245, v241
    v_mul_f32 v246, v246, v241
    v_mul_f32 v247, v247, v241
    v_accvgpr_write_b32 a12, v244
    v_accvgpr_write_b32 a13, v245
    v_accvgpr_write_b32 a14, v246
    v_accvgpr_write_b32 a15, v247
    v_accvgpr_read_b32 v244, a16
    v_accvgpr_read_b32 v245, a17
    v_accvgpr_read_b32 v246, a18
    v_accvgpr_read_b32 v247, a19
    v_mul_f32 v244, v244, v241
    v_mul_f32 v245, v245, v241
    v_mul_f32 v246, v246, v241
    v_mul_f32 v247, v247, v241
    v_accvgpr_write_b32 a16, v244
    v_accvgpr_write_b32 a17, v245
    v_accvgpr_write_b32 a18, v246
    v_accvgpr_write_b32 a19, v247
    v_accvgpr_read_b32 v244, a20
    v_accvgpr_read_b32 v245, a21
    v_accvgpr_read_b32 v246, a22
    v_accvgpr_read_b32 v247, a23
    v_mul_f32 v244, v244, v241
    v_mul_f32 v245, v245, v241
    v_mul_f32 v246, v246, v241
    v_mul_f32 v247, v247, v241
    v_accvgpr_write_b32 a20, v244
    v_accvgpr_write_b32 a21, v245
    v_accvgpr_write_b32 a22, v246
    v_accvgpr_write_b32 a23, v247
    v_accvgpr_read_b32 v244, a24
    v_accvgpr_read_b32 v245, a25
    v_accvgpr_read_b32 v246, a26
    v_accvgpr_read_b32 v247, a27
    v_mul_f32 v244, v244, v241
    v_mul_f32 v245, v245, v241
    v_mul_f32 v246, v246, v241
    v_mul_f32 v247, v247, v241
    v_accvgpr_write_b32 a24, v244
    v_accvgpr_write_b32 a25, v245
    v_accvgpr_write_b32 a26, v246
    v_accvgpr_write_b32 a27, v247
    v_accvgpr_read_b32 v244, a28
    v_accvgpr_read_b32 v245, a29
    v_accvgpr_read_b32 v246, a30
    v_accvgpr_read_b32 v247, a31
    v_mul_f32 v244, v244, v241
    v_mul_f32 v245, v245, v241
    v_mul_f32 v246, v246, v241
    v_mul_f32 v247, v247, v241
    v_accvgpr_write_b32 a28, v244
    v_accvgpr_write_b32 a29, v245
    v_accvgpr_write_b32 a30, v246
    v_accvgpr_write_b32 a31, v247
    v_accvgpr_read_b32 v244, a32
    v_accvgpr_read_b32 v245, a33
    v_accvgpr_read_b32 v246, a34
    v_accvgpr_read_b32 v247, a35
    v_mul_f32 v244, v244, v241
    v_mul_f32 v245, v245, v241
    v_mul_f32 v246, v246, v241
    v_mul_f32 v247, v247, v241
    v_accvgpr_write_b32 a32, v244
    v_accvgpr_write_b32 a33, v245
    v_accvgpr_write_b32 a34, v246
    v_accvgpr_write_b32 a35, v247
    v_accvgpr_read_b32 v244, a36
    v_accvgpr_read_b32 v245, a37
    v_accvgpr_read_b32 v246, a38
    v_accvgpr_read_b32 v247, a39
    v_mul_f32 v244, v244, v241
    v_mul_f32 v245, v245, v241
    v_mul_f32 v246, v246, v241
    v_mul_f32 v247, v247, v241
    v_accvgpr_write_b32 a36, v244
    v_accvgpr_write_b32 a37, v245
    v_accvgpr_write_b32 a38, v246
    v_accvgpr_write_b32 a39, v247
    v_accvgpr_read_b32 v244, a40
    v_accvgpr_read_b32 v245, a41
    v_accvgpr_read_b32 v246, a42
    v_accvgpr_read_b32 v247, a43
    v_mul_f32 v244, v244, v241
    v_mul_f32 v245, v245, v241
    v_mul_f32 v246, v246, v241
    v_mul_f32 v247, v247, v241
    v_accvgpr_write_b32 a40, v244
    v_accvgpr_write_b32 a41, v245
    v_accvgpr_write_b32 a42, v246
    v_accvgpr_write_b32 a43, v247
    v_accvgpr_read_b32 v244, a44
    v_accvgpr_read_b32 v245, a45
    v_accvgpr_read_b32 v246, a46
    v_accvgpr_read_b32 v247, a47
    v_mul_f32 v244, v244, v241
    v_mul_f32 v245, v245, v241
    v_mul_f32 v246, v246, v241
    v_mul_f32 v247, v247, v241
    v_accvgpr_write_b32 a44, v244
    v_accvgpr_write_b32 a45, v245
    v_accvgpr_write_b32 a46, v246
    v_accvgpr_write_b32 a47, v247
    v_accvgpr_read_b32 v244, a48
    v_accvgpr_read_b32 v245, a49
    v_accvgpr_read_b32 v246, a50
    v_accvgpr_read_b32 v247, a51
    v_mul_f32 v244, v244, v241
    v_mul_f32 v245, v245, v241
    v_mul_f32 v246, v246, v241
    v_mul_f32 v247, v247, v241
    v_accvgpr_write_b32 a48, v244
    v_accvgpr_write_b32 a49, v245
    v_accvgpr_write_b32 a50, v246
    v_accvgpr_write_b32 a51, v247
    v_accvgpr_read_b32 v244, a52
    v_accvgpr_read_b32 v245, a53
    v_accvgpr_read_b32 v246, a54
    v_accvgpr_read_b32 v247, a55
    v_mul_f32 v244, v244, v241
    v_mul_f32 v245, v245, v241
    v_mul_f32 v246, v246, v241
    v_mul_f32 v247, v247, v241
    v_accvgpr_write_b32 a52, v244
    v_accvgpr_write_b32 a53, v245
    v_accvgpr_write_b32 a54, v246
    v_accvgpr_write_b32 a55, v247
    v_accvgpr_read_b32 v244, a56
    v_accvgpr_read_b32 v245, a57
    v_accvgpr_read_b32 v246, a58
    v_accvgpr_read_b32 v247, a59
    v_mul_f32 v244, v244, v241
    v_mul_f32 v245, v245, v241
    v_mul_f32 v246, v246, v241
    v_mul_f32 v247, v247, v241
    v_accvgpr_write_b32 a56, v244
    v_accvgpr_write_b32 a57, v245
    v_accvgpr_write_b32 a58, v246
    v_accvgpr_write_b32 a59, v247
    v_accvgpr_read_b32 v244, a60
    v_accvgpr_read_b32 v245, a61
    v_accvgpr_read_b32 v246, a62
    v_accvgpr_read_b32 v247, a63
    v_mul_f32 v244, v244, v241
    v_mul_f32 v245, v245, v241
    v_mul_f32 v246, v246, v241
    v_mul_f32 v247, v247, v241
    v_accvgpr_write_b32 a60, v244
    v_accvgpr_write_b32 a61, v245
    v_accvgpr_write_b32 a62, v246
    v_accvgpr_write_b32 a63, v247
L_attn_slow_a_n:
    v_exp_f32 v64, v32
    v_exp_f32 v65, v33
    v_exp_f32 v66, v34
    v_add_f32 v22, v64, v65
    v_exp_f32 v67, v35
    v_cvt_pk_bf16_f32 v80, v64, v65
    v_exp_f32 v68, v36
    v_add_f32 v23, v66, v67
    v_exp_f32 v69, v37
    v_cvt_pk_bf16_f32 v81, v66, v67
    v_exp_f32 v70, v38
    v_add_f32 v22, v22, v68
    v_add_f32 v23, v23, v69
    v_exp_f32 v71, v39
    v_cvt_pk_bf16_f32 v82, v68, v69
    v_exp_f32 v72, v40
    v_add_f32 v22, v22, v70
    v_add_f32 v23, v23, v71
    v_exp_f32 v73, v41
    v_cvt_pk_bf16_f32 v83, v70, v71
    v_exp_f32 v74, v42
    v_add_f32 v22, v22, v72
    v_add_f32 v23, v23, v73
    v_exp_f32 v75, v43
    v_cvt_pk_bf16_f32 v84, v72, v73
    v_exp_f32 v76, v44
    v_add_f32 v22, v22, v74
    v_add_f32 v23, v23, v75
    v_exp_f32 v77, v45
    v_cvt_pk_bf16_f32 v85, v74, v75
    v_exp_f32 v78, v46
    v_add_f32 v22, v22, v76
    v_add_f32 v23, v23, v77
    v_exp_f32 v79, v47
    v_cvt_pk_bf16_f32 v86, v76, v77
    s_nop 0
    v_add_f32 v22, v22, v78
    v_add_f32 v23, v23, v79
    v_cvt_pk_bf16_f32 v87, v78, v79
    v_add_f32 v22, v22, v23
    s_nop 1
    s_setpc_b64 s[48:49]
L_attn_slow_b:
    v_max3_f32 v240, v48, v49, v50
    v_max3_f32 v240, v240, v51, v52
    v_max3_f32 v240, v240, v53, v54
    v_max3_f32 v240, v240, v55, v56
    v_max3_f32 v240, v240, v57, v58
    v_max3_f32 v240, v240, v59, v60
    v_max3_f32 v240, v240, v61, v62
    v_max_f32 v240, v240, v63
    v_mov_b32 v241, v240
    v_cmp_gt_f32_e64 s[40:41], 0, v20
    s_nop 0
    v_permlane32_swap_b32 v240, v241
    v_mov_b32 v243, 0
    v_mov_b32 v242, 0x43800000
    v_max_f32 v240, v240, v241
    v_cndmask_b32_e64 v241, v243, v25, s[40:41]
    v_max_f32 v240, v240, v241
    v_cmp_eq_f32 vcc, v240, v25
    s_nop 1
    v_cndmask_b32 v240, v240, v243, vcc
    v_cndmask_b32 v20, v242, v20, vcc
    v_sub_f32 v242, v112, v240
    v_mov_b32 v112, v242
    v_sub_f32 v48, v48, v240
    v_mov_b32 v113, v242
    v_sub_f32 v49, v49, v240
    v_mov_b32 v114, v242
    v_sub_f32 v50, v50, v240
    v_mov_b32 v115, v242
    v_sub_f32 v51, v51, v240
    v_mov_b32 v116, v242
    v_sub_f32 v52, v52, v240
    v_mov_b32 v117, v242
    v_sub_f32 v53, v53, v240
    v_mov_b32 v118, v242
    v_sub_f32 v54, v54, v240
    v_mov_b32 v119, v242
    v_sub_f32 v55, v55, v240
    v_mov_b32 v120, v242
    v_sub_f32 v56, v56, v240
    v_mov_b32 v121, v242
    v_sub_f32 v57, v57, v240
    v_mov_b32 v122, v242
    v_sub_f32 v58, v58, v240
    v_mov_b32 v123, v242
    v_sub_f32 v59, v59, v240
    v_mov_b32 v124, v242
    v_sub_f32 v60, v60, v240
    v_mov_b32 v125, v242
    v_sub_f32 v61, v61, v240
    v_mov_b32 v126, v242
    v_sub_f32 v62, v62, v240
    v_mov_b32 v127, v242
    v_sub_f32 v63, v63, v240
    s_cmp_eq_u64 s[40:41], exec
    s_cbranch_scc1 L_attn_slow_b_n
    v_max_f32 v241, 0, v240
    v_exp_f32 v241, -v241
    s_nop 7
    v_mul_f32 v17, v17, v241
    v_accvgpr_read_b32 v244, a64
    v_accvgpr_read_b32 v245, a65
    v_accvgpr_read_b32 v246, a66
    v_accvgpr_read_b32 v247, a67
    v_mul_f32 v244, v244, v241
    v_mul_f32 v245, v245, v241
    v_mul_f32 v246, v246, v241
    v_mul_f32 v247, v247, v241
    v_accvgpr_write_b32 a64, v244
    v_accvgpr_write_b32 a65, v245
    v_accvgpr_write_b32 a66, v246
    v_accvgpr_write_b32 a67, v247
    v_accvgpr_read_b32 v244, a68
    v_accvgpr_read_b32 v245, a69
    v_accvgpr_read_b32 v246, a70
    v_accvgpr_read_b32 v247, a71
    v_mul_f32 v244, v244, v241
    v_mul_f32 v245, v245, v241
    v_mul_f32 v246, v246, v241
    v_mul_f32 v247, v247, v241
    v_accvgpr_write_b32 a68, v244
    v_accvgpr_write_b32 a69, v245
    v_accvgpr_write_b32 a70, v246
    v_accvgpr_write_b32 a71, v247
    v_accvgpr_read_b32 v244, a72
    v_accvgpr_read_b32 v245, a73
    v_accvgpr_read_b32 v246, a74
    v_accvgpr_read_b32 v247, a75
    v_mul_f32 v244, v244, v241
    v_mul_f32 v245, v245, v241
    v_mul_f32 v246, v246, v241
    v_mul_f32 v247, v247, v241
    v_accvgpr_write_b32 a72, v244
    v_accvgpr_write_b32 a73, v245
    v_accvgpr_write_b32 a74, v246
    v_accvgpr_write_b32 a75, v247
    v_accvgpr_read_b32 v244, a76
    v_accvgpr_read_b32 v245, a77
    v_accvgpr_read_b32 v246, a78
    v_accvgpr_read_b32 v247, a79
    v_mul_f32 v244, v244, v241
    v_mul_f32 v245, v245, v241
    v_mul_f32 v246, v246, v241
    v_mul_f32 v247, v247, v241
    v_accvgpr_write_b32 a76, v244
    v_accvgpr_write_b32 a77, v245
    v_accvgpr_write_b32 a78, v246
    v_accvgpr_write_b32 a79, v247
    v_accvgpr_read_b32 v244, a80
    v_accvgpr_read_b32 v245, a81
    v_accvgpr_read_b32 v246, a82
    v_accvgpr_read_b32 v247, a83
    v_mul_f32 v244, v244, v241
    v_mul_f32 v245, v245, v241
    v_mul_f32 v246, v246, v241
    v_mul_f32 v247, v247, v241
    v_accvgpr_write_b32 a80, v244
    v_accvgpr_write_b32 a81, v245
    v_accvgpr_write_b32 a82, v246
    v_accvgpr_write_b32 a83, v247
    v_accvgpr_read_b32 v244, a84
    v_accvgpr_read_b32 v245, a85
    v_accvgpr_read_b32 v246, a86
    v_accvgpr_read_b32 v247, a87
    v_mul_f32 v244, v244, v241
    v_mul_f32 v245, v245, v241
    v_mul_f32 v246, v246, v241
    v_mul_f32 v247, v247, v241
    v_accvgpr_write_b32 a84, v244
    v_accvgpr_write_b32 a85, v245
    v_accvgpr_write_b32 a86, v246
    v_accvgpr_write_b32 a87, v247
    v_accvgpr_read_b32 v244, a88
    v_accvgpr_read_b32 v245, a89
    v_accvgpr_read_b32 v246, a90
    v_accvgpr_read_b32 v247, a91
    v_mul_f32 v244, v244, v241
    v_mul_f32 v245, v245, v241
    v_mul_f32 v246, v246, v241
    v_mul_f32 v247, v247, v241
    v_accvgpr_write_b32 a88, v244
    v_accvgpr_write_b32 a89, v245
    v_accvgpr_write_b32 a90, v246
    v_accvgpr_write_b32 a91, v247
    v_accvgpr_read_b32 v244, a92
    v_accvgpr_read_b32 v245, a93
    v_accvgpr_read_b32 v246, a94
    v_accvgpr_read_b32 v247, a95
    v_mul_f32 v244, v244, v241
    v_mul_f32 v245, v245, v241
    v_mul_f32 v246, v246, v241
    v_mul_f32 v247, v247, v241
    v_accvgpr_write_b32 a92, v244
    v_accvgpr_write_b32 a93, v245
    v_accvgpr_write_b32 a94, v246
    v_accvgpr_write_b32 a95, v247
    v_accvgpr_read_b32 v244, a96
    v_accvgpr_read_b32 v245, a97
    v_accvgpr_read_b32 v246, a98
    v_accvgpr_read_b32 v247, a99
    v_mul_f32 v244, v244, v241
    v_mul_f32 v245, v245, v241
    v_mul_f32 v246, v246, v241
    v_mul_f32 v247, v247, v241
    v_accvgpr_write_b32 a96, v244
    v_accvgpr_write_b32 a97, v245
    v_accvgpr_write_b32 a98, v246
    v_accvgpr_write_b32 a99, v247
    v_accvgpr_read_b32 v244, a100
    v_accvgpr_read_b32 v245, a101
    v_accvgpr_read_b32 v246, a102
    v_accvgpr_read_b32 v247, a103
    v_mul_f32 v244, v244, v241
    v_mul_f32 v245, v245, v241
    v_mul_f32 v246, v246, v241
    v_mul_f32 v247, v247, v241
    v_accvgpr_write_b32 a100, v244
    v_accvgpr_write_b32 a101, v245
    v_accvgpr_write_b32 a102, v246
    v_accvgpr_write_b32 a103, v247
    v_accvgpr_read_b32 v244, a104
    v_accvgpr_read_b32 v245, a105
    v_accvgpr_read_b32 v246, a106
    v_accvgpr_read_b32 v247, a107
    v_mul_f32 v244, v244, v241
    v_mul_f32 v245, v245, v241
    v_mul_f32 v246, v246, v241
    v_mul_f32 v247, v247, v241
    v_accvgpr_write_b32 a104, v244
    v_accvgpr_write_b32 a105, v245
    v_accvgpr_write_b32 a106, v246
    v_accvgpr_write_b32 a107, v247
    v_accvgpr_read_b32 v244, a108
    v_accvgpr_read_b32 v245, a109
    v_accvgpr_read_b32 v246, a110
    v_accvgpr_read_b32 v247, a111
    v_mul_f32 v244, v244, v241
    v_mul_f32 v245, v245, v241
    v_mul_f32 v246, v246, v241
    v_mul_f32 v247, v247, v241
    v_accvgpr_write_b32 a108, v244
    v_accvgpr_write_b32 a109, v245
    v_accvgpr_write_b32 a110, v246
    v_accvgpr_write_b32 a111, v247
    v_accvgpr_read_b32 v244, a112
    v_accvgpr_read_b32 v245, a113
    v_accvgpr_read_b32 v246, a114
    v_accvgpr_read_b32 v247, a115
    v_mul_f32 v244, v244, v241
    v_mul_f32 v245, v245, v241
    v_mul_f32 v246, v246, v241
    v_mul_f32 v247, v247, v241
    v_accvgpr_write_b32 a112, v244
    v_accvgpr_write_b32 a113, v245
    v_accvgpr_write_b32 a114, v246
    v_accvgpr_write_b32 a115, v247
    v_accvgpr_read_b32 v244, a116
    v_accvgpr_read_b32 v245, a117
    v_accvgpr_read_b32 v246, a118
    v_accvgpr_read_b32 v247, a119
    v_mul_f32 v244, v244, v241
    v_mul_f32 v245, v245, v241
    v_mul_f32 v246, v246, v241
    v_mul_f32 v247, v247, v241
    v_accvgpr_write_b32 a116, v244
    v_accvgpr_write_b32 a117, v245
    v_accvgpr_write_b32 a118, v246
    v_accvgpr_write_b32 a119, v247
    v_accvgpr_read_b32 v244, a120
    v_accvgpr_read_b32 v245, a121
    v_accvgpr_read_b32 v246, a122
    v_accvgpr_read_b32 v247, a123
    v_mul_f32 v244, v244, v241
    v_mul_f32 v245, v245, v241
    v_mul_f32 v246, v246, v241
    v_mul_f32 v247, v247, v241
    v_accvgpr_write_b32 a120, v244
    v_accvgpr_write_b32 a121, v245
    v_accvgpr_write_b32 a122, v246
    v_accvgpr_write_b32 a123, v247
    v_accvgpr_read_b32 v244, a124
    v_accvgpr_read_b32 v245, a125
    v_accvgpr_read_b32 v246, a126
    v_accvgpr_read_b32 v247, a127
    v_mul_f32 v244, v244, v241
    v_mul_f32 v245, v245, v241
    v_mul_f32 v246, v246, v241
    v_mul_f32 v247, v247, v241
    v_accvgpr_write_b32 a124, v244
    v_accvgpr_write_b32 a125, v245
    v_accvgpr_write_b32 a126, v246
    v_accvgpr_write_b32 a127, v247
L_attn_slow_b_n:
    v_exp_f32 v64, v48
    v_exp_f32 v65, v49
    v_exp_f32 v66, v50
    v_add_f32 v22, v64, v65
    v_exp_f32 v67, v51
    v_cvt_pk_bf16_f32 v88, v64, v65
    v_exp_f32 v68, v52
    v_add_f32 v23, v66, v67
    v_exp_f32 v69, v53
    v_cvt_pk_bf16_f32 v89, v66, v67
    v_exp_f32 v70, v54
    v_add_f32 v22, v22, v68
    v_add_f32 v23, v23, v69
    v_exp_f32 v71, v55
    v_cvt_pk_bf16_f32 v90, v68, v69
    v_exp_f32 v72, v56
    v_add_f32 v22, v22, v70
    v_add_f32 v23, v23, v71
    v_exp_f32 v73, v57
    v_cvt_pk_bf16_f32 v91, v70, v71
    v_exp_f32 v74, v58
    v_add_f32 v22, v22, v72
    v_add_f32 v23, v23, v73
    v_exp_f32 v75, v59
    v_cvt_pk_bf16_f32 v92, v72, v73
    v_exp_f32 v76, v60
    v_add_f32 v22, v22, v74
    v_add_f32 v23, v23, v75
    v_exp_f32 v77, v61
    v_cvt_pk_bf16_f32 v93, v74, v75
    v_exp_f32 v78, v62
    v_add_f32 v22, v22, v76
    v_add_f32 v23, v23, v77
    v_exp_f32 v79, v63
    v_cvt_pk_bf16_f32 v94, v76, v77
    s_nop 0
    v_add_f32 v22, v22, v78
    v_add_f32 v23, v23, v79
    v_cvt_pk_bf16_f32 v95, v78, v79
    v_add_f32 v22, v22, v23
    s_nop 1
    s_setpc_b64 s[48:49]
L_attn_slow_c:
    v_max3_f32 v240, v32, v33, v34
    v_max3_f32 v240, v240, v35, v36
    v_max3_f32 v240, v240, v37, v38
    v_max3_f32 v240, v240, v39, v40
    v_max3_f32 v240, v240, v41, v42
    v_max3_f32 v240, v240, v43, v44
    v_max3_f32 v240, v240, v45, v46
    v_max_f32 v240, v240, v47
    v_mov_b32 v241, v240
    v_cmp_gt_f32_e64 s[40:41], 0, v21
    s_nop 0
    v_permlane32_swap_b32 v240, v241
    v_mov_b32 v243, 0
    v_mov_b32 v242, 0x43800000
    v_max_f32 v240, v240, v241
    v_cndmask_b32_e64 v241, v243, v25, s[40:41]
    v_max_f32 v240, v240, v241
    v_cmp_eq_f32 vcc, v240, v25
    s_nop 1
    v_cndmask_b32 v240, v240, v243, vcc
    v_cndmask_b32 v21, v242, v21, vcc
    v_sub_f32 v242, v224, v240
    v_mov_b32 v224, v242
    v_sub_f32 v32, v32, v240
    v_mov_b32 v225, v242
    v_sub_f32 v33, v33, v240
    v_mov_b32 v226, v242
    v_sub_f32 v34, v34, v240
    v_mov_b32 v227, v242
    v_sub_f32 v35, v35, v240
    v_mov_b32 v228, v242
    v_sub_f32 v36, v36, v240
    v_mov_b32 v229, v242
    v_sub_f32 v37, v37, v240
    v_mov_b32 v230, v242
    v_sub_f32 v38, v38, v240
    v_mov_b32 v231, v242
    v_sub_f32 v39, v39, v240
    v_mov_b32 v232, v242
    v_sub_f32 v40, v40, v240
    v_mov_b32 v233, v242
    v_sub_f32 v41, v41, v240
    v_mov_b32 v234, v242
    v_sub_f32 v42, v42, v240
    v_mov_b32 v235, v242
    v_sub_f32 v43, v43, v240
    v_mov_b32 v236, v242
    v_sub_f32 v44, v44, v240
    v_mov_b32 v237, v242
    v_sub_f32 v45, v45, v240
    v_mov_b32 v238, v242
    v_sub_f32 v46, v46, v240
    v_mov_b32 v239, v242
    v_sub_f32 v47, v47, v240
    s_cmp_eq_u64 s[40:41], exec
    s_cbranch_scc1 L_attn_slow_c_n
    v_max_f32 v241, 0, v240
    v_exp_f32 v241, -v241
    s_nop 7
    v_mul_f32 v18, v18, v241
    v_mul_f32 v160, v160, v241
    v_mul_f32 v161, v161, v241
    v_mul_f32 v162, v162, v241
    v_mul_f32 v163, v163, v241
    v_mul_f32 v164, v164, v241
    v_mul_f32 v165, v165, v241
    v_mul_f32 v166, v166, v241
    v_mul_f32 v167, v167, v241
    v_mul_f32 v168, v168, v241
    v_mul_f32 v169, v169, v241
    v_mul_f32 v170, v170, v241
    v_mul_f32 v171, v171, v241
    v_mul_f32 v172, v172, v241
    v_mul_f32 v173, v173, v241
    v_mul_f32 v174, v174, v241
    v_mul_f32 v175, v175, v241
    v_mul_f32 v176, v176, v241
    v_mul_f32 v177, v177, v241
    v_mul_f32 v178, v178, v241
    v_mul_f32 v179, v179, v241
    v_mul_f32 v180, v180, v241
    v_mul_f32 v181, v181, v241
    v_mul_f32 v182, v182, v241
    v_mul_f32 v183, v183, v241
    v_mul_f32 v184, v184, v241
    v_mul_f32 v185, v185, v241
    v_mul_f32 v186, v186, v241
    v_mul_f32 v187, v187, v241
    v_mul_f32 v188, v188, v241
    v_mul_f32 v189, v189, v241
    v_mul_f32 v190, v190, v241
    v_mul_f32 v191, v191, v241
    v_mul_f32 v192, v192, v241
    v_mul_f32 v193, v193, v241
    v_mul_f32 v194, v194, v241
    v_mul_f32 v195, v195, v241
    v_mul_f32 v196, v196, v241
    v_mul_f32 v197, v197, v241
    v_mul_f32 v198, v198, v241
    v_mul_f32 v199, v199, v241
    v_mul_f32 v200, v200, v241
    v_mul_f32 v201, v201, v241
    v_mul_f32 v202, v202, v241
    v_mul_f32 v203, v203, v241
    v_mul_f32 v204, v204, v241
    v_mul_f32 v205, v205, v241
    v_mul_f32 v206, v206, v241
    v_mul_f32 v207, v207, v241
    v_mul_f32 v208, v208, v241
    v_mul_f32 v209, v209, v241
    v_mul_f32 v210, v210, v241
    v_mul_f32 v211, v211, v241
    v_mul_f32 v212, v212, v241
    v_mul_f32 v213, v213, v241
    v_mul_f32 v214, v214, v241
    v_mul_f32 v215, v215, v241
    v_mul_f32 v216, v216, v241
    v_mul_f32 v217, v217, v241
    v_mul_f32 v218, v218, v241
    v_mul_f32 v219, v219, v241
    v_mul_f32 v220, v220, v241
    v_mul_f32 v221, v221, v241
    v_mul_f32 v222, v222, v241
    v_mul_f32 v223, v223, v241
L_attn_slow_c_n:
    v_exp_f32 v64, v32
    v_exp_f32 v65, v33
    v_exp_f32 v66, v34
    v_add_f32 v22, v64, v65
    v_exp_f32 v67, v35
    v_cvt_pk_bf16_f32 v80, v64, v65
    v_exp_f32 v68, v36
    v_add_f32 v23, v66, v67
    v_exp_f32 v69, v37
    v_cvt_pk_bf16_f32 v81, v66, v67
    v_exp_f32 v70, v38
    v_add_f32 v22, v22, v68
    v_add_f32 v23, v23, v69
    v_exp_f32 v71, v39
    v_cvt_pk_bf16_f32 v82, v68, v69
    v_exp_f32 v72, v40
    v_add_f32 v22, v22, v70
    v_add_f32 v23, v23, v71
    v_exp_f32 v73, v41
    v_cvt_pk_bf16_f32 v83, v70, v71
    v_exp_f32 v74, v42
    v_add_f32 v22, v22, v72
    v_add_f32 v23, v23, v73
    v_exp_f32 v75, v43
    v_cvt_pk_bf16_f32 v84, v72, v73
    v_exp_f32 v76, v44
    v_add_f32 v22, v22, v74
    v_add_f32 v23, v23, v75
    v_exp_f32 v77, v45
    v_cvt_pk_bf16_f32 v85, v74, v75
    v_exp_f32 v78, v46
    v_add_f32 v22, v22, v76
    v_add_f32 v23, v23, v77
    v_exp_f32 v79, v47
    v_cvt_pk_bf16_f32 v86, v76, v77
    s_nop 0
    v_add_f32 v22, v22, v78
    v_add_f32 v23, v23, v79
    v_cvt_pk_bf16_f32 v87, v78, v79
    v_add_f32 v22, v22, v23
    s_nop 1
    s_setpc_b64 s[48:49]
L_attn_codeend:
.section .rodata,"a"
.p2align 6
.amdhsa_kernel parallel_sum__compressed_kv_cla__glu_gated_reglu__prompt_kernel
  .amdhsa_next_free_vgpr 512
  .amdhsa_next_free_sgpr 102
  .amdhsa_accum_offset 256
  .amdhsa_group_segment_fixed_size 0
  .amdhsa_kernarg_size 104
  .amdhsa_user_sgpr_count 2
  .amdhsa_user_sgpr_kernarg_segment_ptr 1
  .amdhsa_system_sgpr_workgroup_id_x 1
.end_amdhsa_kernel
```
